```python
import torch

def _softmax(x, axis=-1):
    return torch.softmax(x, dim=axis)

def _gelu(x):
    return torch.nn.functional.gelu(x, approximate='tanh')

def _silu(x):
    return torch.nn.functional.silu(x)

def _sigmoid(x):
    return torch.sigmoid(x)

def _layernorm(x, axis=-1, eps=1e-05):
    m = x.mean(dim=axis, keepdim=True)
    v = x.var(dim=axis, keepdim=True, unbiased=False)
    return (x - m) / torch.sqrt(v + eps)

def _scatter_add(tgt, idx, src, axis=0):
    return tgt.clone().index_add_(axis, idx, src)

def _segment_sum(src, seg, n):
    out = torch.zeros((n,) + src.shape[1:], dtype=src.dtype)
    return out.index_add_(0, seg, src)

def _pad(x, pw):
    flat = tuple((v for pair in reversed(pw) for v in pair))
    return torch.nn.functional.pad(x, flat)
kernel_name = 'adaLN_cond__compressed_kv_cla__mixer_s_mlp__prompt'

def setup_inputs():

    _w = lambda a: (lambda t: t.to(torch.bfloat16) if t.is_floating_point() else t)(torch.as_tensor(a))

    def _A_setup():
        B, H, Sq, Sk, D, M = (1, 32, 2048, 2048, 128, 640)
        Dc = 4 * D
        return {'x': _w((lambda *s: torch.randn(*s, dtype=torch.bfloat16) * 0.05)(B, Sq, M)), 'c_kv': _w((lambda *s: torch.randn(*s, dtype=torch.bfloat16) * 1.6)(B, Sk, Dc)), 'w_q': _w((lambda *s: torch.randn(*s, dtype=torch.bfloat16) * 0.8)(M, H, D) * M ** (-0.5)), 'w_uk': _w((lambda *s: torch.randn(*s, dtype=torch.bfloat16) * 0.8)(Dc, H, D) * Dc ** (-0.5)), 'w_uv': _w((lambda *s: torch.randn(*s, dtype=torch.bfloat16) * 1.6)(Dc, H, D) * Dc ** (-0.5)), 'w_o': _w((lambda *s: torch.randn(*s, dtype=torch.bfloat16) * 1.6)(H, D, M) * (H * D) ** (-0.5))}
    _A_in = _A_setup()

    def _B_setup():
        B, S, D, F = (1, 2048, 640, 1728)
        return {'x': _w((lambda *s: torch.randn(*s, dtype=torch.bfloat16) * 0.05)(B, S, D)), 'w1': _w((lambda *s: torch.randn(*s, dtype=torch.bfloat16) * 3.2)(D, D) * D ** (-0.5)), 'w2': _w((lambda *s: torch.randn(*s, dtype=torch.bfloat16) * 3.2)(D, D) * D ** (-0.5)), 'w3': _w((lambda *s: torch.randn(*s, dtype=torch.bfloat16) * 3.2)(D, F) * D ** (-0.5)), 'w4': _w((lambda *s: torch.randn(*s, dtype=torch.bfloat16) * 3.2)(F, D) * F ** (-0.5))}
    _B_in = _B_setup()
    return {'A_x': _A_in['x'], 'A_c_kv': _A_in['c_kv'], 'A_w_q': _A_in['w_q'], 'A_w_uk': _A_in['w_uk'], 'A_w_uv': _A_in['w_uv'], 'A_w_o': _A_in['w_o'], 'B_x': _B_in['x'], 'B_w1': _B_in['w1'], 'B_w2': _B_in['w2'], 'B_w3': _B_in['w3'], 'B_w4': _B_in['w4'], 'c': _w((lambda *s: torch.randn(*s, dtype=torch.bfloat16) * 0.1)(1, 640) * 8.0), 'w_mod': _w((lambda *s: torch.randn(*s, dtype=torch.bfloat16) * 0.1)(640, 6 * 640) * 640 ** (-0.5) * 8.0)}

def reference(A_x, A_c_kv, A_w_q, A_w_uk, A_w_uv, A_w_o, B_x, B_w1, B_w2, B_w3, B_w4, c, w_mod):

    def _A_ref(x, c_kv, w_q, w_uk, w_uv, w_o):
        B, Sq, M = (x.shape[0], x.shape[1], x.shape[2])
        Sk = c_kv.shape[1]
        H, D = (w_q.shape[1], w_q.shape[2])
        q = torch.einsum('bqm,mhd->bhqd', x, w_q)
        k = torch.einsum('bkc,chd->bhkd', c_kv, w_uk)
        v = torch.einsum('bkc,chd->bhkd', c_kv, w_uv)
        scores = torch.einsum('bhqd,bhkd->bhqk', q, k) * D ** (-0.5)
        off = Sk - Sq
        qi = torch.arange(Sq)[:, None]
        kj = torch.arange(Sk)[None, :]
        cmask = kj <= qi + off
        scores = torch.where(cmask[None, None], scores, -1000000000.0)
        p = _softmax(scores, axis=-1)
        ctx = torch.einsum('bhqk,bhkd->bhqd', p, v)
        return torch.einsum('bhqd,hdm->bqm', ctx, w_o)

    def _B_ref(x, w1, w2, w3, w4):
        B, S, D = x.shape
        h = _gelu(_layernorm(x, axis=-1) @ w1)
        c = D // 4
        g0 = _pad(h[:, :, 0 * c:1 * c], ((0, 0), (1, 0), (0, 0)))[:, :S, :]
        g1 = _pad(h[:, :, 1 * c:2 * c], ((0, 0), (0, 1), (0, 0)))[:, 1:, :]
        g2 = _pad(h[:, :, 2 * c:3 * c], ((0, 0), (2, 0), (0, 0)))[:, :S, :]
        g3 = _pad(h[:, :, 3 * c:], ((0, 0), (0, 2), (0, 0)))[:, 2:, :]
        hs = torch.concatenate([g0, g1, g2, g3], axis=-1) @ w2
        x1 = x + hs
        h2 = _gelu(_layernorm(x1, axis=-1) @ w3) @ w4
        return x1 + h2
    x = A_x
    mod = (_silu(c) @ w_mod).reshape(c.shape[0], 6, 1, -1)
    sa, ca, ga, sb, cb, gb = (mod[:, 0].clone(), mod[:, 1].clone(), mod[:, 2].clone(), mod[:, 3].clone(), mod[:, 4].clone(), mod[:, 5].clone())
    h = _layernorm(x, axis=-1) * (1 + ca) + sa
    x = x + ga * _A_ref(h, A_c_kv, A_w_q, A_w_uk, A_w_uv, A_w_o)
    h = _layernorm(x, axis=-1) * (1 + cb) + sb
    x = x + gb * _B_ref(h, B_w1, B_w2, B_w3, B_w4)
    return x
```

```asm
; @launch grid=(256,1,1) block=(512,1,1) lds=163840
.amdgcn_target "amdgcn-amd-amdhsa--gfx950"
.text
.globl adaLN_cond__compressed_kv_cla__mixer_s_mlp__prompt_kernel
.p2align 8
.type adaLN_cond__compressed_kv_cla__mixer_s_mlp__prompt_kernel,@function
adaLN_cond__compressed_kv_cla__mixer_s_mlp__prompt_kernel:
    s_cmp_ge_u32 s2, 256
    s_cbranch_scc1 KF_end
    s_load_dwordx2 s[4:5], s[0:1], 120
    s_load_dwordx4 s[8:11], s[0:1], 24
    s_load_dwordx2 s[6:7], s[0:1], 16
    s_load_dwordx2 s[12:13], s[0:1], 0
    s_load_dwordx2 s[68:69], s[0:1], 112
    s_load_dwordx2 s[72:73], s[0:1], 8
    s_load_dwordx4 s[56:59], s[0:1], 88
    s_memrealtime s[100:101]
    v_lshrrev_b32 v5, 6, v0
    v_bfe_u32 v3, v0, 4, 1
    v_lshlrev_b32 v3, 19, v3
    v_bfe_u32 v6, v0, 5, 1
    v_lshl_add_u32 v3, v6, 15, v3
    v_and_b32 v6, 15, v0
    v_lshl_add_u32 v3, v6, 4, v3
    v_readfirstlane_b32 s3, v5
    v_and_b32 v4, 63, v0
    v_lshlrev_b32 v4, 4, v4
    s_and_b32 s41, s2, 7
    s_lshr_b32 s42, s2, 3
    s_lshl_b32 s85, s41, 2
    s_lshr_b32 s86, s42, 3
    s_add_u32 s85, s85, s86
    s_and_b32 s86, s42, 7
    s_lshl_b32 s86, s86, 3
    s_add_u32 s86, s86, s3
    s_lshl_b32 s88, s85, 8
    s_and_b32 s41, s3, 1
    s_lshl_b32 s41, s41, 18
    s_add_u32 s88, s88, s41
    s_lshr_b32 s41, s3, 1
    s_lshl_b32 s41, s41, 16
    s_add_u32 s88, s88, s41
    s_mul_i32 s39, s3, 4224
    s_bitcmp0_b32 s2, 5
    s_cselect_b32 s92, 69632, 0
    s_add_u32 s14, s39, s92
    s_sub_u32 s15, s39, s92
    s_lshl_b32 s89, s86, 15
    s_add_u32 s39, s89, 16384
    s_and_b32 s95, s2, 7
    s_lshl_b32 s95, s95, 5
    s_add_u32 s95, s95, s42
    s_lshl_b32 s87, s95, 3
    s_add_u32 s87, s87, s3
    s_getpc_b64 s[64:65]
    s_mov_b32 s66, CODE_END_F-.
    s_mov_b32 s67, 0x00020000
    s_lshl_b32 s44, s42, 3
    s_add_u32 s44, s44, s3
    s_mul_i32 s44, s44, 384
    v_lshlrev_b32 v13, 3, v4
    s_mov_b64 exec, 7
    buffer_load_dword v9, v13, s[64:67], s44 offen
    s_mov_b64 exec, -1
    s_waitcnt lgkmcnt(0)
    s_mov_b32 s48, s8
    s_mov_b32 s49, s9
    s_mov_b32 s50, 0x400000
    s_mov_b32 s51, 0x00020000
    s_mov_b32 s16, s4
    s_mov_b32 s17, s5
    s_mov_b32 s18, 0x10000000
    s_mov_b32 s19, 0x00020000
    s_mov_b32 s74, 0x200000
    s_mov_b32 s75, 0x00020000
    v_bfe_u32 v14, v0, 2, 2
    v_lshlrev_b32 v14, 12, v14
    v_bfe_u32 v6, v0, 4, 2
    v_lshl_add_u32 v14, v6, 6, v14
    v_and_b32 v6, 3, v0
    v_lshl_add_u32 v14, v6, 4, v14
    s_or_b32 s33, s100, 1
    s_mov_b32 s52, s10
    s_mov_b32 s53, s11
    s_mov_b32 s54, 0x400000
    s_mov_b32 s55, 0x00020000
    v_lshlrev_b32 v11, 3, v4
    s_lshr_b32 s31, s2, 3
    s_lshl_b32 s31, s31, 3
    s_add_u32 s31, s31, s3
    s_lshr_b32 s30, s31, 1
    s_lshl_b32 s30, s30, 13
    s_and_b32 s31, s31, 1
    s_lshl_b32 s31, s31, 9
    s_add_u32 s30, s30, s31
    s_and_b32 s31, s2, 7
    s_lshl_b32 s31, s31, 10
    s_add_u32 s100, s30, s31
    s_lshl_b32 s101, s2, 3
    s_add_u32 s101, s101, s3
    s_add_u32 m0, s14, 0
    s_add_u32 s41, s88, 0
    buffer_load_dwordx4 v3, s[48:51], s41 offen nt lds
    s_add_u32 m0, s14, 1056
    s_add_u32 s41, s88, 8192
    buffer_load_dwordx4 v3, s[48:51], s41 offen nt lds
    s_add_u32 m0, s14, 2112
    s_add_u32 s41, s88, 16384
    buffer_load_dwordx4 v3, s[48:51], s41 offen nt lds
    s_add_u32 m0, s14, 3168
    s_add_u32 s41, s88, 24576
    buffer_load_dwordx4 v3, s[48:51], s41 offen nt lds
    buffer_load_dwordx4 v[176:179], v14, s[72:75], s89 offen offset:0
    buffer_load_dwordx4 v[180:183], v14, s[72:75], s89 offen offset:1024
    buffer_load_dwordx4 v[184:187], v14, s[72:75], s89 offen offset:2048
    buffer_load_dwordx4 v[188:191], v14, s[72:75], s89 offen offset:3072
    buffer_load_dwordx4 v[192:195], v14, s[72:75], s39 offen offset:0
    buffer_load_dwordx4 v[196:199], v14, s[72:75], s39 offen offset:1024
    buffer_load_dwordx4 v[200:203], v14, s[72:75], s39 offen offset:2048
    buffer_load_dwordx4 v[204:207], v14, s[72:75], s39 offen offset:3072
    s_mov_b32 s60, 0x55555555
    s_mov_b32 s61, 0x55555555
    s_mov_b32 s62, 0xaaaaaaaa
    s_mov_b32 s63, 0xaaaaaaaa
    s_mov_b32 s64, 0x33333333
    s_mov_b32 s65, 0x33333333
    s_mov_b32 s66, 0xcccccccc
    s_mov_b32 s67, 0xcccccccc
    v_mov_b32 v8, s33
    s_mov_b32 s28, s12
    s_mov_b32 s29, s13
    s_mov_b32 s30, 0x280000
    s_mov_b32 s31, 0x00020000
    s_mov_b32 s20, s6
    s_mov_b32 s21, s7
    s_mov_b32 s22, 0x500000
    s_mov_b32 s23, 0x00020000
    s_add_u32 s24, s4, 0xe00000
    s_addc_u32 s25, s5, 0
    s_mov_b32 s26, 0x2200000
    s_mov_b32 s27, 0x00020000
    s_mov_b32 s8, s92
    s_add_u32 s9, s92, 34816
    s_sub_u32 s10, 69632, s92
    s_sub_u32 s11, 104448, s92
    v_bfe_u32 v1, v0, 2, 3
    v_mul_u32_u24 v1, 1056, v1
    v_bfe_u32 v6, v0, 5, 1
    v_lshl_add_u32 v1, v6, 8, v1
    v_and_b32 v6, 3, v0
    v_lshl_add_u32 v1, v6, 3, v1
    s_and_b32 s32, s2, 7
    s_lshl_b32 s32, s32, 2
    s_lshr_b32 s41, s2, 3
    s_and_b32 s42, s41, 3
    s_add_u32 s32, s32, s42
    s_lshr_b32 s33, s41, 2
    s_lshl_b32 s41, s33, 2
    s_sub_u32 s42, 60, s41
    s_add_u32 s42, s42, s3
    s_add_u32 s41, s41, 7
    s_sub_u32 s41, s41, s3
    s_cmp_lt_u32 s3, 4
    s_cselect_b32 s34, s42, s41
    s_add_u32 s35, s34, 1
    s_lshl_b32 s41, s33, 1
    s_sub_u32 s37, 32, s41
    s_mov_b32 s36, 0
    s_lshl_b32 s38, s32, 8
    s_lshr_b32 s41, s3, 1
    s_lshl_b32 s41, s41, 18
    s_add_u32 s38, s38, s41
    s_and_b32 s41, s3, 1
    s_lshl_b32 s41, s41, 15
    s_add_u32 s38, s38, s41
    s_mul_i32 s40, s34, 40960
    s_add_u32 s40, s40, 4194304
    s_and_b32 s84, s3, 3
    s_lshl_b32 s84, s84, 12
    s_mov_b32 s82, 0x7fff0000
    s_mov_b32 s83, 0x45800000
    s_mov_b32 s70, 256
    s_mov_b32 s71, 0x00020000
    s_mov_b32 s76, s58
    s_mov_b32 s77, s59
    s_cmp_lt_u32 s2, 240
    s_cselect_b32 s78, 4915200, 0
    s_mov_b32 s79, 0x00020000
    s_mov_b32 s58, 1280
    s_mov_b32 s59, 0x00020000
    v_mov_b32 v7, 0
    s_or_b32 s41, s2, s3
    s_cmp_eq_u32 s41, 0
    s_cselect_b32 s41, 0, s82
    s_mov_b64 exec, 1
    buffer_store_dword v8, v7, s[68:71], s41 offen sc1
    s_mov_b64 exec, -1
    s_mul_i32 s90, s85, 533504
    s_lshl_b32 s41, s86, 13
    s_add_u32 s90, s90, s41
    v_add_u32 v2, s8, v1
    s_waitcnt vmcnt(9)
    s_barrier
    ds_read_b64_tr_b16 v[80:81], v2 offset:0
    ds_read_b64_tr_b16 v[82:83], v2 offset:512
    ds_read_b64_tr_b16 v[84:85], v2 offset:32
    ds_read_b64_tr_b16 v[86:87], v2 offset:544
    ds_read_b64_tr_b16 v[88:89], v2 offset:64
    ds_read_b64_tr_b16 v[90:91], v2 offset:576
    ds_read_b64_tr_b16 v[92:93], v2 offset:96
    ds_read_b64_tr_b16 v[94:95], v2 offset:608
    ds_read_b64_tr_b16 v[96:97], v2 offset:128
    ds_read_b64_tr_b16 v[98:99], v2 offset:640
    ds_read_b64_tr_b16 v[100:101], v2 offset:160
    ds_read_b64_tr_b16 v[102:103], v2 offset:672
    ds_read_b64_tr_b16 v[104:105], v2 offset:192
    ds_read_b64_tr_b16 v[106:107], v2 offset:704
    s_add_u32 m0, s14, 34816
    s_add_u32 s41, s88, 0
    buffer_load_dwordx4 v3, s[52:55], s41 offen nt lds
    s_add_u32 m0, s14, 35872
    s_add_u32 s41, s88, 8192
    buffer_load_dwordx4 v3, s[52:55], s41 offen nt lds
    s_add_u32 m0, s14, 36928
    s_add_u32 s41, s88, 16384
    buffer_load_dwordx4 v3, s[52:55], s41 offen nt lds
    s_add_u32 m0, s14, 37984
    s_add_u32 s41, s88, 24576
    buffer_load_dwordx4 v3, s[52:55], s41 offen nt lds
    v_lshrrev_b32 v5, 3, v0
    v_mul_u32_u24 v6, 7680, v5
    v_and_b32 v7, 7, v0
    v_lshl_add_u32 v6, v7, 4, v6
    v_lshlrev_b32 v5, 1, v5
    s_and_b32 s46, s2, 3
    s_mul_i32 s47, s46, 320
    s_mul_i32 s46, s46, 1228800
    s_lshr_b32 s44, s2, 2
    s_lshl_b32 s44, s44, 7
    s_add_u32 s46, s46, s44
    buffer_load_ushort v236, v5, s[56:59], s47 offen offset:0
    buffer_load_dwordx4 v[224:227], v6, s[76:79], s46 offen nt
    s_add_u32 s46, s46, 491520
    buffer_load_ushort v237, v5, s[56:59], s47 offen offset:128
    buffer_load_dwordx4 v[228:231], v6, s[76:79], s46 offen nt
    s_add_u32 s46, s46, 491520
    s_cmp_lt_u32 s3, 4
    s_cselect_b32 s46, s46, s82
    s_cselect_b32 s47, s47, s82
    buffer_load_ushort v238, v5, s[56:59], s47 offen offset:256
    buffer_load_dwordx4 v[232:235], v6, s[76:79], s46 offen nt
    s_waitcnt vmcnt(15)
    s_mov_b64 vcc, s[60:61]
    v_cndmask_b32_dpp v252, v180, v176, vcc quad_perm:[1,0,3,2] row_mask:0xf bank_mask:0xf
    v_cndmask_b32_dpp v253, v181, v177, vcc quad_perm:[1,0,3,2] row_mask:0xf bank_mask:0xf
    v_cndmask_b32_dpp v254, v182, v178, vcc quad_perm:[1,0,3,2] row_mask:0xf bank_mask:0xf
    v_cndmask_b32_dpp v255, v183, v179, vcc quad_perm:[1,0,3,2] row_mask:0xf bank_mask:0xf
    s_mov_b64 vcc, s[62:63]
    v_cndmask_b32_dpp v180, v176, v180, vcc quad_perm:[1,0,3,2] row_mask:0xf bank_mask:0xf
    v_cndmask_b32_dpp v181, v177, v181, vcc quad_perm:[1,0,3,2] row_mask:0xf bank_mask:0xf
    v_cndmask_b32_dpp v182, v178, v182, vcc quad_perm:[1,0,3,2] row_mask:0xf bank_mask:0xf
    v_cndmask_b32_dpp v183, v179, v183, vcc quad_perm:[1,0,3,2] row_mask:0xf bank_mask:0xf
    s_mov_b64 vcc, s[60:61]
    v_cndmask_b32_dpp v176, v188, v184, vcc quad_perm:[1,0,3,2] row_mask:0xf bank_mask:0xf
    v_cndmask_b32_dpp v177, v189, v185, vcc quad_perm:[1,0,3,2] row_mask:0xf bank_mask:0xf
    v_cndmask_b32_dpp v178, v190, v186, vcc quad_perm:[1,0,3,2] row_mask:0xf bank_mask:0xf
    v_cndmask_b32_dpp v179, v191, v187, vcc quad_perm:[1,0,3,2] row_mask:0xf bank_mask:0xf
    s_mov_b64 vcc, s[62:63]
    v_cndmask_b32_dpp v188, v184, v188, vcc quad_perm:[1,0,3,2] row_mask:0xf bank_mask:0xf
    v_cndmask_b32_dpp v189, v185, v189, vcc quad_perm:[1,0,3,2] row_mask:0xf bank_mask:0xf
    v_cndmask_b32_dpp v190, v186, v190, vcc quad_perm:[1,0,3,2] row_mask:0xf bank_mask:0xf
    v_cndmask_b32_dpp v191, v187, v191, vcc quad_perm:[1,0,3,2] row_mask:0xf bank_mask:0xf
    s_mov_b64 vcc, s[64:65]
    v_cndmask_b32_dpp v184, v188, v180, vcc quad_perm:[2,3,0,1] row_mask:0xf bank_mask:0xf
    v_cndmask_b32_dpp v185, v189, v181, vcc quad_perm:[2,3,0,1] row_mask:0xf bank_mask:0xf
    v_cndmask_b32_dpp v186, v190, v182, vcc quad_perm:[2,3,0,1] row_mask:0xf bank_mask:0xf
    v_cndmask_b32_dpp v187, v191, v183, vcc quad_perm:[2,3,0,1] row_mask:0xf bank_mask:0xf
    s_mov_b64 vcc, s[66:67]
    v_cndmask_b32_dpp v188, v180, v188, vcc quad_perm:[2,3,0,1] row_mask:0xf bank_mask:0xf
    v_cndmask_b32_dpp v189, v181, v189, vcc quad_perm:[2,3,0,1] row_mask:0xf bank_mask:0xf
    v_cndmask_b32_dpp v190, v182, v190, vcc quad_perm:[2,3,0,1] row_mask:0xf bank_mask:0xf
    v_cndmask_b32_dpp v191, v183, v191, vcc quad_perm:[2,3,0,1] row_mask:0xf bank_mask:0xf
    s_mov_b64 vcc, s[64:65]
    v_cndmask_b32_dpp v180, v176, v252, vcc quad_perm:[2,3,0,1] row_mask:0xf bank_mask:0xf
    v_cndmask_b32_dpp v181, v177, v253, vcc quad_perm:[2,3,0,1] row_mask:0xf bank_mask:0xf
    v_cndmask_b32_dpp v182, v178, v254, vcc quad_perm:[2,3,0,1] row_mask:0xf bank_mask:0xf
    v_cndmask_b32_dpp v183, v179, v255, vcc quad_perm:[2,3,0,1] row_mask:0xf bank_mask:0xf
    s_mov_b64 vcc, s[66:67]
    v_cndmask_b32_dpp v176, v252, v176, vcc quad_perm:[2,3,0,1] row_mask:0xf bank_mask:0xf
    v_cndmask_b32_dpp v177, v253, v177, vcc quad_perm:[2,3,0,1] row_mask:0xf bank_mask:0xf
    v_cndmask_b32_dpp v178, v254, v178, vcc quad_perm:[2,3,0,1] row_mask:0xf bank_mask:0xf
    v_cndmask_b32_dpp v179, v255, v179, vcc quad_perm:[2,3,0,1] row_mask:0xf bank_mask:0xf
    s_waitcnt vmcnt(11)
    s_mov_b64 vcc, s[60:61]
    v_cndmask_b32_dpp v252, v196, v192, vcc quad_perm:[1,0,3,2] row_mask:0xf bank_mask:0xf
    v_cndmask_b32_dpp v253, v197, v193, vcc quad_perm:[1,0,3,2] row_mask:0xf bank_mask:0xf
    v_cndmask_b32_dpp v254, v198, v194, vcc quad_perm:[1,0,3,2] row_mask:0xf bank_mask:0xf
    v_cndmask_b32_dpp v255, v199, v195, vcc quad_perm:[1,0,3,2] row_mask:0xf bank_mask:0xf
    s_mov_b64 vcc, s[62:63]
    v_cndmask_b32_dpp v196, v192, v196, vcc quad_perm:[1,0,3,2] row_mask:0xf bank_mask:0xf
    v_cndmask_b32_dpp v197, v193, v197, vcc quad_perm:[1,0,3,2] row_mask:0xf bank_mask:0xf
    v_cndmask_b32_dpp v198, v194, v198, vcc quad_perm:[1,0,3,2] row_mask:0xf bank_mask:0xf
    v_cndmask_b32_dpp v199, v195, v199, vcc quad_perm:[1,0,3,2] row_mask:0xf bank_mask:0xf
    s_mov_b64 vcc, s[60:61]
    v_cndmask_b32_dpp v192, v204, v200, vcc quad_perm:[1,0,3,2] row_mask:0xf bank_mask:0xf
    v_cndmask_b32_dpp v193, v205, v201, vcc quad_perm:[1,0,3,2] row_mask:0xf bank_mask:0xf
    v_cndmask_b32_dpp v194, v206, v202, vcc quad_perm:[1,0,3,2] row_mask:0xf bank_mask:0xf
    v_cndmask_b32_dpp v195, v207, v203, vcc quad_perm:[1,0,3,2] row_mask:0xf bank_mask:0xf
    s_mov_b64 vcc, s[62:63]
    v_cndmask_b32_dpp v204, v200, v204, vcc quad_perm:[1,0,3,2] row_mask:0xf bank_mask:0xf
    v_cndmask_b32_dpp v205, v201, v205, vcc quad_perm:[1,0,3,2] row_mask:0xf bank_mask:0xf
    v_cndmask_b32_dpp v206, v202, v206, vcc quad_perm:[1,0,3,2] row_mask:0xf bank_mask:0xf
    v_cndmask_b32_dpp v207, v203, v207, vcc quad_perm:[1,0,3,2] row_mask:0xf bank_mask:0xf
    s_mov_b64 vcc, s[64:65]
    v_cndmask_b32_dpp v200, v204, v196, vcc quad_perm:[2,3,0,1] row_mask:0xf bank_mask:0xf
    v_cndmask_b32_dpp v201, v205, v197, vcc quad_perm:[2,3,0,1] row_mask:0xf bank_mask:0xf
    v_cndmask_b32_dpp v202, v206, v198, vcc quad_perm:[2,3,0,1] row_mask:0xf bank_mask:0xf
    v_cndmask_b32_dpp v203, v207, v199, vcc quad_perm:[2,3,0,1] row_mask:0xf bank_mask:0xf
    s_mov_b64 vcc, s[66:67]
    v_cndmask_b32_dpp v204, v196, v204, vcc quad_perm:[2,3,0,1] row_mask:0xf bank_mask:0xf
    v_cndmask_b32_dpp v205, v197, v205, vcc quad_perm:[2,3,0,1] row_mask:0xf bank_mask:0xf
    v_cndmask_b32_dpp v206, v198, v206, vcc quad_perm:[2,3,0,1] row_mask:0xf bank_mask:0xf
    v_cndmask_b32_dpp v207, v199, v207, vcc quad_perm:[2,3,0,1] row_mask:0xf bank_mask:0xf
    s_mov_b64 vcc, s[64:65]
    v_cndmask_b32_dpp v196, v192, v252, vcc quad_perm:[2,3,0,1] row_mask:0xf bank_mask:0xf
    v_cndmask_b32_dpp v197, v193, v253, vcc quad_perm:[2,3,0,1] row_mask:0xf bank_mask:0xf
    v_cndmask_b32_dpp v198, v194, v254, vcc quad_perm:[2,3,0,1] row_mask:0xf bank_mask:0xf
    v_cndmask_b32_dpp v199, v195, v255, vcc quad_perm:[2,3,0,1] row_mask:0xf bank_mask:0xf
    s_mov_b64 vcc, s[66:67]
    v_cndmask_b32_dpp v192, v252, v192, vcc quad_perm:[2,3,0,1] row_mask:0xf bank_mask:0xf
    v_cndmask_b32_dpp v193, v253, v193, vcc quad_perm:[2,3,0,1] row_mask:0xf bank_mask:0xf
    v_cndmask_b32_dpp v194, v254, v194, vcc quad_perm:[2,3,0,1] row_mask:0xf bank_mask:0xf
    v_cndmask_b32_dpp v195, v255, v195, vcc quad_perm:[2,3,0,1] row_mask:0xf bank_mask:0xf
    s_nop 0
    s_waitcnt lgkmcnt(10)
    v_mfma_f32_16x16x32_bf16 v[112:115], v[80:83], v[180:183], 0
    ds_read_b64_tr_b16 v[108:109], v2 offset:224
    ds_read_b64_tr_b16 v[110:111], v2 offset:736
    v_mfma_f32_16x16x32_bf16 v[120:123], v[80:83], v[196:199], 0
    v_mfma_f32_16x16x32_bf16 v[116:119], v[84:87], v[180:183], 0
    ds_read_b64_tr_b16 v[80:81], v2 offset:8448
    ds_read_b64_tr_b16 v[82:83], v2 offset:8960
    v_mfma_f32_16x16x32_bf16 v[124:127], v[84:87], v[196:199], 0
    s_waitcnt lgkmcnt(10)
    v_mfma_f32_16x16x32_bf16 v[128:131], v[88:91], v[180:183], 0
    ds_read_b64_tr_b16 v[84:85], v2 offset:8480
    ds_read_b64_tr_b16 v[86:87], v2 offset:8992
    v_mfma_f32_16x16x32_bf16 v[136:139], v[88:91], v[196:199], 0
    v_mov_b32 v13, 0
    buffer_load_dword v12, v13, s[68:71], 0 offen sc1
    v_mfma_f32_16x16x32_bf16 v[132:135], v[92:95], v[180:183], 0
    ds_read_b64_tr_b16 v[88:89], v2 offset:8512
    ds_read_b64_tr_b16 v[90:91], v2 offset:9024
    v_mfma_f32_16x16x32_bf16 v[140:143], v[92:95], v[196:199], 0
    s_waitcnt lgkmcnt(10)
    v_mfma_f32_16x16x32_bf16 v[144:147], v[96:99], v[180:183], 0
    ds_read_b64_tr_b16 v[92:93], v2 offset:8544
    ds_read_b64_tr_b16 v[94:95], v2 offset:9056
    v_mfma_f32_16x16x32_bf16 v[152:155], v[96:99], v[196:199], 0
    v_mfma_f32_16x16x32_bf16 v[148:151], v[100:103], v[180:183], 0
    ds_read_b64_tr_b16 v[96:97], v2 offset:8576
    ds_read_b64_tr_b16 v[98:99], v2 offset:9088
    v_mfma_f32_16x16x32_bf16 v[156:159], v[100:103], v[196:199], 0
    s_waitcnt lgkmcnt(10)
    v_mfma_f32_16x16x32_bf16 v[160:163], v[104:107], v[180:183], 0
    ds_read_b64_tr_b16 v[100:101], v2 offset:8608
    ds_read_b64_tr_b16 v[102:103], v2 offset:9120
    v_mfma_f32_16x16x32_bf16 v[168:171], v[104:107], v[196:199], 0
    v_mfma_f32_16x16x32_bf16 v[164:167], v[108:111], v[180:183], 0
    ds_read_b64_tr_b16 v[104:105], v2 offset:8640
    ds_read_b64_tr_b16 v[106:107], v2 offset:9152
    v_mfma_f32_16x16x32_bf16 v[172:175], v[108:111], v[196:199], 0
    s_waitcnt lgkmcnt(10)
    v_mfma_f32_16x16x32_bf16 v[112:115], v[80:83], v[184:187], v[112:115]
    ds_read_b64_tr_b16 v[108:109], v2 offset:8672
    ds_read_b64_tr_b16 v[110:111], v2 offset:9184
    v_mfma_f32_16x16x32_bf16 v[120:123], v[80:83], v[200:203], v[120:123]
    s_mov_b64 exec, 15
    s_add_u32 s94, s100, 1048576
    buffer_load_dword v9, v11, s[48:51], s94 offen
    buffer_load_dword v9, v11, s[52:55], s94 offen
    s_mov_b64 exec, -1
    v_mfma_f32_16x16x32_bf16 v[116:119], v[84:87], v[184:187], v[116:119]
    ds_read_b64_tr_b16 v[80:81], v2 offset:16896
    ds_read_b64_tr_b16 v[82:83], v2 offset:17408
    v_mfma_f32_16x16x32_bf16 v[124:127], v[84:87], v[200:203], v[124:127]
    s_waitcnt lgkmcnt(10)
    v_mfma_f32_16x16x32_bf16 v[128:131], v[88:91], v[184:187], v[128:131]
    ds_read_b64_tr_b16 v[84:85], v2 offset:16928
    ds_read_b64_tr_b16 v[86:87], v2 offset:17440
    v_mfma_f32_16x16x32_bf16 v[136:139], v[88:91], v[200:203], v[136:139]
    v_mfma_f32_16x16x32_bf16 v[132:135], v[92:95], v[184:187], v[132:135]
    ds_read_b64_tr_b16 v[88:89], v2 offset:16960
    ds_read_b64_tr_b16 v[90:91], v2 offset:17472
    v_mfma_f32_16x16x32_bf16 v[140:143], v[92:95], v[200:203], v[140:143]
    s_waitcnt lgkmcnt(10)
    v_mfma_f32_16x16x32_bf16 v[144:147], v[96:99], v[184:187], v[144:147]
    ds_read_b64_tr_b16 v[92:93], v2 offset:16992
    ds_read_b64_tr_b16 v[94:95], v2 offset:17504
    v_mfma_f32_16x16x32_bf16 v[152:155], v[96:99], v[200:203], v[152:155]
    v_mfma_f32_16x16x32_bf16 v[148:151], v[100:103], v[184:187], v[148:151]
    ds_read_b64_tr_b16 v[96:97], v2 offset:17024
    ds_read_b64_tr_b16 v[98:99], v2 offset:17536
    v_mfma_f32_16x16x32_bf16 v[156:159], v[100:103], v[200:203], v[156:159]
    s_waitcnt lgkmcnt(10)
    v_mfma_f32_16x16x32_bf16 v[160:163], v[104:107], v[184:187], v[160:163]
    ds_read_b64_tr_b16 v[100:101], v2 offset:17056
    ds_read_b64_tr_b16 v[102:103], v2 offset:17568
    v_mfma_f32_16x16x32_bf16 v[168:171], v[104:107], v[200:203], v[168:171]
    s_lshl_b32 s94, s101, 10
    s_mov_b64 exec, 15
    buffer_load_dword v9, v11, s[72:75], s94 offen offset:512
    s_mov_b64 exec, -1
    v_mfma_f32_16x16x32_bf16 v[164:167], v[108:111], v[184:187], v[164:167]
    ds_read_b64_tr_b16 v[104:105], v2 offset:17088
    ds_read_b64_tr_b16 v[106:107], v2 offset:17600
    v_mfma_f32_16x16x32_bf16 v[172:175], v[108:111], v[200:203], v[172:175]
    s_waitcnt lgkmcnt(10)
    v_mfma_f32_16x16x32_bf16 v[112:115], v[80:83], v[176:179], v[112:115]
    ds_read_b64_tr_b16 v[108:109], v2 offset:17120
    ds_read_b64_tr_b16 v[110:111], v2 offset:17632
    v_mfma_f32_16x16x32_bf16 v[120:123], v[80:83], v[192:195], v[120:123]
    v_mfma_f32_16x16x32_bf16 v[116:119], v[84:87], v[176:179], v[116:119]
    ds_read_b64_tr_b16 v[80:81], v2 offset:25344
    ds_read_b64_tr_b16 v[82:83], v2 offset:25856
    v_mfma_f32_16x16x32_bf16 v[124:127], v[84:87], v[192:195], v[124:127]
    s_waitcnt lgkmcnt(10)
    v_mfma_f32_16x16x32_bf16 v[128:131], v[88:91], v[176:179], v[128:131]
    ds_read_b64_tr_b16 v[84:85], v2 offset:25376
    ds_read_b64_tr_b16 v[86:87], v2 offset:25888
    v_mfma_f32_16x16x32_bf16 v[136:139], v[88:91], v[192:195], v[136:139]
    s_add_u32 m0, s15, 69632
    s_add_u32 s41, s88, 1048576
    buffer_load_dwordx4 v3, s[48:51], s41 offen nt lds
    v_mfma_f32_16x16x32_bf16 v[132:135], v[92:95], v[176:179], v[132:135]
    ds_read_b64_tr_b16 v[88:89], v2 offset:25408
    ds_read_b64_tr_b16 v[90:91], v2 offset:25920
    v_mfma_f32_16x16x32_bf16 v[140:143], v[92:95], v[192:195], v[140:143]
    s_waitcnt lgkmcnt(10)
    v_mfma_f32_16x16x32_bf16 v[144:147], v[96:99], v[176:179], v[144:147]
    ds_read_b64_tr_b16 v[92:93], v2 offset:25440
    ds_read_b64_tr_b16 v[94:95], v2 offset:25952
    v_mfma_f32_16x16x32_bf16 v[152:155], v[96:99], v[192:195], v[152:155]
    v_mfma_f32_16x16x32_bf16 v[148:151], v[100:103], v[176:179], v[148:151]
    ds_read_b64_tr_b16 v[96:97], v2 offset:25472
    ds_read_b64_tr_b16 v[98:99], v2 offset:25984
    v_mfma_f32_16x16x32_bf16 v[156:159], v[100:103], v[192:195], v[156:159]
    s_add_u32 m0, s15, 70688
    s_add_u32 s41, s88, 1056768
    buffer_load_dwordx4 v3, s[48:51], s41 offen nt lds
    s_waitcnt lgkmcnt(10)
    v_mfma_f32_16x16x32_bf16 v[160:163], v[104:107], v[176:179], v[160:163]
    ds_read_b64_tr_b16 v[100:101], v2 offset:25504
    ds_read_b64_tr_b16 v[102:103], v2 offset:26016
    v_mfma_f32_16x16x32_bf16 v[168:171], v[104:107], v[192:195], v[168:171]
    v_mfma_f32_16x16x32_bf16 v[164:167], v[108:111], v[176:179], v[164:167]
    ds_read_b64_tr_b16 v[104:105], v2 offset:25536
    ds_read_b64_tr_b16 v[106:107], v2 offset:26048
    v_mfma_f32_16x16x32_bf16 v[172:175], v[108:111], v[192:195], v[172:175]
    s_waitcnt lgkmcnt(10)
    v_mfma_f32_16x16x32_bf16 v[112:115], v[80:83], v[188:191], v[112:115]
    ds_read_b64_tr_b16 v[108:109], v2 offset:25568
    ds_read_b64_tr_b16 v[110:111], v2 offset:26080
    v_mfma_f32_16x16x32_bf16 v[120:123], v[80:83], v[204:207], v[120:123]
    v_add_u32 v2, s9, v1
    s_waitcnt vmcnt(12)
    s_barrier
    s_add_u32 m0, s15, 71744
    s_add_u32 s41, s88, 1064960
    buffer_load_dwordx4 v3, s[48:51], s41 offen nt lds
    v_mfma_f32_16x16x32_bf16 v[116:119], v[84:87], v[188:191], v[116:119]
    ds_read_b64_tr_b16 v[80:81], v2 offset:0
    ds_read_b64_tr_b16 v[82:83], v2 offset:512
    v_mfma_f32_16x16x32_bf16 v[124:127], v[84:87], v[204:207], v[124:127]
    s_waitcnt vmcnt(7)
    s_mov_b32 s46, 0xbfb8aa3b
    v_lshlrev_b32 v236, 16, v236
    v_mul_f32 v248, s46, v236
    v_exp_f32 v248, v248
    s_waitcnt lgkmcnt(10)
    v_mfma_f32_16x16x32_bf16 v[128:131], v[88:91], v[188:191], v[128:131]
    ds_read_b64_tr_b16 v[84:85], v2 offset:32
    ds_read_b64_tr_b16 v[86:87], v2 offset:544
    v_mfma_f32_16x16x32_bf16 v[136:139], v[88:91], v[204:207], v[136:139]
    v_add_f32 v248, 1.0, v248
    v_rcp_f32 v248, v248
    s_nop 0
    v_mul_f32 v236, v236, v248
    v_cvt_pk_bf16_f32 v236, v236, v236
    v_lshlrev_b32 v236, 16, v236
    v_mfma_f32_16x16x32_bf16 v[132:135], v[92:95], v[188:191], v[132:135]
    ds_read_b64_tr_b16 v[88:89], v2 offset:64
    ds_read_b64_tr_b16 v[90:91], v2 offset:576
    v_mfma_f32_16x16x32_bf16 v[140:143], v[92:95], v[204:207], v[140:143]
    s_add_u32 m0, s15, 72800
    s_add_u32 s41, s88, 1073152
    buffer_load_dwordx4 v3, s[48:51], s41 offen nt lds
    v_lshlrev_b32 v237, 16, v237
    v_mul_f32 v249, s46, v237
    v_exp_f32 v249, v249
    s_nop 0
    v_add_f32 v249, 1.0, v249
    v_rcp_f32 v249, v249
    s_waitcnt lgkmcnt(10)
    v_mfma_f32_16x16x32_bf16 v[144:147], v[96:99], v[188:191], v[144:147]
    ds_read_b64_tr_b16 v[92:93], v2 offset:96
    ds_read_b64_tr_b16 v[94:95], v2 offset:608
    v_mfma_f32_16x16x32_bf16 v[152:155], v[96:99], v[204:207], v[152:155]
    v_mul_f32 v237, v237, v249
    v_cvt_pk_bf16_f32 v237, v237, v237
    v_lshlrev_b32 v237, 16, v237
    v_lshlrev_b32 v238, 16, v238
    v_mul_f32 v250, s46, v238
    v_mfma_f32_16x16x32_bf16 v[148:151], v[100:103], v[188:191], v[148:151]
    ds_read_b64_tr_b16 v[96:97], v2 offset:128
    ds_read_b64_tr_b16 v[98:99], v2 offset:640
    v_mfma_f32_16x16x32_bf16 v[156:159], v[100:103], v[204:207], v[156:159]
    v_exp_f32 v250, v250
    s_nop 0
    v_add_f32 v250, 1.0, v250
    v_rcp_f32 v250, v250
    s_nop 0
    v_mul_f32 v238, v238, v250
    v_cvt_pk_bf16_f32 v238, v238, v238
    s_waitcnt lgkmcnt(10)
    v_mfma_f32_16x16x32_bf16 v[160:163], v[104:107], v[188:191], v[160:163]
    ds_read_b64_tr_b16 v[100:101], v2 offset:160
    ds_read_b64_tr_b16 v[102:103], v2 offset:672
    v_mfma_f32_16x16x32_bf16 v[168:171], v[104:107], v[204:207], v[168:171]
    v_lshlrev_b32 v238, 16, v238
    v_lshlrev_b32 v248, 16, v224
    v_and_b32 v249, 0xffff0000, v224
    v_mul_f32 v240, v248, v236
    v_mul_f32 v241, v249, v236
    v_mfma_f32_16x16x32_bf16 v[164:167], v[108:111], v[188:191], v[164:167]
    ds_read_b64_tr_b16 v[104:105], v2 offset:192
    ds_read_b64_tr_b16 v[106:107], v2 offset:704
    v_mfma_f32_16x16x32_bf16 v[172:175], v[108:111], v[204:207], v[172:175]
    s_waitcnt vmcnt(7)
    v_readfirstlane_b32 s91, v12
    s_cmp_eq_u32 s91, 0
    s_cbranch_scc1 TG_slow
TG_ok:
    v_lshlrev_b32 v248, 16, v225
    v_and_b32 v249, 0xffff0000, v225
    v_mul_f32 v242, v248, v236
    v_mul_f32 v243, v249, v236
    s_waitcnt lgkmcnt(10)
    v_mfma_f32_16x16x32_bf16 v[16:19], v[180:183], v[80:83], 0
    ds_read_b64_tr_b16 v[108:109], v2 offset:224
    ds_read_b64_tr_b16 v[110:111], v2 offset:736
    v_mfma_f32_16x16x32_bf16 v[20:23], v[196:199], v[80:83], 0
    buffer_load_dwordx4 v[208:211], v14, s[72:75], s89 offen offset:256
    v_lshlrev_b32 v248, 16, v226
    v_and_b32 v249, 0xffff0000, v226
    v_mul_f32 v244, v248, v236
    v_mul_f32 v245, v249, v236
    v_lshlrev_b32 v248, 16, v227
    v_and_b32 v249, 0xffff0000, v227
    v_mfma_f32_16x16x32_bf16 v[24:27], v[180:183], v[84:87], 0
    ds_read_b64_tr_b16 v[80:81], v2 offset:8448
    ds_read_b64_tr_b16 v[82:83], v2 offset:8960
    v_mfma_f32_16x16x32_bf16 v[28:31], v[196:199], v[84:87], 0
    buffer_load_dwordx4 v[212:215], v14, s[72:75], s89 offen offset:1280
    v_mul_f32 v246, v248, v236
    v_mul_f32 v247, v249, v236
    v_lshlrev_b32 v248, 16, v228
    v_and_b32 v249, 0xffff0000, v228
    v_fmac_f32 v240, v248, v237
    v_fmac_f32 v241, v249, v237
    s_waitcnt lgkmcnt(10)
    v_mfma_f32_16x16x32_bf16 v[32:35], v[180:183], v[88:91], 0
    ds_read_b64_tr_b16 v[84:85], v2 offset:8480
    ds_read_b64_tr_b16 v[86:87], v2 offset:8992
    v_mfma_f32_16x16x32_bf16 v[36:39], v[196:199], v[88:91], 0
    buffer_load_dwordx4 v[216:219], v14, s[72:75], s89 offen offset:2304
    v_lshlrev_b32 v248, 16, v229
    v_and_b32 v249, 0xffff0000, v229
    v_fmac_f32 v242, v248, v237
    v_fmac_f32 v243, v249, v237
    v_lshlrev_b32 v248, 16, v230
    v_and_b32 v249, 0xffff0000, v230
    v_mfma_f32_16x16x32_bf16 v[40:43], v[180:183], v[92:95], 0
    ds_read_b64_tr_b16 v[88:89], v2 offset:8512
    ds_read_b64_tr_b16 v[90:91], v2 offset:9024
    v_mfma_f32_16x16x32_bf16 v[44:47], v[196:199], v[92:95], 0
    buffer_load_dwordx4 v[220:223], v14, s[72:75], s89 offen offset:3328
    v_fmac_f32 v244, v248, v237
    v_fmac_f32 v245, v249, v237
    v_lshlrev_b32 v248, 16, v231
    v_and_b32 v249, 0xffff0000, v231
    v_fmac_f32 v246, v248, v237
    s_waitcnt lgkmcnt(10)
    v_mfma_f32_16x16x32_bf16 v[48:51], v[180:183], v[96:99], 0
    ds_read_b64_tr_b16 v[92:93], v2 offset:8544
    ds_read_b64_tr_b16 v[94:95], v2 offset:9056
    v_mfma_f32_16x16x32_bf16 v[52:55], v[196:199], v[96:99], 0
    s_mul_i32 s94, s87, 1280
    s_mov_b64 exec, 0x3ff
    buffer_load_dword v9, v11, s[28:31], s94 offen
    s_mov_b64 exec, -1
    v_fmac_f32 v247, v249, v237
    v_lshlrev_b32 v248, 16, v232
    v_and_b32 v249, 0xffff0000, v232
    v_fmac_f32 v240, v248, v238
    v_fmac_f32 v241, v249, v238
    v_lshlrev_b32 v248, 16, v233
    v_mfma_f32_16x16x32_bf16 v[56:59], v[180:183], v[100:103], 0
    ds_read_b64_tr_b16 v[96:97], v2 offset:8576
    ds_read_b64_tr_b16 v[98:99], v2 offset:9088
    v_mfma_f32_16x16x32_bf16 v[60:63], v[196:199], v[100:103], 0
    v_and_b32 v249, 0xffff0000, v233
    v_fmac_f32 v242, v248, v238
    v_fmac_f32 v243, v249, v238
    v_lshlrev_b32 v248, 16, v234
    v_and_b32 v249, 0xffff0000, v234
    v_fmac_f32 v244, v248, v238
    s_waitcnt lgkmcnt(10)
    v_mfma_f32_16x16x32_bf16 v[64:67], v[180:183], v[104:107], 0
    ds_read_b64_tr_b16 v[100:101], v2 offset:8608
    ds_read_b64_tr_b16 v[102:103], v2 offset:9120
    v_mfma_f32_16x16x32_bf16 v[68:71], v[196:199], v[104:107], 0
    v_fmac_f32 v245, v249, v238
    v_lshlrev_b32 v248, 16, v235
    v_and_b32 v249, 0xffff0000, v235
    v_fmac_f32 v246, v248, v238
    v_fmac_f32 v247, v249, v238
    v_mfma_f32_16x16x32_bf16 v[72:75], v[180:183], v[108:111], 0
    ds_read_b64_tr_b16 v[104:105], v2 offset:8640
    ds_read_b64_tr_b16 v[106:107], v2 offset:9152
    v_mfma_f32_16x16x32_bf16 v[76:79], v[196:199], v[108:111], 0
    buffer_load_dwordx4 v[224:227], v14, s[72:75], s39 offen offset:256
    v_add_f32_dpp v240, v240, v240 row_ror:8 row_mask:0xf bank_mask:0xf
    v_add_f32_dpp v241, v241, v241 row_ror:8 row_mask:0xf bank_mask:0xf
    v_add_f32_dpp v242, v242, v242 row_ror:8 row_mask:0xf bank_mask:0xf
    v_add_f32_dpp v243, v243, v243 row_ror:8 row_mask:0xf bank_mask:0xf
    v_add_f32_dpp v244, v244, v244 row_ror:8 row_mask:0xf bank_mask:0xf
    v_add_f32_dpp v245, v245, v245 row_ror:8 row_mask:0xf bank_mask:0xf
    v_add_f32_dpp v246, v246, v246 row_ror:8 row_mask:0xf bank_mask:0xf
    v_add_f32_dpp v247, v247, v247 row_ror:8 row_mask:0xf bank_mask:0xf
    s_waitcnt lgkmcnt(10)
    v_mfma_f32_16x16x32_bf16 v[16:19], v[184:187], v[80:83], v[16:19]
    ds_read_b64_tr_b16 v[108:109], v2 offset:8672
    ds_read_b64_tr_b16 v[110:111], v2 offset:9184
    v_mfma_f32_16x16x32_bf16 v[20:23], v[200:203], v[80:83], v[20:23]
    buffer_load_dwordx4 v[228:231], v14, s[72:75], s39 offen offset:1280
    v_mov_b32 v248, v240
    v_mov_b32 v249, v241
    v_mov_b32 v250, v242
    v_mov_b32 v251, v243
    v_permlane16_swap_b32 v240, v248
    v_permlane16_swap_b32 v241, v249
    v_permlane16_swap_b32 v242, v250
    v_mfma_f32_16x16x32_bf16 v[24:27], v[184:187], v[84:87], v[24:27]
    ds_read_b64_tr_b16 v[80:81], v2 offset:16896
    ds_read_b64_tr_b16 v[82:83], v2 offset:17408
    v_mfma_f32_16x16x32_bf16 v[28:31], v[200:203], v[84:87], v[28:31]
    buffer_load_dwordx4 v[232:235], v14, s[72:75], s39 offen offset:2304
    v_permlane16_swap_b32 v243, v251
    v_add_f32 v240, v240, v248
    v_add_f32 v241, v241, v249
    v_add_f32 v242, v242, v250
    v_add_f32 v243, v243, v251
    v_mov_b32 v248, v244
    v_mov_b32 v249, v245
    s_waitcnt lgkmcnt(10)
    v_mfma_f32_16x16x32_bf16 v[32:35], v[184:187], v[88:91], v[32:35]
    ds_read_b64_tr_b16 v[84:85], v2 offset:16928
    ds_read_b64_tr_b16 v[86:87], v2 offset:17440
    v_mfma_f32_16x16x32_bf16 v[36:39], v[200:203], v[88:91], v[36:39]
    buffer_load_dwordx4 v[236:239], v14, s[72:75], s39 offen offset:3328
    v_mov_b32 v250, v246
    v_mov_b32 v251, v247
    v_permlane16_swap_b32 v244, v248
    v_permlane16_swap_b32 v245, v249
    v_permlane16_swap_b32 v246, v250
    v_permlane16_swap_b32 v247, v251
    v_add_f32 v244, v244, v248
    v_add_f32 v245, v245, v249
    v_mfma_f32_16x16x32_bf16 v[40:43], v[184:187], v[92:95], v[40:43]
    ds_read_b64_tr_b16 v[88:89], v2 offset:16960
    ds_read_b64_tr_b16 v[90:91], v2 offset:17472
    v_mfma_f32_16x16x32_bf16 v[44:47], v[200:203], v[92:95], v[44:47]
    v_add_f32 v246, v246, v250
    v_add_f32 v247, v247, v251
    v_mov_b32 v248, v240
    v_mov_b32 v249, v241
    v_mov_b32 v250, v242
    v_mov_b32 v251, v243
    v_permlane32_swap_b32 v240, v248
    s_waitcnt lgkmcnt(10)
    v_mfma_f32_16x16x32_bf16 v[48:51], v[184:187], v[96:99], v[48:51]
    ds_read_b64_tr_b16 v[92:93], v2 offset:16992
    ds_read_b64_tr_b16 v[94:95], v2 offset:17504
    v_mfma_f32_16x16x32_bf16 v[52:55], v[200:203], v[96:99], v[52:55]
    v_permlane32_swap_b32 v241, v249
    v_permlane32_swap_b32 v242, v250
    v_permlane32_swap_b32 v243, v251
    v_add_f32 v240, v240, v248
    v_add_f32 v241, v241, v249
    v_add_f32 v242, v242, v250
    v_add_f32 v243, v243, v251
    v_mfma_f32_16x16x32_bf16 v[56:59], v[184:187], v[100:103], v[56:59]
    ds_read_b64_tr_b16 v[96:97], v2 offset:17024
    ds_read_b64_tr_b16 v[98:99], v2 offset:17536
    v_mfma_f32_16x16x32_bf16 v[60:63], v[200:203], v[100:103], v[60:63]
    v_mov_b32 v248, v244
    v_mov_b32 v249, v245
    v_mov_b32 v250, v246
    v_mov_b32 v251, v247
    v_permlane32_swap_b32 v244, v248
    v_permlane32_swap_b32 v245, v249
    v_permlane32_swap_b32 v246, v250
    v_permlane32_swap_b32 v247, v251
    s_waitcnt lgkmcnt(10)
    v_mfma_f32_16x16x32_bf16 v[64:67], v[184:187], v[104:107], v[64:67]
    ds_read_b64_tr_b16 v[100:101], v2 offset:17056
    ds_read_b64_tr_b16 v[102:103], v2 offset:17568
    v_mfma_f32_16x16x32_bf16 v[68:71], v[200:203], v[104:107], v[68:71]
    v_add_f32 v244, v244, v248
    v_add_f32 v245, v245, v249
    v_add_f32 v246, v246, v250
    v_add_f32 v247, v247, v251
    v_and_b32 v5, 7, v0
    v_lshlrev_b32 v5, 5, v5
    s_lshl_b32 s46, s3, 8
    v_mfma_f32_16x16x32_bf16 v[72:75], v[184:187], v[108:111], v[72:75]
    ds_read_b64_tr_b16 v[104:105], v2 offset:17088
    ds_read_b64_tr_b16 v[106:107], v2 offset:17600
    v_mfma_f32_16x16x32_bf16 v[76:79], v[200:203], v[108:111], v[76:79]
    s_add_u32 s46, s46, 139264
    v_add_u32 v5, s46, v5
    ds_write_b128 v5, v[240:243]
    ds_write_b128 v5, v[244:247] offset:16
    v_lshrrev_b32 v5, 2, v4
    v_add_u32 v6, 139264, v5
    s_waitcnt lgkmcnt(0)
    s_waitcnt lgkmcnt(10)
    v_mfma_f32_16x16x32_bf16 v[16:19], v[176:179], v[80:83], v[16:19]
    ds_read_b64_tr_b16 v[108:109], v2 offset:17120
    ds_read_b64_tr_b16 v[110:111], v2 offset:17632
    v_mfma_f32_16x16x32_bf16 v[20:23], v[192:195], v[80:83], v[20:23]
    s_barrier
    v_mfma_f32_16x16x32_bf16 v[24:27], v[176:179], v[84:87], v[24:27]
    ds_read_b64_tr_b16 v[80:81], v2 offset:25344
    ds_read_b64_tr_b16 v[82:83], v2 offset:25856
    v_mfma_f32_16x16x32_bf16 v[28:31], v[192:195], v[84:87], v[28:31]
    ds_read_b32 v240, v6 offset:0
    ds_read_b32 v241, v6 offset:256
    ds_read_b32 v242, v6 offset:512
    s_waitcnt lgkmcnt(10)
    v_mfma_f32_16x16x32_bf16 v[32:35], v[176:179], v[88:91], v[32:35]
    ds_read_b64_tr_b16 v[84:85], v2 offset:25376
    ds_read_b64_tr_b16 v[86:87], v2 offset:25888
    v_mfma_f32_16x16x32_bf16 v[36:39], v[192:195], v[88:91], v[36:39]
    ds_read_b32 v243, v6 offset:768
    ds_read_b32 v244, v6 offset:1024
    ds_read_b32 v245, v6 offset:1280
    s_waitcnt vmcnt(5)
    s_mov_b64 vcc, s[60:61]
    v_cndmask_b32_dpp v252, v212, v208, vcc quad_perm:[1,0,3,2] row_mask:0xf bank_mask:0xf
    v_cndmask_b32_dpp v253, v213, v209, vcc quad_perm:[1,0,3,2] row_mask:0xf bank_mask:0xf
    v_cndmask_b32_dpp v254, v214, v210, vcc quad_perm:[1,0,3,2] row_mask:0xf bank_mask:0xf
    v_cndmask_b32_dpp v255, v215, v211, vcc quad_perm:[1,0,3,2] row_mask:0xf bank_mask:0xf
    s_mov_b64 vcc, s[62:63]
    v_cndmask_b32_dpp v212, v208, v212, vcc quad_perm:[1,0,3,2] row_mask:0xf bank_mask:0xf
    v_cndmask_b32_dpp v213, v209, v213, vcc quad_perm:[1,0,3,2] row_mask:0xf bank_mask:0xf
    v_cndmask_b32_dpp v214, v210, v214, vcc quad_perm:[1,0,3,2] row_mask:0xf bank_mask:0xf
    v_cndmask_b32_dpp v215, v211, v215, vcc quad_perm:[1,0,3,2] row_mask:0xf bank_mask:0xf
    v_mfma_f32_16x16x32_bf16 v[40:43], v[176:179], v[92:95], v[40:43]
    ds_read_b64_tr_b16 v[88:89], v2 offset:25408
    ds_read_b64_tr_b16 v[90:91], v2 offset:25920
    v_mfma_f32_16x16x32_bf16 v[44:47], v[192:195], v[92:95], v[44:47]
    ds_read_b32 v246, v6 offset:1536
    ds_read_b32 v247, v6 offset:1792
    s_waitcnt lgkmcnt(0)
    s_mov_b64 vcc, s[60:61]
    v_cndmask_b32_dpp v208, v220, v216, vcc quad_perm:[1,0,3,2] row_mask:0xf bank_mask:0xf
    v_cndmask_b32_dpp v209, v221, v217, vcc quad_perm:[1,0,3,2] row_mask:0xf bank_mask:0xf
    v_cndmask_b32_dpp v210, v222, v218, vcc quad_perm:[1,0,3,2] row_mask:0xf bank_mask:0xf
    v_cndmask_b32_dpp v211, v223, v219, vcc quad_perm:[1,0,3,2] row_mask:0xf bank_mask:0xf
    s_waitcnt lgkmcnt(10)
    v_mfma_f32_16x16x32_bf16 v[48:51], v[176:179], v[96:99], v[48:51]
    ds_read_b64_tr_b16 v[92:93], v2 offset:25440
    ds_read_b64_tr_b16 v[94:95], v2 offset:25952
    v_mfma_f32_16x16x32_bf16 v[52:55], v[192:195], v[96:99], v[52:55]
    v_add_f32 v240, v240, v241
    v_add_f32 v240, v240, v242
    v_add_f32 v240, v240, v243
    s_mov_b64 vcc, s[62:63]
    v_cndmask_b32_dpp v220, v216, v220, vcc quad_perm:[1,0,3,2] row_mask:0xf bank_mask:0xf
    v_cndmask_b32_dpp v221, v217, v221, vcc quad_perm:[1,0,3,2] row_mask:0xf bank_mask:0xf
    v_cndmask_b32_dpp v222, v218, v222, vcc quad_perm:[1,0,3,2] row_mask:0xf bank_mask:0xf
    v_cndmask_b32_dpp v223, v219, v223, vcc quad_perm:[1,0,3,2] row_mask:0xf bank_mask:0xf
    v_mfma_f32_16x16x32_bf16 v[56:59], v[176:179], v[100:103], v[56:59]
    ds_read_b64_tr_b16 v[96:97], v2 offset:25472
    ds_read_b64_tr_b16 v[98:99], v2 offset:25984
    v_mfma_f32_16x16x32_bf16 v[60:63], v[192:195], v[100:103], v[60:63]
    v_add_f32 v240, v240, v244
    v_add_f32 v240, v240, v245
    v_add_f32 v240, v240, v246
    s_mov_b64 vcc, s[64:65]
    v_cndmask_b32_dpp v216, v220, v212, vcc quad_perm:[2,3,0,1] row_mask:0xf bank_mask:0xf
    v_cndmask_b32_dpp v217, v221, v213, vcc quad_perm:[2,3,0,1] row_mask:0xf bank_mask:0xf
    v_cndmask_b32_dpp v218, v222, v214, vcc quad_perm:[2,3,0,1] row_mask:0xf bank_mask:0xf
    v_cndmask_b32_dpp v219, v223, v215, vcc quad_perm:[2,3,0,1] row_mask:0xf bank_mask:0xf
    s_waitcnt lgkmcnt(10)
    v_mfma_f32_16x16x32_bf16 v[64:67], v[176:179], v[104:107], v[64:67]
    ds_read_b64_tr_b16 v[100:101], v2 offset:25504
    ds_read_b64_tr_b16 v[102:103], v2 offset:26016
    v_mfma_f32_16x16x32_bf16 v[68:71], v[192:195], v[104:107], v[68:71]
    v_add_f32 v240, v240, v247
    s_and_b32 s46, s2, 3
    s_mul_i32 s46, s46, 15360
    s_lshr_b32 s47, s2, 2
    s_lshl_b32 s47, s47, 8
    s_add_u32 s46, s46, s47
    s_add_u32 s46, s46, 393216
    s_cmp_lt_u32 s2, 240
    s_cselect_b32 s46, s46, s82
    s_cmp_eq_u32 s3, 0
    s_cselect_b32 s46, s46, s82
    buffer_store_dword v240, v5, s[16:19], s46 offen sc1
    s_mov_b64 vcc, s[66:67]
    v_cndmask_b32_dpp v220, v212, v220, vcc quad_perm:[2,3,0,1] row_mask:0xf bank_mask:0xf
    v_cndmask_b32_dpp v221, v213, v221, vcc quad_perm:[2,3,0,1] row_mask:0xf bank_mask:0xf
    v_cndmask_b32_dpp v222, v214, v222, vcc quad_perm:[2,3,0,1] row_mask:0xf bank_mask:0xf
    v_cndmask_b32_dpp v223, v215, v223, vcc quad_perm:[2,3,0,1] row_mask:0xf bank_mask:0xf
    s_mov_b64 vcc, s[64:65]
    v_cndmask_b32_dpp v212, v208, v252, vcc quad_perm:[2,3,0,1] row_mask:0xf bank_mask:0xf
    v_cndmask_b32_dpp v213, v209, v253, vcc quad_perm:[2,3,0,1] row_mask:0xf bank_mask:0xf
    v_cndmask_b32_dpp v214, v210, v254, vcc quad_perm:[2,3,0,1] row_mask:0xf bank_mask:0xf
    v_cndmask_b32_dpp v215, v211, v255, vcc quad_perm:[2,3,0,1] row_mask:0xf bank_mask:0xf
    v_mfma_f32_16x16x32_bf16 v[72:75], v[176:179], v[108:111], v[72:75]
    ds_read_b64_tr_b16 v[104:105], v2 offset:25536
    ds_read_b64_tr_b16 v[106:107], v2 offset:26048
    v_mfma_f32_16x16x32_bf16 v[76:79], v[192:195], v[108:111], v[76:79]
    v_lshrrev_b32 v7, 1, v4
    s_mov_b32 s44, -1
    s_mov_b32 s45, 0
    v_mov_b32 v6, 0x7fff0000
    v_add_u32 v8, 1024, v7
    v_cndmask_b32 v8, v6, v8, s[44:45]
    s_mul_i32 s46, s87, 1280
    buffer_load_dwordx2 v[240:241], v7, s[28:31], s46 offen
    buffer_load_dwordx2 v[242:243], v7, s[28:31], s46 offen offset:512
    buffer_load_dwordx2 v[244:245], v8, s[28:31], s46 offen
    v_lshlrev_b32 v10, 14, v4
    s_lshl_b32 s94, s101, 7
    s_mov_b64 exec, 14
    buffer_load_dword v9, v10, s[16:19], s94 offen
    s_mov_b64 exec, -1
    s_mov_b64 vcc, s[66:67]
    v_cndmask_b32_dpp v208, v252, v208, vcc quad_perm:[2,3,0,1] row_mask:0xf bank_mask:0xf
    v_cndmask_b32_dpp v209, v253, v209, vcc quad_perm:[2,3,0,1] row_mask:0xf bank_mask:0xf
    v_cndmask_b32_dpp v210, v254, v210, vcc quad_perm:[2,3,0,1] row_mask:0xf bank_mask:0xf
    v_cndmask_b32_dpp v211, v255, v211, vcc quad_perm:[2,3,0,1] row_mask:0xf bank_mask:0xf
    s_waitcnt lgkmcnt(10)
    v_mfma_f32_16x16x32_bf16 v[16:19], v[188:191], v[80:83], v[16:19]
    ds_read_b64_tr_b16 v[108:109], v2 offset:25568
    ds_read_b64_tr_b16 v[110:111], v2 offset:26080
    v_mfma_f32_16x16x32_bf16 v[20:23], v[204:207], v[80:83], v[20:23]
    v_add_u32 v2, s10, v1
    s_barrier
    s_waitcnt vmcnt(5)
    s_mov_b64 vcc, s[60:61]
    v_cndmask_b32_dpp v252, v228, v224, vcc quad_perm:[1,0,3,2] row_mask:0xf bank_mask:0xf
    v_cndmask_b32_dpp v253, v229, v225, vcc quad_perm:[1,0,3,2] row_mask:0xf bank_mask:0xf
    v_cndmask_b32_dpp v254, v230, v226, vcc quad_perm:[1,0,3,2] row_mask:0xf bank_mask:0xf
    v_cndmask_b32_dpp v255, v231, v227, vcc quad_perm:[1,0,3,2] row_mask:0xf bank_mask:0xf
    v_mfma_f32_16x16x32_bf16 v[24:27], v[188:191], v[84:87], v[24:27]
    ds_read_b64_tr_b16 v[80:81], v2 offset:0
    ds_read_b64_tr_b16 v[82:83], v2 offset:512
    v_mfma_f32_16x16x32_bf16 v[28:31], v[204:207], v[84:87], v[28:31]
    s_mov_b64 vcc, s[62:63]
    v_cndmask_b32_dpp v228, v224, v228, vcc quad_perm:[1,0,3,2] row_mask:0xf bank_mask:0xf
    v_cndmask_b32_dpp v229, v225, v229, vcc quad_perm:[1,0,3,2] row_mask:0xf bank_mask:0xf
    v_cndmask_b32_dpp v230, v226, v230, vcc quad_perm:[1,0,3,2] row_mask:0xf bank_mask:0xf
    v_cndmask_b32_dpp v231, v227, v231, vcc quad_perm:[1,0,3,2] row_mask:0xf bank_mask:0xf
    s_add_u32 m0, s15, 104448
    s_add_u32 s41, s88, 1048576
    buffer_load_dwordx4 v3, s[52:55], s41 offen nt lds
    s_mov_b64 exec, 15
    s_add_u32 s94, s100, 2097152
    buffer_load_dword v9, v11, s[48:51], s94 offen
    s_mov_b64 exec, -1
    s_waitcnt lgkmcnt(10)
    v_mfma_f32_16x16x32_bf16 v[32:35], v[188:191], v[88:91], v[32:35]
    ds_read_b64_tr_b16 v[84:85], v2 offset:32
    ds_read_b64_tr_b16 v[86:87], v2 offset:544
    v_mfma_f32_16x16x32_bf16 v[36:39], v[204:207], v[88:91], v[36:39]
    s_mov_b64 vcc, s[60:61]
    v_cndmask_b32_dpp v224, v236, v232, vcc quad_perm:[1,0,3,2] row_mask:0xf bank_mask:0xf
    v_cndmask_b32_dpp v225, v237, v233, vcc quad_perm:[1,0,3,2] row_mask:0xf bank_mask:0xf
    v_cndmask_b32_dpp v226, v238, v234, vcc quad_perm:[1,0,3,2] row_mask:0xf bank_mask:0xf
    v_cndmask_b32_dpp v227, v239, v235, vcc quad_perm:[1,0,3,2] row_mask:0xf bank_mask:0xf
    s_mov_b64 vcc, s[62:63]
    v_cndmask_b32_dpp v236, v232, v236, vcc quad_perm:[1,0,3,2] row_mask:0xf bank_mask:0xf
    v_cndmask_b32_dpp v237, v233, v237, vcc quad_perm:[1,0,3,2] row_mask:0xf bank_mask:0xf
    v_cndmask_b32_dpp v238, v234, v238, vcc quad_perm:[1,0,3,2] row_mask:0xf bank_mask:0xf
    v_cndmask_b32_dpp v239, v235, v239, vcc quad_perm:[1,0,3,2] row_mask:0xf bank_mask:0xf
    s_add_u32 m0, s15, 105504
    s_add_u32 s41, s88, 1056768
    buffer_load_dwordx4 v3, s[52:55], s41 offen nt lds
    v_mfma_f32_16x16x32_bf16 v[40:43], v[188:191], v[92:95], v[40:43]
    ds_read_b64_tr_b16 v[88:89], v2 offset:64
    ds_read_b64_tr_b16 v[90:91], v2 offset:576
    v_mfma_f32_16x16x32_bf16 v[44:47], v[204:207], v[92:95], v[44:47]
    s_mov_b64 vcc, s[64:65]
    v_cndmask_b32_dpp v232, v236, v228, vcc quad_perm:[2,3,0,1] row_mask:0xf bank_mask:0xf
    v_cndmask_b32_dpp v233, v237, v229, vcc quad_perm:[2,3,0,1] row_mask:0xf bank_mask:0xf
    v_cndmask_b32_dpp v234, v238, v230, vcc quad_perm:[2,3,0,1] row_mask:0xf bank_mask:0xf
    v_cndmask_b32_dpp v235, v239, v231, vcc quad_perm:[2,3,0,1] row_mask:0xf bank_mask:0xf
    s_waitcnt lgkmcnt(10)
    v_mfma_f32_16x16x32_bf16 v[48:51], v[188:191], v[96:99], v[48:51]
    ds_read_b64_tr_b16 v[92:93], v2 offset:96
    ds_read_b64_tr_b16 v[94:95], v2 offset:608
    v_mfma_f32_16x16x32_bf16 v[52:55], v[204:207], v[96:99], v[52:55]
    s_mov_b64 vcc, s[66:67]
    v_cndmask_b32_dpp v236, v228, v236, vcc quad_perm:[2,3,0,1] row_mask:0xf bank_mask:0xf
    v_cndmask_b32_dpp v237, v229, v237, vcc quad_perm:[2,3,0,1] row_mask:0xf bank_mask:0xf
    v_cndmask_b32_dpp v238, v230, v238, vcc quad_perm:[2,3,0,1] row_mask:0xf bank_mask:0xf
    v_cndmask_b32_dpp v239, v231, v239, vcc quad_perm:[2,3,0,1] row_mask:0xf bank_mask:0xf
    s_add_u32 m0, s15, 106560
    s_add_u32 s41, s88, 1064960
    buffer_load_dwordx4 v3, s[52:55], s41 offen nt lds
    v_mfma_f32_16x16x32_bf16 v[56:59], v[188:191], v[100:103], v[56:59]
    ds_read_b64_tr_b16 v[96:97], v2 offset:128
    ds_read_b64_tr_b16 v[98:99], v2 offset:640
    v_mfma_f32_16x16x32_bf16 v[60:63], v[204:207], v[100:103], v[60:63]
    s_mov_b64 vcc, s[64:65]
    v_cndmask_b32_dpp v228, v224, v252, vcc quad_perm:[2,3,0,1] row_mask:0xf bank_mask:0xf
    v_cndmask_b32_dpp v229, v225, v253, vcc quad_perm:[2,3,0,1] row_mask:0xf bank_mask:0xf
    v_cndmask_b32_dpp v230, v226, v254, vcc quad_perm:[2,3,0,1] row_mask:0xf bank_mask:0xf
    v_cndmask_b32_dpp v231, v227, v255, vcc quad_perm:[2,3,0,1] row_mask:0xf bank_mask:0xf
    s_add_u32 m0, s15, 107616
    s_add_u32 s41, s88, 1073152
    buffer_load_dwordx4 v3, s[52:55], s41 offen nt lds
    s_waitcnt lgkmcnt(10)
    v_mfma_f32_16x16x32_bf16 v[64:67], v[188:191], v[104:107], v[64:67]
    ds_read_b64_tr_b16 v[100:101], v2 offset:160
    ds_read_b64_tr_b16 v[102:103], v2 offset:672
    v_mfma_f32_16x16x32_bf16 v[68:71], v[204:207], v[104:107], v[68:71]
    s_mov_b64 vcc, s[66:67]
    v_cndmask_b32_dpp v224, v252, v224, vcc quad_perm:[2,3,0,1] row_mask:0xf bank_mask:0xf
    v_cndmask_b32_dpp v225, v253, v225, vcc quad_perm:[2,3,0,1] row_mask:0xf bank_mask:0xf
    v_cndmask_b32_dpp v226, v254, v226, vcc quad_perm:[2,3,0,1] row_mask:0xf bank_mask:0xf
    v_cndmask_b32_dpp v227, v255, v227, vcc quad_perm:[2,3,0,1] row_mask:0xf bank_mask:0xf
    v_mfma_f32_16x16x32_bf16 v[72:75], v[188:191], v[108:111], v[72:75]
    ds_read_b64_tr_b16 v[104:105], v2 offset:192
    ds_read_b64_tr_b16 v[106:107], v2 offset:704
    v_mfma_f32_16x16x32_bf16 v[76:79], v[204:207], v[108:111], v[76:79]
    s_mov_b64 exec, 15
    s_add_u32 s94, s100, 3145728
    buffer_load_dword v9, v11, s[48:51], s94 offen
    s_mov_b64 exec, -1
    s_waitcnt lgkmcnt(10)
    v_mfma_f32_16x16x32_bf16 v[112:115], v[80:83], v[212:215], v[112:115]
    ds_read_b64_tr_b16 v[108:109], v2 offset:224
    ds_read_b64_tr_b16 v[110:111], v2 offset:736
    v_mfma_f32_16x16x32_bf16 v[120:123], v[80:83], v[228:231], v[120:123]
    v_mfma_f32_16x16x32_bf16 v[116:119], v[84:87], v[212:215], v[116:119]
    ds_read_b64_tr_b16 v[80:81], v2 offset:8448
    ds_read_b64_tr_b16 v[82:83], v2 offset:8960
    v_mfma_f32_16x16x32_bf16 v[124:127], v[84:87], v[228:231], v[124:127]
    s_waitcnt vmcnt(10)
    s_lshl_b32 s92, s2, 2
    s_add_u32 s92, s92, 794624
    s_cmp_eq_u32 s3, 0
    s_cselect_b32 s92, s92, s82
    v_mov_b32 v7, 0
    v_mov_b32 v8, s91
    s_mov_b64 exec, 1
    buffer_store_dword v8, v7, s[16:19], s92 offen sc1
    s_mov_b64 exec, -1
    s_waitcnt lgkmcnt(10)
    v_mfma_f32_16x16x32_bf16 v[128:131], v[88:91], v[212:215], v[128:131]
    ds_read_b64_tr_b16 v[84:85], v2 offset:8480
    ds_read_b64_tr_b16 v[86:87], v2 offset:8992
    v_mfma_f32_16x16x32_bf16 v[136:139], v[88:91], v[228:231], v[136:139]
    v_mfma_f32_16x16x32_bf16 v[132:135], v[92:95], v[212:215], v[132:135]
    ds_read_b64_tr_b16 v[88:89], v2 offset:8512
    ds_read_b64_tr_b16 v[90:91], v2 offset:9024
    v_mfma_f32_16x16x32_bf16 v[140:143], v[92:95], v[228:231], v[140:143]
    s_waitcnt lgkmcnt(10)
    v_mfma_f32_16x16x32_bf16 v[144:147], v[96:99], v[212:215], v[144:147]
    ds_read_b64_tr_b16 v[92:93], v2 offset:8544
    ds_read_b64_tr_b16 v[94:95], v2 offset:9056
    v_mfma_f32_16x16x32_bf16 v[152:155], v[96:99], v[228:231], v[152:155]
    s_waitcnt vmcnt(8)
    v_lshlrev_b32 v246, 16, v240
    v_and_b32 v247, 0xffff0000, v240
    v_add_f32 v5, v246, v247
    buffer_load_dwordx4 v[176:179], v14, s[72:75], s89 offen offset:512
    v_mfma_f32_16x16x32_bf16 v[148:151], v[100:103], v[212:215], v[148:151]
    ds_read_b64_tr_b16 v[96:97], v2 offset:8576
    ds_read_b64_tr_b16 v[98:99], v2 offset:9088
    v_mfma_f32_16x16x32_bf16 v[156:159], v[100:103], v[228:231], v[156:159]
    v_lshlrev_b32 v246, 16, v241
    v_and_b32 v247, 0xffff0000, v241
    v_add_f32 v5, v5, v246
    buffer_load_dwordx4 v[180:183], v14, s[72:75], s89 offen offset:1536
    s_waitcnt lgkmcnt(10)
    v_mfma_f32_16x16x32_bf16 v[160:163], v[104:107], v[212:215], v[160:163]
    ds_read_b64_tr_b16 v[100:101], v2 offset:8608
    ds_read_b64_tr_b16 v[102:103], v2 offset:9120
    v_mfma_f32_16x16x32_bf16 v[168:171], v[104:107], v[228:231], v[168:171]
    v_add_f32 v5, v5, v247
    v_lshlrev_b32 v246, 16, v242
    v_and_b32 v247, 0xffff0000, v242
    s_mov_b64 exec, 15
    s_add_u32 s94, s100, 2097152
    buffer_load_dword v9, v11, s[52:55], s94 offen
    s_mov_b64 exec, -1
    v_mfma_f32_16x16x32_bf16 v[164:167], v[108:111], v[212:215], v[164:167]
    ds_read_b64_tr_b16 v[104:105], v2 offset:8640
    ds_read_b64_tr_b16 v[106:107], v2 offset:9152
    v_mfma_f32_16x16x32_bf16 v[172:175], v[108:111], v[228:231], v[172:175]
    v_add_f32 v5, v5, v246
    v_add_f32 v5, v5, v247
    v_lshlrev_b32 v246, 16, v243
    v_and_b32 v247, 0xffff0000, v243
    buffer_load_dwordx4 v[184:187], v14, s[72:75], s89 offen offset:2560
    s_waitcnt lgkmcnt(10)
    v_mfma_f32_16x16x32_bf16 v[112:115], v[80:83], v[216:219], v[112:115]
    ds_read_b64_tr_b16 v[108:109], v2 offset:8672
    ds_read_b64_tr_b16 v[110:111], v2 offset:9184
    v_mfma_f32_16x16x32_bf16 v[120:123], v[80:83], v[232:235], v[120:123]
    v_add_f32 v5, v5, v246
    v_add_f32 v5, v5, v247
    v_lshlrev_b32 v246, 16, v244
    buffer_load_dwordx4 v[188:191], v14, s[72:75], s89 offen offset:3584
    v_mfma_f32_16x16x32_bf16 v[116:119], v[84:87], v[216:219], v[116:119]
    ds_read_b64_tr_b16 v[80:81], v2 offset:16896
    ds_read_b64_tr_b16 v[82:83], v2 offset:17408
    v_mfma_f32_16x16x32_bf16 v[124:127], v[84:87], v[232:235], v[124:127]
    v_and_b32 v247, 0xffff0000, v244
    v_add_f32 v5, v5, v246
    v_add_f32 v5, v5, v247
    s_waitcnt lgkmcnt(10)
    v_mfma_f32_16x16x32_bf16 v[128:131], v[88:91], v[216:219], v[128:131]
    ds_read_b64_tr_b16 v[84:85], v2 offset:16928
    ds_read_b64_tr_b16 v[86:87], v2 offset:17440
    v_mfma_f32_16x16x32_bf16 v[136:139], v[88:91], v[232:235], v[136:139]
    v_lshlrev_b32 v246, 16, v245
    v_and_b32 v247, 0xffff0000, v245
    v_add_f32 v5, v5, v246
    v_add_f32 v5, v5, v247
    buffer_load_dwordx4 v[192:195], v14, s[72:75], s39 offen offset:512
    v_mfma_f32_16x16x32_bf16 v[132:135], v[92:95], v[216:219], v[132:135]
    ds_read_b64_tr_b16 v[88:89], v2 offset:16960
    ds_read_b64_tr_b16 v[90:91], v2 offset:17472
    v_mfma_f32_16x16x32_bf16 v[140:143], v[92:95], v[232:235], v[140:143]
    v_add_f32_dpp v5, v5, v5 quad_perm:[1,0,3,2] row_mask:0xf bank_mask:0xf
    s_nop 1
    v_add_f32_dpp v5, v5, v5 quad_perm:[2,3,0,1] row_mask:0xf bank_mask:0xf
    s_nop 1
    v_add_f32_dpp v5, v5, v5 row_half_mirror row_mask:0xf bank_mask:0xf
    s_waitcnt lgkmcnt(10)
    v_mfma_f32_16x16x32_bf16 v[144:147], v[96:99], v[216:219], v[144:147]
    ds_read_b64_tr_b16 v[92:93], v2 offset:16992
    ds_read_b64_tr_b16 v[94:95], v2 offset:17504
    v_mfma_f32_16x16x32_bf16 v[152:155], v[96:99], v[232:235], v[152:155]
    v_add_f32_dpp v5, v5, v5 row_mirror row_mask:0xf bank_mask:0xf
    v_mov_b32 v6, v5
    s_nop 1
    v_permlane16_swap_b32 v5, v6
    buffer_load_dwordx4 v[196:199], v14, s[72:75], s39 offen offset:1536
    s_mov_b64 exec, 15
    s_add_u32 s94, s100, 3145728
    buffer_load_dword v9, v11, s[52:55], s94 offen
    s_mov_b64 exec, -1
    v_mfma_f32_16x16x32_bf16 v[148:151], v[100:103], v[216:219], v[148:151]
    ds_read_b64_tr_b16 v[96:97], v2 offset:17024
    ds_read_b64_tr_b16 v[98:99], v2 offset:17536
    v_mfma_f32_16x16x32_bf16 v[156:159], v[100:103], v[232:235], v[156:159]
    v_add_f32 v5, v5, v6
    v_mov_b32 v6, v5
    s_nop 1
    v_permlane32_swap_b32 v5, v6
    buffer_load_dwordx4 v[200:203], v14, s[72:75], s39 offen offset:2560
    s_waitcnt lgkmcnt(10)
    v_mfma_f32_16x16x32_bf16 v[160:163], v[104:107], v[216:219], v[160:163]
    ds_read_b64_tr_b16 v[100:101], v2 offset:17056
    ds_read_b64_tr_b16 v[102:103], v2 offset:17568
    v_mfma_f32_16x16x32_bf16 v[168:171], v[104:107], v[232:235], v[168:171]
    v_add_f32 v5, v5, v6
    v_mul_f32 v5, 0x3acccccd, v5
    v_mov_b32 v250, 0
    v_mov_b32 v251, 0
    v_mfma_f32_16x16x32_bf16 v[164:167], v[108:111], v[216:219], v[164:167]
    ds_read_b64_tr_b16 v[104:105], v2 offset:17088
    ds_read_b64_tr_b16 v[106:107], v2 offset:17600
    v_mfma_f32_16x16x32_bf16 v[172:175], v[108:111], v[232:235], v[172:175]
    v_lshlrev_b32 v246, 16, v240
    v_and_b32 v247, 0xffff0000, v240
    v_sub_f32 v246, v246, v5
    buffer_load_dwordx4 v[204:207], v14, s[72:75], s39 offen offset:3584
    s_waitcnt lgkmcnt(10)
    v_mfma_f32_16x16x32_bf16 v[112:115], v[80:83], v[208:211], v[112:115]
    ds_read_b64_tr_b16 v[108:109], v2 offset:17120
    ds_read_b64_tr_b16 v[110:111], v2 offset:17632
    v_mfma_f32_16x16x32_bf16 v[120:123], v[80:83], v[224:227], v[120:123]
    v_sub_f32 v247, v247, v5
    v_fmac_f32 v250, v246, v246
    v_fmac_f32 v250, v247, v247
    v_mfma_f32_16x16x32_bf16 v[116:119], v[84:87], v[208:211], v[116:119]
    ds_read_b64_tr_b16 v[80:81], v2 offset:25344
    ds_read_b64_tr_b16 v[82:83], v2 offset:25856
    v_mfma_f32_16x16x32_bf16 v[124:127], v[84:87], v[224:227], v[124:127]
    v_lshlrev_b32 v246, 16, v241
    v_and_b32 v247, 0xffff0000, v241
    v_sub_f32 v246, v246, v5
    v_sub_f32 v247, v247, v5
    s_waitcnt lgkmcnt(10)
    v_mfma_f32_16x16x32_bf16 v[128:131], v[88:91], v[208:211], v[128:131]
    ds_read_b64_tr_b16 v[84:85], v2 offset:25376
    ds_read_b64_tr_b16 v[86:87], v2 offset:25888
    v_mfma_f32_16x16x32_bf16 v[136:139], v[88:91], v[224:227], v[136:139]
    v_fmac_f32 v250, v246, v246
    v_fmac_f32 v250, v247, v247
    v_lshlrev_b32 v246, 16, v242
    s_mov_b64 exec, 15
    s_add_u32 s94, s100, 0
    buffer_load_dword v9, v11, s[20:23], s94 offen
    s_mov_b64 exec, -1
    v_mfma_f32_16x16x32_bf16 v[132:135], v[92:95], v[208:211], v[132:135]
    ds_read_b64_tr_b16 v[88:89], v2 offset:25408
    ds_read_b64_tr_b16 v[90:91], v2 offset:25920
    v_mfma_f32_16x16x32_bf16 v[140:143], v[92:95], v[224:227], v[140:143]
    v_and_b32 v247, 0xffff0000, v242
    v_sub_f32 v246, v246, v5
    v_sub_f32 v247, v247, v5
    s_waitcnt lgkmcnt(10)
    v_mfma_f32_16x16x32_bf16 v[144:147], v[96:99], v[208:211], v[144:147]
    ds_read_b64_tr_b16 v[92:93], v2 offset:25440
    ds_read_b64_tr_b16 v[94:95], v2 offset:25952
    v_mfma_f32_16x16x32_bf16 v[152:155], v[96:99], v[224:227], v[152:155]
    v_fmac_f32 v250, v246, v246
    v_fmac_f32 v250, v247, v247
    v_lshlrev_b32 v246, 16, v243
    v_and_b32 v247, 0xffff0000, v243
    v_mfma_f32_16x16x32_bf16 v[148:151], v[100:103], v[208:211], v[148:151]
    ds_read_b64_tr_b16 v[96:97], v2 offset:25472
    ds_read_b64_tr_b16 v[98:99], v2 offset:25984
    v_mfma_f32_16x16x32_bf16 v[156:159], v[100:103], v[224:227], v[156:159]
    v_sub_f32 v246, v246, v5
    v_sub_f32 v247, v247, v5
    v_fmac_f32 v250, v246, v246
    s_waitcnt lgkmcnt(10)
    v_mfma_f32_16x16x32_bf16 v[160:163], v[104:107], v[208:211], v[160:163]
    ds_read_b64_tr_b16 v[100:101], v2 offset:25504
    ds_read_b64_tr_b16 v[102:103], v2 offset:26016
    v_mfma_f32_16x16x32_bf16 v[168:171], v[104:107], v[224:227], v[168:171]
    v_fmac_f32 v250, v247, v247
    v_lshlrev_b32 v246, 16, v244
    v_and_b32 v247, 0xffff0000, v244
    v_mfma_f32_16x16x32_bf16 v[164:167], v[108:111], v[208:211], v[164:167]
    ds_read_b64_tr_b16 v[104:105], v2 offset:25536
    ds_read_b64_tr_b16 v[106:107], v2 offset:26048
    v_mfma_f32_16x16x32_bf16 v[172:175], v[108:111], v[224:227], v[172:175]
    v_sub_f32 v246, v246, v5
    v_sub_f32 v247, v247, v5
    v_fmac_f32 v251, v246, v246
    s_mov_b64 exec, 15
    s_add_u32 s94, s100, 1048576
    buffer_load_dword v9, v11, s[20:23], s94 offen
    s_mov_b64 exec, -1
    s_waitcnt lgkmcnt(10)
    v_mfma_f32_16x16x32_bf16 v[112:115], v[80:83], v[220:223], v[112:115]
    ds_read_b64_tr_b16 v[108:109], v2 offset:25568
    ds_read_b64_tr_b16 v[110:111], v2 offset:26080
    v_mfma_f32_16x16x32_bf16 v[120:123], v[80:83], v[236:239], v[120:123]
    v_add_u32 v2, s11, v1
    s_waitcnt vmcnt(14)
    s_barrier
    v_fmac_f32 v251, v247, v247
    v_lshlrev_b32 v246, 16, v245
    v_and_b32 v247, 0xffff0000, v245
    v_sub_f32 v246, v246, v5
    v_mfma_f32_16x16x32_bf16 v[116:119], v[84:87], v[220:223], v[116:119]
    ds_read_b64_tr_b16 v[80:81], v2 offset:0
    ds_read_b64_tr_b16 v[82:83], v2 offset:512
    v_mfma_f32_16x16x32_bf16 v[124:127], v[84:87], v[236:239], v[124:127]
    v_sub_f32 v247, v247, v5
    v_fmac_f32 v251, v246, v246
    v_fmac_f32 v251, v247, v247
    s_mov_b32 s93, 794624
    s_cmp_lt_u32 s2, 4
    s_movk_i32 s92, 304
    s_cselect_b32 s92, 944, s92
    v_min_u32 v13, s92, v4
    buffer_load_dwordx4 v[252:255], v13, s[16:19], s93 offen sc1
    s_waitcnt lgkmcnt(10)
    v_mfma_f32_16x16x32_bf16 v[128:131], v[88:91], v[220:223], v[128:131]
    ds_read_b64_tr_b16 v[84:85], v2 offset:32
    ds_read_b64_tr_b16 v[86:87], v2 offset:544
    v_mfma_f32_16x16x32_bf16 v[136:139], v[88:91], v[236:239], v[136:139]
    v_cndmask_b32 v251, 0, v251, s[44:45]
    v_add_f32 v250, v250, v251
    s_nop 1
    v_add_f32_dpp v250, v250, v250 quad_perm:[1,0,3,2] row_mask:0xf bank_mask:0xf
    s_add_u32 m0, s14, 0
    s_add_u32 s41, s88, 2097152
    buffer_load_dwordx4 v3, s[48:51], s41 offen nt lds
    v_mfma_f32_16x16x32_bf16 v[132:135], v[92:95], v[220:223], v[132:135]
    ds_read_b64_tr_b16 v[88:89], v2 offset:64
    ds_read_b64_tr_b16 v[90:91], v2 offset:576
    v_mfma_f32_16x16x32_bf16 v[140:143], v[92:95], v[236:239], v[140:143]
    v_add_f32_dpp v250, v250, v250 quad_perm:[2,3,0,1] row_mask:0xf bank_mask:0xf
    s_nop 1
    v_add_f32_dpp v250, v250, v250 row_half_mirror row_mask:0xf bank_mask:0xf
    s_nop 1
    v_add_f32_dpp v250, v250, v250 row_mirror row_mask:0xf bank_mask:0xf
    v_mov_b32 v6, v250
    s_add_u32 m0, s14, 1056
    s_add_u32 s41, s88, 2105344
    buffer_load_dwordx4 v3, s[48:51], s41 offen nt lds
    s_waitcnt lgkmcnt(10)
    v_mfma_f32_16x16x32_bf16 v[144:147], v[96:99], v[220:223], v[144:147]
    ds_read_b64_tr_b16 v[92:93], v2 offset:96
    ds_read_b64_tr_b16 v[94:95], v2 offset:608
    v_mfma_f32_16x16x32_bf16 v[152:155], v[96:99], v[236:239], v[152:155]
    v_permlane16_swap_b32 v250, v6
    v_add_f32 v250, v250, v6
    v_mov_b32 v6, v250
    v_mfma_f32_16x16x32_bf16 v[148:151], v[100:103], v[220:223], v[148:151]
    ds_read_b64_tr_b16 v[96:97], v2 offset:128
    ds_read_b64_tr_b16 v[98:99], v2 offset:640
    v_mfma_f32_16x16x32_bf16 v[156:159], v[100:103], v[236:239], v[156:159]
    v_permlane32_swap_b32 v250, v6
    v_add_f32 v250, v250, v6
    v_mov_b32 v6, 0x3727c5ac
    s_add_u32 m0, s14, 2112
    s_add_u32 s41, s88, 2113536
    buffer_load_dwordx4 v3, s[48:51], s41 offen nt lds
    s_waitcnt lgkmcnt(10)
    v_mfma_f32_16x16x32_bf16 v[160:163], v[104:107], v[220:223], v[160:163]
    ds_read_b64_tr_b16 v[100:101], v2 offset:160
    ds_read_b64_tr_b16 v[102:103], v2 offset:672
    v_mfma_f32_16x16x32_bf16 v[168:171], v[104:107], v[236:239], v[168:171]
    v_fmac_f32 v6, 0x3acccccd, v250
    v_rsq_f32 v251, v6
    s_nop 0
    v_mul_f32 v5, v5, v251
    s_add_u32 m0, s14, 3168
    s_add_u32 s41, s88, 2121728
    buffer_load_dwordx4 v3, s[48:51], s41 offen nt lds
    v_mfma_f32_16x16x32_bf16 v[164:167], v[108:111], v[220:223], v[164:167]
    ds_read_b64_tr_b16 v[104:105], v2 offset:192
    ds_read_b64_tr_b16 v[106:107], v2 offset:704
    v_mfma_f32_16x16x32_bf16 v[172:175], v[108:111], v[236:239], v[172:175]
    s_waitcnt vmcnt(4)
    v_xor_b32 v252, s91, v252
    v_xor_b32 v253, s91, v253
    v_xor_b32 v254, s91, v254
    v_xor_b32 v255, s91, v255
    v_or3_b32 v252, v252, v253, v254
    v_or_b32 v252, v252, v255
    v_cmp_ne_u32 vcc, 0, v252
    s_cbranch_vccnz FM_slow
FM_ok:
    s_mul_i32 s43, s2, 3072
    s_cmp_lt_u32 s2, 4
    s_cselect_b32 s43, s43, 0x70000000
    s_cmp_lt_u32 s3, 5
    s_cselect_b32 s43, 0, s43
    v_lshlrev_b32 v7, 4, v0
    v_add_u32 v7, s43, v7
    s_mov_b32 s46, 393216
    s_mov_b32 s47, 408576
    buffer_load_dwordx4 v[252:255], v7, s[16:19], s46 offen sc1
    buffer_load_dwordx4 v[246:249], v7, s[16:19], s47 offen sc1
    s_waitcnt lgkmcnt(10)
    v_mfma_f32_16x16x32_bf16 v[16:19], v[212:215], v[80:83], v[16:19]
    ds_read_b64_tr_b16 v[108:109], v2 offset:224
    ds_read_b64_tr_b16 v[110:111], v2 offset:736
    v_mfma_f32_16x16x32_bf16 v[20:23], v[228:231], v[80:83], v[20:23]
    v_mfma_f32_16x16x32_bf16 v[24:27], v[212:215], v[84:87], v[24:27]
    ds_read_b64_tr_b16 v[80:81], v2 offset:8448
    ds_read_b64_tr_b16 v[82:83], v2 offset:8960
    v_mfma_f32_16x16x32_bf16 v[28:31], v[228:231], v[84:87], v[28:31]
    s_waitcnt lgkmcnt(10)
    v_mfma_f32_16x16x32_bf16 v[32:35], v[212:215], v[88:91], v[32:35]
    ds_read_b64_tr_b16 v[84:85], v2 offset:8480
    ds_read_b64_tr_b16 v[86:87], v2 offset:8992
    v_mfma_f32_16x16x32_bf16 v[36:39], v[228:231], v[88:91], v[36:39]
    v_mfma_f32_16x16x32_bf16 v[40:43], v[212:215], v[92:95], v[40:43]
    ds_read_b64_tr_b16 v[88:89], v2 offset:8512
    ds_read_b64_tr_b16 v[90:91], v2 offset:9024
    v_mfma_f32_16x16x32_bf16 v[44:47], v[228:231], v[92:95], v[44:47]
    s_waitcnt vmcnt(0)
    v_add_f32 v246, v246, v252
    v_add_f32 v247, v247, v253
    s_waitcnt lgkmcnt(10)
    v_mfma_f32_16x16x32_bf16 v[48:51], v[212:215], v[96:99], v[48:51]
    ds_read_b64_tr_b16 v[92:93], v2 offset:8544
    ds_read_b64_tr_b16 v[94:95], v2 offset:9056
    v_mfma_f32_16x16x32_bf16 v[52:55], v[228:231], v[96:99], v[52:55]
    v_add_f32 v248, v248, v254
    v_add_f32 v249, v249, v255
    s_mov_b32 s46, 423936
    s_mov_b32 s47, 439296
    buffer_load_dwordx4 v[252:255], v7, s[16:19], s46 offen sc1
    v_mfma_f32_16x16x32_bf16 v[56:59], v[212:215], v[100:103], v[56:59]
    ds_read_b64_tr_b16 v[96:97], v2 offset:8576
    ds_read_b64_tr_b16 v[98:99], v2 offset:9088
    v_mfma_f32_16x16x32_bf16 v[60:63], v[228:231], v[100:103], v[60:63]
    s_waitcnt lgkmcnt(10)
    v_mfma_f32_16x16x32_bf16 v[64:67], v[212:215], v[104:107], v[64:67]
    ds_read_b64_tr_b16 v[100:101], v2 offset:8608
    ds_read_b64_tr_b16 v[102:103], v2 offset:9120
    v_mfma_f32_16x16x32_bf16 v[68:71], v[228:231], v[104:107], v[68:71]
    v_mfma_f32_16x16x32_bf16 v[72:75], v[212:215], v[108:111], v[72:75]
    ds_read_b64_tr_b16 v[104:105], v2 offset:8640
    ds_read_b64_tr_b16 v[106:107], v2 offset:9152
    v_mfma_f32_16x16x32_bf16 v[76:79], v[228:231], v[108:111], v[76:79]
    s_waitcnt vmcnt(0)
    v_add_f32 v246, v246, v252
    v_add_f32 v247, v247, v253
    s_waitcnt lgkmcnt(10)
    v_mfma_f32_16x16x32_bf16 v[16:19], v[216:219], v[80:83], v[16:19]
    ds_read_b64_tr_b16 v[108:109], v2 offset:8672
    ds_read_b64_tr_b16 v[110:111], v2 offset:9184
    v_mfma_f32_16x16x32_bf16 v[20:23], v[232:235], v[80:83], v[20:23]
    v_add_f32 v248, v248, v254
    v_add_f32 v249, v249, v255
    buffer_load_dwordx4 v[252:255], v7, s[16:19], s47 offen sc1
    v_mfma_f32_16x16x32_bf16 v[24:27], v[216:219], v[84:87], v[24:27]
    ds_read_b64_tr_b16 v[80:81], v2 offset:16896
    ds_read_b64_tr_b16 v[82:83], v2 offset:17408
    v_mfma_f32_16x16x32_bf16 v[28:31], v[232:235], v[84:87], v[28:31]
    s_waitcnt lgkmcnt(10)
    v_mfma_f32_16x16x32_bf16 v[32:35], v[216:219], v[88:91], v[32:35]
    ds_read_b64_tr_b16 v[84:85], v2 offset:16928
    ds_read_b64_tr_b16 v[86:87], v2 offset:17440
    v_mfma_f32_16x16x32_bf16 v[36:39], v[232:235], v[88:91], v[36:39]
    v_mfma_f32_16x16x32_bf16 v[40:43], v[216:219], v[92:95], v[40:43]
    ds_read_b64_tr_b16 v[88:89], v2 offset:16960
    ds_read_b64_tr_b16 v[90:91], v2 offset:17472
    v_mfma_f32_16x16x32_bf16 v[44:47], v[232:235], v[92:95], v[44:47]
    s_waitcnt vmcnt(0)
    v_add_f32 v246, v246, v252
    v_add_f32 v247, v247, v253
    v_add_f32 v248, v248, v254
    v_add_f32 v249, v249, v255
    v_cvt_pk_bf16_f32 v252, v246, v247
    v_cvt_pk_bf16_f32 v253, v248, v249
    v_subrev_u32 v6, 2560, v7
    s_waitcnt lgkmcnt(10)
    v_mfma_f32_16x16x32_bf16 v[48:51], v[216:219], v[96:99], v[48:51]
    ds_read_b64_tr_b16 v[92:93], v2 offset:16992
    ds_read_b64_tr_b16 v[94:95], v2 offset:17504
    v_mfma_f32_16x16x32_bf16 v[52:55], v[232:235], v[96:99], v[52:55]
    v_subrev_u32 v250, 10240, v7
    v_min_u32 v6, v6, v250
    s_movk_i32 s46, 2560
    v_cmp_gt_u32 s[46:47], s46, v6
    v_lshlrev_b32 v246, 16, v252
    v_and_b32 v247, 0xffff0000, v252
    v_cndmask_b32 v6, 0, 1.0, s[46:47]
    s_mov_b64 exec, 15
    s_add_u32 s94, s100, 2097152
    buffer_load_dword v9, v11, s[20:23], s94 offen
    s_mov_b64 exec, -1
    v_mfma_f32_16x16x32_bf16 v[56:59], v[216:219], v[100:103], v[56:59]
    ds_read_b64_tr_b16 v[96:97], v2 offset:17024
    ds_read_b64_tr_b16 v[98:99], v2 offset:17536
    v_mfma_f32_16x16x32_bf16 v[60:63], v[232:235], v[100:103], v[60:63]
    v_lshlrev_b32 v248, 16, v253
    v_and_b32 v249, 0xffff0000, v253
    v_add_f32 v246, v246, v6
    v_add_f32 v247, v247, v6
    v_add_f32 v248, v248, v6
    v_add_f32 v249, v249, v6
    v_cvt_pk_bf16_f32 v252, v246, v247
    v_cvt_pk_bf16_f32 v253, v248, v249
    s_waitcnt lgkmcnt(10)
    v_mfma_f32_16x16x32_bf16 v[64:67], v[216:219], v[104:107], v[64:67]
    ds_read_b64_tr_b16 v[100:101], v2 offset:17056
    ds_read_b64_tr_b16 v[102:103], v2 offset:17568
    v_mfma_f32_16x16x32_bf16 v[68:71], v[232:235], v[104:107], v[68:71]
    v_lshlrev_b32 v246, 16, v252
    v_and_b32 v247, 0xffff0000, v252
    v_lshlrev_b32 v248, 16, v253
    v_and_b32 v249, 0xffff0000, v253
    s_cmp_lt_u32 s3, 5
    s_cselect_b32 s46, s82, 0
    buffer_store_dwordx4 v[246:249], v7, s[16:19], s46 offen sc1
    v_lshlrev_b32 v7, 3, v0
    v_add_u32 v7, 159744, v7
    v_mfma_f32_16x16x32_bf16 v[72:75], v[216:219], v[108:111], v[72:75]
    ds_read_b64_tr_b16 v[104:105], v2 offset:17088
    ds_read_b64_tr_b16 v[106:107], v2 offset:17600
    v_mfma_f32_16x16x32_bf16 v[76:79], v[232:235], v[108:111], v[76:79]
    ds_write_b64 v7, v[252:253]
    v_bfe_u32 v7, v0, 3, 3
    v_lshlrev_b32 v7, 9, v7
    v_and_b32 v6, 3, v0
    v_lshl_add_u32 v7, v6, 7, v7
    v_bfe_u32 v6, v0, 2, 1
    v_lshl_add_u32 v7, v6, 3, v7
    s_lshl_b32 s46, s3, 4
    s_waitcnt lgkmcnt(10)
    v_mfma_f32_16x16x32_bf16 v[16:19], v[208:211], v[80:83], v[16:19]
    ds_read_b64_tr_b16 v[108:109], v2 offset:17120
    ds_read_b64_tr_b16 v[110:111], v2 offset:17632
    v_mfma_f32_16x16x32_bf16 v[20:23], v[224:227], v[80:83], v[20:23]
    s_add_u32 s46, s46, 139264
    v_add_u32 v7, s46, v7
    v_mov_b32 v6, 0x100000
    v_cndmask_b32 v8, v6, v7, s[44:45]
    v_lshrrev_b32 v13, 1, v4
    v_add_u32 v13, 159744, v13
    s_waitcnt lgkmcnt(0)
    v_mfma_f32_16x16x32_bf16 v[24:27], v[208:211], v[84:87], v[24:27]
    ds_read_b64_tr_b16 v[80:81], v2 offset:25344
    ds_read_b64_tr_b16 v[82:83], v2 offset:25856
    v_mfma_f32_16x16x32_bf16 v[28:31], v[224:227], v[84:87], v[28:31]
    s_mov_b64 vcc, s[60:61]
    v_cndmask_b32_dpp v252, v180, v176, vcc quad_perm:[1,0,3,2] row_mask:0xf bank_mask:0xf
    v_cndmask_b32_dpp v253, v181, v177, vcc quad_perm:[1,0,3,2] row_mask:0xf bank_mask:0xf
    v_cndmask_b32_dpp v254, v182, v178, vcc quad_perm:[1,0,3,2] row_mask:0xf bank_mask:0xf
    v_cndmask_b32_dpp v255, v183, v179, vcc quad_perm:[1,0,3,2] row_mask:0xf bank_mask:0xf
    s_mov_b64 vcc, s[62:63]
    v_cndmask_b32_dpp v180, v176, v180, vcc quad_perm:[1,0,3,2] row_mask:0xf bank_mask:0xf
    v_cndmask_b32_dpp v181, v177, v181, vcc quad_perm:[1,0,3,2] row_mask:0xf bank_mask:0xf
    v_cndmask_b32_dpp v182, v178, v182, vcc quad_perm:[1,0,3,2] row_mask:0xf bank_mask:0xf
    v_cndmask_b32_dpp v183, v179, v183, vcc quad_perm:[1,0,3,2] row_mask:0xf bank_mask:0xf
    s_add_u32 m0, s14, 34816
    s_add_u32 s41, s88, 3145728
    buffer_load_dwordx4 v3, s[48:51], s41 offen nt lds
    s_mov_b64 exec, 15
    s_add_u32 s94, s100, 3145728
    buffer_load_dword v9, v11, s[20:23], s94 offen
    s_mov_b64 exec, -1
    s_waitcnt lgkmcnt(10)
    v_mfma_f32_16x16x32_bf16 v[32:35], v[208:211], v[88:91], v[32:35]
    ds_read_b64_tr_b16 v[84:85], v2 offset:25376
    ds_read_b64_tr_b16 v[86:87], v2 offset:25888
    v_mfma_f32_16x16x32_bf16 v[36:39], v[224:227], v[88:91], v[36:39]
    s_mov_b64 vcc, s[60:61]
    v_cndmask_b32_dpp v176, v188, v184, vcc quad_perm:[1,0,3,2] row_mask:0xf bank_mask:0xf
    v_cndmask_b32_dpp v177, v189, v185, vcc quad_perm:[1,0,3,2] row_mask:0xf bank_mask:0xf
    v_cndmask_b32_dpp v178, v190, v186, vcc quad_perm:[1,0,3,2] row_mask:0xf bank_mask:0xf
    v_cndmask_b32_dpp v179, v191, v187, vcc quad_perm:[1,0,3,2] row_mask:0xf bank_mask:0xf
    s_add_u32 m0, s14, 35872
    s_add_u32 s41, s88, 3153920
    buffer_load_dwordx4 v3, s[48:51], s41 offen nt lds
    v_mfma_f32_16x16x32_bf16 v[40:43], v[208:211], v[92:95], v[40:43]
    ds_read_b64_tr_b16 v[88:89], v2 offset:25408
    ds_read_b64_tr_b16 v[90:91], v2 offset:25920
    v_mfma_f32_16x16x32_bf16 v[44:47], v[224:227], v[92:95], v[44:47]
    s_mov_b64 vcc, s[62:63]
    v_cndmask_b32_dpp v188, v184, v188, vcc quad_perm:[1,0,3,2] row_mask:0xf bank_mask:0xf
    v_cndmask_b32_dpp v189, v185, v189, vcc quad_perm:[1,0,3,2] row_mask:0xf bank_mask:0xf
    v_cndmask_b32_dpp v190, v186, v190, vcc quad_perm:[1,0,3,2] row_mask:0xf bank_mask:0xf
    v_cndmask_b32_dpp v191, v187, v191, vcc quad_perm:[1,0,3,2] row_mask:0xf bank_mask:0xf
    s_waitcnt lgkmcnt(10)
    v_mfma_f32_16x16x32_bf16 v[48:51], v[208:211], v[96:99], v[48:51]
    ds_read_b64_tr_b16 v[92:93], v2 offset:25440
    ds_read_b64_tr_b16 v[94:95], v2 offset:25952
    v_mfma_f32_16x16x32_bf16 v[52:55], v[224:227], v[96:99], v[52:55]
    s_mov_b64 vcc, s[64:65]
    v_cndmask_b32_dpp v184, v188, v180, vcc quad_perm:[2,3,0,1] row_mask:0xf bank_mask:0xf
    v_cndmask_b32_dpp v185, v189, v181, vcc quad_perm:[2,3,0,1] row_mask:0xf bank_mask:0xf
    v_cndmask_b32_dpp v186, v190, v182, vcc quad_perm:[2,3,0,1] row_mask:0xf bank_mask:0xf
    v_cndmask_b32_dpp v187, v191, v183, vcc quad_perm:[2,3,0,1] row_mask:0xf bank_mask:0xf
    s_add_u32 m0, s14, 36928
    s_add_u32 s41, s88, 3162112
    buffer_load_dwordx4 v3, s[48:51], s41 offen nt lds
    v_mfma_f32_16x16x32_bf16 v[56:59], v[208:211], v[100:103], v[56:59]
    ds_read_b64_tr_b16 v[96:97], v2 offset:25472
    ds_read_b64_tr_b16 v[98:99], v2 offset:25984
    v_mfma_f32_16x16x32_bf16 v[60:63], v[224:227], v[100:103], v[60:63]
    s_mov_b64 vcc, s[66:67]
    v_cndmask_b32_dpp v188, v180, v188, vcc quad_perm:[2,3,0,1] row_mask:0xf bank_mask:0xf
    v_cndmask_b32_dpp v189, v181, v189, vcc quad_perm:[2,3,0,1] row_mask:0xf bank_mask:0xf
    v_cndmask_b32_dpp v190, v182, v190, vcc quad_perm:[2,3,0,1] row_mask:0xf bank_mask:0xf
    v_cndmask_b32_dpp v191, v183, v191, vcc quad_perm:[2,3,0,1] row_mask:0xf bank_mask:0xf
    s_add_u32 m0, s14, 37984
    s_add_u32 s41, s88, 3170304
    buffer_load_dwordx4 v3, s[48:51], s41 offen nt lds
    s_waitcnt lgkmcnt(10)
    v_mfma_f32_16x16x32_bf16 v[64:67], v[208:211], v[104:107], v[64:67]
    ds_read_b64_tr_b16 v[100:101], v2 offset:25504
    ds_read_b64_tr_b16 v[102:103], v2 offset:26016
    v_mfma_f32_16x16x32_bf16 v[68:71], v[224:227], v[104:107], v[68:71]
    s_mov_b64 vcc, s[64:65]
    v_cndmask_b32_dpp v180, v176, v252, vcc quad_perm:[2,3,0,1] row_mask:0xf bank_mask:0xf
    v_cndmask_b32_dpp v181, v177, v253, vcc quad_perm:[2,3,0,1] row_mask:0xf bank_mask:0xf
    v_cndmask_b32_dpp v182, v178, v254, vcc quad_perm:[2,3,0,1] row_mask:0xf bank_mask:0xf
    v_cndmask_b32_dpp v183, v179, v255, vcc quad_perm:[2,3,0,1] row_mask:0xf bank_mask:0xf
    v_mfma_f32_16x16x32_bf16 v[72:75], v[208:211], v[108:111], v[72:75]
    ds_read_b64_tr_b16 v[104:105], v2 offset:25536
    ds_read_b64_tr_b16 v[106:107], v2 offset:26048
    v_mfma_f32_16x16x32_bf16 v[76:79], v[224:227], v[108:111], v[76:79]
    s_mov_b64 vcc, s[66:67]
    v_cndmask_b32_dpp v176, v252, v176, vcc quad_perm:[2,3,0,1] row_mask:0xf bank_mask:0xf
    v_cndmask_b32_dpp v177, v253, v177, vcc quad_perm:[2,3,0,1] row_mask:0xf bank_mask:0xf
    v_cndmask_b32_dpp v178, v254, v178, vcc quad_perm:[2,3,0,1] row_mask:0xf bank_mask:0xf
    v_cndmask_b32_dpp v179, v255, v179, vcc quad_perm:[2,3,0,1] row_mask:0xf bank_mask:0xf
    s_mov_b64 exec, 15
    s_add_u32 s94, s100, 4194304
    buffer_load_dword v9, v11, s[20:23], s94 offen
    s_mov_b64 exec, -1
    s_waitcnt lgkmcnt(10)
    v_mfma_f32_16x16x32_bf16 v[16:19], v[220:223], v[80:83], v[16:19]
    ds_read_b64_tr_b16 v[108:109], v2 offset:25568
    ds_read_b64_tr_b16 v[110:111], v2 offset:26080
    v_mfma_f32_16x16x32_bf16 v[20:23], v[236:239], v[80:83], v[20:23]
    v_add_u32 v2, s8, v1
    s_barrier
    s_mov_b64 vcc, s[60:61]
    v_cndmask_b32_dpp v252, v196, v192, vcc quad_perm:[1,0,3,2] row_mask:0xf bank_mask:0xf
    v_cndmask_b32_dpp v253, v197, v193, vcc quad_perm:[1,0,3,2] row_mask:0xf bank_mask:0xf
    v_cndmask_b32_dpp v254, v198, v194, vcc quad_perm:[1,0,3,2] row_mask:0xf bank_mask:0xf
    v_cndmask_b32_dpp v255, v199, v195, vcc quad_perm:[1,0,3,2] row_mask:0xf bank_mask:0xf
    s_mov_b64 vcc, s[62:63]
    v_cndmask_b32_dpp v196, v192, v196, vcc quad_perm:[1,0,3,2] row_mask:0xf bank_mask:0xf
    v_cndmask_b32_dpp v197, v193, v197, vcc quad_perm:[1,0,3,2] row_mask:0xf bank_mask:0xf
    v_cndmask_b32_dpp v198, v194, v198, vcc quad_perm:[1,0,3,2] row_mask:0xf bank_mask:0xf
    v_cndmask_b32_dpp v199, v195, v199, vcc quad_perm:[1,0,3,2] row_mask:0xf bank_mask:0xf
    v_mfma_f32_16x16x32_bf16 v[24:27], v[220:223], v[84:87], v[24:27]
    ds_read_b64_tr_b16 v[80:81], v2 offset:0
    ds_read_b64_tr_b16 v[82:83], v2 offset:512
    v_mfma_f32_16x16x32_bf16 v[28:31], v[236:239], v[84:87], v[28:31]
    s_mov_b64 vcc, s[60:61]
    v_cndmask_b32_dpp v192, v204, v200, vcc quad_perm:[1,0,3,2] row_mask:0xf bank_mask:0xf
    v_cndmask_b32_dpp v193, v205, v201, vcc quad_perm:[1,0,3,2] row_mask:0xf bank_mask:0xf
    v_cndmask_b32_dpp v194, v206, v202, vcc quad_perm:[1,0,3,2] row_mask:0xf bank_mask:0xf
    v_cndmask_b32_dpp v195, v207, v203, vcc quad_perm:[1,0,3,2] row_mask:0xf bank_mask:0xf
    s_waitcnt lgkmcnt(10)
    v_mfma_f32_16x16x32_bf16 v[32:35], v[220:223], v[88:91], v[32:35]
    ds_read_b64_tr_b16 v[84:85], v2 offset:32
    ds_read_b64_tr_b16 v[86:87], v2 offset:544
    v_mfma_f32_16x16x32_bf16 v[36:39], v[236:239], v[88:91], v[36:39]
    s_mov_b64 vcc, s[62:63]
    v_cndmask_b32_dpp v204, v200, v204, vcc quad_perm:[1,0,3,2] row_mask:0xf bank_mask:0xf
    v_cndmask_b32_dpp v205, v201, v205, vcc quad_perm:[1,0,3,2] row_mask:0xf bank_mask:0xf
    v_cndmask_b32_dpp v206, v202, v206, vcc quad_perm:[1,0,3,2] row_mask:0xf bank_mask:0xf
    v_cndmask_b32_dpp v207, v203, v207, vcc quad_perm:[1,0,3,2] row_mask:0xf bank_mask:0xf
    v_mfma_f32_16x16x32_bf16 v[40:43], v[220:223], v[92:95], v[40:43]
    ds_read_b64_tr_b16 v[88:89], v2 offset:64
    ds_read_b64_tr_b16 v[90:91], v2 offset:576
    v_mfma_f32_16x16x32_bf16 v[44:47], v[236:239], v[92:95], v[44:47]
    s_mov_b64 vcc, s[64:65]
    v_cndmask_b32_dpp v200, v204, v196, vcc quad_perm:[2,3,0,1] row_mask:0xf bank_mask:0xf
    v_cndmask_b32_dpp v201, v205, v197, vcc quad_perm:[2,3,0,1] row_mask:0xf bank_mask:0xf
    v_cndmask_b32_dpp v202, v206, v198, vcc quad_perm:[2,3,0,1] row_mask:0xf bank_mask:0xf
    v_cndmask_b32_dpp v203, v207, v199, vcc quad_perm:[2,3,0,1] row_mask:0xf bank_mask:0xf
    s_waitcnt lgkmcnt(10)
    v_mfma_f32_16x16x32_bf16 v[48:51], v[220:223], v[96:99], v[48:51]
    ds_read_b64_tr_b16 v[92:93], v2 offset:96
    ds_read_b64_tr_b16 v[94:95], v2 offset:608
    v_mfma_f32_16x16x32_bf16 v[52:55], v[236:239], v[96:99], v[52:55]
    s_mov_b64 vcc, s[66:67]
    v_cndmask_b32_dpp v204, v196, v204, vcc quad_perm:[2,3,0,1] row_mask:0xf bank_mask:0xf
    v_cndmask_b32_dpp v205, v197, v205, vcc quad_perm:[2,3,0,1] row_mask:0xf bank_mask:0xf
    v_cndmask_b32_dpp v206, v198, v206, vcc quad_perm:[2,3,0,1] row_mask:0xf bank_mask:0xf
    v_cndmask_b32_dpp v207, v199, v207, vcc quad_perm:[2,3,0,1] row_mask:0xf bank_mask:0xf
    v_mfma_f32_16x16x32_bf16 v[56:59], v[220:223], v[100:103], v[56:59]
    ds_read_b64_tr_b16 v[96:97], v2 offset:128
    ds_read_b64_tr_b16 v[98:99], v2 offset:640
    v_mfma_f32_16x16x32_bf16 v[60:63], v[236:239], v[100:103], v[60:63]
    s_mov_b64 vcc, s[64:65]
    v_cndmask_b32_dpp v196, v192, v252, vcc quad_perm:[2,3,0,1] row_mask:0xf bank_mask:0xf
    v_cndmask_b32_dpp v197, v193, v253, vcc quad_perm:[2,3,0,1] row_mask:0xf bank_mask:0xf
    v_cndmask_b32_dpp v198, v194, v254, vcc quad_perm:[2,3,0,1] row_mask:0xf bank_mask:0xf
    v_cndmask_b32_dpp v199, v195, v255, vcc quad_perm:[2,3,0,1] row_mask:0xf bank_mask:0xf
    s_waitcnt lgkmcnt(10)
    v_mfma_f32_16x16x32_bf16 v[64:67], v[220:223], v[104:107], v[64:67]
    ds_read_b64_tr_b16 v[100:101], v2 offset:160
    ds_read_b64_tr_b16 v[102:103], v2 offset:672
    v_mfma_f32_16x16x32_bf16 v[68:71], v[236:239], v[104:107], v[68:71]
    s_mov_b64 vcc, s[66:67]
    v_cndmask_b32_dpp v192, v252, v192, vcc quad_perm:[2,3,0,1] row_mask:0xf bank_mask:0xf
    v_cndmask_b32_dpp v193, v253, v193, vcc quad_perm:[2,3,0,1] row_mask:0xf bank_mask:0xf
    v_cndmask_b32_dpp v194, v254, v194, vcc quad_perm:[2,3,0,1] row_mask:0xf bank_mask:0xf
    v_cndmask_b32_dpp v195, v255, v195, vcc quad_perm:[2,3,0,1] row_mask:0xf bank_mask:0xf
    v_mfma_f32_16x16x32_bf16 v[72:75], v[220:223], v[108:111], v[72:75]
    ds_read_b64_tr_b16 v[104:105], v2 offset:192
    ds_read_b64_tr_b16 v[106:107], v2 offset:704
    v_mfma_f32_16x16x32_bf16 v[76:79], v[236:239], v[108:111], v[76:79]
    s_waitcnt lgkmcnt(10)
    v_mfma_f32_16x16x32_bf16 v[112:115], v[80:83], v[180:183], v[112:115]
    ds_read_b64_tr_b16 v[108:109], v2 offset:224
    ds_read_b64_tr_b16 v[110:111], v2 offset:736
    v_mfma_f32_16x16x32_bf16 v[120:123], v[80:83], v[196:199], v[120:123]
    buffer_load_dwordx4 v[208:211], v14, s[72:75], s89 offen offset:768
    ds_read_b64 v[252:253], v13 offset:0
    ds_read_b64 v[254:255], v13 offset:1280
    v_lshlrev_b32 v246, 16, v240
    v_and_b32 v247, 0xffff0000, v240
    v_lshlrev_b32 v248, 16, v241
    v_and_b32 v249, 0xffff0000, v241
    v_mfma_f32_16x16x32_bf16 v[116:119], v[84:87], v[180:183], v[116:119]
    ds_read_b64_tr_b16 v[80:81], v2 offset:8448
    ds_read_b64_tr_b16 v[82:83], v2 offset:8960
    v_mfma_f32_16x16x32_bf16 v[124:127], v[84:87], v[196:199], v[124:127]
    buffer_load_dwordx4 v[212:215], v14, s[72:75], s89 offen offset:1792
    v_fma_f32 v246, v246, v251, -v5
    v_fma_f32 v247, v247, v251, -v5
    v_fma_f32 v248, v248, v251, -v5
    v_fma_f32 v249, v249, v251, -v5
    s_waitcnt lgkmcnt(0)
    v_lshlrev_b32 v6, 16, v254
    s_waitcnt lgkmcnt(10)
    v_mfma_f32_16x16x32_bf16 v[128:131], v[88:91], v[180:183], v[128:131]
    ds_read_b64_tr_b16 v[84:85], v2 offset:8480
    ds_read_b64_tr_b16 v[86:87], v2 offset:8992
    v_mfma_f32_16x16x32_bf16 v[136:139], v[88:91], v[196:199], v[136:139]
    buffer_load_dwordx4 v[216:219], v14, s[72:75], s89 offen offset:2816
    v_lshlrev_b32 v250, 16, v252
    v_fma_f32 v246, v246, v6, v250
    v_and_b32 v6, 0xffff0000, v254
    v_and_b32 v250, 0xffff0000, v252
    v_fma_f32 v247, v247, v6, v250
    v_mfma_f32_16x16x32_bf16 v[132:135], v[92:95], v[180:183], v[132:135]
    ds_read_b64_tr_b16 v[88:89], v2 offset:8512
    ds_read_b64_tr_b16 v[90:91], v2 offset:9024
    v_mfma_f32_16x16x32_bf16 v[140:143], v[92:95], v[196:199], v[140:143]
    buffer_load_dwordx4 v[220:223], v14, s[72:75], s89 offen offset:3840
    v_lshlrev_b32 v6, 16, v255
    v_lshlrev_b32 v250, 16, v253
    v_fma_f32 v248, v248, v6, v250
    v_and_b32 v6, 0xffff0000, v255
    v_and_b32 v250, 0xffff0000, v253
    v_fma_f32 v249, v249, v6, v250
    s_waitcnt lgkmcnt(10)
    v_mfma_f32_16x16x32_bf16 v[144:147], v[96:99], v[180:183], v[144:147]
    ds_read_b64_tr_b16 v[92:93], v2 offset:8544
    ds_read_b64_tr_b16 v[94:95], v2 offset:9056
    v_mfma_f32_16x16x32_bf16 v[152:155], v[96:99], v[196:199], v[152:155]
    buffer_load_dwordx4 v[224:227], v14, s[72:75], s39 offen offset:768
    v_cvt_pk_bf16_f32 v240, v246, v247
    v_cvt_pk_bf16_f32 v241, v248, v249
    ds_write_b64 v7, v[240:241] offset:0
    ds_read_b64 v[252:253], v13 offset:512
    ds_read_b64 v[254:255], v13 offset:1792
    v_lshlrev_b32 v246, 16, v242
    v_mfma_f32_16x16x32_bf16 v[148:151], v[100:103], v[180:183], v[148:151]
    ds_read_b64_tr_b16 v[96:97], v2 offset:8576
    ds_read_b64_tr_b16 v[98:99], v2 offset:9088
    v_mfma_f32_16x16x32_bf16 v[156:159], v[100:103], v[196:199], v[156:159]
    buffer_load_dwordx4 v[228:231], v14, s[72:75], s39 offen offset:1792
    v_and_b32 v247, 0xffff0000, v242
    v_lshlrev_b32 v248, 16, v243
    v_and_b32 v249, 0xffff0000, v243
    v_fma_f32 v246, v246, v251, -v5
    v_fma_f32 v247, v247, v251, -v5
    s_waitcnt lgkmcnt(10)
    v_mfma_f32_16x16x32_bf16 v[160:163], v[104:107], v[180:183], v[160:163]
    ds_read_b64_tr_b16 v[100:101], v2 offset:8608
    ds_read_b64_tr_b16 v[102:103], v2 offset:9120
    v_mfma_f32_16x16x32_bf16 v[168:171], v[104:107], v[196:199], v[168:171]
    buffer_load_dwordx4 v[232:235], v14, s[72:75], s39 offen offset:2816
    v_fma_f32 v248, v248, v251, -v5
    v_fma_f32 v249, v249, v251, -v5
    s_waitcnt lgkmcnt(0)
    v_lshlrev_b32 v6, 16, v254
    v_lshlrev_b32 v250, 16, v252
    v_fma_f32 v246, v246, v6, v250
    v_mfma_f32_16x16x32_bf16 v[164:167], v[108:111], v[180:183], v[164:167]
    ds_read_b64_tr_b16 v[104:105], v2 offset:8640
    ds_read_b64_tr_b16 v[106:107], v2 offset:9152
    v_mfma_f32_16x16x32_bf16 v[172:175], v[108:111], v[196:199], v[172:175]
    buffer_load_dwordx4 v[236:239], v14, s[72:75], s39 offen offset:3840
    v_and_b32 v6, 0xffff0000, v254
    v_and_b32 v250, 0xffff0000, v252
    v_fma_f32 v247, v247, v6, v250
    v_lshlrev_b32 v6, 16, v255
    v_lshlrev_b32 v250, 16, v253
    v_fma_f32 v248, v248, v6, v250
    s_waitcnt lgkmcnt(10)
    v_mfma_f32_16x16x32_bf16 v[112:115], v[80:83], v[184:187], v[112:115]
    ds_read_b64_tr_b16 v[108:109], v2 offset:8672
    ds_read_b64_tr_b16 v[110:111], v2 offset:9184
    v_mfma_f32_16x16x32_bf16 v[120:123], v[80:83], v[200:203], v[120:123]
    s_add_u32 m0, s15, 69632
    s_add_u32 s41, s88, 2097152
    buffer_load_dwordx4 v3, s[52:55], s41 offen nt lds
    v_and_b32 v6, 0xffff0000, v255
    v_and_b32 v250, 0xffff0000, v253
    v_fma_f32 v249, v249, v6, v250
    v_cvt_pk_bf16_f32 v242, v246, v247
    v_cvt_pk_bf16_f32 v243, v248, v249
    v_mfma_f32_16x16x32_bf16 v[116:119], v[84:87], v[184:187], v[116:119]
    ds_read_b64_tr_b16 v[80:81], v2 offset:16896
    ds_read_b64_tr_b16 v[82:83], v2 offset:17408
    v_mfma_f32_16x16x32_bf16 v[124:127], v[84:87], v[200:203], v[124:127]
    s_add_u32 m0, s15, 70688
    s_add_u32 s41, s88, 2105344
    buffer_load_dwordx4 v3, s[52:55], s41 offen nt lds
    ds_write_b64 v7, v[242:243] offset:4096
    ds_read_b64 v[252:253], v13 offset:1024
    ds_read_b64 v[254:255], v13 offset:2304
    v_lshlrev_b32 v246, 16, v244
    v_and_b32 v247, 0xffff0000, v244
    v_lshlrev_b32 v248, 16, v245
    s_waitcnt lgkmcnt(10)
    v_mfma_f32_16x16x32_bf16 v[128:131], v[88:91], v[184:187], v[128:131]
    ds_read_b64_tr_b16 v[84:85], v2 offset:16928
    ds_read_b64_tr_b16 v[86:87], v2 offset:17440
    v_mfma_f32_16x16x32_bf16 v[136:139], v[88:91], v[200:203], v[136:139]
    s_add_u32 m0, s15, 71744
    s_add_u32 s41, s88, 2113536
    buffer_load_dwordx4 v3, s[52:55], s41 offen nt lds
    v_and_b32 v249, 0xffff0000, v245
    v_fma_f32 v246, v246, v251, -v5
    v_fma_f32 v247, v247, v251, -v5
    v_fma_f32 v248, v248, v251, -v5
    v_fma_f32 v249, v249, v251, -v5
    s_waitcnt lgkmcnt(0)
    v_mfma_f32_16x16x32_bf16 v[132:135], v[92:95], v[184:187], v[132:135]
    ds_read_b64_tr_b16 v[88:89], v2 offset:16960
    ds_read_b64_tr_b16 v[90:91], v2 offset:17472
    v_mfma_f32_16x16x32_bf16 v[140:143], v[92:95], v[200:203], v[140:143]
    s_add_u32 m0, s15, 72800
    s_add_u32 s41, s88, 2121728
    buffer_load_dwordx4 v3, s[52:55], s41 offen nt lds
    v_lshlrev_b32 v6, 16, v254
    v_lshlrev_b32 v250, 16, v252
    v_fma_f32 v246, v246, v6, v250
    v_and_b32 v6, 0xffff0000, v254
    v_and_b32 v250, 0xffff0000, v252
    s_waitcnt lgkmcnt(10)
    v_mfma_f32_16x16x32_bf16 v[144:147], v[96:99], v[184:187], v[144:147]
    ds_read_b64_tr_b16 v[92:93], v2 offset:16992
    ds_read_b64_tr_b16 v[94:95], v2 offset:17504
    v_mfma_f32_16x16x32_bf16 v[152:155], v[96:99], v[200:203], v[152:155]
    v_fma_f32 v247, v247, v6, v250
    v_lshlrev_b32 v6, 16, v255
    v_lshlrev_b32 v250, 16, v253
    v_fma_f32 v248, v248, v6, v250
    v_and_b32 v6, 0xffff0000, v255
    v_and_b32 v250, 0xffff0000, v253
    v_mfma_f32_16x16x32_bf16 v[148:151], v[100:103], v[184:187], v[148:151]
    ds_read_b64_tr_b16 v[96:97], v2 offset:17024
    ds_read_b64_tr_b16 v[98:99], v2 offset:17536
    v_mfma_f32_16x16x32_bf16 v[156:159], v[100:103], v[200:203], v[156:159]
    v_fma_f32 v249, v249, v6, v250
    v_cvt_pk_bf16_f32 v244, v246, v247
    v_cvt_pk_bf16_f32 v245, v248, v249
    ds_write_b64 v8, v[244:245] offset:8192
    s_waitcnt lgkmcnt(0)
    s_waitcnt lgkmcnt(10)
    v_mfma_f32_16x16x32_bf16 v[160:163], v[104:107], v[184:187], v[160:163]
    ds_read_b64_tr_b16 v[100:101], v2 offset:17056
    ds_read_b64_tr_b16 v[102:103], v2 offset:17568
    v_mfma_f32_16x16x32_bf16 v[168:171], v[104:107], v[200:203], v[168:171]
    s_barrier
    s_lshl_b32 s46, s3, 10
    s_add_u32 s46, s46, 139264
    v_add_u32 v13, s46, v4
    ds_read_b128 v[240:243], v13 offset:0
    ds_read_b128 v[244:247], v13 offset:8192
    v_bfe_u32 v12, v0, 5, 1
    v_lshlrev_b32 v12, 11, v12
    v_bfe_u32 v13, v0, 3, 2
    v_lshl_add_u32 v12, v13, 8, v12
    v_and_b32 v13, 7, v0
    v_lshl_add_u32 v12, v13, 4, v12
    s_lshr_b32 s46, s95, 2
    s_mul_i32 s46, s46, 40960
    s_and_b32 s47, s95, 1
    s_lshl_b32 s47, s47, 7
    s_add_u32 s46, s46, s47
    s_and_b32 s47, s95, 2
    s_lshl_b32 s47, s47, 9
    s_add_u32 s46, s46, s47
    s_lshl_b32 s47, s3, 12
    s_add_u32 s46, s46, s47
    v_mfma_f32_16x16x32_bf16 v[164:167], v[108:111], v[184:187], v[164:167]
    ds_read_b64_tr_b16 v[104:105], v2 offset:17088
    ds_read_b64_tr_b16 v[106:107], v2 offset:17600
    v_mfma_f32_16x16x32_bf16 v[172:175], v[108:111], v[200:203], v[172:175]
    s_waitcnt lgkmcnt(10)
    v_mfma_f32_16x16x32_bf16 v[112:115], v[80:83], v[176:179], v[112:115]
    ds_read_b64_tr_b16 v[108:109], v2 offset:17120
    ds_read_b64_tr_b16 v[110:111], v2 offset:17632
    v_mfma_f32_16x16x32_bf16 v[120:123], v[80:83], v[192:195], v[120:123]
    s_waitcnt vmcnt(8)
    s_mov_b64 vcc, s[60:61]
    v_cndmask_b32_dpp v252, v212, v208, vcc quad_perm:[1,0,3,2] row_mask:0xf bank_mask:0xf
    v_cndmask_b32_dpp v253, v213, v209, vcc quad_perm:[1,0,3,2] row_mask:0xf bank_mask:0xf
    v_cndmask_b32_dpp v254, v214, v210, vcc quad_perm:[1,0,3,2] row_mask:0xf bank_mask:0xf
    v_cndmask_b32_dpp v255, v215, v211, vcc quad_perm:[1,0,3,2] row_mask:0xf bank_mask:0xf
    s_mov_b64 vcc, s[62:63]
    v_cndmask_b32_dpp v212, v208, v212, vcc quad_perm:[1,0,3,2] row_mask:0xf bank_mask:0xf
    v_cndmask_b32_dpp v213, v209, v213, vcc quad_perm:[1,0,3,2] row_mask:0xf bank_mask:0xf
    v_cndmask_b32_dpp v214, v210, v214, vcc quad_perm:[1,0,3,2] row_mask:0xf bank_mask:0xf
    v_cndmask_b32_dpp v215, v211, v215, vcc quad_perm:[1,0,3,2] row_mask:0xf bank_mask:0xf
    v_mfma_f32_16x16x32_bf16 v[116:119], v[84:87], v[176:179], v[116:119]
    ds_read_b64_tr_b16 v[80:81], v2 offset:25344
    ds_read_b64_tr_b16 v[82:83], v2 offset:25856
    v_mfma_f32_16x16x32_bf16 v[124:127], v[84:87], v[192:195], v[124:127]
    s_mov_b64 vcc, s[60:61]
    v_cndmask_b32_dpp v208, v220, v216, vcc quad_perm:[1,0,3,2] row_mask:0xf bank_mask:0xf
    v_cndmask_b32_dpp v209, v221, v217, vcc quad_perm:[1,0,3,2] row_mask:0xf bank_mask:0xf
    v_cndmask_b32_dpp v210, v222, v218, vcc quad_perm:[1,0,3,2] row_mask:0xf bank_mask:0xf
    v_cndmask_b32_dpp v211, v223, v219, vcc quad_perm:[1,0,3,2] row_mask:0xf bank_mask:0xf
    s_waitcnt lgkmcnt(0)
    s_add_u32 s47, s46, 4194304
    buffer_store_dwordx4 v[240:243], v12, s[16:19], s47 offen sc1
    s_waitcnt lgkmcnt(10)
    v_mfma_f32_16x16x32_bf16 v[128:131], v[88:91], v[176:179], v[128:131]
    ds_read_b64_tr_b16 v[84:85], v2 offset:25376
    ds_read_b64_tr_b16 v[86:87], v2 offset:25888
    v_mfma_f32_16x16x32_bf16 v[136:139], v[88:91], v[192:195], v[136:139]
    s_mov_b64 vcc, s[62:63]
    v_cndmask_b32_dpp v220, v216, v220, vcc quad_perm:[1,0,3,2] row_mask:0xf bank_mask:0xf
    v_cndmask_b32_dpp v221, v217, v221, vcc quad_perm:[1,0,3,2] row_mask:0xf bank_mask:0xf
    v_cndmask_b32_dpp v222, v218, v222, vcc quad_perm:[1,0,3,2] row_mask:0xf bank_mask:0xf
    v_cndmask_b32_dpp v223, v219, v223, vcc quad_perm:[1,0,3,2] row_mask:0xf bank_mask:0xf
    s_add_u32 s47, s46, 4227072
    s_cmp_lt_u32 s3, 2
    s_cselect_b32 s47, s47, s82
    buffer_store_dwordx4 v[244:247], v12, s[16:19], s47 offen sc1
    v_mfma_f32_16x16x32_bf16 v[132:135], v[92:95], v[176:179], v[132:135]
    ds_read_b64_tr_b16 v[88:89], v2 offset:25408
    ds_read_b64_tr_b16 v[90:91], v2 offset:25920
    v_mfma_f32_16x16x32_bf16 v[140:143], v[92:95], v[192:195], v[140:143]
    s_mov_b64 vcc, s[64:65]
    v_cndmask_b32_dpp v216, v220, v212, vcc quad_perm:[2,3,0,1] row_mask:0xf bank_mask:0xf
    v_cndmask_b32_dpp v217, v221, v213, vcc quad_perm:[2,3,0,1] row_mask:0xf bank_mask:0xf
    v_cndmask_b32_dpp v218, v222, v214, vcc quad_perm:[2,3,0,1] row_mask:0xf bank_mask:0xf
    v_cndmask_b32_dpp v219, v223, v215, vcc quad_perm:[2,3,0,1] row_mask:0xf bank_mask:0xf
    s_waitcnt lgkmcnt(10)
    v_mfma_f32_16x16x32_bf16 v[144:147], v[96:99], v[176:179], v[144:147]
    ds_read_b64_tr_b16 v[92:93], v2 offset:25440
    ds_read_b64_tr_b16 v[94:95], v2 offset:25952
    v_mfma_f32_16x16x32_bf16 v[152:155], v[96:99], v[192:195], v[152:155]
    s_mov_b64 vcc, s[66:67]
    v_cndmask_b32_dpp v220, v212, v220, vcc quad_perm:[2,3,0,1] row_mask:0xf bank_mask:0xf
    v_cndmask_b32_dpp v221, v213, v221, vcc quad_perm:[2,3,0,1] row_mask:0xf bank_mask:0xf
    v_cndmask_b32_dpp v222, v214, v222, vcc quad_perm:[2,3,0,1] row_mask:0xf bank_mask:0xf
    v_cndmask_b32_dpp v223, v215, v223, vcc quad_perm:[2,3,0,1] row_mask:0xf bank_mask:0xf
    v_mfma_f32_16x16x32_bf16 v[148:151], v[100:103], v[176:179], v[148:151]
    ds_read_b64_tr_b16 v[96:97], v2 offset:25472
    ds_read_b64_tr_b16 v[98:99], v2 offset:25984
    v_mfma_f32_16x16x32_bf16 v[156:159], v[100:103], v[192:195], v[156:159]
    s_mov_b64 vcc, s[64:65]
    v_cndmask_b32_dpp v212, v208, v252, vcc quad_perm:[2,3,0,1] row_mask:0xf bank_mask:0xf
    v_cndmask_b32_dpp v213, v209, v253, vcc quad_perm:[2,3,0,1] row_mask:0xf bank_mask:0xf
    v_cndmask_b32_dpp v214, v210, v254, vcc quad_perm:[2,3,0,1] row_mask:0xf bank_mask:0xf
    v_cndmask_b32_dpp v215, v211, v255, vcc quad_perm:[2,3,0,1] row_mask:0xf bank_mask:0xf
    s_waitcnt lgkmcnt(10)
    v_mfma_f32_16x16x32_bf16 v[160:163], v[104:107], v[176:179], v[160:163]
    ds_read_b64_tr_b16 v[100:101], v2 offset:25504
    ds_read_b64_tr_b16 v[102:103], v2 offset:26016
    v_mfma_f32_16x16x32_bf16 v[168:171], v[104:107], v[192:195], v[168:171]
    s_mov_b64 vcc, s[66:67]
    v_cndmask_b32_dpp v208, v252, v208, vcc quad_perm:[2,3,0,1] row_mask:0xf bank_mask:0xf
    v_cndmask_b32_dpp v209, v253, v209, vcc quad_perm:[2,3,0,1] row_mask:0xf bank_mask:0xf
    v_cndmask_b32_dpp v210, v254, v210, vcc quad_perm:[2,3,0,1] row_mask:0xf bank_mask:0xf
    v_cndmask_b32_dpp v211, v255, v211, vcc quad_perm:[2,3,0,1] row_mask:0xf bank_mask:0xf
    v_mfma_f32_16x16x32_bf16 v[164:167], v[108:111], v[176:179], v[164:167]
    ds_read_b64_tr_b16 v[104:105], v2 offset:25536
    ds_read_b64_tr_b16 v[106:107], v2 offset:26048
    v_mfma_f32_16x16x32_bf16 v[172:175], v[108:111], v[192:195], v[172:175]
    s_waitcnt vmcnt(6)
    s_mov_b64 vcc, s[60:61]
    v_cndmask_b32_dpp v252, v228, v224, vcc quad_perm:[1,0,3,2] row_mask:0xf bank_mask:0xf
    v_cndmask_b32_dpp v253, v229, v225, vcc quad_perm:[1,0,3,2] row_mask:0xf bank_mask:0xf
    v_cndmask_b32_dpp v254, v230, v226, vcc quad_perm:[1,0,3,2] row_mask:0xf bank_mask:0xf
    v_cndmask_b32_dpp v255, v231, v227, vcc quad_perm:[1,0,3,2] row_mask:0xf bank_mask:0xf
    s_waitcnt lgkmcnt(10)
    v_mfma_f32_16x16x32_bf16 v[112:115], v[80:83], v[188:191], v[112:115]
    ds_read_b64_tr_b16 v[108:109], v2 offset:25568
    ds_read_b64_tr_b16 v[110:111], v2 offset:26080
    v_mfma_f32_16x16x32_bf16 v[120:123], v[80:83], v[204:207], v[120:123]
    v_add_u32 v2, s9, v1
    s_barrier
    s_mov_b64 vcc, s[62:63]
    v_cndmask_b32_dpp v228, v224, v228, vcc quad_perm:[1,0,3,2] row_mask:0xf bank_mask:0xf
    v_cndmask_b32_dpp v229, v225, v229, vcc quad_perm:[1,0,3,2] row_mask:0xf bank_mask:0xf
    v_cndmask_b32_dpp v230, v226, v230, vcc quad_perm:[1,0,3,2] row_mask:0xf bank_mask:0xf
    v_cndmask_b32_dpp v231, v227, v231, vcc quad_perm:[1,0,3,2] row_mask:0xf bank_mask:0xf
    v_mfma_f32_16x16x32_bf16 v[116:119], v[84:87], v[188:191], v[116:119]
    ds_read_b64_tr_b16 v[80:81], v2 offset:0
    ds_read_b64_tr_b16 v[82:83], v2 offset:512
    v_mfma_f32_16x16x32_bf16 v[124:127], v[84:87], v[204:207], v[124:127]
    s_mov_b64 vcc, s[60:61]
    v_cndmask_b32_dpp v224, v236, v232, vcc quad_perm:[1,0,3,2] row_mask:0xf bank_mask:0xf
    v_cndmask_b32_dpp v225, v237, v233, vcc quad_perm:[1,0,3,2] row_mask:0xf bank_mask:0xf
    v_cndmask_b32_dpp v226, v238, v234, vcc quad_perm:[1,0,3,2] row_mask:0xf bank_mask:0xf
    v_cndmask_b32_dpp v227, v239, v235, vcc quad_perm:[1,0,3,2] row_mask:0xf bank_mask:0xf
    s_waitcnt lgkmcnt(10)
    v_mfma_f32_16x16x32_bf16 v[128:131], v[88:91], v[188:191], v[128:131]
    ds_read_b64_tr_b16 v[84:85], v2 offset:32
    ds_read_b64_tr_b16 v[86:87], v2 offset:544
    v_mfma_f32_16x16x32_bf16 v[136:139], v[88:91], v[204:207], v[136:139]
    s_mov_b64 vcc, s[62:63]
    v_cndmask_b32_dpp v236, v232, v236, vcc quad_perm:[1,0,3,2] row_mask:0xf bank_mask:0xf
    v_cndmask_b32_dpp v237, v233, v237, vcc quad_perm:[1,0,3,2] row_mask:0xf bank_mask:0xf
    v_cndmask_b32_dpp v238, v234, v238, vcc quad_perm:[1,0,3,2] row_mask:0xf bank_mask:0xf
    v_cndmask_b32_dpp v239, v235, v239, vcc quad_perm:[1,0,3,2] row_mask:0xf bank_mask:0xf
    v_mfma_f32_16x16x32_bf16 v[132:135], v[92:95], v[188:191], v[132:135]
    ds_read_b64_tr_b16 v[88:89], v2 offset:8448
    ds_read_b64_tr_b16 v[90:91], v2 offset:8960
    v_mfma_f32_16x16x32_bf16 v[140:143], v[92:95], v[204:207], v[140:143]
    s_mov_b64 vcc, s[64:65]
    v_cndmask_b32_dpp v232, v236, v228, vcc quad_perm:[2,3,0,1] row_mask:0xf bank_mask:0xf
    v_cndmask_b32_dpp v233, v237, v229, vcc quad_perm:[2,3,0,1] row_mask:0xf bank_mask:0xf
    v_cndmask_b32_dpp v234, v238, v230, vcc quad_perm:[2,3,0,1] row_mask:0xf bank_mask:0xf
    v_cndmask_b32_dpp v235, v239, v231, vcc quad_perm:[2,3,0,1] row_mask:0xf bank_mask:0xf
    s_waitcnt lgkmcnt(10)
    v_mfma_f32_16x16x32_bf16 v[144:147], v[96:99], v[188:191], v[144:147]
    ds_read_b64_tr_b16 v[92:93], v2 offset:8480
    ds_read_b64_tr_b16 v[94:95], v2 offset:8992
    v_mfma_f32_16x16x32_bf16 v[152:155], v[96:99], v[204:207], v[152:155]
    s_mov_b64 vcc, s[66:67]
    v_cndmask_b32_dpp v236, v228, v236, vcc quad_perm:[2,3,0,1] row_mask:0xf bank_mask:0xf
    v_cndmask_b32_dpp v237, v229, v237, vcc quad_perm:[2,3,0,1] row_mask:0xf bank_mask:0xf
    v_cndmask_b32_dpp v238, v230, v238, vcc quad_perm:[2,3,0,1] row_mask:0xf bank_mask:0xf
    v_cndmask_b32_dpp v239, v231, v239, vcc quad_perm:[2,3,0,1] row_mask:0xf bank_mask:0xf
    v_mfma_f32_16x16x32_bf16 v[148:151], v[100:103], v[188:191], v[148:151]
    ds_read_b64_tr_b16 v[96:97], v2 offset:16896
    ds_read_b64_tr_b16 v[98:99], v2 offset:17408
    v_mfma_f32_16x16x32_bf16 v[156:159], v[100:103], v[204:207], v[156:159]
    s_mov_b64 vcc, s[64:65]
    v_cndmask_b32_dpp v228, v224, v252, vcc quad_perm:[2,3,0,1] row_mask:0xf bank_mask:0xf
    v_cndmask_b32_dpp v229, v225, v253, vcc quad_perm:[2,3,0,1] row_mask:0xf bank_mask:0xf
    v_cndmask_b32_dpp v230, v226, v254, vcc quad_perm:[2,3,0,1] row_mask:0xf bank_mask:0xf
    v_cndmask_b32_dpp v231, v227, v255, vcc quad_perm:[2,3,0,1] row_mask:0xf bank_mask:0xf
    s_waitcnt lgkmcnt(10)
    v_mfma_f32_16x16x32_bf16 v[160:163], v[104:107], v[188:191], v[160:163]
    ds_read_b64_tr_b16 v[100:101], v2 offset:16928
    ds_read_b64_tr_b16 v[102:103], v2 offset:17440
    v_mfma_f32_16x16x32_bf16 v[168:171], v[104:107], v[204:207], v[168:171]
    s_mov_b64 vcc, s[66:67]
    v_cndmask_b32_dpp v224, v252, v224, vcc quad_perm:[2,3,0,1] row_mask:0xf bank_mask:0xf
    v_cndmask_b32_dpp v225, v253, v225, vcc quad_perm:[2,3,0,1] row_mask:0xf bank_mask:0xf
    v_cndmask_b32_dpp v226, v254, v226, vcc quad_perm:[2,3,0,1] row_mask:0xf bank_mask:0xf
    v_cndmask_b32_dpp v227, v255, v227, vcc quad_perm:[2,3,0,1] row_mask:0xf bank_mask:0xf
    v_mfma_f32_16x16x32_bf16 v[164:167], v[108:111], v[188:191], v[164:167]
    ds_read_b64_tr_b16 v[104:105], v2 offset:25344
    ds_read_b64_tr_b16 v[106:107], v2 offset:25856
    v_mfma_f32_16x16x32_bf16 v[172:175], v[108:111], v[204:207], v[172:175]
    s_waitcnt lgkmcnt(10)
    v_mfma_f32_16x16x32_bf16 v[112:115], v[80:83], v[212:215], v[112:115]
    ds_read_b64_tr_b16 v[108:109], v2 offset:25376
    ds_read_b64_tr_b16 v[110:111], v2 offset:25888
    v_mfma_f32_16x16x32_bf16 v[120:123], v[80:83], v[228:231], v[120:123]
    s_add_u32 m0, s15, 104448
    s_add_u32 s41, s88, 3145728
    buffer_load_dwordx4 v3, s[52:55], s41 offen nt lds
    s_add_u32 m0, s15, 105504
    s_add_u32 s41, s88, 3153920
    buffer_load_dwordx4 v3, s[52:55], s41 offen nt lds
    v_mfma_f32_16x16x32_bf16 v[116:119], v[84:87], v[212:215], v[116:119]
    ds_read_b64_tr_b16 v[80:81], v2 offset:64
    ds_read_b64_tr_b16 v[82:83], v2 offset:576
    v_mfma_f32_16x16x32_bf16 v[124:127], v[84:87], v[228:231], v[124:127]
    s_add_u32 m0, s15, 106560
    s_add_u32 s41, s88, 3162112
    buffer_load_dwordx4 v3, s[52:55], s41 offen nt lds
    s_waitcnt lgkmcnt(10)
    v_mfma_f32_16x16x32_bf16 v[112:115], v[88:91], v[216:219], v[112:115]
    ds_read_b64_tr_b16 v[84:85], v2 offset:96
    ds_read_b64_tr_b16 v[86:87], v2 offset:608
    v_mfma_f32_16x16x32_bf16 v[120:123], v[88:91], v[232:235], v[120:123]
    s_add_u32 m0, s15, 107616
    s_add_u32 s41, s88, 3170304
    buffer_load_dwordx4 v3, s[52:55], s41 offen nt lds
    v_mfma_f32_16x16x32_bf16 v[116:119], v[92:95], v[216:219], v[116:119]
    ds_read_b64_tr_b16 v[88:89], v2 offset:8512
    ds_read_b64_tr_b16 v[90:91], v2 offset:9024
    v_mfma_f32_16x16x32_bf16 v[124:127], v[92:95], v[232:235], v[124:127]
    s_mul_i32 s80, s32, 533504
    s_add_u32 s80, s80, s84
    s_waitcnt lgkmcnt(10)
    v_mfma_f32_16x16x32_bf16 v[112:115], v[96:99], v[208:211], v[112:115]
    ds_read_b64_tr_b16 v[92:93], v2 offset:8544
    ds_read_b64_tr_b16 v[94:95], v2 offset:9056
    v_mfma_f32_16x16x32_bf16 v[120:123], v[96:99], v[224:227], v[120:123]
    s_add_u32 s46, s80, 32768
    v_mfma_f32_16x16x32_bf16 v[116:119], v[100:103], v[208:211], v[116:119]
    ds_read_b64_tr_b16 v[96:97], v2 offset:16960
    ds_read_b64_tr_b16 v[98:99], v2 offset:17472
    v_mfma_f32_16x16x32_bf16 v[124:127], v[100:103], v[224:227], v[124:127]
    s_add_u32 s47, s80, 17842176
    s_waitcnt lgkmcnt(10)
    v_mfma_f32_16x16x32_bf16 v[112:115], v[104:107], v[220:223], v[112:115]
    ds_read_b64_tr_b16 v[100:101], v2 offset:16992
    ds_read_b64_tr_b16 v[102:103], v2 offset:17504
    v_mfma_f32_16x16x32_bf16 v[120:123], v[104:107], v[236:239], v[120:123]
    s_lshl_b32 s81, s37, 14
    v_mfma_f32_16x16x32_bf16 v[116:119], v[108:111], v[220:223], v[116:119]
    ds_read_b64_tr_b16 v[104:105], v2 offset:25408
    ds_read_b64_tr_b16 v[106:107], v2 offset:25920
    v_mfma_f32_16x16x32_bf16 v[124:127], v[108:111], v[236:239], v[124:127]
    s_add_u32 s80, s80, s81
    s_add_u32 s81, s80, 17825792
    s_waitcnt lgkmcnt(10)
    v_mfma_f32_16x16x32_bf16 v[128:131], v[80:83], v[212:215], v[128:131]
    ds_read_b64_tr_b16 v[108:109], v2 offset:25440
    ds_read_b64_tr_b16 v[110:111], v2 offset:25952
    v_mfma_f32_16x16x32_bf16 v[136:139], v[80:83], v[228:231], v[136:139]
    s_mov_b32 s43, s11
    s_waitcnt vmcnt(4)
    s_barrier
    s_lshl_b32 s92, s95, 2
    s_add_u32 s92, s92, 692224
    s_cmp_eq_u32 s3, 0
    s_cselect_b32 s92, s92, s82
    v_mov_b32 v7, 0
    v_mov_b32 v8, s91
    s_mov_b64 exec, 1
    buffer_store_dword v8, v7, s[16:19], s92 offen sc1
    s_mov_b64 exec, -1
    v_mfma_f32_16x16x32_bf16 v[132:135], v[84:87], v[212:215], v[132:135]
    ds_read_b64_tr_b16 v[80:81], v2 offset:128
    ds_read_b64_tr_b16 v[82:83], v2 offset:640
    v_mfma_f32_16x16x32_bf16 v[140:143], v[84:87], v[228:231], v[140:143]
    s_mov_b32 s45, s10
    s_waitcnt lgkmcnt(10)
    v_mfma_f32_16x16x32_bf16 v[128:131], v[88:91], v[216:219], v[128:131]
    ds_read_b64_tr_b16 v[84:85], v2 offset:160
    ds_read_b64_tr_b16 v[86:87], v2 offset:672
    v_mfma_f32_16x16x32_bf16 v[136:139], v[88:91], v[232:235], v[136:139]
    v_lshrrev_b32 v7, 2, v4
    v_add_u32 v7, 162816, v7
    v_mov_b32 v8, 0
    ds_write_b32 v7, v8
    v_mfma_f32_16x16x32_bf16 v[132:135], v[92:95], v[216:219], v[132:135]
    ds_read_b64_tr_b16 v[88:89], v2 offset:8576
    ds_read_b64_tr_b16 v[90:91], v2 offset:9088
    v_mfma_f32_16x16x32_bf16 v[140:143], v[92:95], v[232:235], v[140:143]
    v_cvt_pk_bf16_f32 v112, v112, v113
    v_cvt_pk_bf16_f32 v113, v114, v115
    v_cvt_pk_bf16_f32 v114, v120, v121
    v_cvt_pk_bf16_f32 v115, v122, v123
    s_waitcnt lgkmcnt(10)
    v_mfma_f32_16x16x32_bf16 v[128:131], v[96:99], v[208:211], v[128:131]
    ds_read_b64_tr_b16 v[92:93], v2 offset:8608
    ds_read_b64_tr_b16 v[94:95], v2 offset:9120
    v_mfma_f32_16x16x32_bf16 v[136:139], v[96:99], v[224:227], v[136:139]
    v_cvt_pk_bf16_f32 v120, v116, v117
    v_cvt_pk_bf16_f32 v121, v118, v119
    v_cvt_pk_bf16_f32 v122, v124, v125
    v_cvt_pk_bf16_f32 v123, v126, v127
    v_mfma_f32_16x16x32_bf16 v[132:135], v[100:103], v[208:211], v[132:135]
    ds_read_b64_tr_b16 v[96:97], v2 offset:17024
    ds_read_b64_tr_b16 v[98:99], v2 offset:17536
    v_mfma_f32_16x16x32_bf16 v[140:143], v[100:103], v[224:227], v[140:143]
    v_permlane16_swap_b32 v112, v114
    v_permlane16_swap_b32 v113, v115
    v_permlane16_swap_b32 v120, v122
    v_permlane16_swap_b32 v121, v123
    s_waitcnt lgkmcnt(10)
    v_mfma_f32_16x16x32_bf16 v[128:131], v[104:107], v[220:223], v[128:131]
    ds_read_b64_tr_b16 v[100:101], v2 offset:17056
    ds_read_b64_tr_b16 v[102:103], v2 offset:17568
    v_mfma_f32_16x16x32_bf16 v[136:139], v[104:107], v[236:239], v[136:139]
    v_permlane32_swap_b32 v112, v114
    v_permlane32_swap_b32 v113, v115
    v_permlane32_swap_b32 v120, v122
    v_permlane32_swap_b32 v121, v123
    v_mfma_f32_16x16x32_bf16 v[132:135], v[108:111], v[220:223], v[132:135]
    ds_read_b64_tr_b16 v[104:105], v2 offset:25472
    ds_read_b64_tr_b16 v[106:107], v2 offset:25984
    v_mfma_f32_16x16x32_bf16 v[140:143], v[108:111], v[236:239], v[140:143]
    s_add_u32 s92, s90, 14680064
    buffer_store_dwordx4 v[112:115], v4, s[16:19], s92 offen offset:0 sc1
    s_waitcnt lgkmcnt(10)
    v_mfma_f32_16x16x32_bf16 v[144:147], v[80:83], v[212:215], v[144:147]
    ds_read_b64_tr_b16 v[108:109], v2 offset:25504
    ds_read_b64_tr_b16 v[110:111], v2 offset:26016
    v_mfma_f32_16x16x32_bf16 v[152:155], v[80:83], v[228:231], v[152:155]
    v_bfe_u32 v14, v0, 4, 2
    v_mfma_f32_16x16x32_bf16 v[148:151], v[84:87], v[212:215], v[148:151]
    ds_read_b64_tr_b16 v[80:81], v2 offset:192
    ds_read_b64_tr_b16 v[82:83], v2 offset:704
    v_mfma_f32_16x16x32_bf16 v[156:159], v[84:87], v[228:231], v[156:159]
    v_lshlrev_b32 v14, 16, v14
    s_waitcnt lgkmcnt(10)
    v_mfma_f32_16x16x32_bf16 v[144:147], v[88:91], v[216:219], v[144:147]
    ds_read_b64_tr_b16 v[84:85], v2 offset:224
    ds_read_b64_tr_b16 v[86:87], v2 offset:736
    v_mfma_f32_16x16x32_bf16 v[152:155], v[88:91], v[232:235], v[152:155]
    v_and_b32 v10, 15, v0
    v_mfma_f32_16x16x32_bf16 v[148:151], v[92:95], v[216:219], v[148:151]
    ds_read_b64_tr_b16 v[88:89], v2 offset:8640
    ds_read_b64_tr_b16 v[90:91], v2 offset:9152
    v_mfma_f32_16x16x32_bf16 v[156:159], v[92:95], v[232:235], v[156:159]
    v_lshl_add_u32 v14, v10, 4, v14
    v_cvt_pk_bf16_f32 v128, v128, v129
    v_cvt_pk_bf16_f32 v129, v130, v131
    v_cvt_pk_bf16_f32 v130, v136, v137
    v_cvt_pk_bf16_f32 v131, v138, v139
    s_waitcnt lgkmcnt(10)
    v_mfma_f32_16x16x32_bf16 v[144:147], v[96:99], v[208:211], v[144:147]
    ds_read_b64_tr_b16 v[92:93], v2 offset:8672
    ds_read_b64_tr_b16 v[94:95], v2 offset:9184
    v_mfma_f32_16x16x32_bf16 v[152:155], v[96:99], v[224:227], v[152:155]
    v_cvt_pk_bf16_f32 v136, v132, v133
    v_cvt_pk_bf16_f32 v137, v134, v135
    v_cvt_pk_bf16_f32 v138, v140, v141
    v_cvt_pk_bf16_f32 v139, v142, v143
    v_mfma_f32_16x16x32_bf16 v[148:151], v[100:103], v[208:211], v[148:151]
    ds_read_b64_tr_b16 v[96:97], v2 offset:17088
    ds_read_b64_tr_b16 v[98:99], v2 offset:17600
    v_mfma_f32_16x16x32_bf16 v[156:159], v[100:103], v[224:227], v[156:159]
    v_permlane16_swap_b32 v128, v130
    v_permlane16_swap_b32 v129, v131
    v_permlane16_swap_b32 v136, v138
    v_permlane16_swap_b32 v137, v139
    s_waitcnt lgkmcnt(10)
    v_mfma_f32_16x16x32_bf16 v[144:147], v[104:107], v[220:223], v[144:147]
    ds_read_b64_tr_b16 v[100:101], v2 offset:17120
    ds_read_b64_tr_b16 v[102:103], v2 offset:17632
    v_mfma_f32_16x16x32_bf16 v[152:155], v[104:107], v[236:239], v[152:155]
    v_permlane32_swap_b32 v128, v130
    v_permlane32_swap_b32 v129, v131
    v_permlane32_swap_b32 v136, v138
    v_permlane32_swap_b32 v137, v139
    v_mfma_f32_16x16x32_bf16 v[148:151], v[108:111], v[220:223], v[148:151]
    ds_read_b64_tr_b16 v[104:105], v2 offset:25536
    ds_read_b64_tr_b16 v[106:107], v2 offset:26048
    v_mfma_f32_16x16x32_bf16 v[156:159], v[108:111], v[236:239], v[156:159]
    s_waitcnt lgkmcnt(10)
    v_mfma_f32_16x16x32_bf16 v[160:163], v[80:83], v[212:215], v[160:163]
    ds_read_b64_tr_b16 v[108:109], v2 offset:25568
    ds_read_b64_tr_b16 v[110:111], v2 offset:26080
    v_mfma_f32_16x16x32_bf16 v[168:171], v[80:83], v[228:231], v[168:171]
    v_add_u32 v2, s10, v1
    s_barrier
    v_mfma_f32_16x16x32_bf16 v[164:167], v[84:87], v[212:215], v[164:167]
    ds_read_b64_tr_b16 v[80:81], v2 offset:0
    ds_read_b64_tr_b16 v[82:83], v2 offset:512
    v_mfma_f32_16x16x32_bf16 v[172:175], v[84:87], v[228:231], v[172:175]
    s_waitcnt lgkmcnt(10)
    v_mfma_f32_16x16x32_bf16 v[160:163], v[88:91], v[216:219], v[160:163]
    ds_read_b64_tr_b16 v[84:85], v2 offset:32
    ds_read_b64_tr_b16 v[86:87], v2 offset:544
    v_mfma_f32_16x16x32_bf16 v[168:171], v[88:91], v[232:235], v[168:171]
    s_add_u32 s92, s90, 14680064
    buffer_store_dwordx4 v[120:123], v4, s[16:19], s92 offen offset:1024 sc1
    v_mfma_f32_16x16x32_bf16 v[164:167], v[92:95], v[216:219], v[164:167]
    ds_read_b64_tr_b16 v[88:89], v2 offset:64
    ds_read_b64_tr_b16 v[90:91], v2 offset:576
    v_mfma_f32_16x16x32_bf16 v[172:175], v[92:95], v[232:235], v[172:175]
    v_cvt_pk_bf16_f32 v240, v144, v145
    v_cvt_pk_bf16_f32 v241, v146, v147
    v_cvt_pk_bf16_f32 v242, v152, v153
    v_cvt_pk_bf16_f32 v243, v154, v155
    s_waitcnt lgkmcnt(10)
    v_mfma_f32_16x16x32_bf16 v[160:163], v[96:99], v[208:211], v[160:163]
    ds_read_b64_tr_b16 v[92:93], v2 offset:96
    ds_read_b64_tr_b16 v[94:95], v2 offset:608
    v_mfma_f32_16x16x32_bf16 v[168:171], v[96:99], v[224:227], v[168:171]
    v_cvt_pk_bf16_f32 v244, v148, v149
    v_cvt_pk_bf16_f32 v245, v150, v151
    v_cvt_pk_bf16_f32 v246, v156, v157
    v_cvt_pk_bf16_f32 v247, v158, v159
    v_mfma_f32_16x16x32_bf16 v[164:167], v[100:103], v[208:211], v[164:167]
    ds_read_b64_tr_b16 v[96:97], v2 offset:128
    ds_read_b64_tr_b16 v[98:99], v2 offset:640
    v_mfma_f32_16x16x32_bf16 v[172:175], v[100:103], v[224:227], v[172:175]
    v_permlane16_swap_b32 v240, v242
    v_permlane16_swap_b32 v241, v243
    v_permlane16_swap_b32 v244, v246
    v_permlane16_swap_b32 v245, v247
    s_waitcnt lgkmcnt(10)
    v_mfma_f32_16x16x32_bf16 v[160:163], v[104:107], v[220:223], v[160:163]
    ds_read_b64_tr_b16 v[100:101], v2 offset:160
    ds_read_b64_tr_b16 v[102:103], v2 offset:672
    v_mfma_f32_16x16x32_bf16 v[168:171], v[104:107], v[236:239], v[168:171]
    v_permlane32_swap_b32 v240, v242
    v_permlane32_swap_b32 v241, v243
    v_permlane32_swap_b32 v244, v246
    v_permlane32_swap_b32 v245, v247
    v_mfma_f32_16x16x32_bf16 v[164:167], v[108:111], v[220:223], v[164:167]
    ds_read_b64_tr_b16 v[104:105], v2 offset:192
    ds_read_b64_tr_b16 v[106:107], v2 offset:704
    v_mfma_f32_16x16x32_bf16 v[172:175], v[108:111], v[236:239], v[172:175]
    s_waitcnt lgkmcnt(10)
    v_mfma_f32_16x16x32_bf16 v[16:19], v[180:183], v[80:83], v[16:19]
    ds_read_b64_tr_b16 v[108:109], v2 offset:224
    ds_read_b64_tr_b16 v[110:111], v2 offset:736
    v_mfma_f32_16x16x32_bf16 v[20:23], v[196:199], v[80:83], v[20:23]
    s_add_u32 m0, s14, 0
    s_add_u32 s41, s38, 0
    buffer_load_dwordx4 v14, s[20:23], s41 offen nt lds
    v_mfma_f32_16x16x32_bf16 v[24:27], v[180:183], v[84:87], v[24:27]
    ds_read_b64_tr_b16 v[80:81], v2 offset:8448
    ds_read_b64_tr_b16 v[82:83], v2 offset:8960
    v_mfma_f32_16x16x32_bf16 v[28:31], v[196:199], v[84:87], v[28:31]
    s_waitcnt lgkmcnt(10)
    v_mfma_f32_16x16x32_bf16 v[32:35], v[180:183], v[88:91], v[32:35]
    ds_read_b64_tr_b16 v[84:85], v2 offset:8480
    ds_read_b64_tr_b16 v[86:87], v2 offset:8992
    v_mfma_f32_16x16x32_bf16 v[36:39], v[196:199], v[88:91], v[36:39]
    s_add_u32 m0, s14, 1056
    s_add_u32 s41, s38, 8192
    buffer_load_dwordx4 v14, s[20:23], s41 offen nt lds
    v_mfma_f32_16x16x32_bf16 v[40:43], v[180:183], v[92:95], v[40:43]
    ds_read_b64_tr_b16 v[88:89], v2 offset:8512
    ds_read_b64_tr_b16 v[90:91], v2 offset:9024
    v_mfma_f32_16x16x32_bf16 v[44:47], v[196:199], v[92:95], v[44:47]
    v_cvt_pk_bf16_f32 v248, v160, v161
    v_cvt_pk_bf16_f32 v249, v162, v163
    v_cvt_pk_bf16_f32 v250, v168, v169
    v_cvt_pk_bf16_f32 v251, v170, v171
    s_add_u32 s92, s90, 14680064
    buffer_store_dwordx4 v[128:131], v4, s[16:19], s92 offen offset:2048 sc1
    s_waitcnt lgkmcnt(10)
    v_mfma_f32_16x16x32_bf16 v[48:51], v[180:183], v[96:99], v[48:51]
    ds_read_b64_tr_b16 v[92:93], v2 offset:8544
    ds_read_b64_tr_b16 v[94:95], v2 offset:9056
    v_mfma_f32_16x16x32_bf16 v[52:55], v[196:199], v[96:99], v[52:55]
    v_cvt_pk_bf16_f32 v252, v164, v165
    v_cvt_pk_bf16_f32 v253, v166, v167
    v_cvt_pk_bf16_f32 v254, v172, v173
    v_cvt_pk_bf16_f32 v255, v174, v175
    s_add_u32 m0, s14, 2112
    s_add_u32 s41, s38, 16384
    buffer_load_dwordx4 v14, s[20:23], s41 offen nt lds
    v_mfma_f32_16x16x32_bf16 v[56:59], v[180:183], v[100:103], v[56:59]
    ds_read_b64_tr_b16 v[96:97], v2 offset:8576
    ds_read_b64_tr_b16 v[98:99], v2 offset:9088
    v_mfma_f32_16x16x32_bf16 v[60:63], v[196:199], v[100:103], v[60:63]
    v_permlane16_swap_b32 v248, v250
    v_permlane16_swap_b32 v249, v251
    v_permlane16_swap_b32 v252, v254
    v_permlane16_swap_b32 v253, v255
    s_waitcnt lgkmcnt(10)
    v_mfma_f32_16x16x32_bf16 v[64:67], v[180:183], v[104:107], v[64:67]
    ds_read_b64_tr_b16 v[100:101], v2 offset:8608
    ds_read_b64_tr_b16 v[102:103], v2 offset:9120
    v_mfma_f32_16x16x32_bf16 v[68:71], v[196:199], v[104:107], v[68:71]
    v_permlane32_swap_b32 v248, v250
    v_permlane32_swap_b32 v249, v251
    v_permlane32_swap_b32 v252, v254
    v_permlane32_swap_b32 v253, v255
    s_add_u32 m0, s14, 3168
    s_add_u32 s41, s38, 24576
    buffer_load_dwordx4 v14, s[20:23], s41 offen nt lds
    v_mfma_f32_16x16x32_bf16 v[72:75], v[180:183], v[108:111], v[72:75]
    ds_read_b64_tr_b16 v[104:105], v2 offset:8640
    ds_read_b64_tr_b16 v[106:107], v2 offset:9152
    v_mfma_f32_16x16x32_bf16 v[76:79], v[196:199], v[108:111], v[76:79]
    s_waitcnt lgkmcnt(10)
    v_mfma_f32_16x16x32_bf16 v[16:19], v[184:187], v[80:83], v[16:19]
    ds_read_b64_tr_b16 v[108:109], v2 offset:8672
    ds_read_b64_tr_b16 v[110:111], v2 offset:9184
    v_mfma_f32_16x16x32_bf16 v[20:23], v[200:203], v[80:83], v[20:23]
    v_mfma_f32_16x16x32_bf16 v[24:27], v[184:187], v[84:87], v[24:27]
    ds_read_b64_tr_b16 v[80:81], v2 offset:16896
    ds_read_b64_tr_b16 v[82:83], v2 offset:17408
    v_mfma_f32_16x16x32_bf16 v[28:31], v[200:203], v[84:87], v[28:31]
    s_waitcnt lgkmcnt(10)
    v_mfma_f32_16x16x32_bf16 v[32:35], v[184:187], v[88:91], v[32:35]
    ds_read_b64_tr_b16 v[84:85], v2 offset:16928
    ds_read_b64_tr_b16 v[86:87], v2 offset:17440
    v_mfma_f32_16x16x32_bf16 v[36:39], v[200:203], v[88:91], v[36:39]
    v_mfma_f32_16x16x32_bf16 v[40:43], v[184:187], v[92:95], v[40:43]
    ds_read_b64_tr_b16 v[88:89], v2 offset:16960
    ds_read_b64_tr_b16 v[90:91], v2 offset:17472
    v_mfma_f32_16x16x32_bf16 v[44:47], v[200:203], v[92:95], v[44:47]
    s_add_u32 s92, s90, 14680064
    buffer_store_dwordx4 v[136:139], v4, s[16:19], s92 offen offset:3072 sc1
    s_waitcnt lgkmcnt(10)
    v_mfma_f32_16x16x32_bf16 v[48:51], v[184:187], v[96:99], v[48:51]
    ds_read_b64_tr_b16 v[92:93], v2 offset:16992
    ds_read_b64_tr_b16 v[94:95], v2 offset:17504
    v_mfma_f32_16x16x32_bf16 v[52:55], v[200:203], v[96:99], v[52:55]
    v_mfma_f32_16x16x32_bf16 v[56:59], v[184:187], v[100:103], v[56:59]
    ds_read_b64_tr_b16 v[96:97], v2 offset:17024
    ds_read_b64_tr_b16 v[98:99], v2 offset:17536
    v_mfma_f32_16x16x32_bf16 v[60:63], v[200:203], v[100:103], v[60:63]
    s_waitcnt lgkmcnt(10)
    v_mfma_f32_16x16x32_bf16 v[64:67], v[184:187], v[104:107], v[64:67]
    ds_read_b64_tr_b16 v[100:101], v2 offset:17056
    ds_read_b64_tr_b16 v[102:103], v2 offset:17568
    v_mfma_f32_16x16x32_bf16 v[68:71], v[200:203], v[104:107], v[68:71]
    v_mfma_f32_16x16x32_bf16 v[72:75], v[184:187], v[108:111], v[72:75]
    ds_read_b64_tr_b16 v[104:105], v2 offset:17088
    ds_read_b64_tr_b16 v[106:107], v2 offset:17600
    v_mfma_f32_16x16x32_bf16 v[76:79], v[200:203], v[108:111], v[76:79]
    s_waitcnt lgkmcnt(10)
    v_mfma_f32_16x16x32_bf16 v[16:19], v[176:179], v[80:83], v[16:19]
    ds_read_b64_tr_b16 v[108:109], v2 offset:17120
    ds_read_b64_tr_b16 v[110:111], v2 offset:17632
    v_mfma_f32_16x16x32_bf16 v[20:23], v[192:195], v[80:83], v[20:23]
    v_mfma_f32_16x16x32_bf16 v[24:27], v[176:179], v[84:87], v[24:27]
    ds_read_b64_tr_b16 v[80:81], v2 offset:25344
    ds_read_b64_tr_b16 v[82:83], v2 offset:25856
    v_mfma_f32_16x16x32_bf16 v[28:31], v[192:195], v[84:87], v[28:31]
    s_waitcnt lgkmcnt(10)
    v_mfma_f32_16x16x32_bf16 v[32:35], v[176:179], v[88:91], v[32:35]
    ds_read_b64_tr_b16 v[84:85], v2 offset:25376
    ds_read_b64_tr_b16 v[86:87], v2 offset:25888
    v_mfma_f32_16x16x32_bf16 v[36:39], v[192:195], v[88:91], v[36:39]
    v_mfma_f32_16x16x32_bf16 v[40:43], v[176:179], v[92:95], v[40:43]
    ds_read_b64_tr_b16 v[88:89], v2 offset:25408
    ds_read_b64_tr_b16 v[90:91], v2 offset:25920
    v_mfma_f32_16x16x32_bf16 v[44:47], v[192:195], v[92:95], v[44:47]
    s_waitcnt lgkmcnt(10)
    v_mfma_f32_16x16x32_bf16 v[48:51], v[176:179], v[96:99], v[48:51]
    ds_read_b64_tr_b16 v[92:93], v2 offset:25440
    ds_read_b64_tr_b16 v[94:95], v2 offset:25952
    v_mfma_f32_16x16x32_bf16 v[52:55], v[192:195], v[96:99], v[52:55]
    v_mfma_f32_16x16x32_bf16 v[56:59], v[176:179], v[100:103], v[56:59]
    ds_read_b64_tr_b16 v[96:97], v2 offset:25472
    ds_read_b64_tr_b16 v[98:99], v2 offset:25984
    v_mfma_f32_16x16x32_bf16 v[60:63], v[192:195], v[100:103], v[60:63]
    s_waitcnt lgkmcnt(10)
    v_mfma_f32_16x16x32_bf16 v[64:67], v[176:179], v[104:107], v[64:67]
    ds_read_b64_tr_b16 v[100:101], v2 offset:25504
    ds_read_b64_tr_b16 v[102:103], v2 offset:26016
    v_mfma_f32_16x16x32_bf16 v[68:71], v[192:195], v[104:107], v[68:71]
    s_lshl_b32 s93, s34, 4
    s_add_u32 s93, s93, 692224
    v_lshrrev_b32 v13, 2, v4
    v_min_u32 v13, 12, v13
    buffer_load_dword v12, v13, s[16:19], s93 offen sc1
    v_mfma_f32_16x16x32_bf16 v[72:75], v[176:179], v[108:111], v[72:75]
    ds_read_b64_tr_b16 v[104:105], v2 offset:25536
    ds_read_b64_tr_b16 v[106:107], v2 offset:26048
    v_mfma_f32_16x16x32_bf16 v[76:79], v[192:195], v[108:111], v[76:79]
    s_waitcnt lgkmcnt(10)
    v_mfma_f32_16x16x32_bf16 v[16:19], v[188:191], v[80:83], v[16:19]
    ds_read_b64_tr_b16 v[108:109], v2 offset:25568
    ds_read_b64_tr_b16 v[110:111], v2 offset:26080
    v_mfma_f32_16x16x32_bf16 v[20:23], v[204:207], v[80:83], v[20:23]
    v_add_u32 v2, s11, v1
    s_waitcnt vmcnt(10)
    s_barrier
    v_mfma_f32_16x16x32_bf16 v[24:27], v[188:191], v[84:87], v[24:27]
    ds_read_b64_tr_b16 v[80:81], v2 offset:0
    ds_read_b64_tr_b16 v[82:83], v2 offset:512
    v_mfma_f32_16x16x32_bf16 v[28:31], v[204:207], v[84:87], v[28:31]
    s_waitcnt lgkmcnt(10)
    v_mfma_f32_16x16x32_bf16 v[32:35], v[188:191], v[88:91], v[32:35]
    ds_read_b64_tr_b16 v[84:85], v2 offset:32
    ds_read_b64_tr_b16 v[86:87], v2 offset:544
    v_mfma_f32_16x16x32_bf16 v[36:39], v[204:207], v[88:91], v[36:39]
    s_add_u32 s92, s90, 14684160
    buffer_store_dwordx4 v[240:243], v4, s[16:19], s92 offen offset:0 sc1
    v_mfma_f32_16x16x32_bf16 v[40:43], v[188:191], v[92:95], v[40:43]
    ds_read_b64_tr_b16 v[88:89], v2 offset:8448
    ds_read_b64_tr_b16 v[90:91], v2 offset:8960
    v_mfma_f32_16x16x32_bf16 v[44:47], v[204:207], v[92:95], v[44:47]
    s_waitcnt lgkmcnt(10)
    v_mfma_f32_16x16x32_bf16 v[48:51], v[188:191], v[96:99], v[48:51]
    ds_read_b64_tr_b16 v[92:93], v2 offset:8480
    ds_read_b64_tr_b16 v[94:95], v2 offset:8992
    v_mfma_f32_16x16x32_bf16 v[52:55], v[204:207], v[96:99], v[52:55]
    v_mfma_f32_16x16x32_bf16 v[56:59], v[188:191], v[100:103], v[56:59]
    ds_read_b64_tr_b16 v[96:97], v2 offset:16896
    ds_read_b64_tr_b16 v[98:99], v2 offset:17408
    v_mfma_f32_16x16x32_bf16 v[60:63], v[204:207], v[100:103], v[60:63]
    s_waitcnt lgkmcnt(10)
    v_mfma_f32_16x16x32_bf16 v[64:67], v[188:191], v[104:107], v[64:67]
    ds_read_b64_tr_b16 v[100:101], v2 offset:16928
    ds_read_b64_tr_b16 v[102:103], v2 offset:17440
    v_mfma_f32_16x16x32_bf16 v[68:71], v[204:207], v[104:107], v[68:71]
    v_mfma_f32_16x16x32_bf16 v[72:75], v[188:191], v[108:111], v[72:75]
    ds_read_b64_tr_b16 v[104:105], v2 offset:25344
    ds_read_b64_tr_b16 v[106:107], v2 offset:25856
    v_mfma_f32_16x16x32_bf16 v[76:79], v[204:207], v[108:111], v[76:79]
    s_waitcnt vmcnt(1)
    v_cmp_ne_u32 vcc, s91, v12
    s_cbranch_vccnz F_slow0
F_ok0:
    s_waitcnt lgkmcnt(10)
    v_mfma_f32_16x16x32_bf16 v[16:19], v[212:215], v[80:83], v[16:19]
    ds_read_b64_tr_b16 v[108:109], v2 offset:25376
    ds_read_b64_tr_b16 v[110:111], v2 offset:25888
    v_mfma_f32_16x16x32_bf16 v[20:23], v[228:231], v[80:83], v[20:23]
    s_add_u32 s42, s40, 0
    buffer_load_dwordx4 v[112:115], v4, s[16:19], s42 offen offset:0 sc1
    v_mfma_f32_16x16x32_bf16 v[24:27], v[212:215], v[84:87], v[24:27]
    ds_read_b64_tr_b16 v[80:81], v2 offset:64
    ds_read_b64_tr_b16 v[82:83], v2 offset:576
    v_mfma_f32_16x16x32_bf16 v[28:31], v[228:231], v[84:87], v[28:31]
    buffer_load_dwordx4 v[116:119], v4, s[16:19], s42 offen offset:1024 sc1
    s_waitcnt lgkmcnt(10)
    v_mfma_f32_16x16x32_bf16 v[16:19], v[216:219], v[88:91], v[16:19]
    ds_read_b64_tr_b16 v[84:85], v2 offset:96
    ds_read_b64_tr_b16 v[86:87], v2 offset:608
    v_mfma_f32_16x16x32_bf16 v[20:23], v[232:235], v[88:91], v[20:23]
    v_mfma_f32_16x16x32_bf16 v[24:27], v[216:219], v[92:95], v[24:27]
    ds_read_b64_tr_b16 v[88:89], v2 offset:8512
    ds_read_b64_tr_b16 v[90:91], v2 offset:9024
    v_mfma_f32_16x16x32_bf16 v[28:31], v[232:235], v[92:95], v[28:31]
    buffer_load_dwordx4 v[120:123], v4, s[16:19], s42 offen offset:2048 sc1
    s_waitcnt lgkmcnt(10)
    v_mfma_f32_16x16x32_bf16 v[16:19], v[208:211], v[96:99], v[16:19]
    ds_read_b64_tr_b16 v[92:93], v2 offset:8544
    ds_read_b64_tr_b16 v[94:95], v2 offset:9056
    v_mfma_f32_16x16x32_bf16 v[20:23], v[224:227], v[96:99], v[20:23]
    s_add_u32 s92, s90, 14684160
    buffer_store_dwordx4 v[244:247], v4, s[16:19], s92 offen offset:1024 sc1
    buffer_load_dwordx4 v[124:127], v4, s[16:19], s42 offen offset:3072 sc1
    v_mfma_f32_16x16x32_bf16 v[24:27], v[208:211], v[100:103], v[24:27]
    ds_read_b64_tr_b16 v[96:97], v2 offset:16960
    ds_read_b64_tr_b16 v[98:99], v2 offset:17472
    v_mfma_f32_16x16x32_bf16 v[28:31], v[224:227], v[100:103], v[28:31]
    s_waitcnt lgkmcnt(10)
    v_mfma_f32_16x16x32_bf16 v[16:19], v[220:223], v[104:107], v[16:19]
    ds_read_b64_tr_b16 v[100:101], v2 offset:16992
    ds_read_b64_tr_b16 v[102:103], v2 offset:17504
    v_mfma_f32_16x16x32_bf16 v[20:23], v[236:239], v[104:107], v[20:23]
    s_add_u32 s42, s40, 4096
    buffer_load_dwordx4 v[128:131], v4, s[16:19], s42 offen offset:0 sc1
    v_mfma_f32_16x16x32_bf16 v[24:27], v[220:223], v[108:111], v[24:27]
    ds_read_b64_tr_b16 v[104:105], v2 offset:25408
    ds_read_b64_tr_b16 v[106:107], v2 offset:25920
    v_mfma_f32_16x16x32_bf16 v[28:31], v[236:239], v[108:111], v[28:31]
    buffer_load_dwordx4 v[132:135], v4, s[16:19], s42 offen offset:1024 sc1
    s_waitcnt lgkmcnt(10)
    v_mfma_f32_16x16x32_bf16 v[32:35], v[212:215], v[80:83], v[32:35]
    ds_read_b64_tr_b16 v[108:109], v2 offset:25440
    ds_read_b64_tr_b16 v[110:111], v2 offset:25952
    v_mfma_f32_16x16x32_bf16 v[36:39], v[228:231], v[80:83], v[36:39]
    v_mfma_f32_16x16x32_bf16 v[40:43], v[212:215], v[84:87], v[40:43]
    ds_read_b64_tr_b16 v[80:81], v2 offset:128
    ds_read_b64_tr_b16 v[82:83], v2 offset:640
    v_mfma_f32_16x16x32_bf16 v[44:47], v[228:231], v[84:87], v[44:47]
    buffer_load_dwordx4 v[136:139], v4, s[16:19], s42 offen offset:2048 sc1
    s_waitcnt lgkmcnt(10)
    v_mfma_f32_16x16x32_bf16 v[32:35], v[216:219], v[88:91], v[32:35]
    ds_read_b64_tr_b16 v[84:85], v2 offset:160
    ds_read_b64_tr_b16 v[86:87], v2 offset:672
    v_mfma_f32_16x16x32_bf16 v[36:39], v[232:235], v[88:91], v[36:39]
    buffer_load_dwordx4 v[140:143], v4, s[16:19], s42 offen offset:3072 sc1
    v_mfma_f32_16x16x32_bf16 v[40:43], v[216:219], v[92:95], v[40:43]
    ds_read_b64_tr_b16 v[88:89], v2 offset:8576
    ds_read_b64_tr_b16 v[90:91], v2 offset:9088
    v_mfma_f32_16x16x32_bf16 v[44:47], v[232:235], v[92:95], v[44:47]
    v_cvt_pk_bf16_f32 v192, v16, v17
    v_cvt_pk_bf16_f32 v193, v18, v19
    v_cvt_pk_bf16_f32 v194, v24, v25
    v_cvt_pk_bf16_f32 v195, v26, v27
    s_waitcnt lgkmcnt(10)
    v_mfma_f32_16x16x32_bf16 v[32:35], v[208:211], v[96:99], v[32:35]
    ds_read_b64_tr_b16 v[92:93], v2 offset:8608
    ds_read_b64_tr_b16 v[94:95], v2 offset:9120
    v_mfma_f32_16x16x32_bf16 v[36:39], v[224:227], v[96:99], v[36:39]
    s_add_u32 m0, s14, 34816
    s_add_u32 s41, s38, 1048576
    buffer_load_dwordx4 v14, s[20:23], s41 offen nt lds
    v_cvt_pk_bf16_f32 v196, v20, v21
    v_cvt_pk_bf16_f32 v197, v22, v23
    v_cvt_pk_bf16_f32 v198, v28, v29
    v_cvt_pk_bf16_f32 v199, v30, v31
    v_mfma_f32_16x16x32_bf16 v[40:43], v[208:211], v[100:103], v[40:43]
    ds_read_b64_tr_b16 v[96:97], v2 offset:17024
    ds_read_b64_tr_b16 v[98:99], v2 offset:17536
    v_mfma_f32_16x16x32_bf16 v[44:47], v[224:227], v[100:103], v[44:47]
    s_add_u32 m0, s14, 35872
    s_add_u32 s41, s38, 1056768
    buffer_load_dwordx4 v14, s[20:23], s41 offen nt lds
    v_permlane16_swap_b32 v192, v194
    v_permlane16_swap_b32 v193, v195
    v_permlane16_swap_b32 v196, v198
    v_permlane16_swap_b32 v197, v199
    s_waitcnt lgkmcnt(10)
    v_mfma_f32_16x16x32_bf16 v[32:35], v[220:223], v[104:107], v[32:35]
    ds_read_b64_tr_b16 v[100:101], v2 offset:17056
    ds_read_b64_tr_b16 v[102:103], v2 offset:17568
    v_mfma_f32_16x16x32_bf16 v[36:39], v[236:239], v[104:107], v[36:39]
    v_permlane32_swap_b32 v192, v194
    v_permlane32_swap_b32 v193, v195
    v_permlane32_swap_b32 v196, v198
    v_permlane32_swap_b32 v197, v199
    v_mfma_f32_16x16x32_bf16 v[40:43], v[220:223], v[108:111], v[40:43]
    ds_read_b64_tr_b16 v[104:105], v2 offset:25472
    ds_read_b64_tr_b16 v[106:107], v2 offset:25984
    v_mfma_f32_16x16x32_bf16 v[44:47], v[236:239], v[108:111], v[44:47]
    s_add_u32 s92, s90, 14684160
    buffer_store_dwordx4 v[248:251], v4, s[16:19], s92 offen offset:2048 sc1
    s_add_u32 m0, s14, 36928
    s_add_u32 s41, s38, 1064960
    buffer_load_dwordx4 v14, s[20:23], s41 offen nt lds
    s_waitcnt lgkmcnt(10)
    v_mfma_f32_16x16x32_bf16 v[48:51], v[212:215], v[80:83], v[48:51]
    ds_read_b64_tr_b16 v[108:109], v2 offset:25504
    ds_read_b64_tr_b16 v[110:111], v2 offset:26016
    v_mfma_f32_16x16x32_bf16 v[52:55], v[228:231], v[80:83], v[52:55]
    v_mfma_f32_16x16x32_bf16 v[56:59], v[212:215], v[84:87], v[56:59]
    ds_read_b64_tr_b16 v[80:81], v2 offset:192
    ds_read_b64_tr_b16 v[82:83], v2 offset:704
    v_mfma_f32_16x16x32_bf16 v[60:63], v[228:231], v[84:87], v[60:63]
    s_add_u32 m0, s14, 37984
    s_add_u32 s41, s38, 1073152
    buffer_load_dwordx4 v14, s[20:23], s41 offen nt lds
    s_waitcnt lgkmcnt(10)
    v_mfma_f32_16x16x32_bf16 v[48:51], v[216:219], v[88:91], v[48:51]
    ds_read_b64_tr_b16 v[84:85], v2 offset:224
    ds_read_b64_tr_b16 v[86:87], v2 offset:736
    v_mfma_f32_16x16x32_bf16 v[52:55], v[232:235], v[88:91], v[52:55]
    s_add_u32 s42, s40, 8192
    buffer_load_dwordx4 v[144:147], v4, s[16:19], s42 offen offset:0 sc1
    v_mfma_f32_16x16x32_bf16 v[56:59], v[216:219], v[92:95], v[56:59]
    ds_read_b64_tr_b16 v[88:89], v2 offset:8640
    ds_read_b64_tr_b16 v[90:91], v2 offset:9152
    v_mfma_f32_16x16x32_bf16 v[60:63], v[232:235], v[92:95], v[60:63]
    v_cvt_pk_bf16_f32 v200, v32, v33
    v_cvt_pk_bf16_f32 v201, v34, v35
    v_cvt_pk_bf16_f32 v202, v40, v41
    v_cvt_pk_bf16_f32 v203, v42, v43
    s_waitcnt lgkmcnt(10)
    v_mfma_f32_16x16x32_bf16 v[48:51], v[208:211], v[96:99], v[48:51]
    ds_read_b64_tr_b16 v[92:93], v2 offset:8672
    ds_read_b64_tr_b16 v[94:95], v2 offset:9184
    v_mfma_f32_16x16x32_bf16 v[52:55], v[224:227], v[96:99], v[52:55]
    buffer_load_dwordx4 v[148:151], v4, s[16:19], s42 offen offset:1024 sc1
    v_cvt_pk_bf16_f32 v204, v36, v37
    v_cvt_pk_bf16_f32 v205, v38, v39
    v_cvt_pk_bf16_f32 v206, v44, v45
    v_cvt_pk_bf16_f32 v207, v46, v47
    v_mfma_f32_16x16x32_bf16 v[56:59], v[208:211], v[100:103], v[56:59]
    ds_read_b64_tr_b16 v[96:97], v2 offset:17088
    ds_read_b64_tr_b16 v[98:99], v2 offset:17600
    v_mfma_f32_16x16x32_bf16 v[60:63], v[224:227], v[100:103], v[60:63]
    buffer_load_dwordx4 v[152:155], v4, s[16:19], s42 offen offset:2048 sc1
    v_permlane16_swap_b32 v200, v202
    v_permlane16_swap_b32 v201, v203
    v_permlane16_swap_b32 v204, v206
    v_permlane16_swap_b32 v205, v207
    s_waitcnt lgkmcnt(10)
    v_mfma_f32_16x16x32_bf16 v[48:51], v[220:223], v[104:107], v[48:51]
    ds_read_b64_tr_b16 v[100:101], v2 offset:17120
    ds_read_b64_tr_b16 v[102:103], v2 offset:17632
    v_mfma_f32_16x16x32_bf16 v[52:55], v[236:239], v[104:107], v[52:55]
    v_permlane32_swap_b32 v200, v202
    v_permlane32_swap_b32 v201, v203
    v_permlane32_swap_b32 v204, v206
    v_permlane32_swap_b32 v205, v207
    v_mfma_f32_16x16x32_bf16 v[56:59], v[220:223], v[108:111], v[56:59]
    ds_read_b64_tr_b16 v[104:105], v2 offset:25536
    ds_read_b64_tr_b16 v[106:107], v2 offset:26048
    v_mfma_f32_16x16x32_bf16 v[60:63], v[236:239], v[108:111], v[60:63]
    buffer_load_dwordx4 v[156:159], v4, s[16:19], s42 offen offset:3072 sc1
    s_waitcnt lgkmcnt(10)
    v_mfma_f32_16x16x32_bf16 v[64:67], v[212:215], v[80:83], v[64:67]
    ds_read_b64_tr_b16 v[108:109], v2 offset:25568
    ds_read_b64_tr_b16 v[110:111], v2 offset:26080
    v_mfma_f32_16x16x32_bf16 v[68:71], v[228:231], v[80:83], v[68:71]
    v_add_u32 v2, s8, v1
    s_barrier
    s_add_u32 s42, s40, 12288
    buffer_load_dwordx4 v[160:163], v4, s[16:19], s42 offen offset:0 sc1
    v_mfma_f32_16x16x32_bf16 v[72:75], v[212:215], v[84:87], v[72:75]
    ds_read_b64_tr_b16 v[80:81], v2 offset:0
    ds_read_b64_tr_b16 v[82:83], v2 offset:512
    v_mfma_f32_16x16x32_bf16 v[76:79], v[228:231], v[84:87], v[76:79]
    s_waitcnt lgkmcnt(10)
    v_mfma_f32_16x16x32_bf16 v[64:67], v[216:219], v[88:91], v[64:67]
    ds_read_b64_tr_b16 v[84:85], v2 offset:32
    ds_read_b64_tr_b16 v[86:87], v2 offset:544
    v_mfma_f32_16x16x32_bf16 v[68:71], v[232:235], v[88:91], v[68:71]
    s_add_u32 s92, s90, 14684160
    buffer_store_dwordx4 v[252:255], v4, s[16:19], s92 offen offset:3072 sc1
    buffer_load_dwordx4 v[164:167], v4, s[16:19], s42 offen offset:1024 sc1
    v_mfma_f32_16x16x32_bf16 v[72:75], v[216:219], v[92:95], v[72:75]
    ds_read_b64_tr_b16 v[88:89], v2 offset:8448
    ds_read_b64_tr_b16 v[90:91], v2 offset:8960
    v_mfma_f32_16x16x32_bf16 v[76:79], v[232:235], v[92:95], v[76:79]
    buffer_load_dwordx4 v[168:171], v4, s[16:19], s42 offen offset:2048 sc1
    v_cvt_pk_bf16_f32 v240, v48, v49
    v_cvt_pk_bf16_f32 v241, v50, v51
    v_cvt_pk_bf16_f32 v242, v56, v57
    v_cvt_pk_bf16_f32 v243, v58, v59
    s_waitcnt lgkmcnt(10)
    v_mfma_f32_16x16x32_bf16 v[64:67], v[208:211], v[96:99], v[64:67]
    ds_read_b64_tr_b16 v[92:93], v2 offset:8480
    ds_read_b64_tr_b16 v[94:95], v2 offset:8992
    v_mfma_f32_16x16x32_bf16 v[68:71], v[224:227], v[96:99], v[68:71]
    v_cvt_pk_bf16_f32 v244, v52, v53
    v_cvt_pk_bf16_f32 v245, v54, v55
    v_cvt_pk_bf16_f32 v246, v60, v61
    v_cvt_pk_bf16_f32 v247, v62, v63
    v_mfma_f32_16x16x32_bf16 v[72:75], v[208:211], v[100:103], v[72:75]
    ds_read_b64_tr_b16 v[96:97], v2 offset:16896
    ds_read_b64_tr_b16 v[98:99], v2 offset:17408
    v_mfma_f32_16x16x32_bf16 v[76:79], v[224:227], v[100:103], v[76:79]
    buffer_load_dwordx4 v[172:175], v4, s[16:19], s42 offen offset:3072 sc1
    v_permlane16_swap_b32 v240, v242
    v_permlane16_swap_b32 v241, v243
    v_permlane16_swap_b32 v244, v246
    v_permlane16_swap_b32 v245, v247
    s_waitcnt lgkmcnt(10)
    v_mfma_f32_16x16x32_bf16 v[64:67], v[220:223], v[104:107], v[64:67]
    ds_read_b64_tr_b16 v[100:101], v2 offset:16928
    ds_read_b64_tr_b16 v[102:103], v2 offset:17440
    v_mfma_f32_16x16x32_bf16 v[68:71], v[236:239], v[104:107], v[68:71]
    v_permlane32_swap_b32 v240, v242
    v_permlane32_swap_b32 v241, v243
    v_permlane32_swap_b32 v244, v246
    v_permlane32_swap_b32 v245, v247
    v_mfma_f32_16x16x32_bf16 v[72:75], v[220:223], v[108:111], v[72:75]
    ds_read_b64_tr_b16 v[104:105], v2 offset:25344
    ds_read_b64_tr_b16 v[106:107], v2 offset:25856
    v_mfma_f32_16x16x32_bf16 v[76:79], v[236:239], v[108:111], v[76:79]
    s_waitcnt vmcnt(14)
    s_cmp_ge_u32 s3, 4
    s_cbranch_scc1 S_path
    s_waitcnt lgkmcnt(10)
    v_mfma_f32_16x16x32_bf16 v[16:19], v[80:83], v[112:115], 0
    ds_read_b64_tr_b16 v[108:109], v2 offset:25376
    ds_read_b64_tr_b16 v[110:111], v2 offset:25888
    v_mfma_f32_16x16x32_bf16 v[24:27], v[80:83], v[116:119], 0
    s_add_u32 m0, s15, 69632
    s_add_u32 s41, s38, 2097152
    buffer_load_dwordx4 v14, s[20:23], s41 offen nt lds
    v_mfma_f32_16x16x32_bf16 v[20:23], v[84:87], v[112:115], 0
    ds_read_b64_tr_b16 v[80:81], v2 offset:64
    ds_read_b64_tr_b16 v[82:83], v2 offset:576
    v_mfma_f32_16x16x32_bf16 v[28:31], v[84:87], v[116:119], 0
    s_waitcnt lgkmcnt(10)
    v_mfma_f32_16x16x32_bf16 v[16:19], v[88:91], v[120:123], v[16:19]
    ds_read_b64_tr_b16 v[84:85], v2 offset:96
    ds_read_b64_tr_b16 v[86:87], v2 offset:608
    v_mfma_f32_16x16x32_bf16 v[24:27], v[88:91], v[124:127], v[24:27]
    s_add_u32 s92, s90, 32505856
    buffer_store_dwordx4 v[192:195], v4, s[16:19], s92 offen offset:0 sc1
    v_mfma_f32_16x16x32_bf16 v[20:23], v[92:95], v[120:123], v[20:23]
    ds_read_b64_tr_b16 v[88:89], v2 offset:8512
    ds_read_b64_tr_b16 v[90:91], v2 offset:9024
    v_mfma_f32_16x16x32_bf16 v[28:31], v[92:95], v[124:127], v[28:31]
    v_cvt_pk_bf16_f32 v248, v64, v65
    v_cvt_pk_bf16_f32 v249, v66, v67
    v_cvt_pk_bf16_f32 v250, v72, v73
    v_cvt_pk_bf16_f32 v251, v74, v75
    v_cvt_pk_bf16_f32 v252, v68, v69
    s_add_u32 m0, s15, 70688
    s_add_u32 s41, s38, 2105344
    buffer_load_dwordx4 v14, s[20:23], s41 offen nt lds
    s_waitcnt lgkmcnt(10)
    v_mfma_f32_16x16x32_bf16 v[16:19], v[96:99], v[128:131], v[16:19]
    ds_read_b64_tr_b16 v[92:93], v2 offset:8544
    ds_read_b64_tr_b16 v[94:95], v2 offset:9056
    v_mfma_f32_16x16x32_bf16 v[24:27], v[96:99], v[132:135], v[24:27]
    v_cvt_pk_bf16_f32 v253, v70, v71
    v_cvt_pk_bf16_f32 v254, v76, v77
    v_cvt_pk_bf16_f32 v255, v78, v79
    s_nop 0
    v_mfma_f32_16x16x32_bf16 v[20:23], v[100:103], v[128:131], v[20:23]
    ds_read_b64_tr_b16 v[96:97], v2 offset:16960
    ds_read_b64_tr_b16 v[98:99], v2 offset:17472
    v_mfma_f32_16x16x32_bf16 v[28:31], v[100:103], v[132:135], v[28:31]
    v_permlane16_swap_b32 v248, v250
    v_permlane16_swap_b32 v249, v251
    v_permlane16_swap_b32 v252, v254
    v_permlane16_swap_b32 v253, v255
    s_waitcnt lgkmcnt(10)
    v_mfma_f32_16x16x32_bf16 v[16:19], v[104:107], v[136:139], v[16:19]
    ds_read_b64_tr_b16 v[100:101], v2 offset:16992
    ds_read_b64_tr_b16 v[102:103], v2 offset:17504
    v_mfma_f32_16x16x32_bf16 v[24:27], v[104:107], v[140:143], v[24:27]
    v_permlane32_swap_b32 v248, v250
    v_permlane32_swap_b32 v249, v251
    v_permlane32_swap_b32 v252, v254
    v_permlane32_swap_b32 v253, v255
    s_add_u32 m0, s15, 71744
    s_add_u32 s41, s38, 2113536
    buffer_load_dwordx4 v14, s[20:23], s41 offen nt lds
    v_mfma_f32_16x16x32_bf16 v[20:23], v[108:111], v[136:139], v[20:23]
    ds_read_b64_tr_b16 v[104:105], v2 offset:25408
    ds_read_b64_tr_b16 v[106:107], v2 offset:25920
    v_mfma_f32_16x16x32_bf16 v[28:31], v[108:111], v[140:143], v[28:31]
    s_waitcnt lgkmcnt(10)
    v_mfma_f32_16x16x32_bf16 v[32:35], v[80:83], v[112:115], 0
    ds_read_b64_tr_b16 v[108:109], v2 offset:25440
    ds_read_b64_tr_b16 v[110:111], v2 offset:25952
    v_mfma_f32_16x16x32_bf16 v[40:43], v[80:83], v[116:119], 0
    v_mfma_f32_16x16x32_bf16 v[36:39], v[84:87], v[112:115], 0
    ds_read_b64_tr_b16 v[80:81], v2 offset:128
    ds_read_b64_tr_b16 v[82:83], v2 offset:640
    v_mfma_f32_16x16x32_bf16 v[44:47], v[84:87], v[116:119], 0
    s_add_u32 m0, s15, 72800
    s_add_u32 s41, s38, 2121728
    buffer_load_dwordx4 v14, s[20:23], s41 offen nt lds
    s_waitcnt lgkmcnt(10)
    v_mfma_f32_16x16x32_bf16 v[32:35], v[88:91], v[120:123], v[32:35]
    ds_read_b64_tr_b16 v[84:85], v2 offset:160
    ds_read_b64_tr_b16 v[86:87], v2 offset:672
    v_mfma_f32_16x16x32_bf16 v[40:43], v[88:91], v[124:127], v[40:43]
    v_mfma_f32_16x16x32_bf16 v[36:39], v[92:95], v[120:123], v[36:39]
    ds_read_b64_tr_b16 v[88:89], v2 offset:8576
    ds_read_b64_tr_b16 v[90:91], v2 offset:9088
    v_mfma_f32_16x16x32_bf16 v[44:47], v[92:95], v[124:127], v[44:47]
    s_waitcnt lgkmcnt(10)
    v_mfma_f32_16x16x32_bf16 v[32:35], v[96:99], v[128:131], v[32:35]
    ds_read_b64_tr_b16 v[92:93], v2 offset:8608
    ds_read_b64_tr_b16 v[94:95], v2 offset:9120
    v_mfma_f32_16x16x32_bf16 v[40:43], v[96:99], v[132:135], v[40:43]
    s_add_u32 s92, s90, 32509952
    buffer_store_dwordx4 v[196:199], v4, s[16:19], s92 offen offset:0 sc1
    s_add_u32 s42, s40, 16384
    buffer_load_dwordx4 v[176:179], v4, s[16:19], s42 offen offset:0 sc1
    v_mfma_f32_16x16x32_bf16 v[36:39], v[100:103], v[128:131], v[36:39]
    ds_read_b64_tr_b16 v[96:97], v2 offset:17024
    ds_read_b64_tr_b16 v[98:99], v2 offset:17536
    v_mfma_f32_16x16x32_bf16 v[44:47], v[100:103], v[132:135], v[44:47]
    s_waitcnt lgkmcnt(10)
    v_mfma_f32_16x16x32_bf16 v[32:35], v[104:107], v[136:139], v[32:35]
    ds_read_b64_tr_b16 v[100:101], v2 offset:17056
    ds_read_b64_tr_b16 v[102:103], v2 offset:17568
    v_mfma_f32_16x16x32_bf16 v[40:43], v[104:107], v[140:143], v[40:43]
    v_mfma_f32_16x16x32_bf16 v[36:39], v[108:111], v[136:139], v[36:39]
    ds_read_b64_tr_b16 v[104:105], v2 offset:25472
    ds_read_b64_tr_b16 v[106:107], v2 offset:25984
    v_mfma_f32_16x16x32_bf16 v[44:47], v[108:111], v[140:143], v[44:47]
    buffer_load_dwordx4 v[180:183], v4, s[16:19], s42 offen offset:1024 sc1
    s_waitcnt lgkmcnt(10)
    v_mfma_f32_16x16x32_bf16 v[48:51], v[80:83], v[112:115], 0
    ds_read_b64_tr_b16 v[108:109], v2 offset:25504
    ds_read_b64_tr_b16 v[110:111], v2 offset:26016
    v_mfma_f32_16x16x32_bf16 v[56:59], v[80:83], v[116:119], 0
    v_mfma_f32_16x16x32_bf16 v[52:55], v[84:87], v[112:115], 0
    ds_read_b64_tr_b16 v[80:81], v2 offset:192
    ds_read_b64_tr_b16 v[82:83], v2 offset:704
    v_mfma_f32_16x16x32_bf16 v[60:63], v[84:87], v[116:119], 0
    s_waitcnt lgkmcnt(10)
    v_mfma_f32_16x16x32_bf16 v[48:51], v[88:91], v[120:123], v[48:51]
    ds_read_b64_tr_b16 v[84:85], v2 offset:224
    ds_read_b64_tr_b16 v[86:87], v2 offset:736
    v_mfma_f32_16x16x32_bf16 v[56:59], v[88:91], v[124:127], v[56:59]
    buffer_load_dwordx4 v[184:187], v4, s[16:19], s42 offen offset:2048 sc1
    v_mfma_f32_16x16x32_bf16 v[52:55], v[92:95], v[120:123], v[52:55]
    ds_read_b64_tr_b16 v[88:89], v2 offset:8640
    ds_read_b64_tr_b16 v[90:91], v2 offset:9152
    v_mfma_f32_16x16x32_bf16 v[60:63], v[92:95], v[124:127], v[60:63]
    s_waitcnt lgkmcnt(10)
    v_mfma_f32_16x16x32_bf16 v[48:51], v[96:99], v[128:131], v[48:51]
    ds_read_b64_tr_b16 v[92:93], v2 offset:8672
    ds_read_b64_tr_b16 v[94:95], v2 offset:9184
    v_mfma_f32_16x16x32_bf16 v[56:59], v[96:99], v[132:135], v[56:59]
    v_mfma_f32_16x16x32_bf16 v[52:55], v[100:103], v[128:131], v[52:55]
    ds_read_b64_tr_b16 v[96:97], v2 offset:17088
    ds_read_b64_tr_b16 v[98:99], v2 offset:17600
    v_mfma_f32_16x16x32_bf16 v[60:63], v[100:103], v[132:135], v[60:63]
    buffer_load_dwordx4 v[188:191], v4, s[16:19], s42 offen offset:3072 sc1
    s_waitcnt lgkmcnt(10)
    v_mfma_f32_16x16x32_bf16 v[48:51], v[104:107], v[136:139], v[48:51]
    ds_read_b64_tr_b16 v[100:101], v2 offset:17120
    ds_read_b64_tr_b16 v[102:103], v2 offset:17632
    v_mfma_f32_16x16x32_bf16 v[56:59], v[104:107], v[140:143], v[56:59]
    s_add_u32 s92, s90, 32505856
    buffer_store_dwordx4 v[200:203], v4, s[16:19], s92 offen offset:1024 sc1
    v_mfma_f32_16x16x32_bf16 v[52:55], v[108:111], v[136:139], v[52:55]
    ds_read_b64_tr_b16 v[104:105], v2 offset:25536
    ds_read_b64_tr_b16 v[106:107], v2 offset:26048
    v_mfma_f32_16x16x32_bf16 v[60:63], v[108:111], v[140:143], v[60:63]
    s_waitcnt lgkmcnt(10)
    v_mfma_f32_16x16x32_bf16 v[64:67], v[80:83], v[112:115], 0
    ds_read_b64_tr_b16 v[108:109], v2 offset:25568
    ds_read_b64_tr_b16 v[110:111], v2 offset:26080
    v_mfma_f32_16x16x32_bf16 v[72:75], v[80:83], v[116:119], 0
    v_add_u32 v2, s9, v1
    s_waitcnt vmcnt(14)
    s_barrier
    v_mfma_f32_16x16x32_bf16 v[68:71], v[84:87], v[112:115], 0
    ds_read_b64_tr_b16 v[80:81], v2 offset:0
    ds_read_b64_tr_b16 v[82:83], v2 offset:512
    v_mfma_f32_16x16x32_bf16 v[76:79], v[84:87], v[116:119], 0
    s_lshl_b32 s92, s85, 5
    s_lshr_b32 s94, s86, 3
    s_lshl_b32 s94, s94, 2
    s_add_u32 s92, s92, s94
    s_add_u32 s92, s92, 693248
    s_cmp_eq_u32 s3, 0
    s_cselect_b32 s92, s92, s82
    v_mov_b32 v7, 0
    v_mov_b32 v8, s91
    s_mov_b64 exec, 1
    buffer_store_dword v8, v7, s[16:19], s92 offen sc1
    s_mov_b64 exec, -1
    s_waitcnt lgkmcnt(10)
    v_mfma_f32_16x16x32_bf16 v[64:67], v[88:91], v[120:123], v[64:67]
    ds_read_b64_tr_b16 v[84:85], v2 offset:32
    ds_read_b64_tr_b16 v[86:87], v2 offset:544
    v_mfma_f32_16x16x32_bf16 v[72:75], v[88:91], v[124:127], v[72:75]
    v_mfma_f32_16x16x32_bf16 v[68:71], v[92:95], v[120:123], v[68:71]
    ds_read_b64_tr_b16 v[88:89], v2 offset:64
    ds_read_b64_tr_b16 v[90:91], v2 offset:576
    v_mfma_f32_16x16x32_bf16 v[76:79], v[92:95], v[124:127], v[76:79]
    s_waitcnt lgkmcnt(10)
    v_mfma_f32_16x16x32_bf16 v[64:67], v[96:99], v[128:131], v[64:67]
    ds_read_b64_tr_b16 v[92:93], v2 offset:96
    ds_read_b64_tr_b16 v[94:95], v2 offset:608
    v_mfma_f32_16x16x32_bf16 v[72:75], v[96:99], v[132:135], v[72:75]
    v_mfma_f32_16x16x32_bf16 v[68:71], v[100:103], v[128:131], v[68:71]
    ds_read_b64_tr_b16 v[96:97], v2 offset:128
    ds_read_b64_tr_b16 v[98:99], v2 offset:640
    v_mfma_f32_16x16x32_bf16 v[76:79], v[100:103], v[132:135], v[76:79]
    s_waitcnt lgkmcnt(10)
    v_mfma_f32_16x16x32_bf16 v[64:67], v[104:107], v[136:139], v[64:67]
    ds_read_b64_tr_b16 v[100:101], v2 offset:160
    ds_read_b64_tr_b16 v[102:103], v2 offset:672
    v_mfma_f32_16x16x32_bf16 v[72:75], v[104:107], v[140:143], v[72:75]
    v_mfma_f32_16x16x32_bf16 v[68:71], v[108:111], v[136:139], v[68:71]
    ds_read_b64_tr_b16 v[104:105], v2 offset:192
    ds_read_b64_tr_b16 v[106:107], v2 offset:704
    v_mfma_f32_16x16x32_bf16 v[76:79], v[108:111], v[140:143], v[76:79]
    s_waitcnt lgkmcnt(10)
    v_mfma_f32_16x16x32_bf16 v[16:19], v[80:83], v[144:147], v[16:19]
    ds_read_b64_tr_b16 v[108:109], v2 offset:224
    ds_read_b64_tr_b16 v[110:111], v2 offset:736
    v_mfma_f32_16x16x32_bf16 v[24:27], v[80:83], v[148:151], v[24:27]
    s_add_u32 s92, s90, 32509952
    buffer_store_dwordx4 v[204:207], v4, s[16:19], s92 offen offset:1024 sc1
    v_and_b32 v10, 31, v0
    v_mfma_f32_16x16x32_bf16 v[20:23], v[84:87], v[144:147], v[20:23]
    ds_read_b64_tr_b16 v[80:81], v2 offset:8448
    ds_read_b64_tr_b16 v[82:83], v2 offset:8960
    v_mfma_f32_16x16x32_bf16 v[28:31], v[84:87], v[148:151], v[28:31]
    v_bfe_u32 v11, v0, 5, 1
    s_add_u32 s42, s40, 20480
    buffer_load_dwordx4 v[192:195], v4, s[16:19], s42 offen offset:0 sc1
    s_waitcnt lgkmcnt(10)
    v_mfma_f32_16x16x32_bf16 v[32:35], v[88:91], v[144:147], v[32:35]
    ds_read_b64_tr_b16 v[84:85], v2 offset:8480
    ds_read_b64_tr_b16 v[86:87], v2 offset:8992
    v_mfma_f32_16x16x32_bf16 v[40:43], v[88:91], v[148:151], v[40:43]
    v_lshlrev_b32 v11, 2, v11
    v_mfma_f32_16x16x32_bf16 v[36:39], v[92:95], v[144:147], v[36:39]
    ds_read_b64_tr_b16 v[88:89], v2 offset:8512
    ds_read_b64_tr_b16 v[90:91], v2 offset:9024
    v_mfma_f32_16x16x32_bf16 v[44:47], v[92:95], v[148:151], v[44:47]
    v_sub_u32 v10, v10, v11
    buffer_load_dwordx4 v[196:199], v4, s[16:19], s42 offen offset:1024 sc1
    s_waitcnt lgkmcnt(10)
    v_mfma_f32_16x16x32_bf16 v[48:51], v[96:99], v[144:147], v[48:51]
    ds_read_b64_tr_b16 v[92:93], v2 offset:8544
    ds_read_b64_tr_b16 v[94:95], v2 offset:9056
    v_mfma_f32_16x16x32_bf16 v[56:59], v[96:99], v[148:151], v[56:59]
    v_cmp_gt_i32 s[48:49], 0, v10
    v_mfma_f32_16x16x32_bf16 v[52:55], v[100:103], v[144:147], v[52:55]
    ds_read_b64_tr_b16 v[96:97], v2 offset:8576
    ds_read_b64_tr_b16 v[98:99], v2 offset:9088
    v_mfma_f32_16x16x32_bf16 v[60:63], v[100:103], v[148:151], v[60:63]
    v_cmp_gt_i32 s[50:51], 1, v10
    s_waitcnt lgkmcnt(10)
    v_mfma_f32_16x16x32_bf16 v[64:67], v[104:107], v[144:147], v[64:67]
    ds_read_b64_tr_b16 v[100:101], v2 offset:8608
    ds_read_b64_tr_b16 v[102:103], v2 offset:9120
    v_mfma_f32_16x16x32_bf16 v[72:75], v[104:107], v[148:151], v[72:75]
    v_cmp_gt_i32 s[52:53], 2, v10
    buffer_load_dwordx4 v[200:203], v4, s[16:19], s42 offen offset:2048 sc1
    v_mfma_f32_16x16x32_bf16 v[68:71], v[108:111], v[144:147], v[68:71]
    ds_read_b64_tr_b16 v[104:105], v2 offset:8640
    ds_read_b64_tr_b16 v[106:107], v2 offset:9152
    v_mfma_f32_16x16x32_bf16 v[76:79], v[108:111], v[148:151], v[76:79]
    v_cmp_gt_i32 s[54:55], 3, v10
    s_waitcnt lgkmcnt(10)
    v_mfma_f32_16x16x32_bf16 v[16:19], v[80:83], v[152:155], v[16:19]
    ds_read_b64_tr_b16 v[108:109], v2 offset:8672
    ds_read_b64_tr_b16 v[110:111], v2 offset:9184
    v_mfma_f32_16x16x32_bf16 v[24:27], v[80:83], v[156:159], v[24:27]
    v_cmp_gt_i32 s[56:57], 8, v10
    buffer_load_dwordx4 v[204:207], v4, s[16:19], s42 offen offset:3072 sc1
    v_mfma_f32_16x16x32_bf16 v[20:23], v[84:87], v[152:155], v[20:23]
    ds_read_b64_tr_b16 v[80:81], v2 offset:16896
    ds_read_b64_tr_b16 v[82:83], v2 offset:17408
    v_mfma_f32_16x16x32_bf16 v[28:31], v[84:87], v[156:159], v[28:31]
    v_cmp_gt_i32 s[58:59], 9, v10
    s_waitcnt lgkmcnt(10)
    v_mfma_f32_16x16x32_bf16 v[32:35], v[88:91], v[152:155], v[32:35]
    ds_read_b64_tr_b16 v[84:85], v2 offset:16928
    ds_read_b64_tr_b16 v[86:87], v2 offset:17440
    v_mfma_f32_16x16x32_bf16 v[40:43], v[88:91], v[156:159], v[40:43]
    v_cmp_gt_i32 s[60:61], 10, v10
    v_mfma_f32_16x16x32_bf16 v[36:39], v[92:95], v[152:155], v[36:39]
    ds_read_b64_tr_b16 v[88:89], v2 offset:16960
    ds_read_b64_tr_b16 v[90:91], v2 offset:17472
    v_mfma_f32_16x16x32_bf16 v[44:47], v[92:95], v[156:159], v[44:47]
    v_cmp_gt_i32 s[62:63], 11, v10
    s_add_u32 m0, s15, 104448
    s_add_u32 s41, s38, 3145728
    buffer_load_dwordx4 v14, s[20:23], s41 offen nt lds
    s_waitcnt lgkmcnt(10)
    v_mfma_f32_16x16x32_bf16 v[48:51], v[96:99], v[152:155], v[48:51]
    ds_read_b64_tr_b16 v[92:93], v2 offset:16992
    ds_read_b64_tr_b16 v[94:95], v2 offset:17504
    v_mfma_f32_16x16x32_bf16 v[56:59], v[96:99], v[156:159], v[56:59]
    s_add_u32 s92, s90, 32505856
    buffer_store_dwordx4 v[240:243], v4, s[16:19], s92 offen offset:2048 sc1
    v_cmp_gt_i32 s[64:65], 16, v10
    v_mfma_f32_16x16x32_bf16 v[52:55], v[100:103], v[152:155], v[52:55]
    ds_read_b64_tr_b16 v[96:97], v2 offset:17024
    ds_read_b64_tr_b16 v[98:99], v2 offset:17536
    v_mfma_f32_16x16x32_bf16 v[60:63], v[100:103], v[156:159], v[60:63]
    v_cmp_gt_i32 s[66:67], 17, v10
    s_add_u32 m0, s15, 105504
    s_add_u32 s41, s38, 3153920
    buffer_load_dwordx4 v14, s[20:23], s41 offen nt lds
    s_waitcnt lgkmcnt(10)
    v_mfma_f32_16x16x32_bf16 v[64:67], v[104:107], v[152:155], v[64:67]
    ds_read_b64_tr_b16 v[100:101], v2 offset:17056
    ds_read_b64_tr_b16 v[102:103], v2 offset:17568
    v_mfma_f32_16x16x32_bf16 v[72:75], v[104:107], v[156:159], v[72:75]
    v_cmp_gt_i32 s[68:69], 18, v10
    v_mfma_f32_16x16x32_bf16 v[68:71], v[108:111], v[152:155], v[68:71]
    ds_read_b64_tr_b16 v[104:105], v2 offset:17088
    ds_read_b64_tr_b16 v[106:107], v2 offset:17600
    v_mfma_f32_16x16x32_bf16 v[76:79], v[108:111], v[156:159], v[76:79]
    v_cmp_gt_i32 s[70:71], 19, v10
    s_waitcnt vmcnt(22)
    s_waitcnt lgkmcnt(10)
    v_mfma_f32_16x16x32_bf16 v[16:19], v[80:83], v[160:163], v[16:19]
    ds_read_b64_tr_b16 v[108:109], v2 offset:17120
    ds_read_b64_tr_b16 v[110:111], v2 offset:17632
    v_mfma_f32_16x16x32_bf16 v[24:27], v[80:83], v[164:167], v[24:27]
    v_cmp_gt_i32 s[72:73], 24, v10
    s_add_u32 m0, s15, 106560
    s_add_u32 s41, s38, 3162112
    buffer_load_dwordx4 v14, s[20:23], s41 offen nt lds
    v_mfma_f32_16x16x32_bf16 v[20:23], v[84:87], v[160:163], v[20:23]
    ds_read_b64_tr_b16 v[80:81], v2 offset:25344
    ds_read_b64_tr_b16 v[82:83], v2 offset:25856
    v_mfma_f32_16x16x32_bf16 v[28:31], v[84:87], v[164:167], v[28:31]
    v_cmp_gt_i32 s[74:75], 25, v10
    s_waitcnt lgkmcnt(10)
    v_mfma_f32_16x16x32_bf16 v[32:35], v[88:91], v[160:163], v[32:35]
    ds_read_b64_tr_b16 v[84:85], v2 offset:25376
    ds_read_b64_tr_b16 v[86:87], v2 offset:25888
    v_mfma_f32_16x16x32_bf16 v[40:43], v[88:91], v[164:167], v[40:43]
    v_cmp_gt_i32 s[76:77], 26, v10
    s_add_u32 m0, s15, 107616
    s_add_u32 s41, s38, 3170304
    buffer_load_dwordx4 v14, s[20:23], s41 offen nt lds
    v_mfma_f32_16x16x32_bf16 v[36:39], v[92:95], v[160:163], v[36:39]
    ds_read_b64_tr_b16 v[88:89], v2 offset:25408
    ds_read_b64_tr_b16 v[90:91], v2 offset:25920
    v_mfma_f32_16x16x32_bf16 v[44:47], v[92:95], v[164:167], v[44:47]
    v_cmp_gt_i32 s[78:79], 27, v10
    s_waitcnt lgkmcnt(10)
    v_mfma_f32_16x16x32_bf16 v[48:51], v[96:99], v[160:163], v[48:51]
    ds_read_b64_tr_b16 v[92:93], v2 offset:25440
    ds_read_b64_tr_b16 v[94:95], v2 offset:25952
    v_mfma_f32_16x16x32_bf16 v[56:59], v[96:99], v[164:167], v[56:59]
    v_mov_b32 v9, 0xff61b1e6
    v_mfma_f32_16x16x32_bf16 v[52:55], v[100:103], v[160:163], v[52:55]
    ds_read_b64_tr_b16 v[96:97], v2 offset:25472
    ds_read_b64_tr_b16 v[98:99], v2 offset:25984
    v_mfma_f32_16x16x32_bf16 v[60:63], v[100:103], v[164:167], v[60:63]
    s_add_u32 s42, s40, 24576
    buffer_load_dwordx4 v[208:211], v4, s[16:19], s42 offen offset:0 sc1
    s_waitcnt lgkmcnt(10)
    v_mfma_f32_16x16x32_bf16 v[64:67], v[104:107], v[160:163], v[64:67]
    ds_read_b64_tr_b16 v[100:101], v2 offset:25504
    ds_read_b64_tr_b16 v[102:103], v2 offset:26016
    v_mfma_f32_16x16x32_bf16 v[72:75], v[104:107], v[164:167], v[72:75]
    v_mfma_f32_16x16x32_bf16 v[68:71], v[108:111], v[160:163], v[68:71]
    ds_read_b64_tr_b16 v[104:105], v2 offset:25536
    ds_read_b64_tr_b16 v[106:107], v2 offset:26048
    v_mfma_f32_16x16x32_bf16 v[76:79], v[108:111], v[164:167], v[76:79]
    buffer_load_dwordx4 v[212:215], v4, s[16:19], s42 offen offset:1024 sc1
    s_waitcnt vmcnt(24)
    s_waitcnt lgkmcnt(10)
    v_mfma_f32_16x16x32_bf16 v[16:19], v[80:83], v[168:171], v[16:19]
    ds_read_b64_tr_b16 v[108:109], v2 offset:25568
    ds_read_b64_tr_b16 v[110:111], v2 offset:26080
    v_mfma_f32_16x16x32_bf16 v[24:27], v[80:83], v[172:175], v[24:27]
    v_add_u32 v2, s10, v1
    s_waitcnt vmcnt(19)
    s_barrier
    v_mfma_f32_16x16x32_bf16 v[20:23], v[84:87], v[168:171], v[20:23]
    ds_read_b64_tr_b16 v[80:81], v2 offset:0
    ds_read_b64_tr_b16 v[82:83], v2 offset:512
    v_mfma_f32_16x16x32_bf16 v[28:31], v[84:87], v[172:175], v[28:31]
    s_waitcnt lgkmcnt(10)
    v_mfma_f32_16x16x32_bf16 v[32:35], v[88:91], v[168:171], v[32:35]
    ds_read_b64_tr_b16 v[84:85], v2 offset:32
    ds_read_b64_tr_b16 v[86:87], v2 offset:544
    v_mfma_f32_16x16x32_bf16 v[40:43], v[88:91], v[172:175], v[40:43]
    s_add_u32 s92, s90, 32509952
    buffer_store_dwordx4 v[244:247], v4, s[16:19], s92 offen offset:2048 sc1
    buffer_load_dwordx4 v[216:219], v4, s[16:19], s42 offen offset:2048 sc1
    v_mfma_f32_16x16x32_bf16 v[36:39], v[92:95], v[168:171], v[36:39]
    ds_read_b64_tr_b16 v[88:89], v2 offset:64
    ds_read_b64_tr_b16 v[90:91], v2 offset:576
    v_mfma_f32_16x16x32_bf16 v[44:47], v[92:95], v[172:175], v[44:47]
    s_waitcnt lgkmcnt(10)
    v_mfma_f32_16x16x32_bf16 v[48:51], v[96:99], v[168:171], v[48:51]
    ds_read_b64_tr_b16 v[92:93], v2 offset:96
    ds_read_b64_tr_b16 v[94:95], v2 offset:608
    v_mfma_f32_16x16x32_bf16 v[56:59], v[96:99], v[172:175], v[56:59]
    buffer_load_dwordx4 v[220:223], v4, s[16:19], s42 offen offset:3072 sc1
    v_mfma_f32_16x16x32_bf16 v[52:55], v[100:103], v[168:171], v[52:55]
    ds_read_b64_tr_b16 v[96:97], v2 offset:128
    ds_read_b64_tr_b16 v[98:99], v2 offset:640
    v_mfma_f32_16x16x32_bf16 v[60:63], v[100:103], v[172:175], v[60:63]
    s_waitcnt lgkmcnt(10)
    v_mfma_f32_16x16x32_bf16 v[64:67], v[104:107], v[168:171], v[64:67]
    ds_read_b64_tr_b16 v[100:101], v2 offset:160
    ds_read_b64_tr_b16 v[102:103], v2 offset:672
    v_mfma_f32_16x16x32_bf16 v[72:75], v[104:107], v[172:175], v[72:75]
    v_mfma_f32_16x16x32_bf16 v[68:71], v[108:111], v[168:171], v[68:71]
    ds_read_b64_tr_b16 v[104:105], v2 offset:192
    ds_read_b64_tr_b16 v[106:107], v2 offset:704
    v_mfma_f32_16x16x32_bf16 v[76:79], v[108:111], v[172:175], v[76:79]
    s_waitcnt vmcnt(19)
    s_waitcnt lgkmcnt(10)
    v_mfma_f32_16x16x32_bf16 v[16:19], v[80:83], v[176:179], v[16:19]
    ds_read_b64_tr_b16 v[108:109], v2 offset:224
    ds_read_b64_tr_b16 v[110:111], v2 offset:736
    v_mfma_f32_16x16x32_bf16 v[24:27], v[80:83], v[180:183], v[24:27]
    s_add_u32 s42, s40, 28672
    buffer_load_dwordx4 v[224:227], v4, s[16:19], s42 offen offset:0 sc1
    v_mfma_f32_16x16x32_bf16 v[20:23], v[84:87], v[176:179], v[20:23]
    ds_read_b64_tr_b16 v[80:81], v2 offset:8448
    ds_read_b64_tr_b16 v[82:83], v2 offset:8960
    v_mfma_f32_16x16x32_bf16 v[28:31], v[84:87], v[180:183], v[28:31]
    s_waitcnt lgkmcnt(10)
    v_mfma_f32_16x16x32_bf16 v[32:35], v[88:91], v[176:179], v[32:35]
    ds_read_b64_tr_b16 v[84:85], v2 offset:8480
    ds_read_b64_tr_b16 v[86:87], v2 offset:8992
    v_mfma_f32_16x16x32_bf16 v[40:43], v[88:91], v[180:183], v[40:43]
    s_add_u32 s92, s90, 32505856
    buffer_store_dwordx4 v[248:251], v4, s[16:19], s92 offen offset:3072 sc1
    buffer_load_dwordx4 v[228:231], v4, s[16:19], s42 offen offset:1024 sc1
    v_mfma_f32_16x16x32_bf16 v[36:39], v[92:95], v[176:179], v[36:39]
    ds_read_b64_tr_b16 v[88:89], v2 offset:8512
    ds_read_b64_tr_b16 v[90:91], v2 offset:9024
    v_mfma_f32_16x16x32_bf16 v[44:47], v[92:95], v[180:183], v[44:47]
    s_waitcnt lgkmcnt(10)
    v_mfma_f32_16x16x32_bf16 v[48:51], v[96:99], v[176:179], v[48:51]
    ds_read_b64_tr_b16 v[92:93], v2 offset:8544
    ds_read_b64_tr_b16 v[94:95], v2 offset:9056
    v_mfma_f32_16x16x32_bf16 v[56:59], v[96:99], v[180:183], v[56:59]
    v_mfma_f32_16x16x32_bf16 v[52:55], v[100:103], v[176:179], v[52:55]
    ds_read_b64_tr_b16 v[96:97], v2 offset:8576
    ds_read_b64_tr_b16 v[98:99], v2 offset:9088
    v_mfma_f32_16x16x32_bf16 v[60:63], v[100:103], v[180:183], v[60:63]
    buffer_load_dwordx4 v[232:235], v4, s[16:19], s42 offen offset:2048 sc1
    s_waitcnt lgkmcnt(10)
    v_mfma_f32_16x16x32_bf16 v[64:67], v[104:107], v[176:179], v[64:67]
    ds_read_b64_tr_b16 v[100:101], v2 offset:8608
    ds_read_b64_tr_b16 v[102:103], v2 offset:9120
    v_mfma_f32_16x16x32_bf16 v[72:75], v[104:107], v[180:183], v[72:75]
    v_mfma_f32_16x16x32_bf16 v[68:71], v[108:111], v[176:179], v[68:71]
    ds_read_b64_tr_b16 v[104:105], v2 offset:8640
    ds_read_b64_tr_b16 v[106:107], v2 offset:9152
    v_mfma_f32_16x16x32_bf16 v[76:79], v[108:111], v[180:183], v[76:79]
    buffer_load_dwordx4 v[236:239], v4, s[16:19], s42 offen offset:3072 sc1
    s_waitcnt vmcnt(22)
    s_waitcnt lgkmcnt(10)
    v_mfma_f32_16x16x32_bf16 v[16:19], v[80:83], v[184:187], v[16:19]
    ds_read_b64_tr_b16 v[108:109], v2 offset:8672
    ds_read_b64_tr_b16 v[110:111], v2 offset:9184
    v_mfma_f32_16x16x32_bf16 v[24:27], v[80:83], v[188:191], v[24:27]
    v_mfma_f32_16x16x32_bf16 v[20:23], v[84:87], v[184:187], v[20:23]
    ds_read_b64_tr_b16 v[80:81], v2 offset:16896
    ds_read_b64_tr_b16 v[82:83], v2 offset:17408
    v_mfma_f32_16x16x32_bf16 v[28:31], v[84:87], v[188:191], v[28:31]
    s_waitcnt lgkmcnt(10)
    v_mfma_f32_16x16x32_bf16 v[32:35], v[88:91], v[184:187], v[32:35]
    ds_read_b64_tr_b16 v[84:85], v2 offset:16928
    ds_read_b64_tr_b16 v[86:87], v2 offset:17440
    v_mfma_f32_16x16x32_bf16 v[40:43], v[88:91], v[188:191], v[40:43]
    s_add_u32 m0, s14, 0
    s_add_u32 s41, s38, 4194304
    buffer_load_dwordx4 v14, s[20:23], s41 offen nt lds
    v_mfma_f32_16x16x32_bf16 v[36:39], v[92:95], v[184:187], v[36:39]
    ds_read_b64_tr_b16 v[88:89], v2 offset:16960
    ds_read_b64_tr_b16 v[90:91], v2 offset:17472
    v_mfma_f32_16x16x32_bf16 v[44:47], v[92:95], v[188:191], v[44:47]
    s_waitcnt lgkmcnt(10)
    v_mfma_f32_16x16x32_bf16 v[48:51], v[96:99], v[184:187], v[48:51]
    ds_read_b64_tr_b16 v[92:93], v2 offset:16992
    ds_read_b64_tr_b16 v[94:95], v2 offset:17504
    v_mfma_f32_16x16x32_bf16 v[56:59], v[96:99], v[188:191], v[56:59]
    s_add_u32 s92, s90, 32509952
    buffer_store_dwordx4 v[252:255], v4, s[16:19], s92 offen offset:3072 sc1
    s_add_u32 m0, s14, 1056
    s_add_u32 s41, s38, 4202496
    buffer_load_dwordx4 v14, s[20:23], s41 offen nt lds
    v_mfma_f32_16x16x32_bf16 v[52:55], v[100:103], v[184:187], v[52:55]
    ds_read_b64_tr_b16 v[96:97], v2 offset:17024
    ds_read_b64_tr_b16 v[98:99], v2 offset:17536
    v_mfma_f32_16x16x32_bf16 v[60:63], v[100:103], v[188:191], v[60:63]
    s_waitcnt lgkmcnt(10)
    v_mfma_f32_16x16x32_bf16 v[64:67], v[104:107], v[184:187], v[64:67]
    ds_read_b64_tr_b16 v[100:101], v2 offset:17056
    ds_read_b64_tr_b16 v[102:103], v2 offset:17568
    v_mfma_f32_16x16x32_bf16 v[72:75], v[104:107], v[188:191], v[72:75]
    v_mfma_f32_16x16x32_bf16 v[68:71], v[108:111], v[184:187], v[68:71]
    ds_read_b64_tr_b16 v[104:105], v2 offset:17088
    ds_read_b64_tr_b16 v[106:107], v2 offset:17600
    v_mfma_f32_16x16x32_bf16 v[76:79], v[108:111], v[188:191], v[76:79]
    s_add_u32 m0, s14, 2112
    s_add_u32 s41, s38, 4210688
    buffer_load_dwordx4 v14, s[20:23], s41 offen nt lds
    s_waitcnt vmcnt(21)
    s_waitcnt lgkmcnt(10)
    v_mfma_f32_16x16x32_bf16 v[16:19], v[80:83], v[192:195], v[16:19]
    ds_read_b64_tr_b16 v[108:109], v2 offset:17120
    ds_read_b64_tr_b16 v[110:111], v2 offset:17632
    v_mfma_f32_16x16x32_bf16 v[24:27], v[80:83], v[196:199], v[24:27]
    v_mfma_f32_16x16x32_bf16 v[20:23], v[84:87], v[192:195], v[20:23]
    ds_read_b64_tr_b16 v[80:81], v2 offset:25344
    ds_read_b64_tr_b16 v[82:83], v2 offset:25856
    v_mfma_f32_16x16x32_bf16 v[28:31], v[84:87], v[196:199], v[28:31]
    s_waitcnt lgkmcnt(10)
    v_mfma_f32_16x16x32_bf16 v[32:35], v[88:91], v[192:195], v[32:35]
    ds_read_b64_tr_b16 v[84:85], v2 offset:25376
    ds_read_b64_tr_b16 v[86:87], v2 offset:25888
    v_mfma_f32_16x16x32_bf16 v[40:43], v[88:91], v[196:199], v[40:43]
    s_add_u32 m0, s14, 3168
    s_add_u32 s41, s38, 4218880
    buffer_load_dwordx4 v14, s[20:23], s41 offen nt lds
    v_mfma_f32_16x16x32_bf16 v[36:39], v[92:95], v[192:195], v[36:39]
    ds_read_b64_tr_b16 v[88:89], v2 offset:25408
    ds_read_b64_tr_b16 v[90:91], v2 offset:25920
    v_mfma_f32_16x16x32_bf16 v[44:47], v[92:95], v[196:199], v[44:47]
    s_waitcnt lgkmcnt(10)
    v_mfma_f32_16x16x32_bf16 v[48:51], v[96:99], v[192:195], v[48:51]
    ds_read_b64_tr_b16 v[92:93], v2 offset:25440
    ds_read_b64_tr_b16 v[94:95], v2 offset:25952
    v_mfma_f32_16x16x32_bf16 v[56:59], v[96:99], v[196:199], v[56:59]
    s_add_u32 s42, s40, 32768
    buffer_load_dwordx4 v[112:115], v4, s[16:19], s42 offen offset:0 sc1
    v_mfma_f32_16x16x32_bf16 v[52:55], v[100:103], v[192:195], v[52:55]
    ds_read_b64_tr_b16 v[96:97], v2 offset:25472
    ds_read_b64_tr_b16 v[98:99], v2 offset:25984
    v_mfma_f32_16x16x32_bf16 v[60:63], v[100:103], v[196:199], v[60:63]
    s_waitcnt lgkmcnt(10)
    v_mfma_f32_16x16x32_bf16 v[64:67], v[104:107], v[192:195], v[64:67]
    ds_read_b64_tr_b16 v[100:101], v2 offset:25504
    ds_read_b64_tr_b16 v[102:103], v2 offset:26016
    v_mfma_f32_16x16x32_bf16 v[72:75], v[104:107], v[196:199], v[72:75]
    v_mfma_f32_16x16x32_bf16 v[68:71], v[108:111], v[192:195], v[68:71]
    ds_read_b64_tr_b16 v[104:105], v2 offset:25536
    ds_read_b64_tr_b16 v[106:107], v2 offset:26048
    v_mfma_f32_16x16x32_bf16 v[76:79], v[108:111], v[196:199], v[76:79]
    buffer_load_dwordx4 v[116:119], v4, s[16:19], s42 offen offset:1024 sc1
    s_waitcnt vmcnt(22)
    s_waitcnt lgkmcnt(10)
    v_mfma_f32_16x16x32_bf16 v[16:19], v[80:83], v[200:203], v[16:19]
    ds_read_b64_tr_b16 v[108:109], v2 offset:25568
    ds_read_b64_tr_b16 v[110:111], v2 offset:26080
    v_mfma_f32_16x16x32_bf16 v[24:27], v[80:83], v[204:207], v[24:27]
    v_add_u32 v2, s11, v1
    s_waitcnt vmcnt(17)
    s_barrier
    v_mfma_f32_16x16x32_bf16 v[20:23], v[84:87], v[200:203], v[20:23]
    ds_read_b64_tr_b16 v[80:81], v2 offset:0
    ds_read_b64_tr_b16 v[82:83], v2 offset:512
    v_mfma_f32_16x16x32_bf16 v[28:31], v[84:87], v[204:207], v[28:31]
    buffer_load_dwordx4 v[120:123], v4, s[16:19], s42 offen offset:2048 sc1
    s_waitcnt lgkmcnt(10)
    v_mfma_f32_16x16x32_bf16 v[32:35], v[88:91], v[200:203], v[32:35]
    ds_read_b64_tr_b16 v[84:85], v2 offset:32
    ds_read_b64_tr_b16 v[86:87], v2 offset:544
    v_mfma_f32_16x16x32_bf16 v[40:43], v[88:91], v[204:207], v[40:43]
    v_mfma_f32_16x16x32_bf16 v[36:39], v[92:95], v[200:203], v[36:39]
    ds_read_b64_tr_b16 v[88:89], v2 offset:64
    ds_read_b64_tr_b16 v[90:91], v2 offset:576
    v_mfma_f32_16x16x32_bf16 v[44:47], v[92:95], v[204:207], v[44:47]
    s_waitcnt lgkmcnt(10)
    v_mfma_f32_16x16x32_bf16 v[48:51], v[96:99], v[200:203], v[48:51]
    ds_read_b64_tr_b16 v[92:93], v2 offset:96
    ds_read_b64_tr_b16 v[94:95], v2 offset:608
    v_mfma_f32_16x16x32_bf16 v[56:59], v[96:99], v[204:207], v[56:59]
    buffer_load_dwordx4 v[124:127], v4, s[16:19], s42 offen offset:3072 sc1
    v_mfma_f32_16x16x32_bf16 v[52:55], v[100:103], v[200:203], v[52:55]
    ds_read_b64_tr_b16 v[96:97], v2 offset:128
    ds_read_b64_tr_b16 v[98:99], v2 offset:640
    v_mfma_f32_16x16x32_bf16 v[60:63], v[100:103], v[204:207], v[60:63]
    s_waitcnt lgkmcnt(10)
    v_mfma_f32_16x16x32_bf16 v[64:67], v[104:107], v[200:203], v[64:67]
    ds_read_b64_tr_b16 v[100:101], v2 offset:160
    ds_read_b64_tr_b16 v[102:103], v2 offset:672
    v_mfma_f32_16x16x32_bf16 v[72:75], v[104:107], v[204:207], v[72:75]
    v_mfma_f32_16x16x32_bf16 v[68:71], v[108:111], v[200:203], v[68:71]
    ds_read_b64_tr_b16 v[104:105], v2 offset:192
    ds_read_b64_tr_b16 v[106:107], v2 offset:704
    v_mfma_f32_16x16x32_bf16 v[76:79], v[108:111], v[204:207], v[76:79]
    s_lshl_b32 s93, s32, 5
    s_add_u32 s93, s93, 693248
    v_lshrrev_b32 v13, 2, v4
    v_min_u32 v13, 28, v13
    buffer_load_dword v12, v13, s[16:19], s93 offen sc1
    s_waitcnt vmcnt(18)
    s_waitcnt lgkmcnt(10)
    v_mfma_f32_16x16x32_bf16 v[16:19], v[80:83], v[208:211], v[16:19]
    ds_read_b64_tr_b16 v[108:109], v2 offset:224
    ds_read_b64_tr_b16 v[110:111], v2 offset:736
    v_mfma_f32_16x16x32_bf16 v[24:27], v[80:83], v[212:215], v[24:27]
    s_add_u32 s42, s40, 36864
    buffer_load_dwordx4 v[128:131], v4, s[16:19], s42 offen offset:0 sc1
    v_mfma_f32_16x16x32_bf16 v[20:23], v[84:87], v[208:211], v[20:23]
    ds_read_b64_tr_b16 v[80:81], v2 offset:8448
    ds_read_b64_tr_b16 v[82:83], v2 offset:8960
    v_mfma_f32_16x16x32_bf16 v[28:31], v[84:87], v[212:215], v[28:31]
    buffer_load_dwordx4 v[132:135], v4, s[16:19], s42 offen offset:1024 sc1
    s_waitcnt lgkmcnt(10)
    v_mfma_f32_16x16x32_bf16 v[32:35], v[88:91], v[208:211], v[32:35]
    ds_read_b64_tr_b16 v[84:85], v2 offset:8480
    ds_read_b64_tr_b16 v[86:87], v2 offset:8992
    v_mfma_f32_16x16x32_bf16 v[40:43], v[88:91], v[212:215], v[40:43]
    v_mfma_f32_16x16x32_bf16 v[36:39], v[92:95], v[208:211], v[36:39]
    ds_read_b64_tr_b16 v[88:89], v2 offset:8512
    ds_read_b64_tr_b16 v[90:91], v2 offset:9024
    v_mfma_f32_16x16x32_bf16 v[44:47], v[92:95], v[212:215], v[44:47]
    buffer_load_dwordx4 v[136:139], v4, s[16:19], s42 offen offset:2048 sc1
    s_waitcnt lgkmcnt(10)
    v_mfma_f32_16x16x32_bf16 v[48:51], v[96:99], v[208:211], v[48:51]
    ds_read_b64_tr_b16 v[92:93], v2 offset:8544
    ds_read_b64_tr_b16 v[94:95], v2 offset:9056
    v_mfma_f32_16x16x32_bf16 v[56:59], v[96:99], v[212:215], v[56:59]
    v_mfma_f32_16x16x32_bf16 v[52:55], v[100:103], v[208:211], v[52:55]
    ds_read_b64_tr_b16 v[96:97], v2 offset:8576
    ds_read_b64_tr_b16 v[98:99], v2 offset:9088
    v_mfma_f32_16x16x32_bf16 v[60:63], v[100:103], v[212:215], v[60:63]
    buffer_load_dwordx4 v[140:143], v4, s[16:19], s42 offen offset:3072 sc1
    s_waitcnt lgkmcnt(10)
    v_mfma_f32_16x16x32_bf16 v[64:67], v[104:107], v[208:211], v[64:67]
    ds_read_b64_tr_b16 v[100:101], v2 offset:8608
    ds_read_b64_tr_b16 v[102:103], v2 offset:9120
    v_mfma_f32_16x16x32_bf16 v[72:75], v[104:107], v[212:215], v[72:75]
    v_mfma_f32_16x16x32_bf16 v[68:71], v[108:111], v[208:211], v[68:71]
    ds_read_b64_tr_b16 v[104:105], v2 offset:8640
    ds_read_b64_tr_b16 v[106:107], v2 offset:9152
    v_mfma_f32_16x16x32_bf16 v[76:79], v[108:111], v[212:215], v[76:79]
    s_waitcnt vmcnt(12)
    s_barrier
    s_waitcnt lgkmcnt(10)
    v_mfma_f32_16x16x32_bf16 v[16:19], v[80:83], v[216:219], v[16:19]
    ds_read_b64_tr_b16 v[108:109], v2 offset:8672
    ds_read_b64_tr_b16 v[110:111], v2 offset:9184
    v_mfma_f32_16x16x32_bf16 v[24:27], v[80:83], v[220:223], v[24:27]
    s_waitcnt vmcnt(4)
    v_cmp_ne_u32 vcc, s91, v12
    s_cbranch_vccnz F_slow1
F_ok1:
    v_mfma_f32_16x16x32_bf16 v[20:23], v[84:87], v[216:219], v[20:23]
    ds_read_b64_tr_b16 v[80:81], v2 offset:16896
    ds_read_b64_tr_b16 v[82:83], v2 offset:17408
    v_mfma_f32_16x16x32_bf16 v[28:31], v[84:87], v[220:223], v[28:31]
    s_add_u32 m0, s84, s9
    s_add_u32 s41, s46, 4294934528
    buffer_load_dwordx4 v4, s[24:27], s41 offen offset:0 sc1 lds
    s_waitcnt lgkmcnt(10)
    v_mfma_f32_16x16x32_bf16 v[32:35], v[88:91], v[216:219], v[32:35]
    ds_read_b64_tr_b16 v[84:85], v2 offset:16928
    ds_read_b64_tr_b16 v[86:87], v2 offset:17440
    v_mfma_f32_16x16x32_bf16 v[40:43], v[88:91], v[220:223], v[40:43]
    v_mfma_f32_16x16x32_bf16 v[36:39], v[92:95], v[216:219], v[36:39]
    ds_read_b64_tr_b16 v[88:89], v2 offset:16960
    ds_read_b64_tr_b16 v[90:91], v2 offset:17472
    v_mfma_f32_16x16x32_bf16 v[44:47], v[92:95], v[220:223], v[44:47]
    buffer_load_dwordx4 v4, s[24:27], s41 offen offset:1024 sc1 lds
    s_waitcnt lgkmcnt(10)
    v_mfma_f32_16x16x32_bf16 v[48:51], v[96:99], v[216:219], v[48:51]
    ds_read_b64_tr_b16 v[92:93], v2 offset:16992
    ds_read_b64_tr_b16 v[94:95], v2 offset:17504
    v_mfma_f32_16x16x32_bf16 v[56:59], v[96:99], v[220:223], v[56:59]
    v_mfma_f32_16x16x32_bf16 v[52:55], v[100:103], v[216:219], v[52:55]
    ds_read_b64_tr_b16 v[96:97], v2 offset:17024
    ds_read_b64_tr_b16 v[98:99], v2 offset:17536
    v_mfma_f32_16x16x32_bf16 v[60:63], v[100:103], v[220:223], v[60:63]
    buffer_load_dwordx4 v4, s[24:27], s41 offen offset:2048 sc1 lds
    s_waitcnt lgkmcnt(10)
    v_mfma_f32_16x16x32_bf16 v[64:67], v[104:107], v[216:219], v[64:67]
    ds_read_b64_tr_b16 v[100:101], v2 offset:17056
    ds_read_b64_tr_b16 v[102:103], v2 offset:17568
    v_mfma_f32_16x16x32_bf16 v[72:75], v[104:107], v[220:223], v[72:75]
    v_mfma_f32_16x16x32_bf16 v[68:71], v[108:111], v[216:219], v[68:71]
    ds_read_b64_tr_b16 v[104:105], v2 offset:17088
    ds_read_b64_tr_b16 v[106:107], v2 offset:17600
    v_mfma_f32_16x16x32_bf16 v[76:79], v[108:111], v[220:223], v[76:79]
    buffer_load_dwordx4 v4, s[24:27], s41 offen offset:3072 sc1 lds
    s_waitcnt lgkmcnt(10)
    v_mfma_f32_16x16x32_bf16 v[16:19], v[80:83], v[224:227], v[16:19]
    ds_read_b64_tr_b16 v[108:109], v2 offset:17120
    ds_read_b64_tr_b16 v[110:111], v2 offset:17632
    v_mfma_f32_16x16x32_bf16 v[24:27], v[80:83], v[228:231], v[24:27]
    v_mfma_f32_16x16x32_bf16 v[20:23], v[84:87], v[224:227], v[20:23]
    ds_read_b64_tr_b16 v[80:81], v2 offset:25344
    ds_read_b64_tr_b16 v[82:83], v2 offset:25856
    v_mfma_f32_16x16x32_bf16 v[28:31], v[84:87], v[228:231], v[28:31]
    s_waitcnt lgkmcnt(10)
    v_mfma_f32_16x16x32_bf16 v[32:35], v[88:91], v[224:227], v[32:35]
    ds_read_b64_tr_b16 v[84:85], v2 offset:25376
    ds_read_b64_tr_b16 v[86:87], v2 offset:25888
    v_mfma_f32_16x16x32_bf16 v[40:43], v[88:91], v[228:231], v[40:43]
    v_mfma_f32_16x16x32_bf16 v[36:39], v[92:95], v[224:227], v[36:39]
    ds_read_b64_tr_b16 v[88:89], v2 offset:25408
    ds_read_b64_tr_b16 v[90:91], v2 offset:25920
    v_mfma_f32_16x16x32_bf16 v[44:47], v[92:95], v[228:231], v[44:47]
    s_waitcnt lgkmcnt(10)
    v_mfma_f32_16x16x32_bf16 v[48:51], v[96:99], v[224:227], v[48:51]
    ds_read_b64_tr_b16 v[92:93], v2 offset:25440
    ds_read_b64_tr_b16 v[94:95], v2 offset:25952
    v_mfma_f32_16x16x32_bf16 v[56:59], v[96:99], v[228:231], v[56:59]
    v_mfma_f32_16x16x32_bf16 v[52:55], v[100:103], v[224:227], v[52:55]
    ds_read_b64_tr_b16 v[96:97], v2 offset:25472
    ds_read_b64_tr_b16 v[98:99], v2 offset:25984
    v_mfma_f32_16x16x32_bf16 v[60:63], v[100:103], v[228:231], v[60:63]
    s_waitcnt lgkmcnt(10)
    v_mfma_f32_16x16x32_bf16 v[64:67], v[104:107], v[224:227], v[64:67]
    ds_read_b64_tr_b16 v[100:101], v2 offset:25504
    ds_read_b64_tr_b16 v[102:103], v2 offset:26016
    v_mfma_f32_16x16x32_bf16 v[72:75], v[104:107], v[228:231], v[72:75]
    v_mfma_f32_16x16x32_bf16 v[68:71], v[108:111], v[224:227], v[68:71]
    ds_read_b64_tr_b16 v[104:105], v2 offset:25536
    ds_read_b64_tr_b16 v[106:107], v2 offset:26048
    v_mfma_f32_16x16x32_bf16 v[76:79], v[108:111], v[228:231], v[76:79]
    s_waitcnt lgkmcnt(10)
    v_mfma_f32_16x16x32_bf16 v[16:19], v[80:83], v[232:235], v[16:19]
    ds_read_b64_tr_b16 v[108:109], v2 offset:25568
    ds_read_b64_tr_b16 v[110:111], v2 offset:26080
    v_mfma_f32_16x16x32_bf16 v[24:27], v[80:83], v[236:239], v[24:27]
    v_add_u32 v2, s8, v1
    s_barrier
    v_mfma_f32_16x16x32_bf16 v[20:23], v[84:87], v[232:235], v[20:23]
    ds_read_b64_tr_b16 v[80:81], v2 offset:0
    ds_read_b64_tr_b16 v[82:83], v2 offset:512
    v_mfma_f32_16x16x32_bf16 v[28:31], v[84:87], v[236:239], v[28:31]
    s_waitcnt lgkmcnt(10)
    v_mfma_f32_16x16x32_bf16 v[32:35], v[88:91], v[232:235], v[32:35]
    ds_read_b64_tr_b16 v[84:85], v2 offset:32
    ds_read_b64_tr_b16 v[86:87], v2 offset:544
    v_mfma_f32_16x16x32_bf16 v[40:43], v[88:91], v[236:239], v[40:43]
    v_mfma_f32_16x16x32_bf16 v[36:39], v[92:95], v[232:235], v[36:39]
    ds_read_b64_tr_b16 v[88:89], v2 offset:8448
    ds_read_b64_tr_b16 v[90:91], v2 offset:8960
    v_mfma_f32_16x16x32_bf16 v[44:47], v[92:95], v[236:239], v[44:47]
    s_waitcnt lgkmcnt(10)
    v_mfma_f32_16x16x32_bf16 v[48:51], v[96:99], v[232:235], v[48:51]
    ds_read_b64_tr_b16 v[92:93], v2 offset:8480
    ds_read_b64_tr_b16 v[94:95], v2 offset:8992
    v_mfma_f32_16x16x32_bf16 v[56:59], v[96:99], v[236:239], v[56:59]
    v_mfma_f32_16x16x32_bf16 v[52:55], v[100:103], v[232:235], v[52:55]
    ds_read_b64_tr_b16 v[96:97], v2 offset:16896
    ds_read_b64_tr_b16 v[98:99], v2 offset:17408
    v_mfma_f32_16x16x32_bf16 v[60:63], v[100:103], v[236:239], v[60:63]
    s_waitcnt lgkmcnt(10)
    v_mfma_f32_16x16x32_bf16 v[64:67], v[104:107], v[232:235], v[64:67]
    ds_read_b64_tr_b16 v[100:101], v2 offset:16928
    ds_read_b64_tr_b16 v[102:103], v2 offset:17440
    v_mfma_f32_16x16x32_bf16 v[72:75], v[104:107], v[236:239], v[72:75]
    v_mfma_f32_16x16x32_bf16 v[68:71], v[108:111], v[232:235], v[68:71]
    ds_read_b64_tr_b16 v[104:105], v2 offset:25344
    ds_read_b64_tr_b16 v[106:107], v2 offset:25856
    v_mfma_f32_16x16x32_bf16 v[76:79], v[108:111], v[236:239], v[76:79]
    s_waitcnt vmcnt(4)
    s_waitcnt lgkmcnt(10)
    v_mfma_f32_16x16x32_bf16 v[16:19], v[80:83], v[112:115], v[16:19]
    ds_read_b64_tr_b16 v[108:109], v2 offset:25376
    ds_read_b64_tr_b16 v[110:111], v2 offset:25888
    v_mfma_f32_16x16x32_bf16 v[24:27], v[80:83], v[116:119], v[24:27]
    v_mov_b32 v208, 0
    v_mov_b32 v209, 0
    v_mfma_f32_16x16x32_bf16 v[20:23], v[84:87], v[112:115], v[20:23]
    ds_read_b64_tr_b16 v[80:81], v2 offset:64
    ds_read_b64_tr_b16 v[82:83], v2 offset:576
    v_mfma_f32_16x16x32_bf16 v[28:31], v[84:87], v[116:119], v[28:31]
    v_mov_b32 v210, 0
    v_mov_b32 v211, 0
    s_waitcnt lgkmcnt(10)
    v_mfma_f32_16x16x32_bf16 v[16:19], v[88:91], v[120:123], v[16:19]
    ds_read_b64_tr_b16 v[84:85], v2 offset:96
    ds_read_b64_tr_b16 v[86:87], v2 offset:608
    v_mfma_f32_16x16x32_bf16 v[24:27], v[88:91], v[124:127], v[24:27]
    s_add_u32 m0, s84, s10
    s_add_u32 s41, s46, 4294950912
    buffer_load_dwordx4 v4, s[24:27], s41 offen offset:0 sc1 lds
    v_mov_b32 v212, 0
    v_mov_b32 v213, 0
    v_mfma_f32_16x16x32_bf16 v[20:23], v[92:95], v[120:123], v[20:23]
    ds_read_b64_tr_b16 v[88:89], v2 offset:8512
    ds_read_b64_tr_b16 v[90:91], v2 offset:9024
    v_mfma_f32_16x16x32_bf16 v[28:31], v[92:95], v[124:127], v[28:31]
    v_mov_b32 v214, 0
    v_mov_b32 v215, 0
    s_waitcnt lgkmcnt(10)
    v_mfma_f32_16x16x32_bf16 v[16:19], v[96:99], v[128:131], v[16:19]
    ds_read_b64_tr_b16 v[92:93], v2 offset:8544
    ds_read_b64_tr_b16 v[94:95], v2 offset:9056
    v_mfma_f32_16x16x32_bf16 v[24:27], v[96:99], v[132:135], v[24:27]
    buffer_load_dwordx4 v4, s[24:27], s41 offen offset:1024 sc1 lds
    v_mov_b32 v216, 0
    v_mov_b32 v217, 0
    v_mfma_f32_16x16x32_bf16 v[20:23], v[100:103], v[128:131], v[20:23]
    ds_read_b64_tr_b16 v[96:97], v2 offset:16960
    ds_read_b64_tr_b16 v[98:99], v2 offset:17472
    v_mfma_f32_16x16x32_bf16 v[28:31], v[100:103], v[132:135], v[28:31]
    v_mov_b32 v218, 0
    v_mov_b32 v219, 0
    s_waitcnt lgkmcnt(10)
    v_mfma_f32_16x16x32_bf16 v[16:19], v[104:107], v[136:139], v[16:19]
    ds_read_b64_tr_b16 v[100:101], v2 offset:16992
    ds_read_b64_tr_b16 v[102:103], v2 offset:17504
    v_mfma_f32_16x16x32_bf16 v[24:27], v[104:107], v[140:143], v[24:27]
    buffer_load_dwordx4 v4, s[24:27], s41 offen offset:2048 sc1 lds
    v_mov_b32 v220, 0
    v_mov_b32 v221, 0
    v_mfma_f32_16x16x32_bf16 v[20:23], v[108:111], v[136:139], v[20:23]
    ds_read_b64_tr_b16 v[104:105], v2 offset:25408
    ds_read_b64_tr_b16 v[106:107], v2 offset:25920
    v_mfma_f32_16x16x32_bf16 v[28:31], v[108:111], v[140:143], v[28:31]
    v_mov_b32 v222, 0
    v_mov_b32 v223, 0
    s_waitcnt lgkmcnt(10)
    v_mfma_f32_16x16x32_bf16 v[32:35], v[80:83], v[112:115], v[32:35]
    ds_read_b64_tr_b16 v[108:109], v2 offset:25440
    ds_read_b64_tr_b16 v[110:111], v2 offset:25952
    v_mfma_f32_16x16x32_bf16 v[40:43], v[80:83], v[116:119], v[40:43]
    buffer_load_dwordx4 v4, s[24:27], s41 offen offset:3072 sc1 lds
    v_mfma_f32_16x16x32_bf16 v[36:39], v[84:87], v[112:115], v[36:39]
    ds_read_b64_tr_b16 v[80:81], v2 offset:128
    ds_read_b64_tr_b16 v[82:83], v2 offset:640
    v_mfma_f32_16x16x32_bf16 v[44:47], v[84:87], v[116:119], v[44:47]
    s_waitcnt lgkmcnt(10)
    v_mfma_f32_16x16x32_bf16 v[32:35], v[88:91], v[120:123], v[32:35]
    ds_read_b64_tr_b16 v[84:85], v2 offset:160
    ds_read_b64_tr_b16 v[86:87], v2 offset:672
    v_mfma_f32_16x16x32_bf16 v[40:43], v[88:91], v[124:127], v[40:43]
    v_mfma_f32_16x16x32_bf16 v[36:39], v[92:95], v[120:123], v[36:39]
    ds_read_b64_tr_b16 v[88:89], v2 offset:8576
    ds_read_b64_tr_b16 v[90:91], v2 offset:9088
    v_mfma_f32_16x16x32_bf16 v[44:47], v[92:95], v[124:127], v[44:47]
    v_mul_f32 v16, 0x3e0293ee, v16
    v_mul_f32 v17, 0x3e0293ee, v17
    v_mul_f32 v18, 0x3e0293ee, v18
    v_mul_f32 v19, 0x3e0293ee, v19
    v_mul_f32 v20, 0x3e0293ee, v20
    v_mul_f32 v21, 0x3e0293ee, v21
    v_mul_f32 v22, 0x3e0293ee, v22
    v_mul_f32 v23, 0x3e0293ee, v23
    v_mul_f32 v24, 0x3e0293ee, v24
    v_mul_f32 v25, 0x3e0293ee, v25
    s_waitcnt lgkmcnt(10)
    v_mfma_f32_16x16x32_bf16 v[32:35], v[96:99], v[128:131], v[32:35]
    ds_read_b64_tr_b16 v[92:93], v2 offset:8608
    ds_read_b64_tr_b16 v[94:95], v2 offset:9120
    v_mfma_f32_16x16x32_bf16 v[40:43], v[96:99], v[132:135], v[40:43]
    v_mul_f32 v26, 0x3e0293ee, v26
    v_mul_f32 v27, 0x3e0293ee, v27
    v_mul_f32 v28, 0x3e0293ee, v28
    v_mul_f32 v29, 0x3e0293ee, v29
    v_mul_f32 v30, 0x3e0293ee, v30
    v_mul_f32 v31, 0x3e0293ee, v31
    v_cvt_pk_bf16_f32 v144, v16, v17
    v_cvt_pk_bf16_f32 v145, v18, v19
    v_cvt_pk_bf16_f32 v146, v24, v25
    v_cvt_pk_bf16_f32 v147, v26, v27
    v_mfma_f32_16x16x32_bf16 v[36:39], v[100:103], v[128:131], v[36:39]
    ds_read_b64_tr_b16 v[96:97], v2 offset:17024
    ds_read_b64_tr_b16 v[98:99], v2 offset:17536
    v_mfma_f32_16x16x32_bf16 v[44:47], v[100:103], v[132:135], v[44:47]
    v_cvt_pk_bf16_f32 v148, v20, v21
    v_cvt_pk_bf16_f32 v149, v22, v23
    v_cvt_pk_bf16_f32 v150, v28, v29
    v_cvt_pk_bf16_f32 v151, v30, v31
    v_mov_b32 v16, 0
    v_mov_b32 v17, 0
    v_mov_b32 v18, 0
    v_mov_b32 v19, 0
    v_mov_b32 v20, 0
    s_waitcnt lgkmcnt(10)
    v_mfma_f32_16x16x32_bf16 v[32:35], v[104:107], v[136:139], v[32:35]
    ds_read_b64_tr_b16 v[100:101], v2 offset:17056
    ds_read_b64_tr_b16 v[102:103], v2 offset:17568
    v_mfma_f32_16x16x32_bf16 v[40:43], v[104:107], v[140:143], v[40:43]
    v_mov_b32 v21, 0
    v_mov_b32 v22, 0
    v_mov_b32 v23, 0
    v_mov_b32 v24, 0
    v_mov_b32 v25, 0
    v_mov_b32 v26, 0
    v_mov_b32 v27, 0
    v_mov_b32 v28, 0
    v_mov_b32 v29, 0
    v_mov_b32 v30, 0
    v_mfma_f32_16x16x32_bf16 v[36:39], v[108:111], v[136:139], v[36:39]
    ds_read_b64_tr_b16 v[104:105], v2 offset:25472
    ds_read_b64_tr_b16 v[106:107], v2 offset:25984
    v_mfma_f32_16x16x32_bf16 v[44:47], v[108:111], v[140:143], v[44:47]
    v_mov_b32 v31, 0
    v_permlane16_swap_b32 v144, v146
    v_permlane16_swap_b32 v145, v147
    v_permlane16_swap_b32 v148, v150
    v_permlane16_swap_b32 v149, v151
    v_permlane32_swap_b32 v144, v146
    v_permlane32_swap_b32 v145, v147
    v_permlane32_swap_b32 v148, v150
    v_permlane32_swap_b32 v149, v151
    s_waitcnt lgkmcnt(10)
    v_mfma_f32_16x16x32_bf16 v[48:51], v[80:83], v[112:115], v[48:51]
    ds_read_b64_tr_b16 v[108:109], v2 offset:25504
    ds_read_b64_tr_b16 v[110:111], v2 offset:26016
    v_mfma_f32_16x16x32_bf16 v[56:59], v[80:83], v[116:119], v[56:59]
    v_mfma_f32_16x16x32_bf16 v[52:55], v[84:87], v[112:115], v[52:55]
    ds_read_b64_tr_b16 v[80:81], v2 offset:192
    ds_read_b64_tr_b16 v[82:83], v2 offset:704
    v_mfma_f32_16x16x32_bf16 v[60:63], v[84:87], v[116:119], v[60:63]
    s_waitcnt lgkmcnt(10)
    v_mfma_f32_16x16x32_bf16 v[48:51], v[88:91], v[120:123], v[48:51]
    ds_read_b64_tr_b16 v[84:85], v2 offset:224
    ds_read_b64_tr_b16 v[86:87], v2 offset:736
    v_mfma_f32_16x16x32_bf16 v[56:59], v[88:91], v[124:127], v[56:59]
    v_mfma_f32_16x16x32_bf16 v[52:55], v[92:95], v[120:123], v[52:55]
    ds_read_b64_tr_b16 v[88:89], v2 offset:8640
    ds_read_b64_tr_b16 v[90:91], v2 offset:9152
    v_mfma_f32_16x16x32_bf16 v[60:63], v[92:95], v[124:127], v[60:63]
    v_mul_f32 v32, 0x3e0293ee, v32
    v_mul_f32 v33, 0x3e0293ee, v33
    v_mul_f32 v34, 0x3e0293ee, v34
    v_mul_f32 v35, 0x3e0293ee, v35
    v_mul_f32 v36, 0x3e0293ee, v36
    v_mul_f32 v37, 0x3e0293ee, v37
    v_mul_f32 v38, 0x3e0293ee, v38
    v_mul_f32 v39, 0x3e0293ee, v39
    v_mul_f32 v40, 0x3e0293ee, v40
    v_mul_f32 v41, 0x3e0293ee, v41
    s_waitcnt lgkmcnt(10)
    v_mfma_f32_16x16x32_bf16 v[48:51], v[96:99], v[128:131], v[48:51]
    ds_read_b64_tr_b16 v[92:93], v2 offset:8672
    ds_read_b64_tr_b16 v[94:95], v2 offset:9184
    v_mfma_f32_16x16x32_bf16 v[56:59], v[96:99], v[132:135], v[56:59]
    v_mul_f32 v42, 0x3e0293ee, v42
    v_mul_f32 v43, 0x3e0293ee, v43
    v_mul_f32 v44, 0x3e0293ee, v44
    v_mul_f32 v45, 0x3e0293ee, v45
    v_mul_f32 v46, 0x3e0293ee, v46
    v_mul_f32 v47, 0x3e0293ee, v47
    v_cvt_pk_bf16_f32 v152, v32, v33
    v_cvt_pk_bf16_f32 v153, v34, v35
    v_cvt_pk_bf16_f32 v154, v40, v41
    v_cvt_pk_bf16_f32 v155, v42, v43
    v_mfma_f32_16x16x32_bf16 v[52:55], v[100:103], v[128:131], v[52:55]
    ds_read_b64_tr_b16 v[96:97], v2 offset:17088
    ds_read_b64_tr_b16 v[98:99], v2 offset:17600
    v_mfma_f32_16x16x32_bf16 v[60:63], v[100:103], v[132:135], v[60:63]
    v_cvt_pk_bf16_f32 v156, v36, v37
    v_cvt_pk_bf16_f32 v157, v38, v39
    v_cvt_pk_bf16_f32 v158, v44, v45
    v_cvt_pk_bf16_f32 v159, v46, v47
    v_mov_b32 v32, 0
    v_mov_b32 v33, 0
    v_mov_b32 v34, 0
    v_mov_b32 v35, 0
    v_mov_b32 v36, 0
    s_waitcnt lgkmcnt(10)
    v_mfma_f32_16x16x32_bf16 v[48:51], v[104:107], v[136:139], v[48:51]
    ds_read_b64_tr_b16 v[100:101], v2 offset:17120
    ds_read_b64_tr_b16 v[102:103], v2 offset:17632
    v_mfma_f32_16x16x32_bf16 v[56:59], v[104:107], v[140:143], v[56:59]
    v_mov_b32 v37, 0
    v_mov_b32 v38, 0
    v_mov_b32 v39, 0
    v_mov_b32 v40, 0
    v_mov_b32 v41, 0
    v_mov_b32 v42, 0
    v_mov_b32 v43, 0
    v_mov_b32 v44, 0
    v_mov_b32 v45, 0
    v_mov_b32 v46, 0
    v_mfma_f32_16x16x32_bf16 v[52:55], v[108:111], v[136:139], v[52:55]
    ds_read_b64_tr_b16 v[104:105], v2 offset:25536
    ds_read_b64_tr_b16 v[106:107], v2 offset:26048
    v_mfma_f32_16x16x32_bf16 v[60:63], v[108:111], v[140:143], v[60:63]
    v_mov_b32 v47, 0
    v_permlane16_swap_b32 v152, v154
    v_permlane16_swap_b32 v153, v155
    v_permlane16_swap_b32 v156, v158
    v_permlane16_swap_b32 v157, v159
    v_permlane32_swap_b32 v152, v154
    v_permlane32_swap_b32 v153, v155
    v_permlane32_swap_b32 v156, v158
    v_permlane32_swap_b32 v157, v159
    s_waitcnt lgkmcnt(10)
    v_mfma_f32_16x16x32_bf16 v[64:67], v[80:83], v[112:115], v[64:67]
    ds_read_b64_tr_b16 v[108:109], v2 offset:25568
    ds_read_b64_tr_b16 v[110:111], v2 offset:26080
    v_mfma_f32_16x16x32_bf16 v[72:75], v[80:83], v[116:119], v[72:75]
    v_add_u32 v2, s9, v4
    s_waitcnt vmcnt(4)
    s_barrier
    v_mfma_f32_16x16x32_bf16 v[68:71], v[84:87], v[112:115], v[68:71]
    ds_read_b128 v[80:83], v2 offset:0
    v_mfma_f32_16x16x32_bf16 v[76:79], v[84:87], v[116:119], v[76:79]
    s_waitcnt lgkmcnt(9)
    v_mfma_f32_16x16x32_bf16 v[64:67], v[88:91], v[120:123], v[64:67]
    ds_read_b128 v[84:87], v2 offset:1024
    v_mfma_f32_16x16x32_bf16 v[72:75], v[88:91], v[124:127], v[72:75]
    v_mfma_f32_16x16x32_bf16 v[68:71], v[92:95], v[120:123], v[68:71]
    ds_read_b128 v[88:91], v2 offset:2048
    v_mfma_f32_16x16x32_bf16 v[76:79], v[92:95], v[124:127], v[76:79]
    v_mul_f32 v48, 0x3e0293ee, v48
    v_mul_f32 v49, 0x3e0293ee, v49
    v_mul_f32 v50, 0x3e0293ee, v50
    v_mul_f32 v51, 0x3e0293ee, v51
    v_mul_f32 v52, 0x3e0293ee, v52
    v_mul_f32 v53, 0x3e0293ee, v53
    v_mul_f32 v54, 0x3e0293ee, v54
    v_mul_f32 v55, 0x3e0293ee, v55
    v_mul_f32 v56, 0x3e0293ee, v56
    v_mul_f32 v57, 0x3e0293ee, v57
    s_waitcnt lgkmcnt(7)
    v_mfma_f32_16x16x32_bf16 v[64:67], v[96:99], v[128:131], v[64:67]
    ds_read_b128 v[92:95], v2 offset:3072
    v_mfma_f32_16x16x32_bf16 v[72:75], v[96:99], v[132:135], v[72:75]
    v_mul_f32 v58, 0x3e0293ee, v58
    v_mul_f32 v59, 0x3e0293ee, v59
    v_mul_f32 v60, 0x3e0293ee, v60
    v_mul_f32 v61, 0x3e0293ee, v61
    v_mul_f32 v62, 0x3e0293ee, v62
    v_mul_f32 v63, 0x3e0293ee, v63
    v_cvt_pk_bf16_f32 v160, v48, v49
    v_cvt_pk_bf16_f32 v161, v50, v51
    v_cvt_pk_bf16_f32 v162, v56, v57
    v_cvt_pk_bf16_f32 v163, v58, v59
    v_mfma_f32_16x16x32_bf16 v[68:71], v[100:103], v[128:131], v[68:71]
    ds_read_b128 v[96:99], v2 offset:4096
    v_mfma_f32_16x16x32_bf16 v[76:79], v[100:103], v[132:135], v[76:79]
    v_cvt_pk_bf16_f32 v164, v52, v53
    v_cvt_pk_bf16_f32 v165, v54, v55
    v_cvt_pk_bf16_f32 v166, v60, v61
    v_cvt_pk_bf16_f32 v167, v62, v63
    v_mov_b32 v48, 0
    v_mov_b32 v49, 0
    v_mov_b32 v50, 0
    v_mov_b32 v51, 0
    v_mov_b32 v52, 0
    s_waitcnt lgkmcnt(5)
    v_mfma_f32_16x16x32_bf16 v[64:67], v[104:107], v[136:139], v[64:67]
    ds_read_b128 v[100:103], v2 offset:5120
    v_mfma_f32_16x16x32_bf16 v[72:75], v[104:107], v[140:143], v[72:75]
    v_mov_b32 v53, 0
    v_mov_b32 v54, 0
    v_mov_b32 v55, 0
    v_mov_b32 v56, 0
    v_mov_b32 v57, 0
    v_mov_b32 v58, 0
    v_mov_b32 v59, 0
    v_mov_b32 v60, 0
    v_mov_b32 v61, 0
    v_mov_b32 v62, 0
    v_mfma_f32_16x16x32_bf16 v[68:71], v[108:111], v[136:139], v[68:71]
    ds_read_b128 v[104:107], v2 offset:6144
    v_mfma_f32_16x16x32_bf16 v[76:79], v[108:111], v[140:143], v[76:79]
    v_mov_b32 v63, 0
    v_permlane16_swap_b32 v160, v162
    v_permlane16_swap_b32 v161, v163
    v_permlane16_swap_b32 v164, v166
    v_permlane16_swap_b32 v165, v167
    v_permlane32_swap_b32 v160, v162
    v_permlane32_swap_b32 v161, v163
    v_permlane32_swap_b32 v164, v166
    v_permlane32_swap_b32 v165, v167
    s_cmp_lg_u32 s35, 1
    s_cbranch_scc1 L_nm0
    v_cndmask_b32 v208, v208, v9, s[48:49]
    v_cndmask_b32 v209, v209, v9, s[50:51]
    v_cndmask_b32 v210, v210, v9, s[52:53]
    v_cndmask_b32 v211, v211, v9, s[54:55]
    v_cndmask_b32 v212, v212, v9, s[56:57]
    v_cndmask_b32 v213, v213, v9, s[58:59]
    v_cndmask_b32 v214, v214, v9, s[60:61]
    v_cndmask_b32 v215, v215, v9, s[62:63]
    v_cndmask_b32 v216, v216, v9, s[64:65]
    v_cndmask_b32 v217, v217, v9, s[66:67]
    v_cndmask_b32 v218, v218, v9, s[68:69]
    v_cndmask_b32 v219, v219, v9, s[70:71]
    v_cndmask_b32 v220, v220, v9, s[72:73]
    v_cndmask_b32 v221, v221, v9, s[74:75]
    v_cndmask_b32 v222, v222, v9, s[76:77]
    v_cndmask_b32 v223, v223, v9, s[78:79]
L_nm0:
    s_nop 7
    v_mul_f32 v64, 0x3e0293ee, v64
    v_mul_f32 v65, 0x3e0293ee, v65
    v_mul_f32 v66, 0x3e0293ee, v66
    v_mul_f32 v67, 0x3e0293ee, v67
    v_mul_f32 v68, 0x3e0293ee, v68
    v_mul_f32 v69, 0x3e0293ee, v69
    v_mul_f32 v70, 0x3e0293ee, v70
    v_mul_f32 v71, 0x3e0293ee, v71
    v_mul_f32 v72, 0x3e0293ee, v72
    v_mul_f32 v73, 0x3e0293ee, v73
    v_mul_f32 v74, 0x3e0293ee, v74
    v_mul_f32 v75, 0x3e0293ee, v75
    v_mul_f32 v76, 0x3e0293ee, v76
    v_mul_f32 v77, 0x3e0293ee, v77
    v_mul_f32 v78, 0x3e0293ee, v78
    v_mul_f32 v79, 0x3e0293ee, v79
    v_cvt_pk_bf16_f32 v168, v64, v65
    v_cvt_pk_bf16_f32 v169, v66, v67
    v_cvt_pk_bf16_f32 v170, v72, v73
    v_cvt_pk_bf16_f32 v171, v74, v75
    v_cvt_pk_bf16_f32 v172, v68, v69
    v_cvt_pk_bf16_f32 v173, v70, v71
    v_cvt_pk_bf16_f32 v174, v76, v77
    v_cvt_pk_bf16_f32 v175, v78, v79
    v_mov_b32 v64, 0
    v_mov_b32 v65, 0
    v_mov_b32 v66, 0
    v_mov_b32 v67, 0
    v_mov_b32 v68, 0
    v_mov_b32 v69, 0
    v_mov_b32 v70, 0
    v_mov_b32 v71, 0
    v_mov_b32 v72, 0
    v_mov_b32 v73, 0
    v_mov_b32 v74, 0
    v_mov_b32 v75, 0
    v_mov_b32 v76, 0
    v_mov_b32 v77, 0
    v_mov_b32 v78, 0
    v_mov_b32 v79, 0
    v_permlane16_swap_b32 v168, v170
    v_permlane16_swap_b32 v169, v171
    v_permlane16_swap_b32 v172, v174
    v_permlane16_swap_b32 v173, v175
    v_permlane32_swap_b32 v168, v170
    v_permlane32_swap_b32 v169, v171
    v_permlane32_swap_b32 v172, v174
    v_permlane32_swap_b32 v173, v175
    s_waitcnt lgkmcnt(5)
    v_mfma_f32_32x32x16_bf16 v[176:191], v[80:83], v[144:147], v[208:223]
    ds_read_b128 v[108:111], v2 offset:7168
    v_mfma_f32_32x32x16_bf16 v[176:191], v[84:87], v[148:151], v[176:191]
    ds_read_b128 v[80:83], v2 offset:8192
    s_waitcnt lgkmcnt(5)
    v_mfma_f32_32x32x16_bf16 v[176:191], v[88:91], v[152:155], v[176:191]
    ds_read_b128 v[84:87], v2 offset:9216
    v_mfma_f32_32x32x16_bf16 v[176:191], v[92:95], v[156:159], v[176:191]
    ds_read_b128 v[88:91], v2 offset:10240
    s_waitcnt lgkmcnt(5)
    v_mfma_f32_32x32x16_bf16 v[176:191], v[96:99], v[160:163], v[176:191]
    ds_read_b128 v[92:95], v2 offset:11264
    v_mfma_f32_32x32x16_bf16 v[176:191], v[100:103], v[164:167], v[176:191]
    ds_read_b128 v[96:99], v2 offset:12288
    s_waitcnt lgkmcnt(5)
    v_mfma_f32_32x32x16_bf16 v[176:191], v[104:107], v[168:171], v[176:191]
    ds_read_b128 v[100:103], v2 offset:13312
    v_mfma_f32_32x32x16_bf16 v[176:191], v[108:111], v[172:175], v[176:191]
    ds_read_b128 v[104:107], v2 offset:14336
    s_nop 7
    s_nop 3
    v_max3_f32 v10, v176, v177, v178
    v_max3_f32 v10, v10, v179, v180
    v_max3_f32 v10, v10, v181, v182
    v_max3_f32 v10, v10, v183, v184
    v_max3_f32 v10, v10, v185, v186
    v_max3_f32 v10, v10, v187, v188
    v_max3_f32 v10, v10, v189, v190
    v_max_f32 v10, v10, v191
    v_mov_b32 v7, v10
    s_nop 1
    v_permlane32_swap_b32 v10, v7
    v_max_f32 v10, v10, v7
    v_sub_f32 v208, 0, v10
    v_sub_f32 v209, 0, v10
    v_sub_f32 v210, 0, v10
    v_sub_f32 v211, 0, v10
    v_sub_f32 v212, 0, v10
    v_sub_f32 v213, 0, v10
    v_sub_f32 v214, 0, v10
    v_sub_f32 v215, 0, v10
    v_sub_f32 v216, 0, v10
    v_sub_f32 v217, 0, v10
    v_sub_f32 v218, 0, v10
    v_sub_f32 v219, 0, v10
    v_sub_f32 v220, 0, v10
    v_sub_f32 v221, 0, v10
    v_sub_f32 v222, 0, v10
    v_sub_f32 v223, 0, v10
    s_cmp_lg_u32 s35, 2
    s_cbranch_scc1 L_nm1
    v_cndmask_b32 v208, v208, v9, s[48:49]
    v_cndmask_b32 v209, v209, v9, s[50:51]
    v_cndmask_b32 v210, v210, v9, s[52:53]
    v_cndmask_b32 v211, v211, v9, s[54:55]
    v_cndmask_b32 v212, v212, v9, s[56:57]
    v_cndmask_b32 v213, v213, v9, s[58:59]
    v_cndmask_b32 v214, v214, v9, s[60:61]
    v_cndmask_b32 v215, v215, v9, s[62:63]
    v_cndmask_b32 v216, v216, v9, s[64:65]
    v_cndmask_b32 v217, v217, v9, s[66:67]
    v_cndmask_b32 v218, v218, v9, s[68:69]
    v_cndmask_b32 v219, v219, v9, s[70:71]
    v_cndmask_b32 v220, v220, v9, s[72:73]
    v_cndmask_b32 v221, v221, v9, s[74:75]
    v_cndmask_b32 v222, v222, v9, s[76:77]
    v_cndmask_b32 v223, v223, v9, s[78:79]
L_nm1:
    v_sub_f32 v176, v176, v10
    v_sub_f32 v177, v177, v10
    v_sub_f32 v178, v178, v10
    v_sub_f32 v179, v179, v10
    v_sub_f32 v180, v180, v10
    v_sub_f32 v181, v181, v10
    v_sub_f32 v182, v182, v10
    v_sub_f32 v183, v183, v10
    v_sub_f32 v184, v184, v10
    v_sub_f32 v185, v185, v10
    v_sub_f32 v186, v186, v10
    v_sub_f32 v187, v187, v10
    v_sub_f32 v188, v188, v10
    v_sub_f32 v189, v189, v10
    v_sub_f32 v190, v190, v10
    v_sub_f32 v191, v191, v10
    s_waitcnt vmcnt(0)
    s_barrier
    s_waitcnt lgkmcnt(5)
    v_mfma_f32_32x32x16_bf16 v[192:207], v[80:83], v[144:147], v[208:223]
    ds_read_b128 v[108:111], v2 offset:15360
    v_add_u32 v2, s45, v4
    v_exp_f32 v112, v176
    v_exp_f32 v113, v177
    v_exp_f32 v114, v178
    v_add_f32 v6, v112, v113
    v_cvt_pk_bf16_f32 v224, v112, v113
    v_mfma_f32_32x32x16_bf16 v[192:207], v[84:87], v[148:151], v[192:207]
    ds_read_b128 v[80:83], v2 offset:16384
    v_exp_f32 v115, v179
    v_add_f32 v6, v6, v114
    v_exp_f32 v116, v180
    v_add_f32 v6, v6, v115
    v_cvt_pk_bf16_f32 v225, v114, v115
    s_waitcnt lgkmcnt(5)
    v_mfma_f32_32x32x16_bf16 v[192:207], v[88:91], v[152:155], v[192:207]
    ds_read_b128 v[84:87], v2 offset:17408
    v_exp_f32 v117, v181
    v_add_f32 v6, v6, v116
    v_exp_f32 v118, v182
    v_add_f32 v6, v6, v117
    v_cvt_pk_bf16_f32 v226, v116, v117
    v_mfma_f32_32x32x16_bf16 v[192:207], v[92:95], v[156:159], v[192:207]
    ds_read_b128 v[88:91], v2 offset:18432
    v_exp_f32 v119, v183
    v_add_f32 v6, v6, v118
    v_exp_f32 v120, v184
    v_add_f32 v6, v6, v119
    v_cvt_pk_bf16_f32 v227, v118, v119
    s_waitcnt lgkmcnt(5)
    v_mfma_f32_32x32x16_bf16 v[192:207], v[96:99], v[160:163], v[192:207]
    ds_read_b128 v[92:95], v2 offset:19456
    v_exp_f32 v121, v185
    v_add_f32 v6, v6, v120
    v_exp_f32 v122, v186
    v_add_f32 v6, v6, v121
    v_cvt_pk_bf16_f32 v228, v120, v121
    v_mfma_f32_32x32x16_bf16 v[192:207], v[100:103], v[164:167], v[192:207]
    ds_read_b128 v[96:99], v2 offset:20480
    v_exp_f32 v123, v187
    v_add_f32 v6, v6, v122
    v_exp_f32 v124, v188
    v_add_f32 v6, v6, v123
    v_cvt_pk_bf16_f32 v229, v122, v123
    s_waitcnt lgkmcnt(5)
    v_mfma_f32_32x32x16_bf16 v[192:207], v[104:107], v[168:171], v[192:207]
    ds_read_b128 v[100:103], v2 offset:21504
    v_exp_f32 v125, v189
    v_add_f32 v6, v6, v124
    v_exp_f32 v126, v190
    v_add_f32 v6, v6, v125
    v_cvt_pk_bf16_f32 v230, v124, v125
    v_mfma_f32_32x32x16_bf16 v[192:207], v[108:111], v[172:175], v[192:207]
    ds_read_b128 v[104:107], v2 offset:22528
    v_exp_f32 v127, v191
    v_add_f32 v6, v6, v126
    v_add_f32 v6, v6, v127
    v_cvt_pk_bf16_f32 v231, v126, v127
    v_mov_b32 v5, 0
    s_sub_u32 s35, s35, 1
    s_mov_b32 s45, s43
    s_add_u32 s43, s43, 34816
    s_cmp_eq_u32 s43, 139264
    s_cselect_b32 s43, 0, s43
    s_load_dwordx2 s[28:29], s[0:1], 40
    s_load_dwordx8 s[8:15], s[0:1], 56
    s_lshl_b32 s80, s2, 2
    s_add_u32 s80, s80, s3
    v_lshlrev_b32 v13, 3, v4
    s_sub_u32 s46, s35, 15
    s_mov_b32 s47, 0
    s_waitcnt lgkmcnt(0)
    s_branch L_rareA
.p2align 6
L_goA:
    s_waitcnt lgkmcnt(5)
    v_mfma_f32_32x32x16_bf16 v[16:31], v[80:83], v[224:227], v[16:31]
    ds_read_b128 v[108:111], v2 offset:23552
    v_add_f32 v5, v5, v6
    s_sub_u32 s35, s35, 1
    s_sub_u32 s41, s35, 3
    s_cmp_ge_u32 s41, s46
    s_cselect_b32 s44, -1.0, s83
    v_mfma_f32_32x32x16_bf16 v[32:47], v[84:87], v[224:227], v[32:47]
    ds_read_b128 v[80:83], v2 offset:0
    v_exp_f32 v112, v192
    v_exp_f32 v113, v193
    s_waitcnt lgkmcnt(5)
    v_mfma_f32_32x32x16_bf16 v[48:63], v[88:91], v[224:227], v[48:63]
    ds_read_b128 v[84:87], v2 offset:1024
    v_exp_f32 v114, v194
    v_exp_f32 v115, v195
    v_add_f32 v6, v112, v113
    v_mfma_f32_32x32x16_bf16 v[64:79], v[92:95], v[224:227], v[64:79]
    ds_read_b128 v[88:91], v2 offset:2048
    v_exp_f32 v116, v196
    v_add_f32 v6, v6, v114
    v_add_f32 v6, v6, v115
    s_waitcnt lgkmcnt(5)
    v_mfma_f32_32x32x16_bf16 v[16:31], v[96:99], v[228:231], v[16:31]
    ds_read_b128 v[92:95], v2 offset:3072
    v_exp_f32 v117, v197
    v_exp_f32 v118, v198
    v_add_f32 v6, v6, v116
    v_mfma_f32_32x32x16_bf16 v[32:47], v[100:103], v[228:231], v[32:47]
    ds_read_b128 v[96:99], v2 offset:4096
    v_exp_f32 v119, v199
    v_add_f32 v6, v6, v117
    v_add_f32 v6, v6, v118
    s_waitcnt lgkmcnt(5)
    v_mfma_f32_32x32x16_bf16 v[48:63], v[104:107], v[228:231], v[48:63]
    ds_read_b128 v[100:103], v2 offset:5120
    v_exp_f32 v120, v200
    v_add_f32 v6, v6, v119
    v_cvt_pk_bf16_f32 v232, v112, v113
    v_cvt_pk_bf16_f32 v233, v114, v115
    v_mfma_f32_32x32x16_bf16 v[64:79], v[108:111], v[228:231], v[64:79]
    ds_read_b128 v[104:107], v2 offset:6144
    v_exp_f32 v121, v201
    v_add_f32 v6, v6, v120
    v_cvt_pk_bf16_f32 v234, v116, v117
    s_waitcnt lgkmcnt(5)
    v_mfma_f32_32x32x16_bf16 v[176:191], v[80:83], v[144:147], v[208:223]
    ds_read_b128 v[108:111], v2 offset:7168
    v_exp_f32 v122, v202
    v_add_f32 v6, v6, v121
    v_cvt_pk_bf16_f32 v235, v118, v119
    v_mfma_f32_32x32x16_bf16 v[176:191], v[84:87], v[148:151], v[176:191]
    ds_read_b128 v[80:83], v2 offset:24576
    v_exp_f32 v123, v203
    v_add_f32 v6, v6, v122
    v_cvt_pk_bf16_f32 v236, v120, v121
    s_waitcnt lgkmcnt(5)
    v_mfma_f32_32x32x16_bf16 v[176:191], v[88:91], v[152:155], v[176:191]
    ds_read_b128 v[84:87], v2 offset:25600
    v_exp_f32 v124, v204
    v_exp_f32 v125, v205
    v_add_f32 v6, v6, v123
    v_mfma_f32_32x32x16_bf16 v[176:191], v[92:95], v[156:159], v[176:191]
    ds_read_b128 v[88:91], v2 offset:26624
    v_exp_f32 v126, v206
    v_add_f32 v6, v6, v124
    v_add_f32 v6, v6, v125
    s_waitcnt lgkmcnt(5)
    v_mfma_f32_32x32x16_bf16 v[176:191], v[96:99], v[160:163], v[176:191]
    ds_read_b128 v[92:95], v2 offset:27648
    v_exp_f32 v127, v207
    v_add_f32 v6, v6, v126
    v_cvt_pk_bf16_f32 v237, v122, v123
    v_mfma_f32_32x32x16_bf16 v[176:191], v[100:103], v[164:167], v[176:191]
    ds_read_b128 v[96:99], v2 offset:28672
    v_add_f32 v6, v6, v127
    v_cvt_pk_bf16_f32 v238, v124, v125
    s_waitcnt lgkmcnt(5)
    v_mfma_f32_32x32x16_bf16 v[176:191], v[104:107], v[168:171], v[176:191]
    ds_read_b128 v[100:103], v2 offset:29696
    v_cmp_nge_f32 vcc, s44, v6
    v_mfma_f32_32x32x16_bf16 v[176:191], v[108:111], v[172:175], v[176:191]
    ds_read_b128 v[104:107], v2 offset:30720
    v_cvt_pk_bf16_f32 v239, v126, v127
    s_cbranch_vccnz L_hdlA
L_goB:
    s_waitcnt lgkmcnt(5)
    v_mfma_f32_32x32x16_bf16 v[16:31], v[80:83], v[232:235], v[16:31]
    ds_read_b128 v[108:111], v2 offset:31744
    v_add_f32 v5, v5, v6
    s_sub_u32 s35, s35, 1
    s_cmp_le_u32 s35, 2
    s_cselect_b32 s44, -1.0, s83
    v_mfma_f32_32x32x16_bf16 v[32:47], v[84:87], v[232:235], v[32:47]
    ds_read_b128 v[80:83], v2 offset:8192
    v_exp_f32 v112, v176
    v_exp_f32 v113, v177
    s_waitcnt lgkmcnt(5)
    v_mfma_f32_32x32x16_bf16 v[48:63], v[88:91], v[232:235], v[48:63]
    ds_read_b128 v[84:87], v2 offset:9216
    v_exp_f32 v114, v178
    v_exp_f32 v115, v179
    v_add_f32 v6, v112, v113
    v_mfma_f32_32x32x16_bf16 v[64:79], v[92:95], v[232:235], v[64:79]
    ds_read_b128 v[88:91], v2 offset:10240
    v_exp_f32 v116, v180
    v_add_f32 v6, v6, v114
    v_add_f32 v6, v6, v115
    s_waitcnt lgkmcnt(5)
    v_mfma_f32_32x32x16_bf16 v[16:31], v[96:99], v[236:239], v[16:31]
    ds_read_b128 v[92:95], v2 offset:11264
    v_exp_f32 v117, v181
    v_exp_f32 v118, v182
    v_add_f32 v6, v6, v116
    v_mfma_f32_32x32x16_bf16 v[32:47], v[100:103], v[236:239], v[32:47]
    ds_read_b128 v[96:99], v2 offset:12288
    v_exp_f32 v119, v183
    v_add_f32 v6, v6, v117
    v_add_f32 v6, v6, v118
    s_waitcnt lgkmcnt(5)
    v_mfma_f32_32x32x16_bf16 v[48:63], v[104:107], v[236:239], v[48:63]
    ds_read_b128 v[100:103], v2 offset:13312
    v_exp_f32 v120, v184
    v_add_f32 v6, v6, v119
    v_cvt_pk_bf16_f32 v224, v112, v113
    v_cvt_pk_bf16_f32 v225, v114, v115
    v_mfma_f32_32x32x16_bf16 v[64:79], v[108:111], v[236:239], v[64:79]
    ds_read_b128 v[104:107], v2 offset:14336
    v_exp_f32 v121, v185
    v_add_f32 v6, v6, v120
    v_cvt_pk_bf16_f32 v226, v116, v117
    s_waitcnt lgkmcnt(5)
    v_mfma_f32_32x32x16_bf16 v[192:207], v[80:83], v[144:147], v[208:223]
    ds_read_b128 v[108:111], v2 offset:15360
    v_add_u32 v2, s45, v4
    v_exp_f32 v122, v186
    v_add_f32 v6, v6, v121
    v_cvt_pk_bf16_f32 v227, v118, v119
    s_barrier
    v_mfma_f32_32x32x16_bf16 v[192:207], v[84:87], v[148:151], v[192:207]
    ds_read_b128 v[80:83], v2 offset:16384
    v_exp_f32 v123, v187
    v_add_f32 v6, v6, v122
    v_cvt_pk_bf16_f32 v228, v120, v121
    s_waitcnt lgkmcnt(5)
    v_mfma_f32_32x32x16_bf16 v[192:207], v[88:91], v[152:155], v[192:207]
    ds_read_b128 v[84:87], v2 offset:17408
    v_exp_f32 v124, v188
    v_exp_f32 v125, v189
    v_add_f32 v6, v6, v123
    v_mfma_f32_32x32x16_bf16 v[192:207], v[92:95], v[156:159], v[192:207]
    ds_read_b128 v[88:91], v2 offset:18432
    v_exp_f32 v126, v190
    v_add_f32 v6, v6, v124
    v_add_f32 v6, v6, v125
    s_waitcnt lgkmcnt(5)
    v_mfma_f32_32x32x16_bf16 v[192:207], v[96:99], v[160:163], v[192:207]
    ds_read_b128 v[92:95], v2 offset:19456
    v_exp_f32 v127, v191
    v_add_f32 v6, v6, v126
    v_cvt_pk_bf16_f32 v229, v122, v123
    s_mov_b32 s45, s43
    v_mfma_f32_32x32x16_bf16 v[192:207], v[100:103], v[164:167], v[192:207]
    ds_read_b128 v[96:99], v2 offset:20480
    v_add_f32 v6, v6, v127
    v_cvt_pk_bf16_f32 v230, v124, v125
    s_add_u32 s43, s43, 34816
    s_waitcnt lgkmcnt(5)
    v_mfma_f32_32x32x16_bf16 v[192:207], v[104:107], v[168:171], v[192:207]
    ds_read_b128 v[100:103], v2 offset:21504
    v_cmp_nge_f32 vcc, s44, v6
    s_cmp_eq_u32 s43, 139264
    s_cselect_b32 s43, 0, s43
    v_mfma_f32_32x32x16_bf16 v[192:207], v[108:111], v[172:175], v[192:207]
    ds_read_b128 v[104:107], v2 offset:22528
    v_cvt_pk_bf16_f32 v231, v126, v127
    s_cbranch_vccz L_goA
L_hdlB:
    v_cmp_lt_f32 vcc, s83, v6
    s_cbranch_vccnz L_slowB
L_rareA:
    s_cmp_eq_u32 s35, 0
    s_cbranch_scc1 L_finA
    s_cmp_lg_u32 s35, 2
    s_cbranch_scc1 L_goA
    v_cndmask_b32 v208, v208, v9, s[48:49]
    v_cndmask_b32 v209, v209, v9, s[50:51]
    v_cndmask_b32 v210, v210, v9, s[52:53]
    v_cndmask_b32 v211, v211, v9, s[54:55]
    v_cndmask_b32 v212, v212, v9, s[56:57]
    v_cndmask_b32 v213, v213, v9, s[58:59]
    v_cndmask_b32 v214, v214, v9, s[60:61]
    v_cndmask_b32 v215, v215, v9, s[62:63]
    v_cndmask_b32 v216, v216, v9, s[64:65]
    v_cndmask_b32 v217, v217, v9, s[66:67]
    v_cndmask_b32 v218, v218, v9, s[68:69]
    v_cndmask_b32 v219, v219, v9, s[70:71]
    v_cndmask_b32 v220, v220, v9, s[72:73]
    v_cndmask_b32 v221, v221, v9, s[74:75]
    v_cndmask_b32 v222, v222, v9, s[76:77]
    v_cndmask_b32 v223, v223, v9, s[78:79]
    s_branch L_goA
L_hdlA:
    v_cmp_lt_f32 vcc, s83, v6
    s_cbranch_vccnz L_slowA
L_rareB:
    s_cmp_eq_u32 s35, 0
    s_cbranch_scc1 L_finB
    s_cmp_lg_u32 s35, 2
    s_cbranch_scc1 L_pfBx
    v_cndmask_b32 v208, v208, v9, s[48:49]
    v_cndmask_b32 v209, v209, v9, s[50:51]
    v_cndmask_b32 v210, v210, v9, s[52:53]
    v_cndmask_b32 v211, v211, v9, s[54:55]
    v_cndmask_b32 v212, v212, v9, s[56:57]
    v_cndmask_b32 v213, v213, v9, s[58:59]
    v_cndmask_b32 v214, v214, v9, s[60:61]
    v_cndmask_b32 v215, v215, v9, s[62:63]
    v_cndmask_b32 v216, v216, v9, s[64:65]
    v_cndmask_b32 v217, v217, v9, s[66:67]
    v_cndmask_b32 v218, v218, v9, s[68:69]
    v_cndmask_b32 v219, v219, v9, s[70:71]
    v_cndmask_b32 v220, v220, v9, s[72:73]
    v_cndmask_b32 v221, v221, v9, s[74:75]
    v_cndmask_b32 v222, v222, v9, s[76:77]
    v_cndmask_b32 v223, v223, v9, s[78:79]
    s_branch L_goB
L_pfBx:
    s_mov_b32 s81, 1
L_pf:
    s_cmp_lg_u32 s47, 0
    s_cbranch_scc1 L_pf0
    s_mov_b32 s20, s28
    s_mov_b32 s21, s29
    s_mov_b32 s22, 0x500000
    s_mov_b32 s23, 0x00020000
    s_mul_i32 s41, s80, 5120
    s_mov_b64 exec, 0xfffff
    buffer_load_dword v240, v13, s[20:23], s41 offen
    s_mov_b64 exec, -1
    s_branch L_pfe
L_pf0:
    s_cmp_lg_u32 s47, 1
    s_cbranch_scc1 L_pf1
    s_mov_b32 s20, s28
    s_mov_b32 s21, s29
    s_mov_b32 s22, 0x500000
    s_mov_b32 s23, 0x00020000
    s_mul_i32 s41, s80, 5120
    s_add_u32 s41, s41, 2560
    s_mov_b64 exec, 0xfffff
    buffer_load_dword v240, v13, s[20:23], s41 offen
    s_mov_b64 exec, -1
    s_branch L_pfe
L_pf1:
    s_cmp_lg_u32 s47, 2
    s_cbranch_scc1 L_pf2
    s_mov_b32 s20, s8
    s_mov_b32 s21, s9
    s_mov_b32 s22, 0xc8000
    s_mov_b32 s23, 0x00020000
    s_mul_i32 s41, s80, 896
    s_mov_b64 exec, 0x7f
    buffer_load_dword v240, v13, s[20:23], s41 offen
    s_mov_b64 exec, -1
    s_branch L_pfe
L_pf2:
    s_cmp_lg_u32 s47, 3
    s_cbranch_scc1 L_pf3
    s_mov_b32 s20, s10
    s_mov_b32 s21, s11
    s_mov_b32 s22, 0xc8000
    s_mov_b32 s23, 0x00020000
    s_mul_i32 s41, s80, 896
    s_mov_b64 exec, 0x7f
    buffer_load_dword v240, v13, s[20:23], s41 offen
    s_mov_b64 exec, -1
    s_branch L_pfe
L_pf3:
    s_cmp_lg_u32 s47, 4
    s_cbranch_scc1 L_pf4
    s_mov_b32 s20, s14
    s_mov_b32 s21, s15
    s_mov_b32 s22, 0x21c000
    s_mov_b32 s23, 0x00020000
    s_mul_i32 s41, s80, 2176
    s_mov_b64 exec, 0x1ffff
    buffer_load_dword v240, v13, s[20:23], s41 offen
    s_mov_b64 exec, -1
    s_branch L_pfe
L_pf4:
    s_cmp_lg_u32 s47, 5
    s_cbranch_scc1 L_pf5
    s_mov_b32 s20, s12
    s_mov_b32 s21, s13
    s_mov_b32 s22, 0x21c000
    s_mov_b32 s23, 0x00020000
    s_mul_i32 s41, s80, 2176
    s_mov_b64 exec, 0x1ffff
    buffer_load_dword v240, v13, s[20:23], s41 offen
    s_mov_b64 exec, -1
    s_branch L_pfe
L_pf5:
L_pfe:
    s_add_u32 s47, s47, 1
    s_cmp_eq_u32 s81, 0
    s_cbranch_scc1 L_goA
    s_branch L_goB
L_slowA:
    v_max3_f32 v10, v192, v193, v194
    v_max3_f32 v10, v10, v195, v196
    v_max3_f32 v10, v10, v197, v198
    v_max3_f32 v10, v10, v199, v200
    v_max3_f32 v10, v10, v201, v202
    v_max3_f32 v10, v10, v203, v204
    v_max3_f32 v10, v10, v205, v206
    v_max3_f32 v10, v10, v207, 0
    v_mov_b32 v7, v10
    s_nop 1
    v_permlane32_swap_b32 v10, v7
    v_max_f32 v10, v10, v7
    v_sub_f32 v11, 0, v10
    v_exp_f32 v11, v11
    v_sub_f32 v192, v192, v10
    v_sub_f32 v193, v193, v10
    v_sub_f32 v194, v194, v10
    v_sub_f32 v195, v195, v10
    v_sub_f32 v196, v196, v10
    v_sub_f32 v197, v197, v10
    v_sub_f32 v198, v198, v10
    v_sub_f32 v199, v199, v10
    v_sub_f32 v200, v200, v10
    v_sub_f32 v201, v201, v10
    v_sub_f32 v202, v202, v10
    v_sub_f32 v203, v203, v10
    v_sub_f32 v204, v204, v10
    v_sub_f32 v205, v205, v10
    v_sub_f32 v206, v206, v10
    v_sub_f32 v207, v207, v10
    v_mul_f32 v16, v16, v11
    v_mul_f32 v17, v17, v11
    v_mul_f32 v18, v18, v11
    v_mul_f32 v19, v19, v11
    v_mul_f32 v20, v20, v11
    v_mul_f32 v21, v21, v11
    v_mul_f32 v22, v22, v11
    v_mul_f32 v23, v23, v11
    v_mul_f32 v24, v24, v11
    v_mul_f32 v25, v25, v11
    v_mul_f32 v26, v26, v11
    v_mul_f32 v27, v27, v11
    v_mul_f32 v28, v28, v11
    v_mul_f32 v29, v29, v11
    v_mul_f32 v30, v30, v11
    v_mul_f32 v31, v31, v11
    v_mul_f32 v32, v32, v11
    v_mul_f32 v33, v33, v11
    v_mul_f32 v34, v34, v11
    v_mul_f32 v35, v35, v11
    v_mul_f32 v36, v36, v11
    v_mul_f32 v37, v37, v11
    v_mul_f32 v38, v38, v11
    v_mul_f32 v39, v39, v11
    v_mul_f32 v40, v40, v11
    v_mul_f32 v41, v41, v11
    v_mul_f32 v42, v42, v11
    v_mul_f32 v43, v43, v11
    v_mul_f32 v44, v44, v11
    v_mul_f32 v45, v45, v11
    v_mul_f32 v46, v46, v11
    v_mul_f32 v47, v47, v11
    v_mul_f32 v48, v48, v11
    v_mul_f32 v49, v49, v11
    v_mul_f32 v50, v50, v11
    v_mul_f32 v51, v51, v11
    v_mul_f32 v52, v52, v11
    v_mul_f32 v53, v53, v11
    v_mul_f32 v54, v54, v11
    v_mul_f32 v55, v55, v11
    v_mul_f32 v56, v56, v11
    v_mul_f32 v57, v57, v11
    v_mul_f32 v58, v58, v11
    v_mul_f32 v59, v59, v11
    v_mul_f32 v60, v60, v11
    v_mul_f32 v61, v61, v11
    v_mul_f32 v62, v62, v11
    v_mul_f32 v63, v63, v11
    v_mul_f32 v64, v64, v11
    v_mul_f32 v65, v65, v11
    v_mul_f32 v66, v66, v11
    v_mul_f32 v67, v67, v11
    v_mul_f32 v68, v68, v11
    v_mul_f32 v69, v69, v11
    v_mul_f32 v70, v70, v11
    v_mul_f32 v71, v71, v11
    v_mul_f32 v72, v72, v11
    v_mul_f32 v73, v73, v11
    v_mul_f32 v74, v74, v11
    v_mul_f32 v75, v75, v11
    v_mul_f32 v76, v76, v11
    v_mul_f32 v77, v77, v11
    v_mul_f32 v78, v78, v11
    v_mul_f32 v79, v79, v11
    v_mul_f32 v5, v5, v11
    v_sub_f32 v208, v208, v10
    v_sub_f32 v209, v209, v10
    v_sub_f32 v210, v210, v10
    v_sub_f32 v211, v211, v10
    v_sub_f32 v212, v212, v10
    v_sub_f32 v213, v213, v10
    v_sub_f32 v214, v214, v10
    v_sub_f32 v215, v215, v10
    v_sub_f32 v216, v216, v10
    v_sub_f32 v217, v217, v10
    v_sub_f32 v218, v218, v10
    v_sub_f32 v219, v219, v10
    v_sub_f32 v220, v220, v10
    v_sub_f32 v221, v221, v10
    v_sub_f32 v222, v222, v10
    v_sub_f32 v223, v223, v10
    v_sub_f32 v176, v176, v10
    v_sub_f32 v177, v177, v10
    v_sub_f32 v178, v178, v10
    v_sub_f32 v179, v179, v10
    v_sub_f32 v180, v180, v10
    v_sub_f32 v181, v181, v10
    v_sub_f32 v182, v182, v10
    v_sub_f32 v183, v183, v10
    v_sub_f32 v184, v184, v10
    v_sub_f32 v185, v185, v10
    v_sub_f32 v186, v186, v10
    v_sub_f32 v187, v187, v10
    v_sub_f32 v188, v188, v10
    v_sub_f32 v189, v189, v10
    v_sub_f32 v190, v190, v10
    v_sub_f32 v191, v191, v10
    v_exp_f32 v112, v192
    v_exp_f32 v113, v193
    v_exp_f32 v114, v194
    v_exp_f32 v115, v195
    v_exp_f32 v116, v196
    v_exp_f32 v117, v197
    v_exp_f32 v118, v198
    v_exp_f32 v119, v199
    v_exp_f32 v120, v200
    v_exp_f32 v121, v201
    v_exp_f32 v122, v202
    v_exp_f32 v123, v203
    v_exp_f32 v124, v204
    v_exp_f32 v125, v205
    v_exp_f32 v126, v206
    v_exp_f32 v127, v207
    v_add_f32 v6, v112, v113
    v_add_f32 v6, v6, v114
    v_add_f32 v6, v6, v115
    v_add_f32 v6, v6, v116
    v_add_f32 v6, v6, v117
    v_add_f32 v6, v6, v118
    v_add_f32 v6, v6, v119
    v_add_f32 v6, v6, v120
    v_add_f32 v6, v6, v121
    v_add_f32 v6, v6, v122
    v_add_f32 v6, v6, v123
    v_add_f32 v6, v6, v124
    v_add_f32 v6, v6, v125
    v_add_f32 v6, v6, v126
    v_add_f32 v6, v6, v127
    v_cvt_pk_bf16_f32 v232, v112, v113
    v_cvt_pk_bf16_f32 v233, v114, v115
    v_cvt_pk_bf16_f32 v234, v116, v117
    v_cvt_pk_bf16_f32 v235, v118, v119
    v_cvt_pk_bf16_f32 v236, v120, v121
    v_cvt_pk_bf16_f32 v237, v122, v123
    v_cvt_pk_bf16_f32 v238, v124, v125
    v_cvt_pk_bf16_f32 v239, v126, v127
    s_branch L_rareB
L_slowB:
    v_max3_f32 v10, v176, v177, v178
    v_max3_f32 v10, v10, v179, v180
    v_max3_f32 v10, v10, v181, v182
    v_max3_f32 v10, v10, v183, v184
    v_max3_f32 v10, v10, v185, v186
    v_max3_f32 v10, v10, v187, v188
    v_max3_f32 v10, v10, v189, v190
    v_max3_f32 v10, v10, v191, 0
    v_mov_b32 v7, v10
    s_nop 1
    v_permlane32_swap_b32 v10, v7
    v_max_f32 v10, v10, v7
    v_sub_f32 v11, 0, v10
    v_exp_f32 v11, v11
    v_sub_f32 v176, v176, v10
    v_sub_f32 v177, v177, v10
    v_sub_f32 v178, v178, v10
    v_sub_f32 v179, v179, v10
    v_sub_f32 v180, v180, v10
    v_sub_f32 v181, v181, v10
    v_sub_f32 v182, v182, v10
    v_sub_f32 v183, v183, v10
    v_sub_f32 v184, v184, v10
    v_sub_f32 v185, v185, v10
    v_sub_f32 v186, v186, v10
    v_sub_f32 v187, v187, v10
    v_sub_f32 v188, v188, v10
    v_sub_f32 v189, v189, v10
    v_sub_f32 v190, v190, v10
    v_sub_f32 v191, v191, v10
    v_mul_f32 v16, v16, v11
    v_mul_f32 v17, v17, v11
    v_mul_f32 v18, v18, v11
    v_mul_f32 v19, v19, v11
    v_mul_f32 v20, v20, v11
    v_mul_f32 v21, v21, v11
    v_mul_f32 v22, v22, v11
    v_mul_f32 v23, v23, v11
    v_mul_f32 v24, v24, v11
    v_mul_f32 v25, v25, v11
    v_mul_f32 v26, v26, v11
    v_mul_f32 v27, v27, v11
    v_mul_f32 v28, v28, v11
    v_mul_f32 v29, v29, v11
    v_mul_f32 v30, v30, v11
    v_mul_f32 v31, v31, v11
    v_mul_f32 v32, v32, v11
    v_mul_f32 v33, v33, v11
    v_mul_f32 v34, v34, v11
    v_mul_f32 v35, v35, v11
    v_mul_f32 v36, v36, v11
    v_mul_f32 v37, v37, v11
    v_mul_f32 v38, v38, v11
    v_mul_f32 v39, v39, v11
    v_mul_f32 v40, v40, v11
    v_mul_f32 v41, v41, v11
    v_mul_f32 v42, v42, v11
    v_mul_f32 v43, v43, v11
    v_mul_f32 v44, v44, v11
    v_mul_f32 v45, v45, v11
    v_mul_f32 v46, v46, v11
    v_mul_f32 v47, v47, v11
    v_mul_f32 v48, v48, v11
    v_mul_f32 v49, v49, v11
    v_mul_f32 v50, v50, v11
    v_mul_f32 v51, v51, v11
    v_mul_f32 v52, v52, v11
    v_mul_f32 v53, v53, v11
    v_mul_f32 v54, v54, v11
    v_mul_f32 v55, v55, v11
    v_mul_f32 v56, v56, v11
    v_mul_f32 v57, v57, v11
    v_mul_f32 v58, v58, v11
    v_mul_f32 v59, v59, v11
    v_mul_f32 v60, v60, v11
    v_mul_f32 v61, v61, v11
    v_mul_f32 v62, v62, v11
    v_mul_f32 v63, v63, v11
    v_mul_f32 v64, v64, v11
    v_mul_f32 v65, v65, v11
    v_mul_f32 v66, v66, v11
    v_mul_f32 v67, v67, v11
    v_mul_f32 v68, v68, v11
    v_mul_f32 v69, v69, v11
    v_mul_f32 v70, v70, v11
    v_mul_f32 v71, v71, v11
    v_mul_f32 v72, v72, v11
    v_mul_f32 v73, v73, v11
    v_mul_f32 v74, v74, v11
    v_mul_f32 v75, v75, v11
    v_mul_f32 v76, v76, v11
    v_mul_f32 v77, v77, v11
    v_mul_f32 v78, v78, v11
    v_mul_f32 v79, v79, v11
    v_mul_f32 v5, v5, v11
    v_sub_f32 v208, v208, v10
    v_sub_f32 v209, v209, v10
    v_sub_f32 v210, v210, v10
    v_sub_f32 v211, v211, v10
    v_sub_f32 v212, v212, v10
    v_sub_f32 v213, v213, v10
    v_sub_f32 v214, v214, v10
    v_sub_f32 v215, v215, v10
    v_sub_f32 v216, v216, v10
    v_sub_f32 v217, v217, v10
    v_sub_f32 v218, v218, v10
    v_sub_f32 v219, v219, v10
    v_sub_f32 v220, v220, v10
    v_sub_f32 v221, v221, v10
    v_sub_f32 v222, v222, v10
    v_sub_f32 v223, v223, v10
    v_sub_f32 v192, v192, v10
    v_sub_f32 v193, v193, v10
    v_sub_f32 v194, v194, v10
    v_sub_f32 v195, v195, v10
    v_sub_f32 v196, v196, v10
    v_sub_f32 v197, v197, v10
    v_sub_f32 v198, v198, v10
    v_sub_f32 v199, v199, v10
    v_sub_f32 v200, v200, v10
    v_sub_f32 v201, v201, v10
    v_sub_f32 v202, v202, v10
    v_sub_f32 v203, v203, v10
    v_sub_f32 v204, v204, v10
    v_sub_f32 v205, v205, v10
    v_sub_f32 v206, v206, v10
    v_sub_f32 v207, v207, v10
    v_exp_f32 v112, v176
    v_exp_f32 v113, v177
    v_exp_f32 v114, v178
    v_exp_f32 v115, v179
    v_exp_f32 v116, v180
    v_exp_f32 v117, v181
    v_exp_f32 v118, v182
    v_exp_f32 v119, v183
    v_exp_f32 v120, v184
    v_exp_f32 v121, v185
    v_exp_f32 v122, v186
    v_exp_f32 v123, v187
    v_exp_f32 v124, v188
    v_exp_f32 v125, v189
    v_exp_f32 v126, v190
    v_exp_f32 v127, v191
    v_add_f32 v6, v112, v113
    v_add_f32 v6, v6, v114
    v_add_f32 v6, v6, v115
    v_add_f32 v6, v6, v116
    v_add_f32 v6, v6, v117
    v_add_f32 v6, v6, v118
    v_add_f32 v6, v6, v119
    v_add_f32 v6, v6, v120
    v_add_f32 v6, v6, v121
    v_add_f32 v6, v6, v122
    v_add_f32 v6, v6, v123
    v_add_f32 v6, v6, v124
    v_add_f32 v6, v6, v125
    v_add_f32 v6, v6, v126
    v_add_f32 v6, v6, v127
    v_cvt_pk_bf16_f32 v224, v112, v113
    v_cvt_pk_bf16_f32 v225, v114, v115
    v_cvt_pk_bf16_f32 v226, v116, v117
    v_cvt_pk_bf16_f32 v227, v118, v119
    v_cvt_pk_bf16_f32 v228, v120, v121
    v_cvt_pk_bf16_f32 v229, v122, v123
    v_cvt_pk_bf16_f32 v230, v124, v125
    v_cvt_pk_bf16_f32 v231, v126, v127
    s_branch L_rareA
L_finA:
    s_waitcnt lgkmcnt(5)
    v_mfma_f32_32x32x16_bf16 v[16:31], v[80:83], v[224:227], v[16:31]
    ds_read_b128 v[108:111], v2 offset:23552
    v_add_f32 v5, v5, v6
    v_mfma_f32_32x32x16_bf16 v[32:47], v[84:87], v[224:227], v[32:47]
    s_waitcnt lgkmcnt(4)
    v_mfma_f32_32x32x16_bf16 v[48:63], v[88:91], v[224:227], v[48:63]
    v_mfma_f32_32x32x16_bf16 v[64:79], v[92:95], v[224:227], v[64:79]
    s_waitcnt lgkmcnt(2)
    v_mfma_f32_32x32x16_bf16 v[16:31], v[96:99], v[228:231], v[16:31]
    v_mfma_f32_32x32x16_bf16 v[32:47], v[100:103], v[228:231], v[32:47]
    s_waitcnt lgkmcnt(0)
    v_mfma_f32_32x32x16_bf16 v[48:63], v[104:107], v[228:231], v[48:63]
    v_mfma_f32_32x32x16_bf16 v[64:79], v[108:111], v[228:231], v[64:79]
    s_branch L_epi
L_finB:
    s_waitcnt lgkmcnt(5)
    v_mfma_f32_32x32x16_bf16 v[16:31], v[80:83], v[232:235], v[16:31]
    ds_read_b128 v[108:111], v2 offset:31744
    v_add_f32 v5, v5, v6
    v_mfma_f32_32x32x16_bf16 v[32:47], v[84:87], v[232:235], v[32:47]
    s_waitcnt lgkmcnt(4)
    v_mfma_f32_32x32x16_bf16 v[48:63], v[88:91], v[232:235], v[48:63]
    v_mfma_f32_32x32x16_bf16 v[64:79], v[92:95], v[232:235], v[64:79]
    s_waitcnt lgkmcnt(2)
    v_mfma_f32_32x32x16_bf16 v[16:31], v[96:99], v[236:239], v[16:31]
    v_mfma_f32_32x32x16_bf16 v[32:47], v[100:103], v[236:239], v[32:47]
    s_waitcnt lgkmcnt(0)
    v_mfma_f32_32x32x16_bf16 v[48:63], v[104:107], v[236:239], v[48:63]
    v_mfma_f32_32x32x16_bf16 v[64:79], v[108:111], v[236:239], v[64:79]
    s_cmp_eq_u32 s3, 3
    s_cbranch_scc1 L_epi
    s_barrier
L_epi:
    s_nop 7
    s_nop 3
    v_mov_b32 v7, v5
    s_nop 1
    v_permlane32_swap_b32 v5, v7
    v_add_f32 v5, v5, v7
    v_rcp_f32 v11, v5
    s_lshl_b32 s41, s34, 18
    s_lshl_b32 s42, s32, 13
    s_add_u32 s41, s41, s42
    s_add_u32 s41, s41, 50331648
    s_add_u32 s42, s41, 4096
    v_mul_f32 v16, v16, v11
    v_mul_f32 v17, v17, v11
    v_mul_f32 v18, v18, v11
    v_mul_f32 v19, v19, v11
    v_mul_f32 v20, v20, v11
    v_mul_f32 v21, v21, v11
    v_mul_f32 v22, v22, v11
    v_mul_f32 v23, v23, v11
    v_cvt_pk_bf16_f32 v16, v16, v17
    v_cvt_pk_bf16_f32 v17, v18, v19
    v_cvt_pk_bf16_f32 v18, v20, v21
    v_cvt_pk_bf16_f32 v19, v22, v23
    buffer_store_dwordx4 v[16:19], v4, s[16:19], s41 offen offset:0 sc1
    v_mul_f32 v24, v24, v11
    v_mul_f32 v25, v25, v11
    v_mul_f32 v26, v26, v11
    v_mul_f32 v27, v27, v11
    v_mul_f32 v28, v28, v11
    v_mul_f32 v29, v29, v11
    v_mul_f32 v30, v30, v11
    v_mul_f32 v31, v31, v11
    v_cvt_pk_bf16_f32 v24, v24, v25
    v_cvt_pk_bf16_f32 v25, v26, v27
    v_cvt_pk_bf16_f32 v26, v28, v29
    v_cvt_pk_bf16_f32 v27, v30, v31
    buffer_store_dwordx4 v[24:27], v4, s[16:19], s41 offen offset:1024 sc1
    v_mul_f32 v32, v32, v11
    v_mul_f32 v33, v33, v11
    v_mul_f32 v34, v34, v11
    v_mul_f32 v35, v35, v11
    v_mul_f32 v36, v36, v11
    v_mul_f32 v37, v37, v11
    v_mul_f32 v38, v38, v11
    v_mul_f32 v39, v39, v11
    v_cvt_pk_bf16_f32 v32, v32, v33
    v_cvt_pk_bf16_f32 v33, v34, v35
    v_cvt_pk_bf16_f32 v34, v36, v37
    v_cvt_pk_bf16_f32 v35, v38, v39
    buffer_store_dwordx4 v[32:35], v4, s[16:19], s41 offen offset:2048 sc1
    v_mul_f32 v40, v40, v11
    v_mul_f32 v41, v41, v11
    v_mul_f32 v42, v42, v11
    v_mul_f32 v43, v43, v11
    v_mul_f32 v44, v44, v11
    v_mul_f32 v45, v45, v11
    v_mul_f32 v46, v46, v11
    v_mul_f32 v47, v47, v11
    v_cvt_pk_bf16_f32 v40, v40, v41
    v_cvt_pk_bf16_f32 v41, v42, v43
    v_cvt_pk_bf16_f32 v42, v44, v45
    v_cvt_pk_bf16_f32 v43, v46, v47
    buffer_store_dwordx4 v[40:43], v4, s[16:19], s41 offen offset:3072 sc1
    v_mul_f32 v48, v48, v11
    v_mul_f32 v49, v49, v11
    v_mul_f32 v50, v50, v11
    v_mul_f32 v51, v51, v11
    v_mul_f32 v52, v52, v11
    v_mul_f32 v53, v53, v11
    v_mul_f32 v54, v54, v11
    v_mul_f32 v55, v55, v11
    v_cvt_pk_bf16_f32 v48, v48, v49
    v_cvt_pk_bf16_f32 v49, v50, v51
    v_cvt_pk_bf16_f32 v50, v52, v53
    v_cvt_pk_bf16_f32 v51, v54, v55
    buffer_store_dwordx4 v[48:51], v4, s[16:19], s42 offen offset:0 sc1
    v_mul_f32 v56, v56, v11
    v_mul_f32 v57, v57, v11
    v_mul_f32 v58, v58, v11
    v_mul_f32 v59, v59, v11
    v_mul_f32 v60, v60, v11
    v_mul_f32 v61, v61, v11
    v_mul_f32 v62, v62, v11
    v_mul_f32 v63, v63, v11
    v_cvt_pk_bf16_f32 v56, v56, v57
    v_cvt_pk_bf16_f32 v57, v58, v59
    v_cvt_pk_bf16_f32 v58, v60, v61
    v_cvt_pk_bf16_f32 v59, v62, v63
    buffer_store_dwordx4 v[56:59], v4, s[16:19], s42 offen offset:1024 sc1
    v_mul_f32 v64, v64, v11
    v_mul_f32 v65, v65, v11
    v_mul_f32 v66, v66, v11
    v_mul_f32 v67, v67, v11
    v_mul_f32 v68, v68, v11
    v_mul_f32 v69, v69, v11
    v_mul_f32 v70, v70, v11
    v_mul_f32 v71, v71, v11
    v_cvt_pk_bf16_f32 v64, v64, v65
    v_cvt_pk_bf16_f32 v65, v66, v67
    v_cvt_pk_bf16_f32 v66, v68, v69
    v_cvt_pk_bf16_f32 v67, v70, v71
    buffer_store_dwordx4 v[64:67], v4, s[16:19], s42 offen offset:2048 sc1
    v_mul_f32 v72, v72, v11
    v_mul_f32 v73, v73, v11
    v_mul_f32 v74, v74, v11
    v_mul_f32 v75, v75, v11
    v_mul_f32 v76, v76, v11
    v_mul_f32 v77, v77, v11
    v_mul_f32 v78, v78, v11
    v_mul_f32 v79, v79, v11
    v_cvt_pk_bf16_f32 v72, v72, v73
    v_cvt_pk_bf16_f32 v73, v74, v75
    v_cvt_pk_bf16_f32 v74, v76, v77
    v_cvt_pk_bf16_f32 v75, v78, v79
    buffer_store_dwordx4 v[72:75], v4, s[16:19], s42 offen offset:3072 sc1
    s_cmp_lg_u32 s3, 0
    s_cbranch_scc1 L_nb
    s_barrier
L_nb:
    s_waitcnt vmcnt(0)
    s_lshr_b32 s92, s34, 2
    s_lshl_b32 s92, s92, 12
    s_lshl_b32 s93, s32, 7
    s_add_u32 s92, s92, s93
    s_add_u32 s92, s92, 696320
    v_mov_b32 v7, 162836
    v_mov_b32 v8, 1
    s_mov_b64 exec, 1
    ds_add_rtn_u32 v8, v7, v8
    v_mov_b32 v7, 0
    s_waitcnt lgkmcnt(0)
    v_cmp_eq_u32 vcc, 3, v8
    v_mov_b32 v8, s91
    s_cbranch_vccz L_sg0
    buffer_store_dword v8, v7, s[16:19], s92 offen sc1
L_sg0:
    s_mov_b64 exec, -1
    s_load_dwordx2 s[28:29], s[0:1], 104
    s_load_dwordx2 s[36:37], s[0:1], 0
    s_mov_b32 s38, 2621440
    s_mov_b32 s39, 0x00020000
    v_lshrrev_b32 v5, 6, v0
    v_and_b32 v3, 63, v0
    v_readfirstlane_b32 s3, v5
    v_lshlrev_b32 v1, 4, v3
    s_and_b32 s52, s2, 7
    s_lshr_b32 s53, s2, 3
    s_and_b32 s55, s3, 3
    s_mov_b32 s54, s91
    s_lshr_b32 s62, s52, 1
    s_and_b32 s34, s53, 15
    s_cmp_lt_u32 s53, 16
    s_cselect_b32 s57, 8, 0
    s_add_u32 s33, s52, s57
    s_lshl_b32 s35, s33, 4
    s_add_u32 s35, s35, s34
    s_lshr_b32 s56, s34, 2
    s_lshl_b32 s56, s56, 1
    s_add_u32 s56, s56, s57
    s_and_b32 s65, s52, 1
    s_add_u32 s65, s65, s56
    s_and_b32 s66, s53, 3
    s_lshl_b32 s63, s65, 2
    s_add_u32 s63, s63, s55
    s_mul_i32 s64, s66, 5
    s_lshl_b32 s56, s62, 6
    s_add_u32 s56, s56, s55
    s_mul_i32 s56, s56, 20
    s_add_u32 s56, s56, s64
    s_lshl_b32 s73, s56, 10
    s_add_u32 s73, s73, 117440512
    s_mul_i32 s77, s55, 5120
    s_lshl_b32 s81, s63, 18
    s_lshl_b32 s56, s62, 16
    s_add_u32 s81, s81, s56
    s_add_u32 s81, s81, 50331648
    s_waitcnt lgkmcnt(0)
    s_and_b32 s56, s34, 1
    s_lshr_b32 s69, s34, 1
    s_lshl_b32 s71, s33, 1
    s_add_u32 s71, s71, s56
    s_lshl_b32 s67, s71, 1
    s_and_b32 s56, s3, 1
    s_add_u32 s67, s67, s56
    s_mul_i32 s68, s69, 3
    s_min_u32 s68, s68, 17
    s_lshr_b32 s70, s55, 1
    s_mov_b32 s90, s33
    s_lshl_b32 s72, s90, 2
    s_add_u32 s72, s72, s55
    s_mov_b32 s91, s34
    s_lshl_b32 s85, s91, 2
    s_min_u32 s85, s85, 50
    s_mov_b32 s20, s4
    s_mov_b32 s21, s5
    s_mov_b32 s22, 0x0
    s_mov_b32 s23, 0x00020000
    s_mov_b32 s31, 0x00020000
    s_cmp_lt_u32 s34, 14
    s_cselect_b32 s22, 268435456, 0
    s_cselect_b32 s30, 2621440, 0
    s_mov_b32 s84, 0xbdd2d3e8
    s_mul_i32 s83, s62, 40960
    s_mul_i32 s57, s63, 262144
    s_add_u32 s83, s83, s57
    s_lshl_b32 s57, s64, 11
    s_add_u32 s83, s83, s57
    s_add_u32 s83, s83, 67108864
    s_cmp_lg_u32 s3, 0
    s_cbranch_scc1 kb_pd0
    s_lshl_b32 s56, s65, 12
    s_lshl_b32 s57, s62, 10
    s_add_u32 s56, s56, s57
    s_add_u32 s56, s56, 696320
    s_mov_b64 s[58:59], 0xff
    v_lshlrev_b32 v2, 3, v1
    s_mov_b32 s57, 0
    s_mov_b64 exec, s[58:59]
    s_cbranch_execz kb_pe0
kb_pl0:
    buffer_load_dword v3, v2, s[16:19], s56 offen sc1
    s_add_u32 s57, s57, 1
    s_waitcnt vmcnt(0)
    v_cmp_ne_u32 vcc, s54, v3
    s_cbranch_vccz kb_pe0
    s_mov_b64 exec, vcc
    s_sleep 1
    s_cmp_lt_u32 s57, 0x40000
    s_cbranch_scc1 kb_pl0
kb_pe0:
    s_mov_b64 exec, -1
kb_pd0:
    s_barrier
    s_add_u32 s60, s81, 0
    buffer_load_dwordx4 v[128:131], v1, s[16:19], s60 offen offset:0 sc1
    buffer_load_dwordx4 v[132:135], v1, s[16:19], s60 offen offset:1024 sc1
    buffer_load_dwordx4 v[136:139], v1, s[16:19], s60 offen offset:2048 sc1
    buffer_load_dwordx4 v[140:143], v1, s[16:19], s60 offen offset:3072 sc1
    s_add_u32 s60, s81, 4096
    buffer_load_dwordx4 v[144:147], v1, s[16:19], s60 offen offset:0 sc1
    buffer_load_dwordx4 v[148:151], v1, s[16:19], s60 offen offset:1024 sc1
    buffer_load_dwordx4 v[152:155], v1, s[16:19], s60 offen offset:2048 sc1
    buffer_load_dwordx4 v[156:159], v1, s[16:19], s60 offen offset:3072 sc1
    s_add_u32 s60, s81, 8192
    buffer_load_dwordx4 v[160:163], v1, s[16:19], s60 offen offset:0 sc1
    buffer_load_dwordx4 v[164:167], v1, s[16:19], s60 offen offset:1024 sc1
    buffer_load_dwordx4 v[168:171], v1, s[16:19], s60 offen offset:2048 sc1
    buffer_load_dwordx4 v[172:175], v1, s[16:19], s60 offen offset:3072 sc1
    v_add_u32 v6, 0, v1
    v_add_u32 v5, 0, v6
    ds_read_b128 v[96:99], v5 offset:0
    ds_read_b128 v[100:103], v5 offset:1024
    ds_read_b128 v[104:107], v5 offset:2048
    ds_read_b128 v[108:111], v5 offset:3072
    ds_read_b128 v[112:115], v5 offset:4096
    ds_read_b128 v[116:119], v5 offset:5120
    ds_read_b128 v[120:123], v5 offset:6144
    s_waitcnt vmcnt(11)
    s_waitcnt lgkmcnt(5)
    v_mfma_f32_32x32x16_bf16 v[16:31], v[96:99], v[128:131], 0
    ds_read_b128 v[124:127], v5 offset:7168
    s_add_u32 s60, s81, 12288
    buffer_load_dwordx4 v[176:179], v1, s[16:19], s60 offen offset:0 sc1
    v_mfma_f32_32x32x16_bf16 v[32:47], v[100:103], v[128:131], 0
    ds_read_b128 v[96:99], v5 offset:8192
    s_waitcnt lgkmcnt(5)
    v_mfma_f32_32x32x16_bf16 v[48:63], v[104:107], v[128:131], 0
    ds_read_b128 v[100:103], v5 offset:9216
    buffer_load_dwordx4 v[180:183], v1, s[16:19], s60 offen offset:1024 sc1
    v_mfma_f32_32x32x16_bf16 v[64:79], v[108:111], v[128:131], 0
    ds_read_b128 v[104:107], v5 offset:10240
    s_waitcnt lgkmcnt(5)
    v_mfma_f32_32x32x16_bf16 v[80:95], v[112:115], v[128:131], 0
    ds_read_b128 v[108:111], v5 offset:11264
    s_waitcnt vmcnt(12)
    v_mfma_f32_32x32x16_bf16 v[16:31], v[116:119], v[132:135], v[16:31]
    ds_read_b128 v[112:115], v5 offset:12288
    buffer_load_dwordx4 v[184:187], v1, s[16:19], s60 offen offset:2048 sc1
    s_waitcnt lgkmcnt(5)
    v_mfma_f32_32x32x16_bf16 v[32:47], v[120:123], v[132:135], v[32:47]
    ds_read_b128 v[116:119], v5 offset:13312
    v_mfma_f32_32x32x16_bf16 v[48:63], v[124:127], v[132:135], v[48:63]
    ds_read_b128 v[120:123], v5 offset:14336
    buffer_load_dwordx4 v[188:191], v1, s[16:19], s60 offen offset:3072 sc1
    s_waitcnt lgkmcnt(5)
    v_mfma_f32_32x32x16_bf16 v[64:79], v[96:99], v[132:135], v[64:79]
    ds_read_b128 v[124:127], v5 offset:15360
    v_mfma_f32_32x32x16_bf16 v[80:95], v[100:103], v[132:135], v[80:95]
    ds_read_b128 v[96:99], v5 offset:16384
    s_waitcnt vmcnt(13)
    s_waitcnt lgkmcnt(5)
    v_mfma_f32_32x32x16_bf16 v[16:31], v[104:107], v[136:139], v[16:31]
    ds_read_b128 v[100:103], v5 offset:17408
    s_add_u32 s60, s81, 16384
    buffer_load_dwordx4 v[192:195], v1, s[16:19], s60 offen offset:0 sc1
    v_mfma_f32_32x32x16_bf16 v[32:47], v[108:111], v[136:139], v[32:47]
    ds_read_b128 v[104:107], v5 offset:18432
    s_waitcnt lgkmcnt(5)
    v_mfma_f32_32x32x16_bf16 v[48:63], v[112:115], v[136:139], v[48:63]
    ds_read_b128 v[108:111], v5 offset:19456
    v_add_u32 v5, 20480, v6
    buffer_load_dwordx4 v[196:199], v1, s[16:19], s60 offen offset:1024 sc1
    v_mfma_f32_32x32x16_bf16 v[64:79], v[116:119], v[136:139], v[64:79]
    ds_read_b128 v[112:115], v5 offset:0
    s_waitcnt lgkmcnt(5)
    v_mfma_f32_32x32x16_bf16 v[80:95], v[120:123], v[136:139], v[80:95]
    ds_read_b128 v[116:119], v5 offset:1024
    s_waitcnt vmcnt(14)
    v_mfma_f32_32x32x16_bf16 v[16:31], v[124:127], v[140:143], v[16:31]
    ds_read_b128 v[120:123], v5 offset:2048
    buffer_load_dwordx4 v[200:203], v1, s[16:19], s60 offen offset:2048 sc1
    s_waitcnt lgkmcnt(5)
    v_mfma_f32_32x32x16_bf16 v[32:47], v[96:99], v[140:143], v[32:47]
    ds_read_b128 v[124:127], v5 offset:3072
    v_mfma_f32_32x32x16_bf16 v[48:63], v[100:103], v[140:143], v[48:63]
    ds_read_b128 v[96:99], v5 offset:4096
    buffer_load_dwordx4 v[204:207], v1, s[16:19], s60 offen offset:3072 sc1
    s_waitcnt lgkmcnt(5)
    v_mfma_f32_32x32x16_bf16 v[64:79], v[104:107], v[140:143], v[64:79]
    ds_read_b128 v[100:103], v5 offset:5120
    v_mfma_f32_32x32x16_bf16 v[80:95], v[108:111], v[140:143], v[80:95]
    ds_read_b128 v[104:107], v5 offset:6144
    s_barrier
    s_waitcnt vmcnt(15)
    s_waitcnt lgkmcnt(5)
    v_mfma_f32_32x32x16_bf16 v[16:31], v[112:115], v[144:147], v[16:31]
    ds_read_b128 v[108:111], v5 offset:7168
    s_add_u32 s60, s81, 20480
    buffer_load_dwordx4 v[208:211], v1, s[16:19], s60 offen offset:0 sc1
    v_mfma_f32_32x32x16_bf16 v[32:47], v[116:119], v[144:147], v[32:47]
    ds_read_b128 v[112:115], v5 offset:8192
    s_waitcnt lgkmcnt(5)
    v_mfma_f32_32x32x16_bf16 v[48:63], v[120:123], v[144:147], v[48:63]
    ds_read_b128 v[116:119], v5 offset:9216
    buffer_load_dwordx4 v[212:215], v1, s[16:19], s60 offen offset:1024 sc1
    v_mfma_f32_32x32x16_bf16 v[64:79], v[124:127], v[144:147], v[64:79]
    ds_read_b128 v[120:123], v5 offset:10240
    s_waitcnt lgkmcnt(5)
    v_mfma_f32_32x32x16_bf16 v[80:95], v[96:99], v[144:147], v[80:95]
    ds_read_b128 v[124:127], v5 offset:11264
    s_waitcnt vmcnt(16)
    v_mfma_f32_32x32x16_bf16 v[16:31], v[100:103], v[148:151], v[16:31]
    ds_read_b128 v[96:99], v5 offset:12288
    buffer_load_dwordx4 v[216:219], v1, s[16:19], s60 offen offset:2048 sc1
    s_waitcnt lgkmcnt(5)
    v_mfma_f32_32x32x16_bf16 v[32:47], v[104:107], v[148:151], v[32:47]
    ds_read_b128 v[100:103], v5 offset:13312
    v_mfma_f32_32x32x16_bf16 v[48:63], v[108:111], v[148:151], v[48:63]
    ds_read_b128 v[104:107], v5 offset:14336
    buffer_load_dwordx4 v[220:223], v1, s[16:19], s60 offen offset:3072 sc1
    s_waitcnt lgkmcnt(5)
    v_mfma_f32_32x32x16_bf16 v[64:79], v[112:115], v[148:151], v[64:79]
    ds_read_b128 v[108:111], v5 offset:15360
    v_mfma_f32_32x32x16_bf16 v[80:95], v[116:119], v[148:151], v[80:95]
    ds_read_b128 v[112:115], v5 offset:16384
    s_waitcnt vmcnt(17)
    s_waitcnt lgkmcnt(5)
    v_mfma_f32_32x32x16_bf16 v[16:31], v[120:123], v[152:155], v[16:31]
    ds_read_b128 v[116:119], v5 offset:17408
    s_add_u32 s60, s81, 24576
    buffer_load_dwordx4 v[224:227], v1, s[16:19], s60 offen offset:0 sc1
    v_mfma_f32_32x32x16_bf16 v[32:47], v[124:127], v[152:155], v[32:47]
    ds_read_b128 v[120:123], v5 offset:18432
    s_waitcnt lgkmcnt(5)
    v_mfma_f32_32x32x16_bf16 v[48:63], v[96:99], v[152:155], v[48:63]
    ds_read_b128 v[124:127], v5 offset:19456
    v_add_u32 v5, 40960, v6
    buffer_load_dwordx4 v[228:231], v1, s[16:19], s60 offen offset:1024 sc1
    v_mfma_f32_32x32x16_bf16 v[64:79], v[100:103], v[152:155], v[64:79]
    ds_read_b128 v[96:99], v5 offset:0
    s_waitcnt lgkmcnt(5)
    v_mfma_f32_32x32x16_bf16 v[80:95], v[104:107], v[152:155], v[80:95]
    ds_read_b128 v[100:103], v5 offset:1024
    s_waitcnt vmcnt(18)
    v_mfma_f32_32x32x16_bf16 v[16:31], v[108:111], v[156:159], v[16:31]
    ds_read_b128 v[104:107], v5 offset:2048
    buffer_load_dwordx4 v[232:235], v1, s[16:19], s60 offen offset:2048 sc1
    s_waitcnt lgkmcnt(5)
    v_mfma_f32_32x32x16_bf16 v[32:47], v[112:115], v[156:159], v[32:47]
    ds_read_b128 v[108:111], v5 offset:3072
    v_mfma_f32_32x32x16_bf16 v[48:63], v[116:119], v[156:159], v[48:63]
    ds_read_b128 v[112:115], v5 offset:4096
    buffer_load_dwordx4 v[236:239], v1, s[16:19], s60 offen offset:3072 sc1
    s_waitcnt lgkmcnt(5)
    v_mfma_f32_32x32x16_bf16 v[64:79], v[120:123], v[156:159], v[64:79]
    ds_read_b128 v[116:119], v5 offset:5120
    v_mfma_f32_32x32x16_bf16 v[80:95], v[124:127], v[156:159], v[80:95]
    ds_read_b128 v[120:123], v5 offset:6144
    s_barrier
    s_waitcnt vmcnt(19)
    s_waitcnt lgkmcnt(5)
    v_mfma_f32_32x32x16_bf16 v[16:31], v[96:99], v[160:163], v[16:31]
    ds_read_b128 v[124:127], v5 offset:7168
    s_add_u32 s60, s81, 28672
    buffer_load_dwordx4 v[240:243], v1, s[16:19], s60 offen offset:0 sc1
    v_mfma_f32_32x32x16_bf16 v[32:47], v[100:103], v[160:163], v[32:47]
    ds_read_b128 v[96:99], v5 offset:8192
    s_waitcnt lgkmcnt(5)
    v_mfma_f32_32x32x16_bf16 v[48:63], v[104:107], v[160:163], v[48:63]
    ds_read_b128 v[100:103], v5 offset:9216
    buffer_load_dwordx4 v[244:247], v1, s[16:19], s60 offen offset:1024 sc1
    v_mfma_f32_32x32x16_bf16 v[64:79], v[108:111], v[160:163], v[64:79]
    ds_read_b128 v[104:107], v5 offset:10240
    s_waitcnt lgkmcnt(5)
    v_mfma_f32_32x32x16_bf16 v[80:95], v[112:115], v[160:163], v[80:95]
    ds_read_b128 v[108:111], v5 offset:11264
    s_waitcnt vmcnt(20)
    v_mfma_f32_32x32x16_bf16 v[16:31], v[116:119], v[164:167], v[16:31]
    ds_read_b128 v[112:115], v5 offset:12288
    buffer_load_dwordx4 v[248:251], v1, s[16:19], s60 offen offset:2048 sc1
    s_waitcnt lgkmcnt(5)
    v_mfma_f32_32x32x16_bf16 v[32:47], v[120:123], v[164:167], v[32:47]
    ds_read_b128 v[116:119], v5 offset:13312
    v_mfma_f32_32x32x16_bf16 v[48:63], v[124:127], v[164:167], v[48:63]
    ds_read_b128 v[120:123], v5 offset:14336
    buffer_load_dwordx4 v[252:255], v1, s[16:19], s60 offen offset:3072 sc1
    s_waitcnt lgkmcnt(5)
    v_mfma_f32_32x32x16_bf16 v[64:79], v[96:99], v[164:167], v[64:79]
    ds_read_b128 v[124:127], v5 offset:15360
    v_mfma_f32_32x32x16_bf16 v[80:95], v[100:103], v[164:167], v[80:95]
    ds_read_b128 v[96:99], v5 offset:16384
    s_waitcnt vmcnt(21)
    s_waitcnt lgkmcnt(5)
    v_mfma_f32_32x32x16_bf16 v[16:31], v[104:107], v[168:171], v[16:31]
    ds_read_b128 v[100:103], v5 offset:17408
    s_add_u32 s60, s81, 32768
    buffer_load_dwordx4 v[128:131], v1, s[16:19], s60 offen offset:0 sc1
    v_mfma_f32_32x32x16_bf16 v[32:47], v[108:111], v[168:171], v[32:47]
    ds_read_b128 v[104:107], v5 offset:18432
    s_waitcnt lgkmcnt(5)
    v_mfma_f32_32x32x16_bf16 v[48:63], v[112:115], v[168:171], v[48:63]
    ds_read_b128 v[108:111], v5 offset:19456
    v_add_u32 v5, 61440, v6
    buffer_load_dwordx4 v[132:135], v1, s[16:19], s60 offen offset:1024 sc1
    v_mfma_f32_32x32x16_bf16 v[64:79], v[116:119], v[168:171], v[64:79]
    ds_read_b128 v[112:115], v5 offset:0
    s_waitcnt lgkmcnt(5)
    v_mfma_f32_32x32x16_bf16 v[80:95], v[120:123], v[168:171], v[80:95]
    ds_read_b128 v[116:119], v5 offset:1024
    s_waitcnt vmcnt(22)
    v_mfma_f32_32x32x16_bf16 v[16:31], v[124:127], v[172:175], v[16:31]
    ds_read_b128 v[120:123], v5 offset:2048
    buffer_load_dwordx4 v[136:139], v1, s[16:19], s60 offen offset:2048 sc1
    s_waitcnt lgkmcnt(5)
    v_mfma_f32_32x32x16_bf16 v[32:47], v[96:99], v[172:175], v[32:47]
    ds_read_b128 v[124:127], v5 offset:3072
    v_mfma_f32_32x32x16_bf16 v[48:63], v[100:103], v[172:175], v[48:63]
    ds_read_b128 v[96:99], v5 offset:4096
    buffer_load_dwordx4 v[140:143], v1, s[16:19], s60 offen offset:3072 sc1
    s_waitcnt lgkmcnt(5)
    v_mfma_f32_32x32x16_bf16 v[64:79], v[104:107], v[172:175], v[64:79]
    ds_read_b128 v[100:103], v5 offset:5120
    v_mfma_f32_32x32x16_bf16 v[80:95], v[108:111], v[172:175], v[80:95]
    ds_read_b128 v[104:107], v5 offset:6144
    s_barrier
    s_waitcnt vmcnt(23)
    s_waitcnt lgkmcnt(5)
    v_mfma_f32_32x32x16_bf16 v[16:31], v[112:115], v[176:179], v[16:31]
    ds_read_b128 v[108:111], v5 offset:7168
    s_add_u32 s60, s81, 36864
    buffer_load_dwordx4 v[144:147], v1, s[16:19], s60 offen offset:0 sc1
    v_mfma_f32_32x32x16_bf16 v[32:47], v[116:119], v[176:179], v[32:47]
    ds_read_b128 v[112:115], v5 offset:8192
    s_waitcnt lgkmcnt(5)
    v_mfma_f32_32x32x16_bf16 v[48:63], v[120:123], v[176:179], v[48:63]
    ds_read_b128 v[116:119], v5 offset:9216
    buffer_load_dwordx4 v[148:151], v1, s[16:19], s60 offen offset:1024 sc1
    v_mfma_f32_32x32x16_bf16 v[64:79], v[124:127], v[176:179], v[64:79]
    ds_read_b128 v[120:123], v5 offset:10240
    s_waitcnt lgkmcnt(5)
    v_mfma_f32_32x32x16_bf16 v[80:95], v[96:99], v[176:179], v[80:95]
    ds_read_b128 v[124:127], v5 offset:11264
    s_waitcnt vmcnt(24)
    v_mfma_f32_32x32x16_bf16 v[16:31], v[100:103], v[180:183], v[16:31]
    ds_read_b128 v[96:99], v5 offset:12288
    buffer_load_dwordx4 v[152:155], v1, s[16:19], s60 offen offset:2048 sc1
    s_waitcnt lgkmcnt(5)
    v_mfma_f32_32x32x16_bf16 v[32:47], v[104:107], v[180:183], v[32:47]
    ds_read_b128 v[100:103], v5 offset:13312
    v_mfma_f32_32x32x16_bf16 v[48:63], v[108:111], v[180:183], v[48:63]
    ds_read_b128 v[104:107], v5 offset:14336
    buffer_load_dwordx4 v[156:159], v1, s[16:19], s60 offen offset:3072 sc1
    s_waitcnt lgkmcnt(5)
    v_mfma_f32_32x32x16_bf16 v[64:79], v[112:115], v[180:183], v[64:79]
    ds_read_b128 v[108:111], v5 offset:15360
    v_mfma_f32_32x32x16_bf16 v[80:95], v[116:119], v[180:183], v[80:95]
    ds_read_b128 v[112:115], v5 offset:16384
    s_waitcnt vmcnt(25)
    s_waitcnt lgkmcnt(5)
    v_mfma_f32_32x32x16_bf16 v[16:31], v[120:123], v[184:187], v[16:31]
    ds_read_b128 v[116:119], v5 offset:17408
    s_add_u32 s60, s81, 40960
    buffer_load_dwordx4 v[160:163], v1, s[16:19], s60 offen offset:0 sc1
    v_mfma_f32_32x32x16_bf16 v[32:47], v[124:127], v[184:187], v[32:47]
    ds_read_b128 v[120:123], v5 offset:18432
    s_waitcnt lgkmcnt(5)
    v_mfma_f32_32x32x16_bf16 v[48:63], v[96:99], v[184:187], v[48:63]
    ds_read_b128 v[124:127], v5 offset:19456
    v_add_u32 v5, 81920, v6
    buffer_load_dwordx4 v[164:167], v1, s[16:19], s60 offen offset:1024 sc1
    v_mfma_f32_32x32x16_bf16 v[64:79], v[100:103], v[184:187], v[64:79]
    ds_read_b128 v[96:99], v5 offset:0
    s_waitcnt lgkmcnt(5)
    v_mfma_f32_32x32x16_bf16 v[80:95], v[104:107], v[184:187], v[80:95]
    ds_read_b128 v[100:103], v5 offset:1024
    s_waitcnt vmcnt(26)
    v_mfma_f32_32x32x16_bf16 v[16:31], v[108:111], v[188:191], v[16:31]
    ds_read_b128 v[104:107], v5 offset:2048
    buffer_load_dwordx4 v[168:171], v1, s[16:19], s60 offen offset:2048 sc1
    s_waitcnt lgkmcnt(5)
    v_mfma_f32_32x32x16_bf16 v[32:47], v[112:115], v[188:191], v[32:47]
    ds_read_b128 v[108:111], v5 offset:3072
    v_mfma_f32_32x32x16_bf16 v[48:63], v[116:119], v[188:191], v[48:63]
    ds_read_b128 v[112:115], v5 offset:4096
    buffer_load_dwordx4 v[172:175], v1, s[16:19], s60 offen offset:3072 sc1
    s_waitcnt lgkmcnt(5)
    v_mfma_f32_32x32x16_bf16 v[64:79], v[120:123], v[188:191], v[64:79]
    ds_read_b128 v[116:119], v5 offset:5120
    v_mfma_f32_32x32x16_bf16 v[80:95], v[124:127], v[188:191], v[80:95]
    ds_read_b128 v[120:123], v5 offset:6144
    s_barrier
    s_waitcnt vmcnt(27)
    s_waitcnt lgkmcnt(5)
    v_mfma_f32_32x32x16_bf16 v[16:31], v[96:99], v[192:195], v[16:31]
    ds_read_b128 v[124:127], v5 offset:7168
    s_add_u32 s60, s81, 45056
    buffer_load_dwordx4 v[176:179], v1, s[16:19], s60 offen offset:0 sc1
    v_mfma_f32_32x32x16_bf16 v[32:47], v[100:103], v[192:195], v[32:47]
    ds_read_b128 v[96:99], v5 offset:8192
    s_waitcnt lgkmcnt(5)
    v_mfma_f32_32x32x16_bf16 v[48:63], v[104:107], v[192:195], v[48:63]
    ds_read_b128 v[100:103], v5 offset:9216
    v_mfma_f32_32x32x16_bf16 v[64:79], v[108:111], v[192:195], v[64:79]
    ds_read_b128 v[104:107], v5 offset:10240
    s_waitcnt lgkmcnt(5)
    v_mfma_f32_32x32x16_bf16 v[80:95], v[112:115], v[192:195], v[80:95]
    ds_read_b128 v[108:111], v5 offset:11264
    s_waitcnt vmcnt(27)
    v_mfma_f32_32x32x16_bf16 v[16:31], v[116:119], v[196:199], v[16:31]
    ds_read_b128 v[112:115], v5 offset:12288
    buffer_load_dwordx4 v[180:183], v1, s[16:19], s60 offen offset:1024 sc1
    s_waitcnt lgkmcnt(5)
    v_mfma_f32_32x32x16_bf16 v[32:47], v[120:123], v[196:199], v[32:47]
    ds_read_b128 v[116:119], v5 offset:13312
    v_mfma_f32_32x32x16_bf16 v[48:63], v[124:127], v[196:199], v[48:63]
    ds_read_b128 v[120:123], v5 offset:14336
    s_waitcnt lgkmcnt(5)
    v_mfma_f32_32x32x16_bf16 v[64:79], v[96:99], v[196:199], v[64:79]
    ds_read_b128 v[124:127], v5 offset:15360
    v_mfma_f32_32x32x16_bf16 v[80:95], v[100:103], v[196:199], v[80:95]
    ds_read_b128 v[96:99], v5 offset:16384
    s_waitcnt vmcnt(27)
    s_waitcnt lgkmcnt(5)
    v_mfma_f32_32x32x16_bf16 v[16:31], v[104:107], v[200:203], v[16:31]
    ds_read_b128 v[100:103], v5 offset:17408
    buffer_load_dwordx4 v[184:187], v1, s[16:19], s60 offen offset:2048 sc1
    v_mfma_f32_32x32x16_bf16 v[32:47], v[108:111], v[200:203], v[32:47]
    ds_read_b128 v[104:107], v5 offset:18432
    s_waitcnt lgkmcnt(5)
    v_mfma_f32_32x32x16_bf16 v[48:63], v[112:115], v[200:203], v[48:63]
    ds_read_b128 v[108:111], v5 offset:19456
    v_add_u32 v5, 102400, v6
    v_mfma_f32_32x32x16_bf16 v[64:79], v[116:119], v[200:203], v[64:79]
    ds_read_b128 v[112:115], v5 offset:0
    s_waitcnt lgkmcnt(5)
    v_mfma_f32_32x32x16_bf16 v[80:95], v[120:123], v[200:203], v[80:95]
    ds_read_b128 v[116:119], v5 offset:1024
    s_waitcnt vmcnt(27)
    v_mfma_f32_32x32x16_bf16 v[16:31], v[124:127], v[204:207], v[16:31]
    ds_read_b128 v[120:123], v5 offset:2048
    buffer_load_dwordx4 v[188:191], v1, s[16:19], s60 offen offset:3072 sc1
    s_waitcnt lgkmcnt(5)
    v_mfma_f32_32x32x16_bf16 v[32:47], v[96:99], v[204:207], v[32:47]
    ds_read_b128 v[124:127], v5 offset:3072
    v_mfma_f32_32x32x16_bf16 v[48:63], v[100:103], v[204:207], v[48:63]
    ds_read_b128 v[96:99], v5 offset:4096
    s_waitcnt lgkmcnt(5)
    v_mfma_f32_32x32x16_bf16 v[64:79], v[104:107], v[204:207], v[64:79]
    ds_read_b128 v[100:103], v5 offset:5120
    v_mfma_f32_32x32x16_bf16 v[80:95], v[108:111], v[204:207], v[80:95]
    ds_read_b128 v[104:107], v5 offset:6144
    s_barrier
    s_waitcnt vmcnt(27)
    s_waitcnt lgkmcnt(5)
    v_mfma_f32_32x32x16_bf16 v[16:31], v[112:115], v[208:211], v[16:31]
    ds_read_b128 v[108:111], v5 offset:7168
    s_add_u32 s60, s81, 49152
    buffer_load_dwordx4 v[192:195], v1, s[16:19], s60 offen offset:0 sc1
    v_mfma_f32_32x32x16_bf16 v[32:47], v[116:119], v[208:211], v[32:47]
    ds_read_b128 v[112:115], v5 offset:8192
    s_waitcnt lgkmcnt(5)
    v_mfma_f32_32x32x16_bf16 v[48:63], v[120:123], v[208:211], v[48:63]
    ds_read_b128 v[116:119], v5 offset:9216
    v_mfma_f32_32x32x16_bf16 v[64:79], v[124:127], v[208:211], v[64:79]
    ds_read_b128 v[120:123], v5 offset:10240
    s_waitcnt lgkmcnt(5)
    v_mfma_f32_32x32x16_bf16 v[80:95], v[96:99], v[208:211], v[80:95]
    ds_read_b128 v[124:127], v5 offset:11264
    s_waitcnt vmcnt(27)
    v_mfma_f32_32x32x16_bf16 v[16:31], v[100:103], v[212:215], v[16:31]
    ds_read_b128 v[96:99], v5 offset:12288
    buffer_load_dwordx4 v[196:199], v1, s[16:19], s60 offen offset:1024 sc1
    s_waitcnt lgkmcnt(5)
    v_mfma_f32_32x32x16_bf16 v[32:47], v[104:107], v[212:215], v[32:47]
    ds_read_b128 v[100:103], v5 offset:13312
    v_mfma_f32_32x32x16_bf16 v[48:63], v[108:111], v[212:215], v[48:63]
    ds_read_b128 v[104:107], v5 offset:14336
    s_waitcnt lgkmcnt(5)
    v_mfma_f32_32x32x16_bf16 v[64:79], v[112:115], v[212:215], v[64:79]
    ds_read_b128 v[108:111], v5 offset:15360
    v_mfma_f32_32x32x16_bf16 v[80:95], v[116:119], v[212:215], v[80:95]
    ds_read_b128 v[112:115], v5 offset:16384
    s_waitcnt vmcnt(27)
    s_waitcnt lgkmcnt(5)
    v_mfma_f32_32x32x16_bf16 v[16:31], v[120:123], v[216:219], v[16:31]
    ds_read_b128 v[116:119], v5 offset:17408
    buffer_load_dwordx4 v[200:203], v1, s[16:19], s60 offen offset:2048 sc1
    v_mfma_f32_32x32x16_bf16 v[32:47], v[124:127], v[216:219], v[32:47]
    ds_read_b128 v[120:123], v5 offset:18432
    s_waitcnt lgkmcnt(5)
    v_mfma_f32_32x32x16_bf16 v[48:63], v[96:99], v[216:219], v[48:63]
    ds_read_b128 v[124:127], v5 offset:19456
    v_add_u32 v5, 122880, v6
    v_mfma_f32_32x32x16_bf16 v[64:79], v[100:103], v[216:219], v[64:79]
    ds_read_b128 v[96:99], v5 offset:0
    s_waitcnt lgkmcnt(5)
    v_mfma_f32_32x32x16_bf16 v[80:95], v[104:107], v[216:219], v[80:95]
    ds_read_b128 v[100:103], v5 offset:1024
    s_waitcnt vmcnt(27)
    v_mfma_f32_32x32x16_bf16 v[16:31], v[108:111], v[220:223], v[16:31]
    ds_read_b128 v[104:107], v5 offset:2048
    buffer_load_dwordx4 v[204:207], v1, s[16:19], s60 offen offset:3072 sc1
    s_waitcnt lgkmcnt(5)
    v_mfma_f32_32x32x16_bf16 v[32:47], v[112:115], v[220:223], v[32:47]
    ds_read_b128 v[108:111], v5 offset:3072
    v_mfma_f32_32x32x16_bf16 v[48:63], v[116:119], v[220:223], v[48:63]
    ds_read_b128 v[112:115], v5 offset:4096
    s_waitcnt lgkmcnt(5)
    v_mfma_f32_32x32x16_bf16 v[64:79], v[120:123], v[220:223], v[64:79]
    ds_read_b128 v[116:119], v5 offset:5120
    v_mfma_f32_32x32x16_bf16 v[80:95], v[124:127], v[220:223], v[80:95]
    ds_read_b128 v[120:123], v5 offset:6144
    s_barrier
    s_waitcnt vmcnt(27)
    s_waitcnt lgkmcnt(5)
    v_mfma_f32_32x32x16_bf16 v[16:31], v[96:99], v[224:227], v[16:31]
    ds_read_b128 v[124:127], v5 offset:7168
    s_add_u32 s60, s81, 53248
    buffer_load_dwordx4 v[208:211], v1, s[16:19], s60 offen offset:0 sc1
    v_mfma_f32_32x32x16_bf16 v[32:47], v[100:103], v[224:227], v[32:47]
    ds_read_b128 v[96:99], v5 offset:8192
    s_waitcnt lgkmcnt(5)
    v_mfma_f32_32x32x16_bf16 v[48:63], v[104:107], v[224:227], v[48:63]
    ds_read_b128 v[100:103], v5 offset:9216
    v_mfma_f32_32x32x16_bf16 v[64:79], v[108:111], v[224:227], v[64:79]
    ds_read_b128 v[104:107], v5 offset:10240
    s_waitcnt lgkmcnt(5)
    v_mfma_f32_32x32x16_bf16 v[80:95], v[112:115], v[224:227], v[80:95]
    ds_read_b128 v[108:111], v5 offset:11264
    s_waitcnt vmcnt(27)
    v_mfma_f32_32x32x16_bf16 v[16:31], v[116:119], v[228:231], v[16:31]
    ds_read_b128 v[112:115], v5 offset:12288
    buffer_load_dwordx4 v[212:215], v1, s[16:19], s60 offen offset:1024 sc1
    s_waitcnt lgkmcnt(5)
    v_mfma_f32_32x32x16_bf16 v[32:47], v[120:123], v[228:231], v[32:47]
    ds_read_b128 v[116:119], v5 offset:13312
    v_mfma_f32_32x32x16_bf16 v[48:63], v[124:127], v[228:231], v[48:63]
    ds_read_b128 v[120:123], v5 offset:14336
    s_waitcnt lgkmcnt(5)
    v_mfma_f32_32x32x16_bf16 v[64:79], v[96:99], v[228:231], v[64:79]
    ds_read_b128 v[124:127], v5 offset:15360
    v_mfma_f32_32x32x16_bf16 v[80:95], v[100:103], v[228:231], v[80:95]
    ds_read_b128 v[96:99], v5 offset:16384
    s_waitcnt vmcnt(27)
    s_waitcnt lgkmcnt(5)
    v_mfma_f32_32x32x16_bf16 v[16:31], v[104:107], v[232:235], v[16:31]
    ds_read_b128 v[100:103], v5 offset:17408
    buffer_load_dwordx4 v[216:219], v1, s[16:19], s60 offen offset:2048 sc1
    v_mfma_f32_32x32x16_bf16 v[32:47], v[108:111], v[232:235], v[32:47]
    ds_read_b128 v[104:107], v5 offset:18432
    s_waitcnt lgkmcnt(5)
    v_mfma_f32_32x32x16_bf16 v[48:63], v[112:115], v[232:235], v[48:63]
    ds_read_b128 v[108:111], v5 offset:19456
    v_add_u32 v5, 0, v6
    v_mfma_f32_32x32x16_bf16 v[64:79], v[116:119], v[232:235], v[64:79]
    ds_read_b128 v[112:115], v5 offset:0
    s_waitcnt lgkmcnt(5)
    v_mfma_f32_32x32x16_bf16 v[80:95], v[120:123], v[232:235], v[80:95]
    ds_read_b128 v[116:119], v5 offset:1024
    s_waitcnt vmcnt(27)
    v_mfma_f32_32x32x16_bf16 v[16:31], v[124:127], v[236:239], v[16:31]
    ds_read_b128 v[120:123], v5 offset:2048
    buffer_load_dwordx4 v[220:223], v1, s[16:19], s60 offen offset:3072 sc1
    s_waitcnt lgkmcnt(5)
    v_mfma_f32_32x32x16_bf16 v[32:47], v[96:99], v[236:239], v[32:47]
    ds_read_b128 v[124:127], v5 offset:3072
    v_mfma_f32_32x32x16_bf16 v[48:63], v[100:103], v[236:239], v[48:63]
    ds_read_b128 v[96:99], v5 offset:4096
    s_waitcnt lgkmcnt(5)
    v_mfma_f32_32x32x16_bf16 v[64:79], v[104:107], v[236:239], v[64:79]
    ds_read_b128 v[100:103], v5 offset:5120
    v_mfma_f32_32x32x16_bf16 v[80:95], v[108:111], v[236:239], v[80:95]
    ds_read_b128 v[104:107], v5 offset:6144
    s_barrier
    s_waitcnt vmcnt(27)
    s_waitcnt lgkmcnt(5)
    v_mfma_f32_32x32x16_bf16 v[16:31], v[112:115], v[240:243], v[16:31]
    ds_read_b128 v[108:111], v5 offset:7168
    s_add_u32 s60, s81, 57344
    buffer_load_dwordx4 v[224:227], v1, s[16:19], s60 offen offset:0 sc1
    v_mfma_f32_32x32x16_bf16 v[32:47], v[116:119], v[240:243], v[32:47]
    ds_read_b128 v[112:115], v5 offset:8192
    s_waitcnt lgkmcnt(5)
    v_mfma_f32_32x32x16_bf16 v[48:63], v[120:123], v[240:243], v[48:63]
    ds_read_b128 v[116:119], v5 offset:9216
    v_mfma_f32_32x32x16_bf16 v[64:79], v[124:127], v[240:243], v[64:79]
    ds_read_b128 v[120:123], v5 offset:10240
    s_waitcnt lgkmcnt(5)
    v_mfma_f32_32x32x16_bf16 v[80:95], v[96:99], v[240:243], v[80:95]
    ds_read_b128 v[124:127], v5 offset:11264
    s_waitcnt vmcnt(27)
    v_mfma_f32_32x32x16_bf16 v[16:31], v[100:103], v[244:247], v[16:31]
    ds_read_b128 v[96:99], v5 offset:12288
    buffer_load_dwordx4 v[228:231], v1, s[16:19], s60 offen offset:1024 sc1
    s_waitcnt lgkmcnt(5)
    v_mfma_f32_32x32x16_bf16 v[32:47], v[104:107], v[244:247], v[32:47]
    ds_read_b128 v[100:103], v5 offset:13312
    v_mfma_f32_32x32x16_bf16 v[48:63], v[108:111], v[244:247], v[48:63]
    ds_read_b128 v[104:107], v5 offset:14336
    s_waitcnt lgkmcnt(5)
    v_mfma_f32_32x32x16_bf16 v[64:79], v[112:115], v[244:247], v[64:79]
    ds_read_b128 v[108:111], v5 offset:15360
    v_mfma_f32_32x32x16_bf16 v[80:95], v[116:119], v[244:247], v[80:95]
    ds_read_b128 v[112:115], v5 offset:16384
    s_waitcnt vmcnt(27)
    s_waitcnt lgkmcnt(5)
    v_mfma_f32_32x32x16_bf16 v[16:31], v[120:123], v[248:251], v[16:31]
    ds_read_b128 v[116:119], v5 offset:17408
    buffer_load_dwordx4 v[232:235], v1, s[16:19], s60 offen offset:2048 sc1
    v_mfma_f32_32x32x16_bf16 v[32:47], v[124:127], v[248:251], v[32:47]
    ds_read_b128 v[120:123], v5 offset:18432
    s_waitcnt lgkmcnt(5)
    v_mfma_f32_32x32x16_bf16 v[48:63], v[96:99], v[248:251], v[48:63]
    ds_read_b128 v[124:127], v5 offset:19456
    v_add_u32 v5, 20480, v6
    v_mfma_f32_32x32x16_bf16 v[64:79], v[100:103], v[248:251], v[64:79]
    ds_read_b128 v[96:99], v5 offset:0
    s_waitcnt lgkmcnt(5)
    v_mfma_f32_32x32x16_bf16 v[80:95], v[104:107], v[248:251], v[80:95]
    ds_read_b128 v[100:103], v5 offset:1024
    s_waitcnt vmcnt(27)
    v_mfma_f32_32x32x16_bf16 v[16:31], v[108:111], v[252:255], v[16:31]
    ds_read_b128 v[104:107], v5 offset:2048
    buffer_load_dwordx4 v[236:239], v1, s[16:19], s60 offen offset:3072 sc1
    s_waitcnt lgkmcnt(5)
    v_mfma_f32_32x32x16_bf16 v[32:47], v[112:115], v[252:255], v[32:47]
    ds_read_b128 v[108:111], v5 offset:3072
    v_mfma_f32_32x32x16_bf16 v[48:63], v[116:119], v[252:255], v[48:63]
    ds_read_b128 v[112:115], v5 offset:4096
    s_waitcnt lgkmcnt(5)
    v_mfma_f32_32x32x16_bf16 v[64:79], v[120:123], v[252:255], v[64:79]
    ds_read_b128 v[116:119], v5 offset:5120
    v_mfma_f32_32x32x16_bf16 v[80:95], v[124:127], v[252:255], v[80:95]
    ds_read_b128 v[120:123], v5 offset:6144
    s_barrier
    s_waitcnt vmcnt(27)
    s_waitcnt lgkmcnt(5)
    v_mfma_f32_32x32x16_bf16 v[16:31], v[96:99], v[128:131], v[16:31]
    ds_read_b128 v[124:127], v5 offset:7168
    s_add_u32 s60, s81, 61440
    buffer_load_dwordx4 v[240:243], v1, s[16:19], s60 offen offset:0 sc1
    v_mfma_f32_32x32x16_bf16 v[32:47], v[100:103], v[128:131], v[32:47]
    ds_read_b128 v[96:99], v5 offset:8192
    s_waitcnt lgkmcnt(5)
    v_mfma_f32_32x32x16_bf16 v[48:63], v[104:107], v[128:131], v[48:63]
    ds_read_b128 v[100:103], v5 offset:9216
    v_mfma_f32_32x32x16_bf16 v[64:79], v[108:111], v[128:131], v[64:79]
    ds_read_b128 v[104:107], v5 offset:10240
    s_waitcnt lgkmcnt(5)
    v_mfma_f32_32x32x16_bf16 v[80:95], v[112:115], v[128:131], v[80:95]
    ds_read_b128 v[108:111], v5 offset:11264
    s_waitcnt vmcnt(27)
    v_mfma_f32_32x32x16_bf16 v[16:31], v[116:119], v[132:135], v[16:31]
    ds_read_b128 v[112:115], v5 offset:12288
    buffer_load_dwordx4 v[244:247], v1, s[16:19], s60 offen offset:1024 sc1
    s_waitcnt lgkmcnt(5)
    v_mfma_f32_32x32x16_bf16 v[32:47], v[120:123], v[132:135], v[32:47]
    ds_read_b128 v[116:119], v5 offset:13312
    v_mfma_f32_32x32x16_bf16 v[48:63], v[124:127], v[132:135], v[48:63]
    ds_read_b128 v[120:123], v5 offset:14336
    s_waitcnt lgkmcnt(5)
    v_mfma_f32_32x32x16_bf16 v[64:79], v[96:99], v[132:135], v[64:79]
    ds_read_b128 v[124:127], v5 offset:15360
    v_mfma_f32_32x32x16_bf16 v[80:95], v[100:103], v[132:135], v[80:95]
    ds_read_b128 v[96:99], v5 offset:16384
    s_waitcnt vmcnt(27)
    s_waitcnt lgkmcnt(5)
    v_mfma_f32_32x32x16_bf16 v[16:31], v[104:107], v[136:139], v[16:31]
    ds_read_b128 v[100:103], v5 offset:17408
    buffer_load_dwordx4 v[248:251], v1, s[16:19], s60 offen offset:2048 sc1
    v_mfma_f32_32x32x16_bf16 v[32:47], v[108:111], v[136:139], v[32:47]
    ds_read_b128 v[104:107], v5 offset:18432
    s_waitcnt lgkmcnt(5)
    v_mfma_f32_32x32x16_bf16 v[48:63], v[112:115], v[136:139], v[48:63]
    ds_read_b128 v[108:111], v5 offset:19456
    v_add_u32 v5, 40960, v6
    v_mfma_f32_32x32x16_bf16 v[64:79], v[116:119], v[136:139], v[64:79]
    ds_read_b128 v[112:115], v5 offset:0
    s_waitcnt lgkmcnt(5)
    v_mfma_f32_32x32x16_bf16 v[80:95], v[120:123], v[136:139], v[80:95]
    ds_read_b128 v[116:119], v5 offset:1024
    s_waitcnt vmcnt(27)
    v_mfma_f32_32x32x16_bf16 v[16:31], v[124:127], v[140:143], v[16:31]
    ds_read_b128 v[120:123], v5 offset:2048
    buffer_load_dwordx4 v[252:255], v1, s[16:19], s60 offen offset:3072 sc1
    s_waitcnt lgkmcnt(5)
    v_mfma_f32_32x32x16_bf16 v[32:47], v[96:99], v[140:143], v[32:47]
    ds_read_b128 v[124:127], v5 offset:3072
    v_mfma_f32_32x32x16_bf16 v[48:63], v[100:103], v[140:143], v[48:63]
    ds_read_b128 v[96:99], v5 offset:4096
    s_waitcnt lgkmcnt(5)
    v_mfma_f32_32x32x16_bf16 v[64:79], v[104:107], v[140:143], v[64:79]
    ds_read_b128 v[100:103], v5 offset:5120
    v_mfma_f32_32x32x16_bf16 v[80:95], v[108:111], v[140:143], v[80:95]
    ds_read_b128 v[104:107], v5 offset:6144
    s_barrier
    s_waitcnt vmcnt(27)
    s_waitcnt lgkmcnt(5)
    v_mfma_f32_32x32x16_bf16 v[16:31], v[112:115], v[144:147], v[16:31]
    ds_read_b128 v[108:111], v5 offset:7168
    v_mfma_f32_32x32x16_bf16 v[32:47], v[116:119], v[144:147], v[32:47]
    ds_read_b128 v[112:115], v5 offset:8192
    s_waitcnt lgkmcnt(5)
    v_mfma_f32_32x32x16_bf16 v[48:63], v[120:123], v[144:147], v[48:63]
    ds_read_b128 v[116:119], v5 offset:9216
    v_mfma_f32_32x32x16_bf16 v[64:79], v[124:127], v[144:147], v[64:79]
    ds_read_b128 v[120:123], v5 offset:10240
    s_waitcnt lgkmcnt(5)
    v_mfma_f32_32x32x16_bf16 v[80:95], v[96:99], v[144:147], v[80:95]
    ds_read_b128 v[124:127], v5 offset:11264
    s_waitcnt vmcnt(26)
    v_mfma_f32_32x32x16_bf16 v[16:31], v[100:103], v[148:151], v[16:31]
    ds_read_b128 v[96:99], v5 offset:12288
    s_waitcnt lgkmcnt(5)
    v_mfma_f32_32x32x16_bf16 v[32:47], v[104:107], v[148:151], v[32:47]
    ds_read_b128 v[100:103], v5 offset:13312
    v_mfma_f32_32x32x16_bf16 v[48:63], v[108:111], v[148:151], v[48:63]
    ds_read_b128 v[104:107], v5 offset:14336
    s_waitcnt lgkmcnt(5)
    v_mfma_f32_32x32x16_bf16 v[64:79], v[112:115], v[148:151], v[64:79]
    ds_read_b128 v[108:111], v5 offset:15360
    v_mfma_f32_32x32x16_bf16 v[80:95], v[116:119], v[148:151], v[80:95]
    ds_read_b128 v[112:115], v5 offset:16384
    s_waitcnt vmcnt(25)
    s_waitcnt lgkmcnt(5)
    v_mfma_f32_32x32x16_bf16 v[16:31], v[120:123], v[152:155], v[16:31]
    ds_read_b128 v[116:119], v5 offset:17408
    v_mfma_f32_32x32x16_bf16 v[32:47], v[124:127], v[152:155], v[32:47]
    ds_read_b128 v[120:123], v5 offset:18432
    s_waitcnt lgkmcnt(5)
    v_mfma_f32_32x32x16_bf16 v[48:63], v[96:99], v[152:155], v[48:63]
    ds_read_b128 v[124:127], v5 offset:19456
    v_add_u32 v5, 61440, v6
    v_mfma_f32_32x32x16_bf16 v[64:79], v[100:103], v[152:155], v[64:79]
    ds_read_b128 v[96:99], v5 offset:0
    s_waitcnt lgkmcnt(5)
    v_mfma_f32_32x32x16_bf16 v[80:95], v[104:107], v[152:155], v[80:95]
    ds_read_b128 v[100:103], v5 offset:1024
    s_waitcnt vmcnt(24)
    v_mfma_f32_32x32x16_bf16 v[16:31], v[108:111], v[156:159], v[16:31]
    ds_read_b128 v[104:107], v5 offset:2048
    s_waitcnt lgkmcnt(5)
    v_mfma_f32_32x32x16_bf16 v[32:47], v[112:115], v[156:159], v[32:47]
    ds_read_b128 v[108:111], v5 offset:3072
    v_mfma_f32_32x32x16_bf16 v[48:63], v[116:119], v[156:159], v[48:63]
    ds_read_b128 v[112:115], v5 offset:4096
    s_waitcnt lgkmcnt(5)
    v_mfma_f32_32x32x16_bf16 v[64:79], v[120:123], v[156:159], v[64:79]
    ds_read_b128 v[116:119], v5 offset:5120
    v_mfma_f32_32x32x16_bf16 v[80:95], v[124:127], v[156:159], v[80:95]
    ds_read_b128 v[120:123], v5 offset:6144
    s_barrier
    s_waitcnt vmcnt(23)
    s_waitcnt lgkmcnt(5)
    v_mfma_f32_32x32x16_bf16 v[16:31], v[96:99], v[160:163], v[16:31]
    ds_read_b128 v[124:127], v5 offset:7168
    v_mfma_f32_32x32x16_bf16 v[32:47], v[100:103], v[160:163], v[32:47]
    ds_read_b128 v[96:99], v5 offset:8192
    s_waitcnt lgkmcnt(5)
    v_mfma_f32_32x32x16_bf16 v[48:63], v[104:107], v[160:163], v[48:63]
    ds_read_b128 v[100:103], v5 offset:9216
    v_mfma_f32_32x32x16_bf16 v[64:79], v[108:111], v[160:163], v[64:79]
    ds_read_b128 v[104:107], v5 offset:10240
    s_waitcnt lgkmcnt(5)
    v_mfma_f32_32x32x16_bf16 v[80:95], v[112:115], v[160:163], v[80:95]
    ds_read_b128 v[108:111], v5 offset:11264
    s_waitcnt vmcnt(22)
    v_mfma_f32_32x32x16_bf16 v[16:31], v[116:119], v[164:167], v[16:31]
    ds_read_b128 v[112:115], v5 offset:12288
    s_waitcnt lgkmcnt(5)
    v_mfma_f32_32x32x16_bf16 v[32:47], v[120:123], v[164:167], v[32:47]
    ds_read_b128 v[116:119], v5 offset:13312
    v_mfma_f32_32x32x16_bf16 v[48:63], v[124:127], v[164:167], v[48:63]
    ds_read_b128 v[120:123], v5 offset:14336
    s_waitcnt lgkmcnt(5)
    v_mfma_f32_32x32x16_bf16 v[64:79], v[96:99], v[164:167], v[64:79]
    ds_read_b128 v[124:127], v5 offset:15360
    v_mfma_f32_32x32x16_bf16 v[80:95], v[100:103], v[164:167], v[80:95]
    ds_read_b128 v[96:99], v5 offset:16384
    s_waitcnt vmcnt(21)
    s_waitcnt lgkmcnt(5)
    v_mfma_f32_32x32x16_bf16 v[16:31], v[104:107], v[168:171], v[16:31]
    ds_read_b128 v[100:103], v5 offset:17408
    v_mfma_f32_32x32x16_bf16 v[32:47], v[108:111], v[168:171], v[32:47]
    ds_read_b128 v[104:107], v5 offset:18432
    s_waitcnt lgkmcnt(5)
    v_mfma_f32_32x32x16_bf16 v[48:63], v[112:115], v[168:171], v[48:63]
    ds_read_b128 v[108:111], v5 offset:19456
    v_add_u32 v5, 81920, v6
    v_mfma_f32_32x32x16_bf16 v[64:79], v[116:119], v[168:171], v[64:79]
    ds_read_b128 v[112:115], v5 offset:0
    s_waitcnt lgkmcnt(5)
    v_mfma_f32_32x32x16_bf16 v[80:95], v[120:123], v[168:171], v[80:95]
    ds_read_b128 v[116:119], v5 offset:1024
    s_waitcnt vmcnt(20)
    v_mfma_f32_32x32x16_bf16 v[16:31], v[124:127], v[172:175], v[16:31]
    ds_read_b128 v[120:123], v5 offset:2048
    s_waitcnt lgkmcnt(5)
    v_mfma_f32_32x32x16_bf16 v[32:47], v[96:99], v[172:175], v[32:47]
    ds_read_b128 v[124:127], v5 offset:3072
    v_mfma_f32_32x32x16_bf16 v[48:63], v[100:103], v[172:175], v[48:63]
    ds_read_b128 v[96:99], v5 offset:4096
    s_waitcnt lgkmcnt(5)
    v_mfma_f32_32x32x16_bf16 v[64:79], v[104:107], v[172:175], v[64:79]
    ds_read_b128 v[100:103], v5 offset:5120
    v_mfma_f32_32x32x16_bf16 v[80:95], v[108:111], v[172:175], v[80:95]
    ds_read_b128 v[104:107], v5 offset:6144
    s_barrier
    s_waitcnt vmcnt(19)
    s_waitcnt lgkmcnt(5)
    v_mfma_f32_32x32x16_bf16 v[16:31], v[112:115], v[176:179], v[16:31]
    ds_read_b128 v[108:111], v5 offset:7168
    v_mfma_f32_32x32x16_bf16 v[32:47], v[116:119], v[176:179], v[32:47]
    ds_read_b128 v[112:115], v5 offset:8192
    s_waitcnt lgkmcnt(5)
    v_mfma_f32_32x32x16_bf16 v[48:63], v[120:123], v[176:179], v[48:63]
    ds_read_b128 v[116:119], v5 offset:9216
    v_mfma_f32_32x32x16_bf16 v[64:79], v[124:127], v[176:179], v[64:79]
    ds_read_b128 v[120:123], v5 offset:10240
    s_waitcnt lgkmcnt(5)
    v_mfma_f32_32x32x16_bf16 v[80:95], v[96:99], v[176:179], v[80:95]
    ds_read_b128 v[124:127], v5 offset:11264
    s_waitcnt vmcnt(18)
    v_mfma_f32_32x32x16_bf16 v[16:31], v[100:103], v[180:183], v[16:31]
    ds_read_b128 v[96:99], v5 offset:12288
    s_waitcnt lgkmcnt(5)
    v_mfma_f32_32x32x16_bf16 v[32:47], v[104:107], v[180:183], v[32:47]
    ds_read_b128 v[100:103], v5 offset:13312
    v_mfma_f32_32x32x16_bf16 v[48:63], v[108:111], v[180:183], v[48:63]
    ds_read_b128 v[104:107], v5 offset:14336
    s_waitcnt lgkmcnt(5)
    v_mfma_f32_32x32x16_bf16 v[64:79], v[112:115], v[180:183], v[64:79]
    ds_read_b128 v[108:111], v5 offset:15360
    v_mfma_f32_32x32x16_bf16 v[80:95], v[116:119], v[180:183], v[80:95]
    ds_read_b128 v[112:115], v5 offset:16384
    s_waitcnt vmcnt(17)
    s_waitcnt lgkmcnt(5)
    v_mfma_f32_32x32x16_bf16 v[16:31], v[120:123], v[184:187], v[16:31]
    ds_read_b128 v[116:119], v5 offset:17408
    v_mfma_f32_32x32x16_bf16 v[32:47], v[124:127], v[184:187], v[32:47]
    ds_read_b128 v[120:123], v5 offset:18432
    s_waitcnt lgkmcnt(5)
    v_mfma_f32_32x32x16_bf16 v[48:63], v[96:99], v[184:187], v[48:63]
    ds_read_b128 v[124:127], v5 offset:19456
    v_add_u32 v5, 102400, v6
    v_mfma_f32_32x32x16_bf16 v[64:79], v[100:103], v[184:187], v[64:79]
    ds_read_b128 v[96:99], v5 offset:0
    s_waitcnt lgkmcnt(5)
    v_mfma_f32_32x32x16_bf16 v[80:95], v[104:107], v[184:187], v[80:95]
    ds_read_b128 v[100:103], v5 offset:1024
    s_waitcnt vmcnt(16)
    v_mfma_f32_32x32x16_bf16 v[16:31], v[108:111], v[188:191], v[16:31]
    ds_read_b128 v[104:107], v5 offset:2048
    s_waitcnt lgkmcnt(5)
    v_mfma_f32_32x32x16_bf16 v[32:47], v[112:115], v[188:191], v[32:47]
    ds_read_b128 v[108:111], v5 offset:3072
    v_mfma_f32_32x32x16_bf16 v[48:63], v[116:119], v[188:191], v[48:63]
    ds_read_b128 v[112:115], v5 offset:4096
    s_waitcnt lgkmcnt(5)
    v_mfma_f32_32x32x16_bf16 v[64:79], v[120:123], v[188:191], v[64:79]
    ds_read_b128 v[116:119], v5 offset:5120
    v_mfma_f32_32x32x16_bf16 v[80:95], v[124:127], v[188:191], v[80:95]
    ds_read_b128 v[120:123], v5 offset:6144
    s_barrier
    s_waitcnt vmcnt(15)
    s_waitcnt lgkmcnt(5)
    v_mfma_f32_32x32x16_bf16 v[16:31], v[96:99], v[192:195], v[16:31]
    ds_read_b128 v[124:127], v5 offset:7168
    v_mfma_f32_32x32x16_bf16 v[32:47], v[100:103], v[192:195], v[32:47]
    ds_read_b128 v[96:99], v5 offset:8192
    s_waitcnt lgkmcnt(5)
    v_mfma_f32_32x32x16_bf16 v[48:63], v[104:107], v[192:195], v[48:63]
    ds_read_b128 v[100:103], v5 offset:9216
    v_mfma_f32_32x32x16_bf16 v[64:79], v[108:111], v[192:195], v[64:79]
    ds_read_b128 v[104:107], v5 offset:10240
    s_waitcnt lgkmcnt(5)
    v_mfma_f32_32x32x16_bf16 v[80:95], v[112:115], v[192:195], v[80:95]
    ds_read_b128 v[108:111], v5 offset:11264
    s_waitcnt vmcnt(14)
    v_mfma_f32_32x32x16_bf16 v[16:31], v[116:119], v[196:199], v[16:31]
    ds_read_b128 v[112:115], v5 offset:12288
    s_waitcnt lgkmcnt(5)
    v_mfma_f32_32x32x16_bf16 v[32:47], v[120:123], v[196:199], v[32:47]
    ds_read_b128 v[116:119], v5 offset:13312
    v_mfma_f32_32x32x16_bf16 v[48:63], v[124:127], v[196:199], v[48:63]
    ds_read_b128 v[120:123], v5 offset:14336
    s_waitcnt lgkmcnt(5)
    v_mfma_f32_32x32x16_bf16 v[64:79], v[96:99], v[196:199], v[64:79]
    ds_read_b128 v[124:127], v5 offset:15360
    v_mfma_f32_32x32x16_bf16 v[80:95], v[100:103], v[196:199], v[80:95]
    ds_read_b128 v[96:99], v5 offset:16384
    s_waitcnt vmcnt(13)
    s_waitcnt lgkmcnt(5)
    v_mfma_f32_32x32x16_bf16 v[16:31], v[104:107], v[200:203], v[16:31]
    ds_read_b128 v[100:103], v5 offset:17408
    v_mfma_f32_32x32x16_bf16 v[32:47], v[108:111], v[200:203], v[32:47]
    ds_read_b128 v[104:107], v5 offset:18432
    s_waitcnt lgkmcnt(5)
    v_mfma_f32_32x32x16_bf16 v[48:63], v[112:115], v[200:203], v[48:63]
    ds_read_b128 v[108:111], v5 offset:19456
    v_add_u32 v5, 122880, v6
    v_mfma_f32_32x32x16_bf16 v[64:79], v[116:119], v[200:203], v[64:79]
    ds_read_b128 v[112:115], v5 offset:0
    s_waitcnt lgkmcnt(5)
    v_mfma_f32_32x32x16_bf16 v[80:95], v[120:123], v[200:203], v[80:95]
    ds_read_b128 v[116:119], v5 offset:1024
    s_waitcnt vmcnt(12)
    v_mfma_f32_32x32x16_bf16 v[16:31], v[124:127], v[204:207], v[16:31]
    ds_read_b128 v[120:123], v5 offset:2048
    s_waitcnt lgkmcnt(5)
    v_mfma_f32_32x32x16_bf16 v[32:47], v[96:99], v[204:207], v[32:47]
    ds_read_b128 v[124:127], v5 offset:3072
    v_mfma_f32_32x32x16_bf16 v[48:63], v[100:103], v[204:207], v[48:63]
    ds_read_b128 v[96:99], v5 offset:4096
    s_waitcnt lgkmcnt(5)
    v_mfma_f32_32x32x16_bf16 v[64:79], v[104:107], v[204:207], v[64:79]
    ds_read_b128 v[100:103], v5 offset:5120
    v_mfma_f32_32x32x16_bf16 v[80:95], v[108:111], v[204:207], v[80:95]
    ds_read_b128 v[104:107], v5 offset:6144
    s_barrier
    s_waitcnt vmcnt(11)
    s_waitcnt lgkmcnt(5)
    v_mfma_f32_32x32x16_bf16 v[16:31], v[112:115], v[208:211], v[16:31]
    ds_read_b128 v[108:111], v5 offset:7168
    v_mfma_f32_32x32x16_bf16 v[32:47], v[116:119], v[208:211], v[32:47]
    ds_read_b128 v[112:115], v5 offset:8192
    s_waitcnt lgkmcnt(5)
    v_mfma_f32_32x32x16_bf16 v[48:63], v[120:123], v[208:211], v[48:63]
    ds_read_b128 v[116:119], v5 offset:9216
    v_mfma_f32_32x32x16_bf16 v[64:79], v[124:127], v[208:211], v[64:79]
    ds_read_b128 v[120:123], v5 offset:10240
    s_waitcnt lgkmcnt(5)
    v_mfma_f32_32x32x16_bf16 v[80:95], v[96:99], v[208:211], v[80:95]
    ds_read_b128 v[124:127], v5 offset:11264
    s_waitcnt vmcnt(10)
    v_mfma_f32_32x32x16_bf16 v[16:31], v[100:103], v[212:215], v[16:31]
    ds_read_b128 v[96:99], v5 offset:12288
    s_waitcnt lgkmcnt(5)
    v_mfma_f32_32x32x16_bf16 v[32:47], v[104:107], v[212:215], v[32:47]
    ds_read_b128 v[100:103], v5 offset:13312
    v_mfma_f32_32x32x16_bf16 v[48:63], v[108:111], v[212:215], v[48:63]
    ds_read_b128 v[104:107], v5 offset:14336
    s_waitcnt lgkmcnt(5)
    v_mfma_f32_32x32x16_bf16 v[64:79], v[112:115], v[212:215], v[64:79]
    ds_read_b128 v[108:111], v5 offset:15360
    v_mfma_f32_32x32x16_bf16 v[80:95], v[116:119], v[212:215], v[80:95]
    ds_read_b128 v[112:115], v5 offset:16384
    s_waitcnt vmcnt(9)
    s_waitcnt lgkmcnt(5)
    v_mfma_f32_32x32x16_bf16 v[16:31], v[120:123], v[216:219], v[16:31]
    ds_read_b128 v[116:119], v5 offset:17408
    v_mfma_f32_32x32x16_bf16 v[32:47], v[124:127], v[216:219], v[32:47]
    ds_read_b128 v[120:123], v5 offset:18432
    s_waitcnt lgkmcnt(5)
    v_mfma_f32_32x32x16_bf16 v[48:63], v[96:99], v[216:219], v[48:63]
    ds_read_b128 v[124:127], v5 offset:19456
    v_add_u32 v5, 0, v6
    v_mfma_f32_32x32x16_bf16 v[64:79], v[100:103], v[216:219], v[64:79]
    ds_read_b128 v[96:99], v5 offset:0
    s_waitcnt lgkmcnt(5)
    v_mfma_f32_32x32x16_bf16 v[80:95], v[104:107], v[216:219], v[80:95]
    ds_read_b128 v[100:103], v5 offset:1024
    s_waitcnt vmcnt(8)
    v_mfma_f32_32x32x16_bf16 v[16:31], v[108:111], v[220:223], v[16:31]
    ds_read_b128 v[104:107], v5 offset:2048
    s_waitcnt lgkmcnt(5)
    v_mfma_f32_32x32x16_bf16 v[32:47], v[112:115], v[220:223], v[32:47]
    ds_read_b128 v[108:111], v5 offset:3072
    v_mfma_f32_32x32x16_bf16 v[48:63], v[116:119], v[220:223], v[48:63]
    ds_read_b128 v[112:115], v5 offset:4096
    s_waitcnt lgkmcnt(5)
    v_mfma_f32_32x32x16_bf16 v[64:79], v[120:123], v[220:223], v[64:79]
    ds_read_b128 v[116:119], v5 offset:5120
    v_mfma_f32_32x32x16_bf16 v[80:95], v[124:127], v[220:223], v[80:95]
    ds_read_b128 v[120:123], v5 offset:6144
    s_barrier
    s_waitcnt vmcnt(7)
    s_waitcnt lgkmcnt(5)
    v_mfma_f32_32x32x16_bf16 v[16:31], v[96:99], v[224:227], v[16:31]
    ds_read_b128 v[124:127], v5 offset:7168
    v_mfma_f32_32x32x16_bf16 v[32:47], v[100:103], v[224:227], v[32:47]
    ds_read_b128 v[96:99], v5 offset:8192
    s_waitcnt lgkmcnt(5)
    v_mfma_f32_32x32x16_bf16 v[48:63], v[104:107], v[224:227], v[48:63]
    ds_read_b128 v[100:103], v5 offset:9216
    v_mfma_f32_32x32x16_bf16 v[64:79], v[108:111], v[224:227], v[64:79]
    ds_read_b128 v[104:107], v5 offset:10240
    s_waitcnt lgkmcnt(5)
    v_mfma_f32_32x32x16_bf16 v[80:95], v[112:115], v[224:227], v[80:95]
    ds_read_b128 v[108:111], v5 offset:11264
    s_waitcnt vmcnt(6)
    v_mfma_f32_32x32x16_bf16 v[16:31], v[116:119], v[228:231], v[16:31]
    ds_read_b128 v[112:115], v5 offset:12288
    s_waitcnt lgkmcnt(5)
    v_mfma_f32_32x32x16_bf16 v[32:47], v[120:123], v[228:231], v[32:47]
    ds_read_b128 v[116:119], v5 offset:13312
    v_mfma_f32_32x32x16_bf16 v[48:63], v[124:127], v[228:231], v[48:63]
    ds_read_b128 v[120:123], v5 offset:14336
    s_waitcnt lgkmcnt(5)
    v_mfma_f32_32x32x16_bf16 v[64:79], v[96:99], v[228:231], v[64:79]
    ds_read_b128 v[124:127], v5 offset:15360
    v_mfma_f32_32x32x16_bf16 v[80:95], v[100:103], v[228:231], v[80:95]
    ds_read_b128 v[96:99], v5 offset:16384
    s_waitcnt vmcnt(5)
    s_waitcnt lgkmcnt(5)
    v_mfma_f32_32x32x16_bf16 v[16:31], v[104:107], v[232:235], v[16:31]
    ds_read_b128 v[100:103], v5 offset:17408
    v_mfma_f32_32x32x16_bf16 v[32:47], v[108:111], v[232:235], v[32:47]
    ds_read_b128 v[104:107], v5 offset:18432
    s_waitcnt lgkmcnt(5)
    v_mfma_f32_32x32x16_bf16 v[48:63], v[112:115], v[232:235], v[48:63]
    ds_read_b128 v[108:111], v5 offset:19456
    v_add_u32 v5, 20480, v6
    v_mfma_f32_32x32x16_bf16 v[64:79], v[116:119], v[232:235], v[64:79]
    ds_read_b128 v[112:115], v5 offset:0
    s_waitcnt lgkmcnt(5)
    v_mfma_f32_32x32x16_bf16 v[80:95], v[120:123], v[232:235], v[80:95]
    ds_read_b128 v[116:119], v5 offset:5120
    s_waitcnt vmcnt(4)
    v_mfma_f32_32x32x16_bf16 v[16:31], v[124:127], v[236:239], v[16:31]
    ds_read_b128 v[120:123], v5 offset:10240
    s_waitcnt lgkmcnt(5)
    v_mfma_f32_32x32x16_bf16 v[32:47], v[96:99], v[236:239], v[32:47]
    ds_read_b128 v[124:127], v5 offset:15360
    v_mfma_f32_32x32x16_bf16 v[48:63], v[100:103], v[236:239], v[48:63]
    ds_read_b128 v[96:99], v5 offset:1024
    s_waitcnt lgkmcnt(5)
    v_mfma_f32_32x32x16_bf16 v[64:79], v[104:107], v[236:239], v[64:79]
    ds_read_b128 v[100:103], v5 offset:6144
    v_mfma_f32_32x32x16_bf16 v[80:95], v[108:111], v[236:239], v[80:95]
    ds_read_b128 v[104:107], v5 offset:11264
    s_barrier
    s_waitcnt vmcnt(3)
    s_waitcnt lgkmcnt(5)
    v_mfma_f32_32x32x16_bf16 v[16:31], v[112:115], v[240:243], v[16:31]
    ds_read_b128 v[108:111], v5 offset:16384
    s_waitcnt vmcnt(2)
    v_mfma_f32_32x32x16_bf16 v[16:31], v[116:119], v[244:247], v[16:31]
    ds_read_b128 v[112:115], v5 offset:2048
    s_waitcnt vmcnt(1)
    s_waitcnt lgkmcnt(5)
    v_mfma_f32_32x32x16_bf16 v[16:31], v[120:123], v[248:251], v[16:31]
    ds_read_b128 v[116:119], v5 offset:7168
    s_waitcnt vmcnt(0)
    v_mfma_f32_32x32x16_bf16 v[16:31], v[124:127], v[252:255], v[16:31]
    ds_read_b128 v[120:123], v5 offset:12288
    s_waitcnt lgkmcnt(5)
    v_mfma_f32_32x32x16_bf16 v[32:47], v[96:99], v[240:243], v[32:47]
    ds_read_b128 v[124:127], v5 offset:17408
    v_mfma_f32_32x32x16_bf16 v[32:47], v[100:103], v[244:247], v[32:47]
    ds_read_b128 v[96:99], v5 offset:3072
    s_waitcnt lgkmcnt(5)
    v_mfma_f32_32x32x16_bf16 v[32:47], v[104:107], v[248:251], v[32:47]
    ds_read_b128 v[100:103], v5 offset:8192
    v_mfma_f32_32x32x16_bf16 v[32:47], v[108:111], v[252:255], v[32:47]
    ds_read_b128 v[104:107], v5 offset:13312
    s_waitcnt lgkmcnt(5)
    v_mfma_f32_32x32x16_bf16 v[48:63], v[112:115], v[240:243], v[48:63]
    ds_read_b128 v[108:111], v5 offset:18432
    s_nop 1
    v_cvt_pk_bf16_f32 v16, v16, v17
    v_cvt_pk_bf16_f32 v17, v18, v19
    v_cvt_pk_bf16_f32 v18, v20, v21
    v_cvt_pk_bf16_f32 v19, v22, v23
    s_add_u32 s56, s83, 0
    buffer_store_dwordx4 v[16:19], v1, s[16:19], s56 offen offset:0 sc1
    v_mfma_f32_32x32x16_bf16 v[48:63], v[116:119], v[244:247], v[48:63]
    ds_read_b128 v[112:115], v5 offset:4096
    v_cvt_pk_bf16_f32 v24, v24, v25
    v_cvt_pk_bf16_f32 v25, v26, v27
    v_cvt_pk_bf16_f32 v26, v28, v29
    v_cvt_pk_bf16_f32 v27, v30, v31
    s_add_u32 s56, s83, 0
    buffer_store_dwordx4 v[24:27], v1, s[16:19], s56 offen offset:1024 sc1
    s_waitcnt lgkmcnt(5)
    v_mfma_f32_32x32x16_bf16 v[48:63], v[120:123], v[248:251], v[48:63]
    ds_read_b128 v[116:119], v5 offset:9216
    v_mfma_f32_32x32x16_bf16 v[48:63], v[124:127], v[252:255], v[48:63]
    ds_read_b128 v[120:123], v5 offset:14336
    s_waitcnt lgkmcnt(5)
    v_mfma_f32_32x32x16_bf16 v[64:79], v[96:99], v[240:243], v[64:79]
    ds_read_b128 v[124:127], v5 offset:19456
    s_nop 1
    v_cvt_pk_bf16_f32 v32, v32, v33
    v_cvt_pk_bf16_f32 v33, v34, v35
    v_cvt_pk_bf16_f32 v34, v36, v37
    v_cvt_pk_bf16_f32 v35, v38, v39
    s_add_u32 s56, s83, 0
    buffer_store_dwordx4 v[32:35], v1, s[16:19], s56 offen offset:2048 sc1
    v_mfma_f32_32x32x16_bf16 v[64:79], v[100:103], v[244:247], v[64:79]
    v_cvt_pk_bf16_f32 v40, v40, v41
    v_cvt_pk_bf16_f32 v41, v42, v43
    v_cvt_pk_bf16_f32 v42, v44, v45
    v_cvt_pk_bf16_f32 v43, v46, v47
    s_add_u32 s56, s83, 0
    buffer_store_dwordx4 v[40:43], v1, s[16:19], s56 offen offset:3072 sc1
    s_waitcnt lgkmcnt(4)
    v_mfma_f32_32x32x16_bf16 v[64:79], v[104:107], v[248:251], v[64:79]
    v_mfma_f32_32x32x16_bf16 v[64:79], v[108:111], v[252:255], v[64:79]
    s_waitcnt lgkmcnt(2)
    v_mfma_f32_32x32x16_bf16 v[80:95], v[112:115], v[240:243], v[80:95]
    s_nop 1
    v_cvt_pk_bf16_f32 v48, v48, v49
    v_cvt_pk_bf16_f32 v49, v50, v51
    v_cvt_pk_bf16_f32 v50, v52, v53
    v_cvt_pk_bf16_f32 v51, v54, v55
    s_add_u32 s56, s83, 4096
    buffer_store_dwordx4 v[48:51], v1, s[16:19], s56 offen offset:0 sc1
    v_mfma_f32_32x32x16_bf16 v[80:95], v[116:119], v[244:247], v[80:95]
    v_cvt_pk_bf16_f32 v56, v56, v57
    v_cvt_pk_bf16_f32 v57, v58, v59
    v_cvt_pk_bf16_f32 v58, v60, v61
    v_cvt_pk_bf16_f32 v59, v62, v63
    s_add_u32 s56, s83, 4096
    buffer_store_dwordx4 v[56:59], v1, s[16:19], s56 offen offset:1024 sc1
    s_waitcnt lgkmcnt(0)
    v_mfma_f32_32x32x16_bf16 v[80:95], v[120:123], v[248:251], v[80:95]
    v_mfma_f32_32x32x16_bf16 v[80:95], v[124:127], v[252:255], v[80:95]
    s_nop 3
    v_cvt_pk_bf16_f32 v64, v64, v65
    v_cvt_pk_bf16_f32 v65, v66, v67
    v_cvt_pk_bf16_f32 v66, v68, v69
    v_cvt_pk_bf16_f32 v67, v70, v71
    s_add_u32 s56, s83, 4096
    buffer_store_dwordx4 v[64:67], v1, s[16:19], s56 offen offset:2048 sc1
    v_cvt_pk_bf16_f32 v72, v72, v73
    v_cvt_pk_bf16_f32 v73, v74, v75
    v_cvt_pk_bf16_f32 v74, v76, v77
    v_cvt_pk_bf16_f32 v75, v78, v79
    s_add_u32 s56, s83, 4096
    buffer_store_dwordx4 v[72:75], v1, s[16:19], s56 offen offset:3072 sc1
    s_barrier
    v_cvt_pk_bf16_f32 v80, v80, v81
    v_cvt_pk_bf16_f32 v81, v82, v83
    v_cvt_pk_bf16_f32 v82, v84, v85
    v_cvt_pk_bf16_f32 v83, v86, v87
    s_add_u32 s56, s83, 8192
    buffer_store_dwordx4 v[80:83], v1, s[16:19], s56 offen offset:0 sc1
    v_cvt_pk_bf16_f32 v88, v88, v89
    v_cvt_pk_bf16_f32 v89, v90, v91
    v_cvt_pk_bf16_f32 v90, v92, v93
    v_cvt_pk_bf16_f32 v91, v94, v95
    s_add_u32 s56, s83, 8192
    buffer_store_dwordx4 v[88:91], v1, s[16:19], s56 offen offset:1024 sc1
    s_lshl_b32 s56, s65, 11
    s_lshl_b32 s57, s62, 9
    s_add_u32 s56, s56, s57
    s_lshl_b32 s57, s66, 7
    s_add_u32 s56, s56, s57
    s_add_u32 s56, s56, 524288
    v_mov_b32 v2, 162816
    v_mov_b32 v3, 1
    s_waitcnt vmcnt(0)
    s_mov_b64 exec, 1
    ds_add_rtn_u32 v3, v2, v3
    v_mov_b32 v2, 0
    s_waitcnt lgkmcnt(0)
    v_cmp_eq_u32 vcc, 3, v3
    v_mov_b32 v3, s54
    s_cmp_lg_u32 vcc_lo, 0
    s_cselect_b32 s56, s56, 0x70000000
    buffer_store_dword v3, v2, s[16:19], s56 offen sc1
    s_mov_b64 exec, -1
    v_lshrrev_b32 v2, 3, v0
    v_lshlrev_b32 v128, 9, v2
    v_and_b32 v129, 7, v0
    v_lshl_add_u32 v128, v129, 4, v128
    v_lshrrev_b32 v129, 1, v2
    v_lshlrev_b32 v129, 6, v129
    v_and_b32 v2, 1, v2
    v_lshl_add_u32 v129, v2, 4, v129
    s_lshr_b32 s83, s35, 2
    s_mul_i32 s82, s83, 262144
    s_and_b32 s57, s53, 3
    s_lshl_b32 s57, s57, 7
    s_add_u32 s82, s82, s57
    s_mov_b32 s58, 0
    v_and_b32 v2, 7, v0
    v_mul_u32_u24 v2, 1280, v2
    v_lshrrev_b32 v3, 1, v129
    v_add_u32 v2, v2, v3
    s_mul_i32 s57, s35, 10240
    s_add_u32 s57, s57, s58
    buffer_load_dwordx2 v[132:133], v2, s[36:39], s57 offen offset:0
    buffer_load_dwordx2 v[134:135], v2, s[36:39], s57 offen offset:16
    buffer_load_dwordx2 v[136:137], v2, s[36:39], s57 offen offset:512
    buffer_load_dwordx2 v[138:139], v2, s[36:39], s57 offen offset:528
    s_add_u32 s57, s58, 5120
    buffer_load_dwordx4 v[140:143], v129, s[16:19], s57 offen offset:0 sc1
    buffer_load_dwordx4 v[144:147], v129, s[16:19], s57 offen offset:32 sc1
    buffer_load_dwordx4 v[148:151], v129, s[16:19], s57 offen offset:1024 sc1
    buffer_load_dwordx4 v[152:155], v129, s[16:19], s57 offen offset:1056 sc1
    s_add_u32 s57, s58, 10240
    buffer_load_dwordx4 v[156:159], v129, s[16:19], s57 offen offset:0 sc1
    buffer_load_dwordx4 v[160:163], v129, s[16:19], s57 offen offset:32 sc1
    buffer_load_dwordx4 v[164:167], v129, s[16:19], s57 offen offset:1024 sc1
    buffer_load_dwordx4 v[168:171], v129, s[16:19], s57 offen offset:1056 sc1
    s_add_u32 s57, s58, 7680
    buffer_load_dwordx4 v[172:175], v129, s[16:19], s57 offen offset:0 sc1
    buffer_load_dwordx4 v[176:179], v129, s[16:19], s57 offen offset:32 sc1
    buffer_load_dwordx4 v[180:183], v129, s[16:19], s57 offen offset:1024 sc1
    buffer_load_dwordx4 v[184:187], v129, s[16:19], s57 offen offset:1056 sc1
    v_and_b32 v130, 7, v0
    v_lshlrev_b32 v130, 6, v130
    v_add_u32 v130, 161792, v130
    s_lshl_b32 s57, s3, 3
    v_add_u32 v131, s57, v130
    v_mov_b32 v2, 162860
    s_mov_b32 s59, 0
kb_rlC:
    ds_read_b32 v8, v2
    s_waitcnt lgkmcnt(0)
    v_readfirstlane_b32 s58, v8
    s_andn2_b32 s56, s58, s59
    s_cbranch_scc1 kb_rnC
    s_sleep 1
    s_branch kb_rlC
kb_rnC:
    s_mov_b32 s59, s58
    s_bitcmp0_b32 s56, 0
    s_cbranch_scc1 kb_rsC0
    s_add_u32 s57, s82, 67108864
    buffer_load_dwordx4 v[16:19], v128, s[16:19], s57 offen sc1
    s_add_u32 s57, s82, 67125248
    buffer_load_dwordx4 v[20:23], v128, s[16:19], s57 offen sc1
kb_rsC0:
    s_bitcmp0_b32 s56, 4
    s_cbranch_scc1 kb_rsC1
    s_add_u32 s57, s82, 67149824
    buffer_load_dwordx4 v[24:27], v128, s[16:19], s57 offen sc1
    s_add_u32 s57, s82, 67166208
    buffer_load_dwordx4 v[28:31], v128, s[16:19], s57 offen sc1
kb_rsC1:
    s_bitcmp0_b32 s56, 8
    s_cbranch_scc1 kb_rsC2
    s_add_u32 s57, s82, 67190784
    buffer_load_dwordx4 v[32:35], v128, s[16:19], s57 offen sc1
    s_add_u32 s57, s82, 67207168
    buffer_load_dwordx4 v[36:39], v128, s[16:19], s57 offen sc1
kb_rsC2:
    s_bitcmp0_b32 s56, 12
    s_cbranch_scc1 kb_rsC3
    s_add_u32 s57, s82, 67231744
    buffer_load_dwordx4 v[40:43], v128, s[16:19], s57 offen sc1
    s_add_u32 s57, s82, 67248128
    buffer_load_dwordx4 v[44:47], v128, s[16:19], s57 offen sc1
kb_rsC3:
    s_cmp_lg_u32 s59, 0x1111
    s_cbranch_scc1 kb_rlC
    s_waitcnt vmcnt(8)
    v_lshlrev_b32 v192, 16, v132
    v_and_b32 v193, 0xffff0000, v132
    v_lshlrev_b32 v194, 16, v133
    v_and_b32 v195, 0xffff0000, v133
    v_lshlrev_b32 v196, 16, v134
    v_and_b32 v197, 0xffff0000, v134
    v_lshlrev_b32 v198, 16, v135
    v_and_b32 v199, 0xffff0000, v135
    v_lshlrev_b32 v200, 16, v136
    v_and_b32 v201, 0xffff0000, v136
    v_lshlrev_b32 v202, 16, v137
    v_and_b32 v203, 0xffff0000, v137
    v_lshlrev_b32 v204, 16, v138
    v_and_b32 v205, 0xffff0000, v138
    v_lshlrev_b32 v206, 16, v139
    v_and_b32 v207, 0xffff0000, v139
    s_waitcnt vmcnt(0)
    v_lshlrev_b32 v48, 16, v16
    v_and_b32 v49, 0xffff0000, v16
    v_lshlrev_b32 v50, 16, v17
    v_and_b32 v51, 0xffff0000, v17
    v_lshlrev_b32 v52, 16, v18
    v_and_b32 v53, 0xffff0000, v18
    v_lshlrev_b32 v54, 16, v19
    v_and_b32 v55, 0xffff0000, v19
    v_lshlrev_b32 v56, 16, v20
    v_and_b32 v57, 0xffff0000, v20
    v_lshlrev_b32 v58, 16, v21
    v_and_b32 v59, 0xffff0000, v21
    v_lshlrev_b32 v60, 16, v22
    v_and_b32 v61, 0xffff0000, v22
    v_lshlrev_b32 v62, 16, v23
    v_and_b32 v63, 0xffff0000, v23
    v_lshlrev_b32 v64, 16, v24
    v_and_b32 v65, 0xffff0000, v24
    v_lshlrev_b32 v66, 16, v25
    v_and_b32 v67, 0xffff0000, v25
    v_lshlrev_b32 v68, 16, v26
    v_and_b32 v69, 0xffff0000, v26
    v_lshlrev_b32 v70, 16, v27
    v_and_b32 v71, 0xffff0000, v27
    v_lshlrev_b32 v72, 16, v28
    v_and_b32 v73, 0xffff0000, v28
    v_lshlrev_b32 v74, 16, v29
    v_and_b32 v75, 0xffff0000, v29
    v_lshlrev_b32 v76, 16, v30
    v_and_b32 v77, 0xffff0000, v30
    v_lshlrev_b32 v78, 16, v31
    v_and_b32 v79, 0xffff0000, v31
    v_add_f32 v48, v48, v64
    v_add_f32 v49, v49, v65
    v_add_f32 v50, v50, v66
    v_add_f32 v51, v51, v67
    v_add_f32 v52, v52, v68
    v_add_f32 v53, v53, v69
    v_add_f32 v54, v54, v70
    v_add_f32 v55, v55, v71
    v_add_f32 v56, v56, v72
    v_add_f32 v57, v57, v73
    v_add_f32 v58, v58, v74
    v_add_f32 v59, v59, v75
    v_add_f32 v60, v60, v76
    v_add_f32 v61, v61, v77
    v_add_f32 v62, v62, v78
    v_add_f32 v63, v63, v79
    v_lshlrev_b32 v64, 16, v32
    v_and_b32 v65, 0xffff0000, v32
    v_lshlrev_b32 v66, 16, v33
    v_and_b32 v67, 0xffff0000, v33
    v_lshlrev_b32 v68, 16, v34
    v_and_b32 v69, 0xffff0000, v34
    v_lshlrev_b32 v70, 16, v35
    v_and_b32 v71, 0xffff0000, v35
    v_lshlrev_b32 v72, 16, v36
    v_and_b32 v73, 0xffff0000, v36
    v_lshlrev_b32 v74, 16, v37
    v_and_b32 v75, 0xffff0000, v37
    v_lshlrev_b32 v76, 16, v38
    v_and_b32 v77, 0xffff0000, v38
    v_lshlrev_b32 v78, 16, v39
    v_and_b32 v79, 0xffff0000, v39
    v_add_f32 v48, v48, v64
    v_add_f32 v49, v49, v65
    v_add_f32 v50, v50, v66
    v_add_f32 v51, v51, v67
    v_add_f32 v52, v52, v68
    v_add_f32 v53, v53, v69
    v_add_f32 v54, v54, v70
    v_add_f32 v55, v55, v71
    v_add_f32 v56, v56, v72
    v_add_f32 v57, v57, v73
    v_add_f32 v58, v58, v74
    v_add_f32 v59, v59, v75
    v_add_f32 v60, v60, v76
    v_add_f32 v61, v61, v77
    v_add_f32 v62, v62, v78
    v_add_f32 v63, v63, v79
    v_lshlrev_b32 v64, 16, v40
    v_and_b32 v65, 0xffff0000, v40
    v_lshlrev_b32 v66, 16, v41
    v_and_b32 v67, 0xffff0000, v41
    v_lshlrev_b32 v68, 16, v42
    v_and_b32 v69, 0xffff0000, v42
    v_lshlrev_b32 v70, 16, v43
    v_and_b32 v71, 0xffff0000, v43
    v_lshlrev_b32 v72, 16, v44
    v_and_b32 v73, 0xffff0000, v44
    v_lshlrev_b32 v74, 16, v45
    v_and_b32 v75, 0xffff0000, v45
    v_lshlrev_b32 v76, 16, v46
    v_and_b32 v77, 0xffff0000, v46
    v_lshlrev_b32 v78, 16, v47
    v_and_b32 v79, 0xffff0000, v47
    v_add_f32 v48, v48, v64
    v_add_f32 v49, v49, v65
    v_add_f32 v50, v50, v66
    v_add_f32 v51, v51, v67
    v_add_f32 v52, v52, v68
    v_add_f32 v53, v53, v69
    v_add_f32 v54, v54, v70
    v_add_f32 v55, v55, v71
    v_add_f32 v56, v56, v72
    v_add_f32 v57, v57, v73
    v_add_f32 v58, v58, v74
    v_add_f32 v59, v59, v75
    v_add_f32 v60, v60, v76
    v_add_f32 v61, v61, v77
    v_add_f32 v62, v62, v78
    v_add_f32 v63, v63, v79
    v_fma_f32 v48, v48, v140, v192
    v_fma_f32 v49, v49, v141, v193
    v_fma_f32 v50, v50, v142, v194
    v_fma_f32 v51, v51, v143, v195
    v_fma_f32 v52, v52, v144, v196
    v_fma_f32 v53, v53, v145, v197
    v_fma_f32 v54, v54, v146, v198
    v_fma_f32 v55, v55, v147, v199
    v_fma_f32 v56, v56, v148, v200
    v_fma_f32 v57, v57, v149, v201
    v_fma_f32 v58, v58, v150, v202
    v_fma_f32 v59, v59, v151, v203
    v_fma_f32 v60, v60, v152, v204
    v_fma_f32 v61, v61, v153, v205
    v_fma_f32 v62, v62, v154, v206
    v_fma_f32 v63, v63, v155, v207
    v_cvt_pk_bf16_f32 v16, v48, v49
    v_cvt_pk_bf16_f32 v17, v50, v51
    v_cvt_pk_bf16_f32 v18, v52, v53
    v_cvt_pk_bf16_f32 v19, v54, v55
    v_cvt_pk_bf16_f32 v20, v56, v57
    v_cvt_pk_bf16_f32 v21, v58, v59
    v_cvt_pk_bf16_f32 v22, v60, v61
    v_cvt_pk_bf16_f32 v23, v62, v63
    s_add_u32 s57, s82, 83886080
    buffer_store_dwordx4 v[16:19], v128, s[16:19], s57 offen sc1
    s_add_u32 s57, s82, 83902464
    buffer_store_dwordx4 v[20:23], v128, s[16:19], s57 offen sc1
    v_lshlrev_b32 v48, 16, v16
    v_and_b32 v49, 0xffff0000, v16
    v_lshlrev_b32 v50, 16, v17
    v_and_b32 v51, 0xffff0000, v17
    v_lshlrev_b32 v52, 16, v18
    v_and_b32 v53, 0xffff0000, v18
    v_lshlrev_b32 v54, 16, v19
    v_and_b32 v55, 0xffff0000, v19
    v_lshlrev_b32 v56, 16, v20
    v_and_b32 v57, 0xffff0000, v20
    v_lshlrev_b32 v58, 16, v21
    v_and_b32 v59, 0xffff0000, v21
    v_lshlrev_b32 v60, 16, v22
    v_and_b32 v61, 0xffff0000, v22
    v_lshlrev_b32 v62, 16, v23
    v_and_b32 v63, 0xffff0000, v23
    v_add_f32 v80, v48, v49
    v_mul_f32 v81, v48, v48
    v_add_f32 v80, v80, v50
    v_add_f32 v80, v80, v51
    v_add_f32 v80, v80, v52
    v_add_f32 v80, v80, v53
    v_add_f32 v80, v80, v54
    v_add_f32 v80, v80, v55
    v_add_f32 v80, v80, v56
    v_add_f32 v80, v80, v57
    v_add_f32 v80, v80, v58
    v_add_f32 v80, v80, v59
    v_add_f32 v80, v80, v60
    v_add_f32 v80, v80, v61
    v_add_f32 v80, v80, v62
    v_add_f32 v80, v80, v63
    v_fmac_f32 v81, v49, v49
    v_fmac_f32 v81, v50, v50
    v_fmac_f32 v81, v51, v51
    v_fmac_f32 v81, v52, v52
    v_fmac_f32 v81, v53, v53
    v_fmac_f32 v81, v54, v54
    v_fmac_f32 v81, v55, v55
    v_fmac_f32 v81, v56, v56
    v_fmac_f32 v81, v57, v57
    v_fmac_f32 v81, v58, v58
    v_fmac_f32 v81, v59, v59
    v_fmac_f32 v81, v60, v60
    v_fmac_f32 v81, v61, v61
    v_fmac_f32 v81, v62, v62
    v_fmac_f32 v81, v63, v63
    s_nop 1
    v_add_f32_dpp v80, v80, v80 row_ror:8 row_mask:0xf bank_mask:0xf
    v_add_f32_dpp v81, v81, v81 row_ror:8 row_mask:0xf bank_mask:0xf
    v_mov_b32 v82, v80
    v_mov_b32 v83, v81
    s_nop 0
    v_permlane16_swap_b32 v80, v82
    v_permlane16_swap_b32 v81, v83
    v_add_f32 v80, v80, v82
    v_add_f32 v81, v81, v83
    v_mov_b32 v82, v80
    v_mov_b32 v83, v81
    s_nop 0
    v_permlane32_swap_b32 v80, v82
    v_permlane32_swap_b32 v81, v83
    v_add_f32 v80, v80, v82
    v_add_f32 v81, v81, v83
    ds_write_b64 v131, v[80:81] offset:0
    s_waitcnt lgkmcnt(0)
    s_barrier
    ds_read_b128 v[64:67], v130 offset:0
    ds_read_b128 v[68:71], v130 offset:16
    ds_read_b128 v[72:75], v130 offset:32
    s_waitcnt lgkmcnt(0)
    v_add_f32 v80, v64, v66
    v_add_f32 v81, v65, v67
    v_add_f32 v80, v80, v68
    v_add_f32 v81, v81, v69
    v_add_f32 v80, v80, v70
    v_add_f32 v81, v81, v71
    v_add_f32 v80, v80, v72
    v_add_f32 v81, v81, v73
    v_add_f32 v80, v80, v74
    v_add_f32 v81, v81, v75
    v_mul_f32 v80, 0x3acccccd, v80
    v_mov_b32 v82, 0x3727c5ac
    v_fmac_f32 v82, 0x3acccccd, v81
    v_fma_f32 v82, -v80, v80, v82
    v_max_f32 v82, 0x3727c5ac, v82
    v_rsq_f32 v81, v82
    s_nop 0
    v_mul_f32 v80, v80, v81
    v_fma_f32 v48, v48, v81, -v80
    v_fma_f32 v49, v49, v81, -v80
    v_fma_f32 v50, v50, v81, -v80
    v_fma_f32 v51, v51, v81, -v80
    v_fma_f32 v52, v52, v81, -v80
    v_fma_f32 v53, v53, v81, -v80
    v_fma_f32 v54, v54, v81, -v80
    v_fma_f32 v55, v55, v81, -v80
    v_fma_f32 v56, v56, v81, -v80
    v_fma_f32 v57, v57, v81, -v80
    v_fma_f32 v58, v58, v81, -v80
    v_fma_f32 v59, v59, v81, -v80
    v_fma_f32 v60, v60, v81, -v80
    v_fma_f32 v61, v61, v81, -v80
    v_fma_f32 v62, v62, v81, -v80
    v_fma_f32 v63, v63, v81, -v80
    v_fma_f32 v48, v48, v156, v172
    v_fma_f32 v49, v49, v157, v173
    v_fma_f32 v50, v50, v158, v174
    v_fma_f32 v51, v51, v159, v175
    v_fma_f32 v52, v52, v160, v176
    v_fma_f32 v53, v53, v161, v177
    v_fma_f32 v54, v54, v162, v178
    v_fma_f32 v55, v55, v163, v179
    v_fma_f32 v56, v56, v164, v180
    v_fma_f32 v57, v57, v165, v181
    v_fma_f32 v58, v58, v166, v182
    v_fma_f32 v59, v59, v167, v183
    v_fma_f32 v60, v60, v168, v184
    v_fma_f32 v61, v61, v169, v185
    v_fma_f32 v62, v62, v170, v186
    v_fma_f32 v63, v63, v171, v187
    v_cvt_pk_bf16_f32 v24, v48, v49
    v_cvt_pk_bf16_f32 v25, v50, v51
    v_cvt_pk_bf16_f32 v26, v52, v53
    v_cvt_pk_bf16_f32 v27, v54, v55
    v_cvt_pk_bf16_f32 v28, v56, v57
    v_cvt_pk_bf16_f32 v29, v58, v59
    v_cvt_pk_bf16_f32 v30, v60, v61
    v_cvt_pk_bf16_f32 v31, v62, v63
    s_add_u32 s57, s82, 83927040
    buffer_store_dwordx4 v[24:27], v128, s[16:19], s57 offen sc1
    s_add_u32 s57, s82, 83943424
    buffer_store_dwordx4 v[28:31], v128, s[16:19], s57 offen sc1
    v_lshlrev_b32 v48, 16, v24
    v_and_b32 v49, 0xffff0000, v24
    v_lshlrev_b32 v50, 16, v25
    v_and_b32 v51, 0xffff0000, v25
    v_lshlrev_b32 v52, 16, v26
    v_and_b32 v53, 0xffff0000, v26
    v_lshlrev_b32 v54, 16, v27
    v_and_b32 v55, 0xffff0000, v27
    v_lshlrev_b32 v56, 16, v28
    v_and_b32 v57, 0xffff0000, v28
    v_lshlrev_b32 v58, 16, v29
    v_and_b32 v59, 0xffff0000, v29
    v_lshlrev_b32 v60, 16, v30
    v_and_b32 v61, 0xffff0000, v30
    v_lshlrev_b32 v62, 16, v31
    v_and_b32 v63, 0xffff0000, v31
    v_add_f32 v80, v48, v49
    v_mul_f32 v81, v48, v48
    v_add_f32 v80, v80, v50
    v_add_f32 v80, v80, v51
    v_add_f32 v80, v80, v52
    v_add_f32 v80, v80, v53
    v_add_f32 v80, v80, v54
    v_add_f32 v80, v80, v55
    v_add_f32 v80, v80, v56
    v_add_f32 v80, v80, v57
    v_add_f32 v80, v80, v58
    v_add_f32 v80, v80, v59
    v_add_f32 v80, v80, v60
    v_add_f32 v80, v80, v61
    v_add_f32 v80, v80, v62
    v_add_f32 v80, v80, v63
    v_fmac_f32 v81, v49, v49
    v_fmac_f32 v81, v50, v50
    v_fmac_f32 v81, v51, v51
    v_fmac_f32 v81, v52, v52
    v_fmac_f32 v81, v53, v53
    v_fmac_f32 v81, v54, v54
    v_fmac_f32 v81, v55, v55
    v_fmac_f32 v81, v56, v56
    v_fmac_f32 v81, v57, v57
    v_fmac_f32 v81, v58, v58
    v_fmac_f32 v81, v59, v59
    v_fmac_f32 v81, v60, v60
    v_fmac_f32 v81, v61, v61
    v_fmac_f32 v81, v62, v62
    v_fmac_f32 v81, v63, v63
    s_nop 1
    v_add_f32_dpp v80, v80, v80 row_ror:8 row_mask:0xf bank_mask:0xf
    v_add_f32_dpp v81, v81, v81 row_ror:8 row_mask:0xf bank_mask:0xf
    v_mov_b32 v82, v80
    v_mov_b32 v83, v81
    s_nop 0
    v_permlane16_swap_b32 v80, v82
    v_permlane16_swap_b32 v81, v83
    v_add_f32 v80, v80, v82
    v_add_f32 v81, v81, v83
    v_mov_b32 v82, v80
    v_mov_b32 v83, v81
    s_nop 0
    v_permlane32_swap_b32 v80, v82
    v_permlane32_swap_b32 v81, v83
    v_add_f32 v80, v80, v82
    v_add_f32 v81, v81, v83
    ds_write_b64 v131, v[80:81] offset:512
    s_waitcnt lgkmcnt(0)
    s_barrier
    ds_read_b128 v[64:67], v130 offset:512
    ds_read_b128 v[68:71], v130 offset:528
    ds_read_b128 v[72:75], v130 offset:544
    s_waitcnt lgkmcnt(0)
    v_add_f32 v80, v64, v66
    v_add_f32 v81, v65, v67
    v_add_f32 v80, v80, v68
    v_add_f32 v81, v81, v69
    v_add_f32 v80, v80, v70
    v_add_f32 v81, v81, v71
    v_add_f32 v80, v80, v72
    v_add_f32 v81, v81, v73
    v_add_f32 v80, v80, v74
    v_add_f32 v81, v81, v75
    v_mul_f32 v80, 0x3acccccd, v80
    v_mov_b32 v82, 0x3727c5ac
    v_fmac_f32 v82, 0x3acccccd, v81
    v_fma_f32 v82, -v80, v80, v82
    v_max_f32 v82, 0x3727c5ac, v82
    v_rsq_f32 v81, v82
    s_nop 0
    v_mul_f32 v80, v80, v81
    v_fma_f32 v48, v48, v81, -v80
    v_fma_f32 v49, v49, v81, -v80
    v_fma_f32 v50, v50, v81, -v80
    v_fma_f32 v51, v51, v81, -v80
    v_fma_f32 v52, v52, v81, -v80
    v_fma_f32 v53, v53, v81, -v80
    v_fma_f32 v54, v54, v81, -v80
    v_fma_f32 v55, v55, v81, -v80
    v_fma_f32 v56, v56, v81, -v80
    v_fma_f32 v57, v57, v81, -v80
    v_fma_f32 v58, v58, v81, -v80
    v_fma_f32 v59, v59, v81, -v80
    v_fma_f32 v60, v60, v81, -v80
    v_fma_f32 v61, v61, v81, -v80
    v_fma_f32 v62, v62, v81, -v80
    v_fma_f32 v63, v63, v81, -v80
    v_cvt_pk_bf16_f32 v32, v48, v49
    v_cvt_pk_bf16_f32 v33, v50, v51
    v_cvt_pk_bf16_f32 v34, v52, v53
    v_cvt_pk_bf16_f32 v35, v54, v55
    v_cvt_pk_bf16_f32 v36, v56, v57
    v_cvt_pk_bf16_f32 v37, v58, v59
    v_cvt_pk_bf16_f32 v38, v60, v61
    v_cvt_pk_bf16_f32 v39, v62, v63
    s_add_u32 s57, s82, 83968000
    buffer_store_dwordx4 v[32:35], v128, s[16:19], s57 offen sc1
    s_add_u32 s57, s82, 83984384
    buffer_store_dwordx4 v[36:39], v128, s[16:19], s57 offen sc1
    s_lshl_b32 s56, s35, 7
    s_add_u32 s56, s56, 557056
    v_mov_b32 v2, 162820
    v_mov_b32 v3, 1
    s_waitcnt vmcnt(0)
    s_mov_b64 exec, 1
    ds_add_rtn_u32 v3, v2, v3
    v_mov_b32 v2, 0
    s_waitcnt lgkmcnt(0)
    v_cmp_eq_u32 vcc, 7, v3
    v_mov_b32 v3, s54
    s_cmp_lg_u32 vcc_lo, 0
    s_cselect_b32 s56, s56, 0x70000000
    buffer_store_dword v3, v2, s[16:19], s56 offen sc1
    s_mov_b64 exec, -1
    s_mul_i32 s82, s67, 262144
    s_lshl_b32 s57, s68, 11
    s_add_u32 s82, s82, s57
    s_mul_i32 s57, s70, 3072
    s_add_u32 s82, s82, s57
    s_mul_i32 s81, s67, 262144
    s_mul_i32 s56, s70, 20480
    s_add_u32 s81, s81, s56
    s_add_u32 s81, s81, 83968000
    s_cmp_lg_u32 s3, 0
    s_cbranch_scc1 kb_pd1
    s_lshl_b32 s56, s71, 10
    s_add_u32 s56, s56, 557056
    s_cmp_lt_u32 s34, 14
    s_cselect_b32 s58, 0xff, 0
    s_mov_b32 s59, 0
    v_lshlrev_b32 v2, 3, v1
    s_mov_b32 s57, 0
    s_mov_b64 exec, s[58:59]
    s_cbranch_execz kb_pe1
kb_pl1:
    buffer_load_dword v3, v2, s[16:19], s56 offen sc1
    s_add_u32 s57, s57, 1
    s_waitcnt vmcnt(0)
    v_cmp_ne_u32 vcc, s54, v3
    s_cbranch_vccz kb_pe1
    s_mov_b64 exec, vcc
    s_sleep 1
    s_cmp_lt_u32 s57, 0x40000
    s_cbranch_scc1 kb_pl1
kb_pe1:
    s_mov_b64 exec, -1
kb_pd1:
    s_barrier
    s_add_u32 s60, s81, 0
    buffer_load_dwordx4 v[128:131], v1, s[20:23], s60 offen offset:0 sc1
    buffer_load_dwordx4 v[132:135], v1, s[20:23], s60 offen offset:1024 sc1
    buffer_load_dwordx4 v[136:139], v1, s[20:23], s60 offen offset:2048 sc1
    buffer_load_dwordx4 v[140:143], v1, s[20:23], s60 offen offset:3072 sc1
    s_add_u32 s60, s81, 4096
    buffer_load_dwordx4 v[144:147], v1, s[20:23], s60 offen offset:0 sc1
    buffer_load_dwordx4 v[148:151], v1, s[20:23], s60 offen offset:1024 sc1
    buffer_load_dwordx4 v[152:155], v1, s[20:23], s60 offen offset:2048 sc1
    buffer_load_dwordx4 v[156:159], v1, s[20:23], s60 offen offset:3072 sc1
    s_add_u32 s60, s81, 8192
    buffer_load_dwordx4 v[160:163], v1, s[20:23], s60 offen offset:0 sc1
    buffer_load_dwordx4 v[164:167], v1, s[20:23], s60 offen offset:1024 sc1
    buffer_load_dwordx4 v[168:171], v1, s[20:23], s60 offen offset:2048 sc1
    buffer_load_dwordx4 v[172:175], v1, s[20:23], s60 offen offset:3072 sc1
    s_mul_i32 s59, s70, 12288
    v_add_u32 v6, s59, v1
    v_add_u32 v5, 40960, v6
    ds_read_b128 v[96:99], v5 offset:0
    ds_read_b128 v[100:103], v5 offset:1024
    ds_read_b128 v[104:107], v5 offset:2048
    ds_read_b128 v[108:111], v5 offset:3072
    ds_read_b128 v[112:115], v5 offset:4096
    ds_read_b128 v[116:119], v5 offset:5120
    ds_read_b128 v[120:123], v5 offset:6144
    s_waitcnt vmcnt(11)
    s_waitcnt lgkmcnt(5)
    v_mfma_f32_32x32x16_bf16 v[16:31], v[96:99], v[128:131], 0
    ds_read_b128 v[124:127], v5 offset:7168
    s_add_u32 s60, s81, 12288
    buffer_load_dwordx4 v[176:179], v1, s[20:23], s60 offen offset:0 sc1
    v_mfma_f32_32x32x16_bf16 v[32:47], v[100:103], v[128:131], 0
    ds_read_b128 v[96:99], v5 offset:8192
    buffer_load_dwordx4 v[180:183], v1, s[20:23], s60 offen offset:1024 sc1
    s_waitcnt lgkmcnt(5)
    v_mfma_f32_32x32x16_bf16 v[48:63], v[104:107], v[128:131], 0
    ds_read_b128 v[100:103], v5 offset:9216
    s_waitcnt vmcnt(12)
    v_mfma_f32_32x32x16_bf16 v[16:31], v[108:111], v[132:135], v[16:31]
    ds_read_b128 v[104:107], v5 offset:10240
    buffer_load_dwordx4 v[184:187], v1, s[20:23], s60 offen offset:2048 sc1
    s_waitcnt lgkmcnt(5)
    v_mfma_f32_32x32x16_bf16 v[32:47], v[112:115], v[132:135], v[32:47]
    ds_read_b128 v[108:111], v5 offset:11264
    v_add_u32 v5, 65536, v6
    buffer_load_dwordx4 v[188:191], v1, s[20:23], s60 offen offset:3072 sc1
    v_mfma_f32_32x32x16_bf16 v[48:63], v[116:119], v[132:135], v[48:63]
    ds_read_b128 v[112:115], v5 offset:0
    s_waitcnt vmcnt(13)
    s_waitcnt lgkmcnt(5)
    v_mfma_f32_32x32x16_bf16 v[16:31], v[120:123], v[136:139], v[16:31]
    ds_read_b128 v[116:119], v5 offset:1024
    s_add_u32 s60, s81, 16384
    buffer_load_dwordx4 v[192:195], v1, s[20:23], s60 offen offset:0 sc1
    v_mfma_f32_32x32x16_bf16 v[32:47], v[124:127], v[136:139], v[32:47]
    ds_read_b128 v[120:123], v5 offset:2048
    buffer_load_dwordx4 v[196:199], v1, s[20:23], s60 offen offset:1024 sc1
    s_waitcnt lgkmcnt(5)
    v_mfma_f32_32x32x16_bf16 v[48:63], v[96:99], v[136:139], v[48:63]
    ds_read_b128 v[124:127], v5 offset:3072
    s_waitcnt vmcnt(14)
    v_mfma_f32_32x32x16_bf16 v[16:31], v[100:103], v[140:143], v[16:31]
    ds_read_b128 v[96:99], v5 offset:4096
    buffer_load_dwordx4 v[200:203], v1, s[20:23], s60 offen offset:2048 sc1
    s_waitcnt lgkmcnt(5)
    v_mfma_f32_32x32x16_bf16 v[32:47], v[104:107], v[140:143], v[32:47]
    ds_read_b128 v[100:103], v5 offset:5120
    buffer_load_dwordx4 v[204:207], v1, s[20:23], s60 offen offset:3072 sc1
    v_mfma_f32_32x32x16_bf16 v[48:63], v[108:111], v[140:143], v[48:63]
    ds_read_b128 v[104:107], v5 offset:6144
    s_waitcnt vmcnt(15)
    s_waitcnt lgkmcnt(5)
    v_mfma_f32_32x32x16_bf16 v[16:31], v[112:115], v[144:147], v[16:31]
    ds_read_b128 v[108:111], v5 offset:7168
    v_mfma_f32_32x32x16_bf16 v[32:47], v[116:119], v[144:147], v[32:47]
    ds_read_b128 v[112:115], v5 offset:8192
    s_waitcnt lgkmcnt(5)
    v_mfma_f32_32x32x16_bf16 v[48:63], v[120:123], v[144:147], v[48:63]
    ds_read_b128 v[116:119], v5 offset:9216
    s_waitcnt vmcnt(14)
    v_mfma_f32_32x32x16_bf16 v[16:31], v[124:127], v[148:151], v[16:31]
    ds_read_b128 v[120:123], v5 offset:10240
    s_waitcnt lgkmcnt(5)
    v_mfma_f32_32x32x16_bf16 v[32:47], v[96:99], v[148:151], v[32:47]
    ds_read_b128 v[124:127], v5 offset:11264
    v_add_u32 v5, 90112, v6
    v_mfma_f32_32x32x16_bf16 v[48:63], v[100:103], v[148:151], v[48:63]
    ds_read_b128 v[96:99], v5 offset:0
    s_waitcnt vmcnt(13)
    s_waitcnt lgkmcnt(5)
    v_mfma_f32_32x32x16_bf16 v[16:31], v[104:107], v[152:155], v[16:31]
    ds_read_b128 v[100:103], v5 offset:1024
    v_mfma_f32_32x32x16_bf16 v[32:47], v[108:111], v[152:155], v[32:47]
    ds_read_b128 v[104:107], v5 offset:2048
    s_waitcnt lgkmcnt(5)
    v_mfma_f32_32x32x16_bf16 v[48:63], v[112:115], v[152:155], v[48:63]
    ds_read_b128 v[108:111], v5 offset:3072
    s_waitcnt vmcnt(12)
    v_mfma_f32_32x32x16_bf16 v[16:31], v[116:119], v[156:159], v[16:31]
    ds_read_b128 v[112:115], v5 offset:4096
    s_waitcnt lgkmcnt(5)
    v_mfma_f32_32x32x16_bf16 v[32:47], v[120:123], v[156:159], v[32:47]
    ds_read_b128 v[116:119], v5 offset:5120
    v_mfma_f32_32x32x16_bf16 v[48:63], v[124:127], v[156:159], v[48:63]
    ds_read_b128 v[120:123], v5 offset:6144
    s_waitcnt vmcnt(11)
    s_waitcnt lgkmcnt(5)
    v_mfma_f32_32x32x16_bf16 v[16:31], v[96:99], v[160:163], v[16:31]
    ds_read_b128 v[124:127], v5 offset:7168
    v_mfma_f32_32x32x16_bf16 v[32:47], v[100:103], v[160:163], v[32:47]
    ds_read_b128 v[96:99], v5 offset:8192
    s_waitcnt lgkmcnt(5)
    v_mfma_f32_32x32x16_bf16 v[48:63], v[104:107], v[160:163], v[48:63]
    ds_read_b128 v[100:103], v5 offset:9216
    s_waitcnt vmcnt(10)
    v_mfma_f32_32x32x16_bf16 v[16:31], v[108:111], v[164:167], v[16:31]
    ds_read_b128 v[104:107], v5 offset:10240
    s_waitcnt lgkmcnt(5)
    v_mfma_f32_32x32x16_bf16 v[32:47], v[112:115], v[164:167], v[32:47]
    ds_read_b128 v[108:111], v5 offset:11264
    v_add_u32 v5, 114688, v6
    v_mfma_f32_32x32x16_bf16 v[48:63], v[116:119], v[164:167], v[48:63]
    ds_read_b128 v[112:115], v5 offset:0
    s_waitcnt vmcnt(9)
    s_waitcnt lgkmcnt(5)
    v_mfma_f32_32x32x16_bf16 v[16:31], v[120:123], v[168:171], v[16:31]
    ds_read_b128 v[116:119], v5 offset:1024
    v_mfma_f32_32x32x16_bf16 v[32:47], v[124:127], v[168:171], v[32:47]
    ds_read_b128 v[120:123], v5 offset:2048
    s_waitcnt lgkmcnt(5)
    v_mfma_f32_32x32x16_bf16 v[48:63], v[96:99], v[168:171], v[48:63]
    ds_read_b128 v[124:127], v5 offset:3072
    s_waitcnt vmcnt(8)
    v_mfma_f32_32x32x16_bf16 v[16:31], v[100:103], v[172:175], v[16:31]
    ds_read_b128 v[96:99], v5 offset:4096
    s_waitcnt lgkmcnt(5)
    v_mfma_f32_32x32x16_bf16 v[32:47], v[104:107], v[172:175], v[32:47]
    ds_read_b128 v[100:103], v5 offset:5120
    v_mfma_f32_32x32x16_bf16 v[48:63], v[108:111], v[172:175], v[48:63]
    ds_read_b128 v[104:107], v5 offset:6144
    s_waitcnt vmcnt(7)
    s_waitcnt lgkmcnt(5)
    v_mfma_f32_32x32x16_bf16 v[16:31], v[112:115], v[176:179], v[16:31]
    ds_read_b128 v[108:111], v5 offset:7168
    v_mfma_f32_32x32x16_bf16 v[32:47], v[116:119], v[176:179], v[32:47]
    ds_read_b128 v[112:115], v5 offset:8192
    s_waitcnt lgkmcnt(5)
    v_mfma_f32_32x32x16_bf16 v[48:63], v[120:123], v[176:179], v[48:63]
    ds_read_b128 v[116:119], v5 offset:9216
    s_waitcnt vmcnt(6)
    v_mfma_f32_32x32x16_bf16 v[16:31], v[124:127], v[180:183], v[16:31]
    ds_read_b128 v[120:123], v5 offset:10240
    s_waitcnt lgkmcnt(5)
    v_mfma_f32_32x32x16_bf16 v[32:47], v[96:99], v[180:183], v[32:47]
    ds_read_b128 v[124:127], v5 offset:11264
    v_add_u32 v5, 0, v6
    v_mfma_f32_32x32x16_bf16 v[48:63], v[100:103], v[180:183], v[48:63]
    ds_read_b128 v[96:99], v5 offset:0
    s_waitcnt vmcnt(5)
    s_waitcnt lgkmcnt(5)
    v_mfma_f32_32x32x16_bf16 v[16:31], v[104:107], v[184:187], v[16:31]
    ds_read_b128 v[100:103], v5 offset:1024
    v_mfma_f32_32x32x16_bf16 v[32:47], v[108:111], v[184:187], v[32:47]
    ds_read_b128 v[104:107], v5 offset:2048
    s_waitcnt lgkmcnt(5)
    v_mfma_f32_32x32x16_bf16 v[48:63], v[112:115], v[184:187], v[48:63]
    ds_read_b128 v[108:111], v5 offset:3072
    s_waitcnt vmcnt(4)
    v_mfma_f32_32x32x16_bf16 v[16:31], v[116:119], v[188:191], v[16:31]
    ds_read_b128 v[112:115], v5 offset:4096
    s_waitcnt lgkmcnt(5)
    v_mfma_f32_32x32x16_bf16 v[32:47], v[120:123], v[188:191], v[32:47]
    ds_read_b128 v[116:119], v5 offset:5120
    v_mfma_f32_32x32x16_bf16 v[48:63], v[124:127], v[188:191], v[48:63]
    ds_read_b128 v[120:123], v5 offset:6144
    s_barrier
    s_waitcnt vmcnt(3)
    s_waitcnt lgkmcnt(5)
    v_mfma_f32_32x32x16_bf16 v[16:31], v[96:99], v[192:195], v[16:31]
    ds_read_b128 v[124:127], v5 offset:7168
    v_mfma_f32_32x32x16_bf16 v[32:47], v[100:103], v[192:195], v[32:47]
    ds_read_b128 v[96:99], v5 offset:8192
    s_waitcnt lgkmcnt(5)
    v_mfma_f32_32x32x16_bf16 v[48:63], v[104:107], v[192:195], v[48:63]
    ds_read_b128 v[100:103], v5 offset:9216
    s_waitcnt vmcnt(2)
    v_mfma_f32_32x32x16_bf16 v[16:31], v[108:111], v[196:199], v[16:31]
    ds_read_b128 v[104:107], v5 offset:10240
    s_waitcnt lgkmcnt(5)
    v_mfma_f32_32x32x16_bf16 v[32:47], v[112:115], v[196:199], v[32:47]
    ds_read_b128 v[108:111], v5 offset:11264
    v_mfma_f32_32x32x16_bf16 v[48:63], v[116:119], v[196:199], v[48:63]
    s_waitcnt vmcnt(1)
    s_waitcnt lgkmcnt(4)
    v_mfma_f32_32x32x16_bf16 v[16:31], v[120:123], v[200:203], v[16:31]
    v_mfma_f32_32x32x16_bf16 v[32:47], v[124:127], v[200:203], v[32:47]
    s_waitcnt lgkmcnt(2)
    v_mfma_f32_32x32x16_bf16 v[48:63], v[96:99], v[200:203], v[48:63]
    s_waitcnt vmcnt(0)
    v_mfma_f32_32x32x16_bf16 v[16:31], v[100:103], v[204:207], v[16:31]
    s_waitcnt lgkmcnt(0)
    v_mfma_f32_32x32x16_bf16 v[32:47], v[104:107], v[204:207], v[32:47]
    v_mfma_f32_32x32x16_bf16 v[48:63], v[108:111], v[204:207], v[48:63]
    s_barrier
    s_mul_i32 s56, s3, 6144
    s_add_u32 s56, s56, 0
    v_add_u32 v3, s56, v1
    s_xor_b32 s56, s3, 2
    s_mul_i32 s56, s56, 6144
    s_add_u32 s56, s56, 0
    v_add_u32 v5, s56, v1
    v_mov_b32 v4, 0xc0135761
    s_nop 1
    s_cmp_eq_u32 s70, 1
    s_cbranch_scc1 kb_g2e1
    ds_write_b128 v3, v[40:43] offset:0
    ds_write_b128 v3, v[44:47] offset:1024
    ds_write_b128 v3, v[48:51] offset:2048
    ds_write_b128 v3, v[52:55] offset:3072
    ds_write_b128 v3, v[56:59] offset:4096
    ds_write_b128 v3, v[60:63] offset:5120
    s_waitcnt lgkmcnt(0)
    s_barrier
    ds_read_b128 v[96:99], v5 offset:0
    ds_read_b128 v[100:103], v5 offset:1024
    ds_read_b128 v[104:107], v5 offset:2048
    ds_read_b128 v[108:111], v5 offset:3072
    ds_read_b128 v[112:115], v5 offset:4096
    ds_read_b128 v[116:119], v5 offset:5120
    s_waitcnt lgkmcnt(5)
    v_add_f32 v16, v16, v96
    v_add_f32 v17, v17, v97
    v_add_f32 v18, v18, v98
    v_add_f32 v19, v19, v99
    s_waitcnt lgkmcnt(4)
    v_add_f32 v20, v20, v100
    v_add_f32 v21, v21, v101
    v_add_f32 v22, v22, v102
    v_add_f32 v23, v23, v103
    s_waitcnt lgkmcnt(3)
    v_add_f32 v24, v24, v104
    v_add_f32 v25, v25, v105
    v_add_f32 v26, v26, v106
    v_add_f32 v27, v27, v107
    s_waitcnt lgkmcnt(2)
    v_add_f32 v28, v28, v108
    v_add_f32 v29, v29, v109
    v_add_f32 v30, v30, v110
    v_add_f32 v31, v31, v111
    s_waitcnt lgkmcnt(1)
    v_add_f32 v32, v32, v112
    v_add_f32 v33, v33, v113
    v_add_f32 v34, v34, v114
    v_add_f32 v35, v35, v115
    s_waitcnt lgkmcnt(0)
    v_add_f32 v36, v36, v116
    v_add_f32 v37, v37, v117
    v_add_f32 v38, v38, v118
    v_add_f32 v39, v39, v119
    s_add_u32 s56, s82, 84008960
    v_mul_f32 v192, v16, v16
    v_mul_f32 v193, v17, v17
    v_mul_f32 v194, v18, v18
    v_mul_f32 v195, v19, v19
    v_mul_f32 v196, v20, v20
    v_mul_f32 v197, v21, v21
    v_mul_f32 v198, v22, v22
    v_mul_f32 v199, v23, v23
    v_fma_f32 v192, v192, s84, v4
    v_fma_f32 v193, v193, s84, v4
    v_fma_f32 v194, v194, s84, v4
    v_fma_f32 v195, v195, s84, v4
    v_fma_f32 v196, v196, s84, v4
    v_fma_f32 v197, v197, s84, v4
    v_fma_f32 v198, v198, s84, v4
    v_fma_f32 v199, v199, s84, v4
    v_mul_f32 v192, v16, v192
    v_mul_f32 v193, v17, v193
    v_mul_f32 v194, v18, v194
    v_mul_f32 v195, v19, v195
    v_mul_f32 v196, v20, v196
    v_mul_f32 v197, v21, v197
    v_mul_f32 v198, v22, v198
    v_mul_f32 v199, v23, v199
    v_exp_f32 v192, v192
    v_exp_f32 v193, v193
    v_exp_f32 v194, v194
    v_exp_f32 v195, v195
    v_exp_f32 v196, v196
    v_exp_f32 v197, v197
    v_exp_f32 v198, v198
    v_exp_f32 v199, v199
    v_add_f32 v192, 1.0, v192
    v_add_f32 v193, 1.0, v193
    v_add_f32 v194, 1.0, v194
    v_add_f32 v195, 1.0, v195
    v_add_f32 v196, 1.0, v196
    v_add_f32 v197, 1.0, v197
    v_add_f32 v198, 1.0, v198
    v_add_f32 v199, 1.0, v199
    v_rcp_f32 v192, v192
    v_rcp_f32 v193, v193
    v_rcp_f32 v194, v194
    v_rcp_f32 v195, v195
    v_rcp_f32 v196, v196
    v_rcp_f32 v197, v197
    v_rcp_f32 v198, v198
    v_rcp_f32 v199, v199
    v_mul_f32 v16, v16, v192
    v_mul_f32 v17, v17, v193
    v_mul_f32 v18, v18, v194
    v_mul_f32 v19, v19, v195
    v_mul_f32 v20, v20, v196
    v_mul_f32 v21, v21, v197
    v_mul_f32 v22, v22, v198
    v_mul_f32 v23, v23, v199
    v_cvt_pk_bf16_f32 v16, v16, v17
    v_cvt_pk_bf16_f32 v17, v18, v19
    v_cvt_pk_bf16_f32 v18, v20, v21
    v_cvt_pk_bf16_f32 v19, v22, v23
    buffer_store_dwordx4 v[16:19], v1, s[20:23], s56 offen offset:0 sc1
    v_mul_f32 v192, v24, v24
    v_mul_f32 v193, v25, v25
    v_mul_f32 v194, v26, v26
    v_mul_f32 v195, v27, v27
    v_mul_f32 v196, v28, v28
    v_mul_f32 v197, v29, v29
    v_mul_f32 v198, v30, v30
    v_mul_f32 v199, v31, v31
    v_fma_f32 v192, v192, s84, v4
    v_fma_f32 v193, v193, s84, v4
    v_fma_f32 v194, v194, s84, v4
    v_fma_f32 v195, v195, s84, v4
    v_fma_f32 v196, v196, s84, v4
    v_fma_f32 v197, v197, s84, v4
    v_fma_f32 v198, v198, s84, v4
    v_fma_f32 v199, v199, s84, v4
    v_mul_f32 v192, v24, v192
    v_mul_f32 v193, v25, v193
    v_mul_f32 v194, v26, v194
    v_mul_f32 v195, v27, v195
    v_mul_f32 v196, v28, v196
    v_mul_f32 v197, v29, v197
    v_mul_f32 v198, v30, v198
    v_mul_f32 v199, v31, v199
    v_exp_f32 v192, v192
    v_exp_f32 v193, v193
    v_exp_f32 v194, v194
    v_exp_f32 v195, v195
    v_exp_f32 v196, v196
    v_exp_f32 v197, v197
    v_exp_f32 v198, v198
    v_exp_f32 v199, v199
    v_add_f32 v192, 1.0, v192
    v_add_f32 v193, 1.0, v193
    v_add_f32 v194, 1.0, v194
    v_add_f32 v195, 1.0, v195
    v_add_f32 v196, 1.0, v196
    v_add_f32 v197, 1.0, v197
    v_add_f32 v198, 1.0, v198
    v_add_f32 v199, 1.0, v199
    v_rcp_f32 v192, v192
    v_rcp_f32 v193, v193
    v_rcp_f32 v194, v194
    v_rcp_f32 v195, v195
    v_rcp_f32 v196, v196
    v_rcp_f32 v197, v197
    v_rcp_f32 v198, v198
    v_rcp_f32 v199, v199
    v_mul_f32 v24, v24, v192
    v_mul_f32 v25, v25, v193
    v_mul_f32 v26, v26, v194
    v_mul_f32 v27, v27, v195
    v_mul_f32 v28, v28, v196
    v_mul_f32 v29, v29, v197
    v_mul_f32 v30, v30, v198
    v_mul_f32 v31, v31, v199
    v_cvt_pk_bf16_f32 v24, v24, v25
    v_cvt_pk_bf16_f32 v25, v26, v27
    v_cvt_pk_bf16_f32 v26, v28, v29
    v_cvt_pk_bf16_f32 v27, v30, v31
    buffer_store_dwordx4 v[24:27], v1, s[20:23], s56 offen offset:1024 sc1
    v_mul_f32 v192, v32, v32
    v_mul_f32 v193, v33, v33
    v_mul_f32 v194, v34, v34
    v_mul_f32 v195, v35, v35
    v_mul_f32 v196, v36, v36
    v_mul_f32 v197, v37, v37
    v_mul_f32 v198, v38, v38
    v_mul_f32 v199, v39, v39
    v_fma_f32 v192, v192, s84, v4
    v_fma_f32 v193, v193, s84, v4
    v_fma_f32 v194, v194, s84, v4
    v_fma_f32 v195, v195, s84, v4
    v_fma_f32 v196, v196, s84, v4
    v_fma_f32 v197, v197, s84, v4
    v_fma_f32 v198, v198, s84, v4
    v_fma_f32 v199, v199, s84, v4
    v_mul_f32 v192, v32, v192
    v_mul_f32 v193, v33, v193
    v_mul_f32 v194, v34, v194
    v_mul_f32 v195, v35, v195
    v_mul_f32 v196, v36, v196
    v_mul_f32 v197, v37, v197
    v_mul_f32 v198, v38, v198
    v_mul_f32 v199, v39, v199
    v_exp_f32 v192, v192
    v_exp_f32 v193, v193
    v_exp_f32 v194, v194
    v_exp_f32 v195, v195
    v_exp_f32 v196, v196
    v_exp_f32 v197, v197
    v_exp_f32 v198, v198
    v_exp_f32 v199, v199
    v_add_f32 v192, 1.0, v192
    v_add_f32 v193, 1.0, v193
    v_add_f32 v194, 1.0, v194
    v_add_f32 v195, 1.0, v195
    v_add_f32 v196, 1.0, v196
    v_add_f32 v197, 1.0, v197
    v_add_f32 v198, 1.0, v198
    v_add_f32 v199, 1.0, v199
    v_rcp_f32 v192, v192
    v_rcp_f32 v193, v193
    v_rcp_f32 v194, v194
    v_rcp_f32 v195, v195
    v_rcp_f32 v196, v196
    v_rcp_f32 v197, v197
    v_rcp_f32 v198, v198
    v_rcp_f32 v199, v199
    v_mul_f32 v32, v32, v192
    v_mul_f32 v33, v33, v193
    v_mul_f32 v34, v34, v194
    v_mul_f32 v35, v35, v195
    v_mul_f32 v36, v36, v196
    v_mul_f32 v37, v37, v197
    v_mul_f32 v38, v38, v198
    v_mul_f32 v39, v39, v199
    v_cvt_pk_bf16_f32 v32, v32, v33
    v_cvt_pk_bf16_f32 v33, v34, v35
    v_cvt_pk_bf16_f32 v34, v36, v37
    v_cvt_pk_bf16_f32 v35, v38, v39
    buffer_store_dwordx4 v[32:35], v1, s[20:23], s56 offen offset:2048 sc1
    s_branch kb_g2e2
kb_g2e1:
    ds_write_b128 v3, v[16:19] offset:0
    ds_write_b128 v3, v[20:23] offset:1024
    ds_write_b128 v3, v[24:27] offset:2048
    ds_write_b128 v3, v[28:31] offset:3072
    ds_write_b128 v3, v[32:35] offset:4096
    ds_write_b128 v3, v[36:39] offset:5120
    s_waitcnt lgkmcnt(0)
    s_barrier
    ds_read_b128 v[96:99], v5 offset:0
    ds_read_b128 v[100:103], v5 offset:1024
    ds_read_b128 v[104:107], v5 offset:2048
    ds_read_b128 v[108:111], v5 offset:3072
    ds_read_b128 v[112:115], v5 offset:4096
    ds_read_b128 v[116:119], v5 offset:5120
    s_waitcnt lgkmcnt(5)
    v_add_f32 v40, v40, v96
    v_add_f32 v41, v41, v97
    v_add_f32 v42, v42, v98
    v_add_f32 v43, v43, v99
    s_waitcnt lgkmcnt(4)
    v_add_f32 v44, v44, v100
    v_add_f32 v45, v45, v101
    v_add_f32 v46, v46, v102
    v_add_f32 v47, v47, v103
    s_waitcnt lgkmcnt(3)
    v_add_f32 v48, v48, v104
    v_add_f32 v49, v49, v105
    v_add_f32 v50, v50, v106
    v_add_f32 v51, v51, v107
    s_waitcnt lgkmcnt(2)
    v_add_f32 v52, v52, v108
    v_add_f32 v53, v53, v109
    v_add_f32 v54, v54, v110
    v_add_f32 v55, v55, v111
    s_waitcnt lgkmcnt(1)
    v_add_f32 v56, v56, v112
    v_add_f32 v57, v57, v113
    v_add_f32 v58, v58, v114
    v_add_f32 v59, v59, v115
    s_waitcnt lgkmcnt(0)
    v_add_f32 v60, v60, v116
    v_add_f32 v61, v61, v117
    v_add_f32 v62, v62, v118
    v_add_f32 v63, v63, v119
    s_add_u32 s56, s82, 84008960
    v_mul_f32 v192, v40, v40
    v_mul_f32 v193, v41, v41
    v_mul_f32 v194, v42, v42
    v_mul_f32 v195, v43, v43
    v_mul_f32 v196, v44, v44
    v_mul_f32 v197, v45, v45
    v_mul_f32 v198, v46, v46
    v_mul_f32 v199, v47, v47
    v_fma_f32 v192, v192, s84, v4
    v_fma_f32 v193, v193, s84, v4
    v_fma_f32 v194, v194, s84, v4
    v_fma_f32 v195, v195, s84, v4
    v_fma_f32 v196, v196, s84, v4
    v_fma_f32 v197, v197, s84, v4
    v_fma_f32 v198, v198, s84, v4
    v_fma_f32 v199, v199, s84, v4
    v_mul_f32 v192, v40, v192
    v_mul_f32 v193, v41, v193
    v_mul_f32 v194, v42, v194
    v_mul_f32 v195, v43, v195
    v_mul_f32 v196, v44, v196
    v_mul_f32 v197, v45, v197
    v_mul_f32 v198, v46, v198
    v_mul_f32 v199, v47, v199
    v_exp_f32 v192, v192
    v_exp_f32 v193, v193
    v_exp_f32 v194, v194
    v_exp_f32 v195, v195
    v_exp_f32 v196, v196
    v_exp_f32 v197, v197
    v_exp_f32 v198, v198
    v_exp_f32 v199, v199
    v_add_f32 v192, 1.0, v192
    v_add_f32 v193, 1.0, v193
    v_add_f32 v194, 1.0, v194
    v_add_f32 v195, 1.0, v195
    v_add_f32 v196, 1.0, v196
    v_add_f32 v197, 1.0, v197
    v_add_f32 v198, 1.0, v198
    v_add_f32 v199, 1.0, v199
    v_rcp_f32 v192, v192
    v_rcp_f32 v193, v193
    v_rcp_f32 v194, v194
    v_rcp_f32 v195, v195
    v_rcp_f32 v196, v196
    v_rcp_f32 v197, v197
    v_rcp_f32 v198, v198
    v_rcp_f32 v199, v199
    v_mul_f32 v40, v40, v192
    v_mul_f32 v41, v41, v193
    v_mul_f32 v42, v42, v194
    v_mul_f32 v43, v43, v195
    v_mul_f32 v44, v44, v196
    v_mul_f32 v45, v45, v197
    v_mul_f32 v46, v46, v198
    v_mul_f32 v47, v47, v199
    v_cvt_pk_bf16_f32 v40, v40, v41
    v_cvt_pk_bf16_f32 v41, v42, v43
    v_cvt_pk_bf16_f32 v42, v44, v45
    v_cvt_pk_bf16_f32 v43, v46, v47
    buffer_store_dwordx4 v[40:43], v1, s[20:23], s56 offen offset:0 sc1
    v_mul_f32 v192, v48, v48
    v_mul_f32 v193, v49, v49
    v_mul_f32 v194, v50, v50
    v_mul_f32 v195, v51, v51
    v_mul_f32 v196, v52, v52
    v_mul_f32 v197, v53, v53
    v_mul_f32 v198, v54, v54
    v_mul_f32 v199, v55, v55
    v_fma_f32 v192, v192, s84, v4
    v_fma_f32 v193, v193, s84, v4
    v_fma_f32 v194, v194, s84, v4
    v_fma_f32 v195, v195, s84, v4
    v_fma_f32 v196, v196, s84, v4
    v_fma_f32 v197, v197, s84, v4
    v_fma_f32 v198, v198, s84, v4
    v_fma_f32 v199, v199, s84, v4
    v_mul_f32 v192, v48, v192
    v_mul_f32 v193, v49, v193
    v_mul_f32 v194, v50, v194
    v_mul_f32 v195, v51, v195
    v_mul_f32 v196, v52, v196
    v_mul_f32 v197, v53, v197
    v_mul_f32 v198, v54, v198
    v_mul_f32 v199, v55, v199
    v_exp_f32 v192, v192
    v_exp_f32 v193, v193
    v_exp_f32 v194, v194
    v_exp_f32 v195, v195
    v_exp_f32 v196, v196
    v_exp_f32 v197, v197
    v_exp_f32 v198, v198
    v_exp_f32 v199, v199
    v_add_f32 v192, 1.0, v192
    v_add_f32 v193, 1.0, v193
    v_add_f32 v194, 1.0, v194
    v_add_f32 v195, 1.0, v195
    v_add_f32 v196, 1.0, v196
    v_add_f32 v197, 1.0, v197
    v_add_f32 v198, 1.0, v198
    v_add_f32 v199, 1.0, v199
    v_rcp_f32 v192, v192
    v_rcp_f32 v193, v193
    v_rcp_f32 v194, v194
    v_rcp_f32 v195, v195
    v_rcp_f32 v196, v196
    v_rcp_f32 v197, v197
    v_rcp_f32 v198, v198
    v_rcp_f32 v199, v199
    v_mul_f32 v48, v48, v192
    v_mul_f32 v49, v49, v193
    v_mul_f32 v50, v50, v194
    v_mul_f32 v51, v51, v195
    v_mul_f32 v52, v52, v196
    v_mul_f32 v53, v53, v197
    v_mul_f32 v54, v54, v198
    v_mul_f32 v55, v55, v199
    v_cvt_pk_bf16_f32 v48, v48, v49
    v_cvt_pk_bf16_f32 v49, v50, v51
    v_cvt_pk_bf16_f32 v50, v52, v53
    v_cvt_pk_bf16_f32 v51, v54, v55
    buffer_store_dwordx4 v[48:51], v1, s[20:23], s56 offen offset:1024 sc1
    v_mul_f32 v192, v56, v56
    v_mul_f32 v193, v57, v57
    v_mul_f32 v194, v58, v58
    v_mul_f32 v195, v59, v59
    v_mul_f32 v196, v60, v60
    v_mul_f32 v197, v61, v61
    v_mul_f32 v198, v62, v62
    v_mul_f32 v199, v63, v63
    v_fma_f32 v192, v192, s84, v4
    v_fma_f32 v193, v193, s84, v4
    v_fma_f32 v194, v194, s84, v4
    v_fma_f32 v195, v195, s84, v4
    v_fma_f32 v196, v196, s84, v4
    v_fma_f32 v197, v197, s84, v4
    v_fma_f32 v198, v198, s84, v4
    v_fma_f32 v199, v199, s84, v4
    v_mul_f32 v192, v56, v192
    v_mul_f32 v193, v57, v193
    v_mul_f32 v194, v58, v194
    v_mul_f32 v195, v59, v195
    v_mul_f32 v196, v60, v196
    v_mul_f32 v197, v61, v197
    v_mul_f32 v198, v62, v198
    v_mul_f32 v199, v63, v199
    v_exp_f32 v192, v192
    v_exp_f32 v193, v193
    v_exp_f32 v194, v194
    v_exp_f32 v195, v195
    v_exp_f32 v196, v196
    v_exp_f32 v197, v197
    v_exp_f32 v198, v198
    v_exp_f32 v199, v199
    v_add_f32 v192, 1.0, v192
    v_add_f32 v193, 1.0, v193
    v_add_f32 v194, 1.0, v194
    v_add_f32 v195, 1.0, v195
    v_add_f32 v196, 1.0, v196
    v_add_f32 v197, 1.0, v197
    v_add_f32 v198, 1.0, v198
    v_add_f32 v199, 1.0, v199
    v_rcp_f32 v192, v192
    v_rcp_f32 v193, v193
    v_rcp_f32 v194, v194
    v_rcp_f32 v195, v195
    v_rcp_f32 v196, v196
    v_rcp_f32 v197, v197
    v_rcp_f32 v198, v198
    v_rcp_f32 v199, v199
    v_mul_f32 v56, v56, v192
    v_mul_f32 v57, v57, v193
    v_mul_f32 v58, v58, v194
    v_mul_f32 v59, v59, v195
    v_mul_f32 v60, v60, v196
    v_mul_f32 v61, v61, v197
    v_mul_f32 v62, v62, v198
    v_mul_f32 v63, v63, v199
    v_cvt_pk_bf16_f32 v56, v56, v57
    v_cvt_pk_bf16_f32 v57, v58, v59
    v_cvt_pk_bf16_f32 v58, v60, v61
    v_cvt_pk_bf16_f32 v59, v62, v63
    buffer_store_dwordx4 v[56:59], v1, s[20:23], s56 offen offset:2048 sc1
kb_g2e2:
    s_lshl_b32 s56, s71, 10
    s_lshl_b32 s57, s69, 7
    s_add_u32 s56, s56, s57
    s_add_u32 s56, s56, 590848
    v_mov_b32 v2, 162824
    v_mov_b32 v3, 1
    s_waitcnt vmcnt(0)
    s_mov_b64 exec, 1
    ds_add_rtn_u32 v3, v2, v3
    v_mov_b32 v2, 0
    s_waitcnt lgkmcnt(0)
    v_cmp_eq_u32 vcc, 3, v3
    v_mov_b32 v3, s54
    s_cmp_lg_u32 vcc_lo, 0
    s_cselect_b32 s56, s56, 0x70000000
    buffer_store_dword v3, v2, s[20:23], s56 offen sc1
    s_mov_b64 exec, -1
    v_and_b32 v2, 31, v0
    s_lshl_b32 s56, s67, 5
    v_add_u32 v2, s56, v2
    s_add_u32 s56, s70, 1
    v_mov_b32 v4, 0x7fff0000
    v_subrev_u32 v6, s56, v2
    v_cmp_gt_u32 vcc, 2048, v6
    v_lshrrev_b32 v9, 5, v6
    v_mul_u32_u24 v9, 262144, v9
    v_and_b32 v6, 31, v6
    v_lshl_add_u32 v9, v6, 4, v9
    v_bfe_u32 v6, v0, 5, 1
    v_lshl_add_u32 v9, v6, 9, v9
    v_cndmask_b32 v9, v4, v9, vcc
    v_add_u32 v6, s56, v2
    v_cmp_gt_u32 vcc, 2048, v6
    v_lshrrev_b32 v10, 5, v6
    v_mul_u32_u24 v10, 262144, v10
    v_and_b32 v6, 31, v6
    v_lshl_add_u32 v10, v6, 4, v10
    v_bfe_u32 v6, v0, 5, 1
    v_lshl_add_u32 v10, v6, 9, v10
    v_cndmask_b32 v10, v4, v10, vcc
    s_mul_i32 s81, s70, 20480
    s_add_u32 s81, s81, 84008960
    s_add_u32 s83, s82, 83927040
    buffer_load_dwordx4 v[224:227], v1, s[20:23], s83 offen offset:0 sc1
    buffer_load_dwordx4 v[228:231], v1, s[20:23], s83 offen offset:1024 sc1
    buffer_load_dwordx4 v[232:235], v1, s[20:23], s83 offen offset:2048 sc1
    s_cmp_lg_u32 s3, 0
    s_cbranch_scc1 kb_pd2
    s_lshl_b32 s56, s71, 10
    s_add_u32 s56, s56, 589824
    s_mov_b32 s58, 0x7f7f7f
    s_cmp_eq_u32 s71, 0
    s_cselect_b32 s58, 0x7f7f00, s58
    s_cmp_eq_u32 s71, 31
    s_cselect_b32 s58, 0x7f7f, s58
    s_cmp_lt_u32 s34, 14
    s_cselect_b32 s58, s58, 0
    s_mov_b32 s59, 0
    v_lshlrev_b32 v2, 3, v1
    s_mov_b32 s57, 0
    s_mov_b64 exec, s[58:59]
    s_cbranch_execz kb_pe2
kb_pl2:
    buffer_load_dword v3, v2, s[16:19], s56 offen sc1
    s_add_u32 s57, s57, 1
    s_waitcnt vmcnt(0)
    v_cmp_ne_u32 vcc, s54, v3
    s_cbranch_vccz kb_pe2
    s_mov_b64 exec, vcc
    s_sleep 1
    s_cmp_lt_u32 s57, 0x40000
    s_cbranch_scc1 kb_pl2
kb_pe2:
    s_mov_b64 exec, -1
kb_pd2:
    s_barrier
    s_add_u32 s60, s81, 0
    buffer_load_dwordx4 v[128:131], v9, s[20:23], s60 offen offset:0 sc1
    buffer_load_dwordx4 v[132:135], v9, s[20:23], s60 offen offset:1024 sc1
    buffer_load_dwordx4 v[136:139], v9, s[20:23], s60 offen offset:2048 sc1
    buffer_load_dwordx4 v[140:143], v9, s[20:23], s60 offen offset:3072 sc1
    s_add_u32 s60, s81, 4096
    buffer_load_dwordx4 v[144:147], v9, s[20:23], s60 offen offset:0 sc1
    buffer_load_dwordx4 v[148:151], v9, s[20:23], s60 offen offset:1024 sc1
    buffer_load_dwordx4 v[152:155], v9, s[20:23], s60 offen offset:2048 sc1
    buffer_load_dwordx4 v[156:159], v9, s[20:23], s60 offen offset:3072 sc1
    s_add_u32 s60, s81, 8192
    buffer_load_dwordx4 v[160:163], v9, s[20:23], s60 offen offset:0 sc1
    buffer_load_dwordx4 v[164:167], v9, s[20:23], s60 offen offset:1024 sc1
    buffer_load_dwordx4 v[168:171], v10, s[20:23], s60 offen offset:2048 sc1
    buffer_load_dwordx4 v[172:175], v10, s[20:23], s60 offen offset:3072 sc1
    s_mul_i32 s59, s70, 12288
    v_add_u32 v6, s59, v1
    v_add_u32 v5, 24576, v6
    ds_read_b128 v[96:99], v5 offset:0
    ds_read_b128 v[100:103], v5 offset:1024
    ds_read_b128 v[104:107], v5 offset:2048
    ds_read_b128 v[108:111], v5 offset:3072
    ds_read_b128 v[112:115], v5 offset:4096
    ds_read_b128 v[116:119], v5 offset:5120
    ds_read_b128 v[120:123], v5 offset:6144
    s_waitcnt vmcnt(11)
    s_waitcnt lgkmcnt(5)
    v_mfma_f32_32x32x16_bf16 v[16:31], v[96:99], v[128:131], 0
    ds_read_b128 v[124:127], v5 offset:7168
    s_add_u32 s60, s81, 12288
    buffer_load_dwordx4 v[176:179], v10, s[20:23], s60 offen offset:0 sc1
    v_mfma_f32_32x32x16_bf16 v[32:47], v[100:103], v[128:131], 0
    ds_read_b128 v[96:99], v5 offset:8192
    buffer_load_dwordx4 v[180:183], v10, s[20:23], s60 offen offset:1024 sc1
    s_waitcnt lgkmcnt(5)
    v_mfma_f32_32x32x16_bf16 v[48:63], v[104:107], v[128:131], 0
    ds_read_b128 v[100:103], v5 offset:9216
    s_waitcnt vmcnt(12)
    v_mfma_f32_32x32x16_bf16 v[16:31], v[108:111], v[132:135], v[16:31]
    ds_read_b128 v[104:107], v5 offset:10240
    buffer_load_dwordx4 v[184:187], v10, s[20:23], s60 offen offset:2048 sc1
    s_waitcnt lgkmcnt(5)
    v_mfma_f32_32x32x16_bf16 v[32:47], v[112:115], v[132:135], v[32:47]
    ds_read_b128 v[108:111], v5 offset:11264
    v_add_u32 v5, 49152, v6
    buffer_load_dwordx4 v[188:191], v10, s[20:23], s60 offen offset:3072 sc1
    v_mfma_f32_32x32x16_bf16 v[48:63], v[116:119], v[132:135], v[48:63]
    ds_read_b128 v[112:115], v5 offset:0
    s_waitcnt vmcnt(13)
    s_waitcnt lgkmcnt(5)
    v_mfma_f32_32x32x16_bf16 v[16:31], v[120:123], v[136:139], v[16:31]
    ds_read_b128 v[116:119], v5 offset:1024
    s_add_u32 s60, s81, 16384
    buffer_load_dwordx4 v[192:195], v10, s[20:23], s60 offen offset:0 sc1
    v_mfma_f32_32x32x16_bf16 v[32:47], v[124:127], v[136:139], v[32:47]
    ds_read_b128 v[120:123], v5 offset:2048
    buffer_load_dwordx4 v[196:199], v10, s[20:23], s60 offen offset:1024 sc1
    s_waitcnt lgkmcnt(5)
    v_mfma_f32_32x32x16_bf16 v[48:63], v[96:99], v[136:139], v[48:63]
    ds_read_b128 v[124:127], v5 offset:3072
    s_waitcnt vmcnt(14)
    v_mfma_f32_32x32x16_bf16 v[16:31], v[100:103], v[140:143], v[16:31]
    ds_read_b128 v[96:99], v5 offset:4096
    buffer_load_dwordx4 v[200:203], v10, s[20:23], s60 offen offset:2048 sc1
    s_waitcnt lgkmcnt(5)
    v_mfma_f32_32x32x16_bf16 v[32:47], v[104:107], v[140:143], v[32:47]
    ds_read_b128 v[100:103], v5 offset:5120
    buffer_load_dwordx4 v[204:207], v10, s[20:23], s60 offen offset:3072 sc1
    v_mfma_f32_32x32x16_bf16 v[48:63], v[108:111], v[140:143], v[48:63]
    ds_read_b128 v[104:107], v5 offset:6144
    s_waitcnt vmcnt(15)
    s_waitcnt lgkmcnt(5)
    v_mfma_f32_32x32x16_bf16 v[16:31], v[112:115], v[144:147], v[16:31]
    ds_read_b128 v[108:111], v5 offset:7168
    v_mfma_f32_32x32x16_bf16 v[32:47], v[116:119], v[144:147], v[32:47]
    ds_read_b128 v[112:115], v5 offset:8192
    s_waitcnt lgkmcnt(5)
    v_mfma_f32_32x32x16_bf16 v[48:63], v[120:123], v[144:147], v[48:63]
    ds_read_b128 v[116:119], v5 offset:9216
    s_waitcnt vmcnt(14)
    v_mfma_f32_32x32x16_bf16 v[16:31], v[124:127], v[148:151], v[16:31]
    ds_read_b128 v[120:123], v5 offset:10240
    s_waitcnt lgkmcnt(5)
    v_mfma_f32_32x32x16_bf16 v[32:47], v[96:99], v[148:151], v[32:47]
    ds_read_b128 v[124:127], v5 offset:11264
    v_add_u32 v5, 73728, v6
    v_mfma_f32_32x32x16_bf16 v[48:63], v[100:103], v[148:151], v[48:63]
    ds_read_b128 v[96:99], v5 offset:0
    s_waitcnt vmcnt(13)
    s_waitcnt lgkmcnt(5)
    v_mfma_f32_32x32x16_bf16 v[16:31], v[104:107], v[152:155], v[16:31]
    ds_read_b128 v[100:103], v5 offset:1024
    v_mfma_f32_32x32x16_bf16 v[32:47], v[108:111], v[152:155], v[32:47]
    ds_read_b128 v[104:107], v5 offset:2048
    s_waitcnt lgkmcnt(5)
    v_mfma_f32_32x32x16_bf16 v[48:63], v[112:115], v[152:155], v[48:63]
    ds_read_b128 v[108:111], v5 offset:3072
    s_waitcnt vmcnt(12)
    v_mfma_f32_32x32x16_bf16 v[16:31], v[116:119], v[156:159], v[16:31]
    ds_read_b128 v[112:115], v5 offset:4096
    s_waitcnt lgkmcnt(5)
    v_mfma_f32_32x32x16_bf16 v[32:47], v[120:123], v[156:159], v[32:47]
    ds_read_b128 v[116:119], v5 offset:5120
    v_mfma_f32_32x32x16_bf16 v[48:63], v[124:127], v[156:159], v[48:63]
    ds_read_b128 v[120:123], v5 offset:6144
    s_waitcnt vmcnt(11)
    s_waitcnt lgkmcnt(5)
    v_mfma_f32_32x32x16_bf16 v[16:31], v[96:99], v[160:163], v[16:31]
    ds_read_b128 v[124:127], v5 offset:7168
    v_mfma_f32_32x32x16_bf16 v[32:47], v[100:103], v[160:163], v[32:47]
    ds_read_b128 v[96:99], v5 offset:8192
    s_waitcnt lgkmcnt(5)
    v_mfma_f32_32x32x16_bf16 v[48:63], v[104:107], v[160:163], v[48:63]
    ds_read_b128 v[100:103], v5 offset:9216
    s_waitcnt vmcnt(10)
    v_mfma_f32_32x32x16_bf16 v[16:31], v[108:111], v[164:167], v[16:31]
    ds_read_b128 v[104:107], v5 offset:10240
    s_waitcnt lgkmcnt(5)
    v_mfma_f32_32x32x16_bf16 v[32:47], v[112:115], v[164:167], v[32:47]
    ds_read_b128 v[108:111], v5 offset:11264
    v_add_u32 v5, 98304, v6
    v_mfma_f32_32x32x16_bf16 v[48:63], v[116:119], v[164:167], v[48:63]
    ds_read_b128 v[112:115], v5 offset:0
    s_waitcnt vmcnt(9)
    s_waitcnt lgkmcnt(5)
    v_mfma_f32_32x32x16_bf16 v[16:31], v[120:123], v[168:171], v[16:31]
    ds_read_b128 v[116:119], v5 offset:1024
    v_mfma_f32_32x32x16_bf16 v[32:47], v[124:127], v[168:171], v[32:47]
    ds_read_b128 v[120:123], v5 offset:2048
    s_waitcnt lgkmcnt(5)
    v_mfma_f32_32x32x16_bf16 v[48:63], v[96:99], v[168:171], v[48:63]
    ds_read_b128 v[124:127], v5 offset:3072
    s_waitcnt vmcnt(8)
    v_mfma_f32_32x32x16_bf16 v[16:31], v[100:103], v[172:175], v[16:31]
    ds_read_b128 v[96:99], v5 offset:4096
    s_waitcnt lgkmcnt(5)
    v_mfma_f32_32x32x16_bf16 v[32:47], v[104:107], v[172:175], v[32:47]
    ds_read_b128 v[100:103], v5 offset:5120
    v_mfma_f32_32x32x16_bf16 v[48:63], v[108:111], v[172:175], v[48:63]
    ds_read_b128 v[104:107], v5 offset:6144
    s_waitcnt vmcnt(7)
    s_waitcnt lgkmcnt(5)
    v_mfma_f32_32x32x16_bf16 v[16:31], v[112:115], v[176:179], v[16:31]
    ds_read_b128 v[108:111], v5 offset:7168
    v_mfma_f32_32x32x16_bf16 v[32:47], v[116:119], v[176:179], v[32:47]
    ds_read_b128 v[112:115], v5 offset:8192
    s_waitcnt lgkmcnt(5)
    v_mfma_f32_32x32x16_bf16 v[48:63], v[120:123], v[176:179], v[48:63]
    ds_read_b128 v[116:119], v5 offset:9216
    s_waitcnt vmcnt(6)
    v_mfma_f32_32x32x16_bf16 v[16:31], v[124:127], v[180:183], v[16:31]
    ds_read_b128 v[120:123], v5 offset:10240
    s_waitcnt lgkmcnt(5)
    v_mfma_f32_32x32x16_bf16 v[32:47], v[96:99], v[180:183], v[32:47]
    ds_read_b128 v[124:127], v5 offset:11264
    v_add_u32 v5, 122880, v6
    v_mfma_f32_32x32x16_bf16 v[48:63], v[100:103], v[180:183], v[48:63]
    ds_read_b128 v[96:99], v5 offset:0
    s_waitcnt vmcnt(5)
    s_waitcnt lgkmcnt(5)
    v_mfma_f32_32x32x16_bf16 v[16:31], v[104:107], v[184:187], v[16:31]
    ds_read_b128 v[100:103], v5 offset:1024
    v_mfma_f32_32x32x16_bf16 v[32:47], v[108:111], v[184:187], v[32:47]
    ds_read_b128 v[104:107], v5 offset:2048
    s_waitcnt lgkmcnt(5)
    v_mfma_f32_32x32x16_bf16 v[48:63], v[112:115], v[184:187], v[48:63]
    ds_read_b128 v[108:111], v5 offset:3072
    s_waitcnt vmcnt(4)
    v_mfma_f32_32x32x16_bf16 v[16:31], v[116:119], v[188:191], v[16:31]
    ds_read_b128 v[112:115], v5 offset:4096
    s_waitcnt lgkmcnt(5)
    v_mfma_f32_32x32x16_bf16 v[32:47], v[120:123], v[188:191], v[32:47]
    ds_read_b128 v[116:119], v5 offset:5120
    v_mfma_f32_32x32x16_bf16 v[48:63], v[124:127], v[188:191], v[48:63]
    ds_read_b128 v[120:123], v5 offset:6144
    s_barrier
    s_waitcnt vmcnt(3)
    s_waitcnt lgkmcnt(5)
    v_mfma_f32_32x32x16_bf16 v[16:31], v[96:99], v[192:195], v[16:31]
    ds_read_b128 v[124:127], v5 offset:7168
    v_mfma_f32_32x32x16_bf16 v[32:47], v[100:103], v[192:195], v[32:47]
    ds_read_b128 v[96:99], v5 offset:8192
    s_waitcnt lgkmcnt(5)
    v_mfma_f32_32x32x16_bf16 v[48:63], v[104:107], v[192:195], v[48:63]
    ds_read_b128 v[100:103], v5 offset:9216
    s_waitcnt vmcnt(2)
    v_mfma_f32_32x32x16_bf16 v[16:31], v[108:111], v[196:199], v[16:31]
    ds_read_b128 v[104:107], v5 offset:10240
    s_waitcnt lgkmcnt(5)
    v_mfma_f32_32x32x16_bf16 v[32:47], v[112:115], v[196:199], v[32:47]
    ds_read_b128 v[108:111], v5 offset:11264
    v_mfma_f32_32x32x16_bf16 v[48:63], v[116:119], v[196:199], v[48:63]
    s_waitcnt vmcnt(1)
    s_waitcnt lgkmcnt(4)
    v_mfma_f32_32x32x16_bf16 v[16:31], v[120:123], v[200:203], v[16:31]
    v_mfma_f32_32x32x16_bf16 v[32:47], v[124:127], v[200:203], v[32:47]
    s_waitcnt lgkmcnt(2)
    v_mfma_f32_32x32x16_bf16 v[48:63], v[96:99], v[200:203], v[48:63]
    s_waitcnt vmcnt(0)
    v_mfma_f32_32x32x16_bf16 v[16:31], v[100:103], v[204:207], v[16:31]
    s_waitcnt lgkmcnt(0)
    v_mfma_f32_32x32x16_bf16 v[32:47], v[104:107], v[204:207], v[32:47]
    v_mfma_f32_32x32x16_bf16 v[48:63], v[108:111], v[204:207], v[48:63]
    s_barrier
    s_mul_i32 s56, s3, 6144
    s_add_u32 s56, s56, 122880
    v_add_u32 v3, s56, v1
    s_xor_b32 s56, s3, 2
    s_mul_i32 s56, s56, 6144
    s_add_u32 s56, s56, 122880
    v_add_u32 v5, s56, v1
    v_mov_b32 v4, 0xc0135761
    s_nop 1
    s_cmp_eq_u32 s70, 1
    s_cbranch_scc1 kb_g3e1
    ds_write_b128 v3, v[40:43] offset:0
    ds_write_b128 v3, v[44:47] offset:1024
    ds_write_b128 v3, v[48:51] offset:2048
    ds_write_b128 v3, v[52:55] offset:3072
    ds_write_b128 v3, v[56:59] offset:4096
    ds_write_b128 v3, v[60:63] offset:5120
    s_waitcnt lgkmcnt(0)
    s_barrier
    ds_read_b128 v[96:99], v5 offset:0
    ds_read_b128 v[100:103], v5 offset:1024
    ds_read_b128 v[104:107], v5 offset:2048
    ds_read_b128 v[108:111], v5 offset:3072
    ds_read_b128 v[112:115], v5 offset:4096
    ds_read_b128 v[116:119], v5 offset:5120
    s_waitcnt lgkmcnt(5)
    v_add_f32 v16, v16, v96
    v_add_f32 v17, v17, v97
    v_add_f32 v18, v18, v98
    v_add_f32 v19, v19, v99
    s_waitcnt lgkmcnt(4)
    v_add_f32 v20, v20, v100
    v_add_f32 v21, v21, v101
    v_add_f32 v22, v22, v102
    v_add_f32 v23, v23, v103
    s_waitcnt lgkmcnt(3)
    v_add_f32 v24, v24, v104
    v_add_f32 v25, v25, v105
    v_add_f32 v26, v26, v106
    v_add_f32 v27, v27, v107
    s_waitcnt lgkmcnt(2)
    v_add_f32 v28, v28, v108
    v_add_f32 v29, v29, v109
    v_add_f32 v30, v30, v110
    v_add_f32 v31, v31, v111
    s_waitcnt lgkmcnt(1)
    v_add_f32 v32, v32, v112
    v_add_f32 v33, v33, v113
    v_add_f32 v34, v34, v114
    v_add_f32 v35, v35, v115
    s_waitcnt lgkmcnt(0)
    v_add_f32 v36, v36, v116
    v_add_f32 v37, v37, v117
    v_add_f32 v38, v38, v118
    v_add_f32 v39, v39, v119
    v_lshlrev_b32 v192, 16, v224
    v_and_b32 v193, 0xffff0000, v224
    v_lshlrev_b32 v194, 16, v225
    v_and_b32 v195, 0xffff0000, v225
    v_lshlrev_b32 v196, 16, v226
    v_and_b32 v197, 0xffff0000, v226
    v_lshlrev_b32 v198, 16, v227
    v_and_b32 v199, 0xffff0000, v227
    v_lshlrev_b32 v200, 16, v228
    v_and_b32 v201, 0xffff0000, v228
    v_lshlrev_b32 v202, 16, v229
    v_and_b32 v203, 0xffff0000, v229
    v_lshlrev_b32 v204, 16, v230
    v_and_b32 v205, 0xffff0000, v230
    v_lshlrev_b32 v206, 16, v231
    v_and_b32 v207, 0xffff0000, v231
    v_lshlrev_b32 v208, 16, v232
    v_and_b32 v209, 0xffff0000, v232
    v_lshlrev_b32 v210, 16, v233
    v_and_b32 v211, 0xffff0000, v233
    v_lshlrev_b32 v212, 16, v234
    v_and_b32 v213, 0xffff0000, v234
    v_lshlrev_b32 v214, 16, v235
    v_and_b32 v215, 0xffff0000, v235
    v_add_f32 v16, v16, v192
    v_add_f32 v17, v17, v193
    v_add_f32 v18, v18, v194
    v_add_f32 v19, v19, v195
    v_add_f32 v20, v20, v196
    v_add_f32 v21, v21, v197
    v_add_f32 v22, v22, v198
    v_add_f32 v23, v23, v199
    v_add_f32 v24, v24, v200
    v_add_f32 v25, v25, v201
    v_add_f32 v26, v26, v202
    v_add_f32 v27, v27, v203
    v_add_f32 v28, v28, v204
    v_add_f32 v29, v29, v205
    v_add_f32 v30, v30, v206
    v_add_f32 v31, v31, v207
    v_add_f32 v32, v32, v208
    v_add_f32 v33, v33, v209
    v_add_f32 v34, v34, v210
    v_add_f32 v35, v35, v211
    v_add_f32 v36, v36, v212
    v_add_f32 v37, v37, v213
    v_add_f32 v38, v38, v214
    v_add_f32 v39, v39, v215
    s_add_u32 s56, s82, 84049920
    v_cvt_pk_bf16_f32 v128, v16, v17
    v_cvt_pk_bf16_f32 v129, v18, v19
    v_cvt_pk_bf16_f32 v130, v20, v21
    v_cvt_pk_bf16_f32 v131, v22, v23
    buffer_store_dwordx4 v[128:131], v1, s[20:23], s56 offen offset:0 sc1
    v_cvt_pk_bf16_f32 v132, v24, v25
    v_cvt_pk_bf16_f32 v133, v26, v27
    v_cvt_pk_bf16_f32 v134, v28, v29
    v_cvt_pk_bf16_f32 v135, v30, v31
    buffer_store_dwordx4 v[132:135], v1, s[20:23], s56 offen offset:1024 sc1
    v_cvt_pk_bf16_f32 v136, v32, v33
    v_cvt_pk_bf16_f32 v137, v34, v35
    v_cvt_pk_bf16_f32 v138, v36, v37
    v_cvt_pk_bf16_f32 v139, v38, v39
    buffer_store_dwordx4 v[136:139], v1, s[20:23], s56 offen offset:2048 sc1
    v_lshlrev_b32 v192, 16, v128
    v_and_b32 v193, 0xffff0000, v128
    v_lshlrev_b32 v194, 16, v129
    v_and_b32 v195, 0xffff0000, v129
    v_lshlrev_b32 v196, 16, v130
    v_and_b32 v197, 0xffff0000, v130
    v_lshlrev_b32 v198, 16, v131
    v_and_b32 v199, 0xffff0000, v131
    v_lshlrev_b32 v200, 16, v132
    v_and_b32 v201, 0xffff0000, v132
    v_lshlrev_b32 v202, 16, v133
    v_and_b32 v203, 0xffff0000, v133
    v_lshlrev_b32 v204, 16, v134
    v_and_b32 v205, 0xffff0000, v134
    v_lshlrev_b32 v206, 16, v135
    v_and_b32 v207, 0xffff0000, v135
    v_lshlrev_b32 v208, 16, v136
    v_and_b32 v209, 0xffff0000, v136
    v_lshlrev_b32 v210, 16, v137
    v_and_b32 v211, 0xffff0000, v137
    v_lshlrev_b32 v212, 16, v138
    v_and_b32 v213, 0xffff0000, v138
    v_lshlrev_b32 v214, 16, v139
    v_and_b32 v215, 0xffff0000, v139
    v_mov_b32 v216, v208
    v_mul_f32 v217, v208, v208
    v_add_f32 v216, v216, v209
    v_fmac_f32 v217, v209, v209
    v_add_f32 v216, v216, v210
    v_fmac_f32 v217, v210, v210
    v_add_f32 v216, v216, v211
    v_fmac_f32 v217, v211, v211
    v_add_f32 v216, v216, v212
    v_fmac_f32 v217, v212, v212
    v_add_f32 v216, v216, v213
    v_fmac_f32 v217, v213, v213
    v_add_f32 v216, v216, v214
    v_fmac_f32 v217, v214, v214
    v_add_f32 v216, v216, v215
    v_fmac_f32 v217, v215, v215
    v_mov_b32 v218, v192
    v_mul_f32 v219, v192, v192
    v_add_f32 v218, v218, v193
    v_fmac_f32 v219, v193, v193
    v_add_f32 v218, v218, v194
    v_fmac_f32 v219, v194, v194
    v_add_f32 v218, v218, v195
    v_fmac_f32 v219, v195, v195
    v_add_f32 v218, v218, v196
    v_fmac_f32 v219, v196, v196
    v_add_f32 v218, v218, v197
    v_fmac_f32 v219, v197, v197
    v_add_f32 v218, v218, v198
    v_fmac_f32 v219, v198, v198
    v_add_f32 v218, v218, v199
    v_fmac_f32 v219, v199, v199
    v_add_f32 v218, v218, v200
    v_fmac_f32 v219, v200, v200
    v_add_f32 v218, v218, v201
    v_fmac_f32 v219, v201, v201
    v_add_f32 v218, v218, v202
    v_fmac_f32 v219, v202, v202
    v_add_f32 v218, v218, v203
    v_fmac_f32 v219, v203, v203
    v_add_f32 v218, v218, v204
    v_fmac_f32 v219, v204, v204
    v_add_f32 v218, v218, v205
    v_fmac_f32 v219, v205, v205
    v_add_f32 v218, v218, v206
    v_fmac_f32 v219, v206, v206
    v_add_f32 v218, v218, v207
    v_fmac_f32 v219, v207, v207
    s_cmp_eq_u32 s69, 6
    s_cselect_b32 s57, 0, 1.0
    v_fmac_f32 v216, s57, v218
    v_fmac_f32 v217, s57, v219
    v_mov_b32 v218, v216
    s_nop 1
    v_permlane32_swap_b32 v216, v218
    v_add_f32 v216, v216, v218
    v_mov_b32 v218, v217
    s_nop 1
    v_permlane32_swap_b32 v217, v218
    v_add_f32 v217, v217, v218
    v_lshrrev_b32 v2, 1, v1
    s_lshl_b32 s56, s69, 15
    s_lshl_b32 s57, s67, 8
    s_add_u32 s56, s56, s57
    s_add_u32 s56, s56, 65536
    s_mov_b32 exec_hi, 0
    buffer_store_dwordx2 v[216:217], v2, s[20:23], s56 offen sc1
    s_mov_b32 exec_hi, -1
    s_branch kb_g3e2
kb_g3e1:
    ds_write_b128 v3, v[16:19] offset:0
    ds_write_b128 v3, v[20:23] offset:1024
    ds_write_b128 v3, v[24:27] offset:2048
    ds_write_b128 v3, v[28:31] offset:3072
    ds_write_b128 v3, v[32:35] offset:4096
    ds_write_b128 v3, v[36:39] offset:5120
    s_waitcnt lgkmcnt(0)
    s_barrier
    ds_read_b128 v[96:99], v5 offset:0
    ds_read_b128 v[100:103], v5 offset:1024
    ds_read_b128 v[104:107], v5 offset:2048
    ds_read_b128 v[108:111], v5 offset:3072
    ds_read_b128 v[112:115], v5 offset:4096
    ds_read_b128 v[116:119], v5 offset:5120
    s_waitcnt lgkmcnt(5)
    v_add_f32 v40, v40, v96
    v_add_f32 v41, v41, v97
    v_add_f32 v42, v42, v98
    v_add_f32 v43, v43, v99
    s_waitcnt lgkmcnt(4)
    v_add_f32 v44, v44, v100
    v_add_f32 v45, v45, v101
    v_add_f32 v46, v46, v102
    v_add_f32 v47, v47, v103
    s_waitcnt lgkmcnt(3)
    v_add_f32 v48, v48, v104
    v_add_f32 v49, v49, v105
    v_add_f32 v50, v50, v106
    v_add_f32 v51, v51, v107
    s_waitcnt lgkmcnt(2)
    v_add_f32 v52, v52, v108
    v_add_f32 v53, v53, v109
    v_add_f32 v54, v54, v110
    v_add_f32 v55, v55, v111
    s_waitcnt lgkmcnt(1)
    v_add_f32 v56, v56, v112
    v_add_f32 v57, v57, v113
    v_add_f32 v58, v58, v114
    v_add_f32 v59, v59, v115
    s_waitcnt lgkmcnt(0)
    v_add_f32 v60, v60, v116
    v_add_f32 v61, v61, v117
    v_add_f32 v62, v62, v118
    v_add_f32 v63, v63, v119
    v_lshlrev_b32 v192, 16, v224
    v_and_b32 v193, 0xffff0000, v224
    v_lshlrev_b32 v194, 16, v225
    v_and_b32 v195, 0xffff0000, v225
    v_lshlrev_b32 v196, 16, v226
    v_and_b32 v197, 0xffff0000, v226
    v_lshlrev_b32 v198, 16, v227
    v_and_b32 v199, 0xffff0000, v227
    v_lshlrev_b32 v200, 16, v228
    v_and_b32 v201, 0xffff0000, v228
    v_lshlrev_b32 v202, 16, v229
    v_and_b32 v203, 0xffff0000, v229
    v_lshlrev_b32 v204, 16, v230
    v_and_b32 v205, 0xffff0000, v230
    v_lshlrev_b32 v206, 16, v231
    v_and_b32 v207, 0xffff0000, v231
    v_lshlrev_b32 v208, 16, v232
    v_and_b32 v209, 0xffff0000, v232
    v_lshlrev_b32 v210, 16, v233
    v_and_b32 v211, 0xffff0000, v233
    v_lshlrev_b32 v212, 16, v234
    v_and_b32 v213, 0xffff0000, v234
    v_lshlrev_b32 v214, 16, v235
    v_and_b32 v215, 0xffff0000, v235
    v_add_f32 v40, v40, v192
    v_add_f32 v41, v41, v193
    v_add_f32 v42, v42, v194
    v_add_f32 v43, v43, v195
    v_add_f32 v44, v44, v196
    v_add_f32 v45, v45, v197
    v_add_f32 v46, v46, v198
    v_add_f32 v47, v47, v199
    v_add_f32 v48, v48, v200
    v_add_f32 v49, v49, v201
    v_add_f32 v50, v50, v202
    v_add_f32 v51, v51, v203
    v_add_f32 v52, v52, v204
    v_add_f32 v53, v53, v205
    v_add_f32 v54, v54, v206
    v_add_f32 v55, v55, v207
    v_add_f32 v56, v56, v208
    v_add_f32 v57, v57, v209
    v_add_f32 v58, v58, v210
    v_add_f32 v59, v59, v211
    v_add_f32 v60, v60, v212
    v_add_f32 v61, v61, v213
    v_add_f32 v62, v62, v214
    v_add_f32 v63, v63, v215
    s_add_u32 s56, s82, 84049920
    v_cvt_pk_bf16_f32 v128, v40, v41
    v_cvt_pk_bf16_f32 v129, v42, v43
    v_cvt_pk_bf16_f32 v130, v44, v45
    v_cvt_pk_bf16_f32 v131, v46, v47
    buffer_store_dwordx4 v[128:131], v1, s[20:23], s56 offen offset:0 sc1
    v_cvt_pk_bf16_f32 v132, v48, v49
    v_cvt_pk_bf16_f32 v133, v50, v51
    v_cvt_pk_bf16_f32 v134, v52, v53
    v_cvt_pk_bf16_f32 v135, v54, v55
    buffer_store_dwordx4 v[132:135], v1, s[20:23], s56 offen offset:1024 sc1
    v_cvt_pk_bf16_f32 v136, v56, v57
    v_cvt_pk_bf16_f32 v137, v58, v59
    v_cvt_pk_bf16_f32 v138, v60, v61
    v_cvt_pk_bf16_f32 v139, v62, v63
    buffer_store_dwordx4 v[136:139], v1, s[20:23], s56 offen offset:2048 sc1
    v_lshlrev_b32 v192, 16, v128
    v_and_b32 v193, 0xffff0000, v128
    v_lshlrev_b32 v194, 16, v129
    v_and_b32 v195, 0xffff0000, v129
    v_lshlrev_b32 v196, 16, v130
    v_and_b32 v197, 0xffff0000, v130
    v_lshlrev_b32 v198, 16, v131
    v_and_b32 v199, 0xffff0000, v131
    v_lshlrev_b32 v200, 16, v132
    v_and_b32 v201, 0xffff0000, v132
    v_lshlrev_b32 v202, 16, v133
    v_and_b32 v203, 0xffff0000, v133
    v_lshlrev_b32 v204, 16, v134
    v_and_b32 v205, 0xffff0000, v134
    v_lshlrev_b32 v206, 16, v135
    v_and_b32 v207, 0xffff0000, v135
    v_lshlrev_b32 v208, 16, v136
    v_and_b32 v209, 0xffff0000, v136
    v_lshlrev_b32 v210, 16, v137
    v_and_b32 v211, 0xffff0000, v137
    v_lshlrev_b32 v212, 16, v138
    v_and_b32 v213, 0xffff0000, v138
    v_lshlrev_b32 v214, 16, v139
    v_and_b32 v215, 0xffff0000, v139
    v_mov_b32 v216, v192
    v_mul_f32 v217, v192, v192
    v_add_f32 v216, v216, v193
    v_fmac_f32 v217, v193, v193
    v_add_f32 v216, v216, v194
    v_fmac_f32 v217, v194, v194
    v_add_f32 v216, v216, v195
    v_fmac_f32 v217, v195, v195
    v_add_f32 v216, v216, v196
    v_fmac_f32 v217, v196, v196
    v_add_f32 v216, v216, v197
    v_fmac_f32 v217, v197, v197
    v_add_f32 v216, v216, v198
    v_fmac_f32 v217, v198, v198
    v_add_f32 v216, v216, v199
    v_fmac_f32 v217, v199, v199
    v_add_f32 v216, v216, v200
    v_fmac_f32 v217, v200, v200
    v_add_f32 v216, v216, v201
    v_fmac_f32 v217, v201, v201
    v_add_f32 v216, v216, v202
    v_fmac_f32 v217, v202, v202
    v_add_f32 v216, v216, v203
    v_fmac_f32 v217, v203, v203
    v_add_f32 v216, v216, v204
    v_fmac_f32 v217, v204, v204
    v_add_f32 v216, v216, v205
    v_fmac_f32 v217, v205, v205
    v_add_f32 v216, v216, v206
    v_fmac_f32 v217, v206, v206
    v_add_f32 v216, v216, v207
    v_fmac_f32 v217, v207, v207
    v_add_f32 v216, v216, v208
    v_fmac_f32 v217, v208, v208
    v_add_f32 v216, v216, v209
    v_fmac_f32 v217, v209, v209
    v_add_f32 v216, v216, v210
    v_fmac_f32 v217, v210, v210
    v_add_f32 v216, v216, v211
    v_fmac_f32 v217, v211, v211
    v_add_f32 v216, v216, v212
    v_fmac_f32 v217, v212, v212
    v_add_f32 v216, v216, v213
    v_fmac_f32 v217, v213, v213
    v_add_f32 v216, v216, v214
    v_fmac_f32 v217, v214, v214
    v_add_f32 v216, v216, v215
    v_fmac_f32 v217, v215, v215
    v_mov_b32 v218, v216
    s_nop 1
    v_permlane32_swap_b32 v216, v218
    v_add_f32 v216, v216, v218
    v_mov_b32 v218, v217
    s_nop 1
    v_permlane32_swap_b32 v217, v218
    v_add_f32 v217, v217, v218
    v_lshrrev_b32 v2, 1, v1
    s_lshl_b32 s56, s69, 15
    s_lshl_b32 s57, s67, 8
    s_add_u32 s56, s56, s57
    s_add_u32 s56, s56, 81920
    s_mov_b32 exec_hi, 0
    buffer_store_dwordx2 v[216:217], v2, s[20:23], s56 offen sc1
    s_mov_b32 exec_hi, -1
kb_g3e2:
    s_lshl_b32 s56, s71, 10
    s_lshl_b32 s57, s69, 7
    s_add_u32 s56, s56, s57
    s_add_u32 s56, s56, 626688
    v_mov_b32 v2, 162828
    v_mov_b32 v3, 1
    s_waitcnt vmcnt(0)
    s_mov_b64 exec, 1
    ds_add_rtn_u32 v3, v2, v3
    v_mov_b32 v2, 0
    s_waitcnt lgkmcnt(0)
    v_cmp_eq_u32 vcc, 3, v3
    v_mov_b32 v3, s54
    s_cmp_lg_u32 vcc_lo, 0
    s_cselect_b32 s56, s56, 0x70000000
    buffer_store_dword v3, v2, s[20:23], s56 offen sc1
    s_mov_b64 exec, -1
    s_mul_i32 s81, s72, 262144
    s_add_u32 s81, s81, 84049920
    v_bfe_u32 v6, v0, 5, 1
    v_lshlrev_b32 v6, 4, v6
    s_lshl_b32 s57, s85, 7
    s_add_u32 s57, s57, 20480
    buffer_load_dwordx4 v[208:211], v6, s[20:23], s57 offen offset:0 sc1
    buffer_load_dwordx4 v[212:215], v6, s[20:23], s57 offen offset:32 sc1
    buffer_load_dwordx4 v[216:219], v6, s[20:23], s57 offen offset:64 sc1
    buffer_load_dwordx4 v[220:223], v6, s[20:23], s57 offen offset:96 sc1
    buffer_load_dwordx4 v[224:227], v6, s[20:23], s57 offen offset:256 sc1
    buffer_load_dwordx4 v[228:231], v6, s[20:23], s57 offen offset:288 sc1
    buffer_load_dwordx4 v[232:235], v6, s[20:23], s57 offen offset:320 sc1
    buffer_load_dwordx4 v[236:239], v6, s[20:23], s57 offen offset:352 sc1
    s_lshl_b32 s56, s91, 1
    s_add_u32 s56, s56, 0
    s_mul_i32 s58, s72, 262144
    s_add_u32 s58, s58, 100663296
    s_cmp_ge_u32 s56, 14
    s_cselect_b32 s57, 26624, 0
    s_lshl_b32 s93, s56, 11
    s_add_u32 s93, s93, s57
    s_add_u32 s93, s93, s58
    s_min_u32 s56, s56, 24
    s_cmp_ge_u32 s56, 13
    s_cselect_b32 s57, 28672, 0
    s_lshl_b32 s94, s56, 11
    s_add_u32 s94, s94, s57
    s_add_u32 s94, s94, s58
    s_add_u32 s94, s94, 28672
    s_cmp_eq_u32 s91, 12
    s_cselect_b32 s94, 0x70000000, s94
    v_add_u32 v6, 0, v1
    v_add_u32 v5, 0, v6
    s_lshl_b32 s56, s55, 12
    v_add_u32 v9, s56, v1
    v_add_u32 v10, 139264, v9
    v_add_u32 v9, 122880, v9
    v_mov_b32 v4, 0xc0135761
    s_cmp_lg_u32 s3, 0
    s_cbranch_scc1 kb_pd3
    s_lshl_b32 s56, s90, 11
    s_add_u32 s56, s56, 626688
    s_cmp_lt_u32 s34, 14
    s_cselect_b32 s58, 0x7f7f, 0
    s_mov_b32 s59, 0
    v_lshlrev_b32 v2, 3, v1
    s_mov_b32 s57, 0
    s_mov_b64 exec, s[58:59]
    s_cbranch_execz kb_pe3
kb_pl3:
    buffer_load_dword v3, v2, s[16:19], s56 offen sc1
    s_add_u32 s57, s57, 1
    s_waitcnt vmcnt(0)
    v_cmp_ne_u32 vcc, s54, v3
    s_cbranch_vccz kb_pe3
    s_mov_b64 exec, vcc
    s_sleep 1
    s_cmp_lt_u32 s57, 0x40000
    s_cbranch_scc1 kb_pl3
kb_pe3:
    s_mov_b64 exec, -1
kb_pd3:
    s_barrier
    s_add_u32 s60, s81, 0
    buffer_load_dwordx4 v[128:131], v1, s[20:23], s60 offen offset:0 sc1
    buffer_load_dwordx4 v[132:135], v1, s[20:23], s60 offen offset:1024 sc1
    buffer_load_dwordx4 v[136:139], v1, s[20:23], s60 offen offset:2048 sc1
    buffer_load_dwordx4 v[140:143], v1, s[20:23], s60 offen offset:3072 sc1
    s_add_u32 s60, s81, 4096
    buffer_load_dwordx4 v[144:147], v1, s[20:23], s60 offen offset:0 sc1
    buffer_load_dwordx4 v[148:151], v1, s[20:23], s60 offen offset:1024 sc1
    buffer_load_dwordx4 v[152:155], v1, s[20:23], s60 offen offset:2048 sc1
    buffer_load_dwordx4 v[156:159], v1, s[20:23], s60 offen offset:3072 sc1
    ds_read_b128 v[96:99], v5 offset:0
    ds_read_b128 v[100:103], v5 offset:1024
    ds_read_b128 v[104:107], v5 offset:2048
    ds_read_b128 v[108:111], v5 offset:3072
    ds_read_b128 v[112:115], v5 offset:4096
    ds_read_b128 v[116:119], v5 offset:5120
    ds_read_b128 v[120:123], v5 offset:6144
    s_waitcnt vmcnt(7)
    s_waitcnt lgkmcnt(5)
    v_mfma_f32_32x32x16_bf16 v[16:31], v[96:99], v[128:131], 0
    ds_read_b128 v[124:127], v5 offset:7168
    s_add_u32 s60, s81, 8192
    buffer_load_dwordx4 v[160:163], v1, s[20:23], s60 offen offset:0 sc1
    v_mfma_f32_32x32x16_bf16 v[32:47], v[100:103], v[128:131], 0
    ds_read_b128 v[96:99], v5 offset:8192
    buffer_load_dwordx4 v[164:167], v1, s[20:23], s60 offen offset:1024 sc1
    s_waitcnt vmcnt(8)
    s_waitcnt lgkmcnt(5)
    v_mfma_f32_32x32x16_bf16 v[16:31], v[104:107], v[132:135], v[16:31]
    ds_read_b128 v[100:103], v5 offset:9216
    buffer_load_dwordx4 v[168:171], v1, s[20:23], s60 offen offset:2048 sc1
    v_mfma_f32_32x32x16_bf16 v[32:47], v[108:111], v[132:135], v[32:47]
    ds_read_b128 v[104:107], v5 offset:10240
    buffer_load_dwordx4 v[172:175], v1, s[20:23], s60 offen offset:3072 sc1
    s_waitcnt vmcnt(9)
    s_waitcnt lgkmcnt(5)
    v_mfma_f32_32x32x16_bf16 v[16:31], v[112:115], v[136:139], v[16:31]
    ds_read_b128 v[108:111], v5 offset:11264
    s_add_u32 s60, s81, 12288
    buffer_load_dwordx4 v[176:179], v1, s[20:23], s60 offen offset:0 sc1
    v_mfma_f32_32x32x16_bf16 v[32:47], v[116:119], v[136:139], v[32:47]
    ds_read_b128 v[112:115], v5 offset:12288
    buffer_load_dwordx4 v[180:183], v1, s[20:23], s60 offen offset:1024 sc1
    s_waitcnt vmcnt(10)
    s_waitcnt lgkmcnt(5)
    v_mfma_f32_32x32x16_bf16 v[16:31], v[120:123], v[140:143], v[16:31]
    ds_read_b128 v[116:119], v5 offset:13312
    buffer_load_dwordx4 v[184:187], v1, s[20:23], s60 offen offset:2048 sc1
    v_mfma_f32_32x32x16_bf16 v[32:47], v[124:127], v[140:143], v[32:47]
    ds_read_b128 v[120:123], v5 offset:14336
    buffer_load_dwordx4 v[188:191], v1, s[20:23], s60 offen offset:3072 sc1
    s_waitcnt vmcnt(11)
    s_waitcnt lgkmcnt(5)
    v_mfma_f32_32x32x16_bf16 v[16:31], v[96:99], v[144:147], v[16:31]
    ds_read_b128 v[124:127], v5 offset:15360
    s_add_u32 s60, s81, 16384
    buffer_load_dwordx4 v[192:195], v1, s[20:23], s60 offen offset:0 sc1
    v_mfma_f32_32x32x16_bf16 v[32:47], v[100:103], v[144:147], v[32:47]
    ds_read_b128 v[96:99], v5 offset:16384
    buffer_load_dwordx4 v[196:199], v1, s[20:23], s60 offen offset:1024 sc1
    s_waitcnt vmcnt(12)
    s_waitcnt lgkmcnt(5)
    v_mfma_f32_32x32x16_bf16 v[16:31], v[104:107], v[148:151], v[16:31]
    ds_read_b128 v[100:103], v5 offset:17408
    buffer_load_dwordx4 v[200:203], v1, s[20:23], s60 offen offset:2048 sc1
    v_mfma_f32_32x32x16_bf16 v[32:47], v[108:111], v[148:151], v[32:47]
    ds_read_b128 v[104:107], v5 offset:18432
    buffer_load_dwordx4 v[204:207], v1, s[20:23], s60 offen offset:3072 sc1
    s_waitcnt vmcnt(13)
    s_waitcnt lgkmcnt(5)
    v_mfma_f32_32x32x16_bf16 v[16:31], v[112:115], v[152:155], v[16:31]
    ds_read_b128 v[108:111], v5 offset:19456
    v_add_u32 v5, 40960, v6
    v_and_b32 v2, 31, v0
    v_lshlrev_b32 v2, 3, v2
    v_bfe_u32 v3, v0, 5, 1
    v_lshl_add_u32 v2, v3, 14, v2
    s_lshl_b32 s56, s72, 8
    s_add_u32 s56, s56, 65536
    v_mfma_f32_32x32x16_bf16 v[32:47], v[116:119], v[152:155], v[32:47]
    ds_read_b128 v[112:115], v5 offset:0
    buffer_load_dwordx2 v[80:81], v2, s[20:23], s56 offen sc1
    s_add_u32 s56, s56, 32768
    s_waitcnt vmcnt(13)
    s_waitcnt lgkmcnt(5)
    v_mfma_f32_32x32x16_bf16 v[16:31], v[120:123], v[156:159], v[16:31]
    ds_read_b128 v[116:119], v5 offset:1024
    buffer_load_dwordx2 v[82:83], v2, s[20:23], s56 offen sc1
    s_add_u32 s56, s56, 32768
    v_mfma_f32_32x32x16_bf16 v[32:47], v[124:127], v[156:159], v[32:47]
    ds_read_b128 v[120:123], v5 offset:2048
    buffer_load_dwordx2 v[84:85], v2, s[20:23], s56 offen sc1
    s_add_u32 s56, s56, 32768
    s_waitcnt vmcnt(14)
    s_waitcnt lgkmcnt(5)
    v_mfma_f32_32x32x16_bf16 v[16:31], v[96:99], v[160:163], v[16:31]
    ds_read_b128 v[124:127], v5 offset:3072
    buffer_load_dwordx2 v[86:87], v2, s[20:23], s56 offen sc1
    s_add_u32 s56, s56, 32768
    v_mfma_f32_32x32x16_bf16 v[32:47], v[100:103], v[160:163], v[32:47]
    ds_read_b128 v[96:99], v5 offset:4096
    buffer_load_dwordx2 v[88:89], v2, s[20:23], s56 offen sc1
    s_add_u32 s56, s56, 32768
    s_waitcnt vmcnt(15)
    s_waitcnt lgkmcnt(5)
    v_mfma_f32_32x32x16_bf16 v[16:31], v[104:107], v[164:167], v[16:31]
    ds_read_b128 v[100:103], v5 offset:5120
    buffer_load_dwordx2 v[90:91], v2, s[20:23], s56 offen sc1
    s_add_u32 s56, s56, 32768
    v_mfma_f32_32x32x16_bf16 v[32:47], v[108:111], v[164:167], v[32:47]
    ds_read_b128 v[104:107], v5 offset:6144
    buffer_load_dwordx2 v[92:93], v2, s[20:23], s56 offen sc1
    s_add_u32 s56, s56, 32768
    s_barrier
    s_waitcnt vmcnt(16)
    s_waitcnt lgkmcnt(5)
    v_mfma_f32_32x32x16_bf16 v[16:31], v[112:115], v[168:171], v[16:31]
    ds_read_b128 v[108:111], v5 offset:7168
    v_mfma_f32_32x32x16_bf16 v[32:47], v[116:119], v[168:171], v[32:47]
    ds_read_b128 v[112:115], v5 offset:8192
    s_waitcnt vmcnt(15)
    s_waitcnt lgkmcnt(5)
    v_mfma_f32_32x32x16_bf16 v[16:31], v[120:123], v[172:175], v[16:31]
    ds_read_b128 v[116:119], v5 offset:9216
    v_mfma_f32_32x32x16_bf16 v[32:47], v[124:127], v[172:175], v[32:47]
    ds_read_b128 v[120:123], v5 offset:10240
    s_waitcnt vmcnt(14)
    s_waitcnt lgkmcnt(5)
    v_mfma_f32_32x32x16_bf16 v[16:31], v[96:99], v[176:179], v[16:31]
    ds_read_b128 v[124:127], v5 offset:11264
    v_mfma_f32_32x32x16_bf16 v[32:47], v[100:103], v[176:179], v[32:47]
    ds_read_b128 v[96:99], v5 offset:12288
    s_waitcnt vmcnt(13)
    s_waitcnt lgkmcnt(5)
    v_mfma_f32_32x32x16_bf16 v[16:31], v[104:107], v[180:183], v[16:31]
    ds_read_b128 v[100:103], v5 offset:13312
    v_mfma_f32_32x32x16_bf16 v[32:47], v[108:111], v[180:183], v[32:47]
    ds_read_b128 v[104:107], v5 offset:14336
    s_waitcnt vmcnt(12)
    s_waitcnt lgkmcnt(5)
    v_mfma_f32_32x32x16_bf16 v[16:31], v[112:115], v[184:187], v[16:31]
    ds_read_b128 v[108:111], v5 offset:15360
    v_mfma_f32_32x32x16_bf16 v[32:47], v[116:119], v[184:187], v[32:47]
    ds_read_b128 v[112:115], v5 offset:16384
    s_waitcnt vmcnt(11)
    s_waitcnt lgkmcnt(5)
    v_mfma_f32_32x32x16_bf16 v[16:31], v[120:123], v[188:191], v[16:31]
    ds_read_b128 v[116:119], v5 offset:17408
    v_mfma_f32_32x32x16_bf16 v[32:47], v[124:127], v[188:191], v[32:47]
    ds_read_b128 v[120:123], v5 offset:18432
    s_waitcnt vmcnt(10)
    s_waitcnt lgkmcnt(5)
    v_mfma_f32_32x32x16_bf16 v[16:31], v[96:99], v[192:195], v[16:31]
    ds_read_b128 v[124:127], v5 offset:19456
    v_add_u32 v5, 81920, v6
    s_waitcnt vmcnt(0)
    v_add_f32 v80, v80, v82
    v_add_f32 v81, v81, v83
    v_add_f32 v80, v80, v84
    v_mfma_f32_32x32x16_bf16 v[32:47], v[100:103], v[192:195], v[32:47]
    ds_read_b128 v[96:99], v5 offset:0
    v_add_f32 v81, v81, v85
    v_add_f32 v80, v80, v86
    v_add_f32 v81, v81, v87
    s_waitcnt lgkmcnt(5)
    v_mfma_f32_32x32x16_bf16 v[16:31], v[104:107], v[196:199], v[16:31]
    ds_read_b128 v[100:103], v5 offset:1024
    v_add_f32 v80, v80, v88
    v_add_f32 v81, v81, v89
    v_add_f32 v80, v80, v90
    v_add_f32 v81, v81, v91
    v_mfma_f32_32x32x16_bf16 v[32:47], v[108:111], v[196:199], v[32:47]
    ds_read_b128 v[104:107], v5 offset:2048
    v_add_f32 v80, v80, v92
    v_add_f32 v81, v81, v93
    v_mov_b32 v2, v80
    s_waitcnt lgkmcnt(5)
    v_mfma_f32_32x32x16_bf16 v[16:31], v[112:115], v[200:203], v[16:31]
    ds_read_b128 v[108:111], v5 offset:3072
    s_nop 1
    v_permlane32_swap_b32 v80, v2
    v_add_f32 v80, v80, v2
    v_mov_b32 v2, v81
    v_mfma_f32_32x32x16_bf16 v[32:47], v[116:119], v[200:203], v[32:47]
    ds_read_b128 v[112:115], v5 offset:4096
    s_nop 1
    v_permlane32_swap_b32 v81, v2
    v_add_f32 v81, v81, v2
    s_waitcnt lgkmcnt(5)
    v_mfma_f32_32x32x16_bf16 v[16:31], v[120:123], v[204:207], v[16:31]
    ds_read_b128 v[116:119], v5 offset:5120
    v_mul_f32 v80, 0x3acccccd, v80
    v_mov_b32 v2, 0x3727c5ac
    v_fmac_f32 v2, 0x3acccccd, v81
    v_fma_f32 v2, -v80, v80, v2
    v_mfma_f32_32x32x16_bf16 v[32:47], v[124:127], v[204:207], v[32:47]
    ds_read_b128 v[120:123], v5 offset:6144
    v_max_f32 v2, 0x3727c5ac, v2
    v_rsq_f32 v81, v2
    s_nop 0
    s_waitcnt lgkmcnt(5)
    v_mfma_f32_32x32x16_bf16 v[48:63], v[96:99], v[128:131], 0
    ds_read_b128 v[124:127], v5 offset:7168
    v_mfma_f32_32x32x16_bf16 v[64:79], v[100:103], v[128:131], 0
    ds_read_b128 v[96:99], v5 offset:8192
    s_waitcnt lgkmcnt(5)
    v_mfma_f32_32x32x16_bf16 v[48:63], v[104:107], v[132:135], v[48:63]
    ds_read_b128 v[100:103], v5 offset:9216
    v_mfma_f32_32x32x16_bf16 v[64:79], v[108:111], v[132:135], v[64:79]
    ds_read_b128 v[104:107], v5 offset:10240
    s_waitcnt lgkmcnt(5)
    v_mfma_f32_32x32x16_bf16 v[48:63], v[112:115], v[136:139], v[48:63]
    ds_read_b128 v[108:111], v5 offset:11264
    ds_write_b128 v9, v[32:35] offset:0
    v_fma_f32 v16, -v80, v208, v16
    v_fma_f32 v17, -v80, v209, v17
    v_fma_f32 v18, -v80, v210, v18
    v_mfma_f32_32x32x16_bf16 v[64:79], v[116:119], v[136:139], v[64:79]
    ds_read_b128 v[112:115], v5 offset:12288
    ds_write_b128 v9, v[36:39] offset:1024
    v_fma_f32 v19, -v80, v211, v19
    v_fma_f32 v20, -v80, v212, v20
    s_waitcnt lgkmcnt(5)
    v_mfma_f32_32x32x16_bf16 v[48:63], v[120:123], v[140:143], v[48:63]
    ds_read_b128 v[116:119], v5 offset:13312
    ds_write_b128 v9, v[40:43] offset:2048
    v_fma_f32 v21, -v80, v213, v21
    v_fma_f32 v22, -v80, v214, v22
    v_mfma_f32_32x32x16_bf16 v[64:79], v[124:127], v[140:143], v[64:79]
    ds_read_b128 v[120:123], v5 offset:14336
    ds_write_b128 v9, v[44:47] offset:3072
    v_fma_f32 v23, -v80, v215, v23
    v_fma_f32 v24, -v80, v216, v24
    v_fma_f32 v25, -v80, v217, v25
    s_waitcnt lgkmcnt(5)
    v_mfma_f32_32x32x16_bf16 v[48:63], v[96:99], v[144:147], v[48:63]
    ds_read_b128 v[124:127], v5 offset:15360
    v_fma_f32 v26, -v80, v218, v26
    v_fma_f32 v27, -v80, v219, v27
    v_mfma_f32_32x32x16_bf16 v[64:79], v[100:103], v[144:147], v[64:79]
    ds_read_b128 v[96:99], v5 offset:16384
    v_fma_f32 v28, -v80, v220, v28
    v_fma_f32 v29, -v80, v221, v29
    s_waitcnt lgkmcnt(5)
    v_mfma_f32_32x32x16_bf16 v[48:63], v[104:107], v[148:151], v[48:63]
    ds_read_b128 v[100:103], v5 offset:17408
    v_fma_f32 v30, -v80, v222, v30
    v_fma_f32 v31, -v80, v223, v31
    v_mfma_f32_32x32x16_bf16 v[64:79], v[108:111], v[148:151], v[64:79]
    ds_read_b128 v[104:107], v5 offset:18432
    s_waitcnt lgkmcnt(0)
    s_barrier
    ds_read_b128 v[240:243], v10 offset:0
    ds_read_b128 v[244:247], v10 offset:1024
    ds_read_b128 v[248:251], v10 offset:2048
    ds_read_b128 v[252:255], v10 offset:3072
    s_waitcnt lgkmcnt(5)
    v_mfma_f32_32x32x16_bf16 v[48:63], v[112:115], v[152:155], v[48:63]
    ds_read_b128 v[108:111], v5 offset:19456
    v_add_u32 v5, 0, v6
    v_mfma_f32_32x32x16_bf16 v[64:79], v[116:119], v[152:155], v[64:79]
    ds_read_b128 v[112:115], v5 offset:0
    s_waitcnt lgkmcnt(5)
    v_mfma_f32_32x32x16_bf16 v[48:63], v[120:123], v[156:159], v[48:63]
    ds_read_b128 v[116:119], v5 offset:1024
    s_waitcnt lgkmcnt(3)
    v_mfma_f32_32x32x16_bf16 v[64:79], v[124:127], v[156:159], v[64:79]
    ds_read_b128 v[120:123], v5 offset:2048
    v_add_f32 v16, v16, v240
    v_add_f32 v17, v17, v241
    v_add_f32 v18, v18, v242
    v_add_f32 v19, v19, v243
    v_add_f32 v20, v20, v244
    v_add_f32 v21, v21, v245
    v_add_f32 v22, v22, v246
    v_add_f32 v23, v23, v247
    s_waitcnt lgkmcnt(5)
    v_mfma_f32_32x32x16_bf16 v[48:63], v[96:99], v[160:163], v[48:63]
    ds_read_b128 v[124:127], v5 offset:3072
    v_mul_f32 v16, v16, v81
    v_mul_f32 v17, v17, v81
    v_mul_f32 v18, v18, v81
    v_mul_f32 v19, v19, v81
    v_mul_f32 v20, v20, v81
    v_mul_f32 v21, v21, v81
    v_mul_f32 v22, v22, v81
    v_mul_f32 v23, v23, v81
    v_mfma_f32_32x32x16_bf16 v[64:79], v[100:103], v[160:163], v[64:79]
    ds_read_b128 v[96:99], v5 offset:4096
    v_mul_f32 v84, v16, v16
    v_mul_f32 v85, v17, v17
    v_mul_f32 v86, v18, v18
    v_mul_f32 v87, v19, v19
    v_mul_f32 v88, v20, v20
    v_mul_f32 v89, v21, v21
    v_mul_f32 v90, v22, v22
    v_mul_f32 v91, v23, v23
    s_waitcnt lgkmcnt(5)
    v_mfma_f32_32x32x16_bf16 v[48:63], v[104:107], v[164:167], v[48:63]
    ds_read_b128 v[100:103], v5 offset:5120
    v_fma_f32 v84, v84, s84, v4
    v_fma_f32 v85, v85, s84, v4
    v_fma_f32 v86, v86, s84, v4
    v_fma_f32 v87, v87, s84, v4
    v_fma_f32 v88, v88, s84, v4
    v_fma_f32 v89, v89, s84, v4
    v_fma_f32 v90, v90, s84, v4
    v_fma_f32 v91, v91, s84, v4
    v_mfma_f32_32x32x16_bf16 v[64:79], v[108:111], v[164:167], v[64:79]
    ds_read_b128 v[104:107], v5 offset:6144
    v_mul_f32 v84, v16, v84
    v_mul_f32 v85, v17, v85
    v_mul_f32 v86, v18, v86
    v_mul_f32 v87, v19, v87
    v_mul_f32 v88, v20, v88
    v_mul_f32 v89, v21, v89
    v_mul_f32 v90, v22, v90
    v_mul_f32 v91, v23, v91
    s_barrier
    s_waitcnt lgkmcnt(5)
    v_mfma_f32_32x32x16_bf16 v[48:63], v[112:115], v[168:171], v[48:63]
    ds_read_b128 v[108:111], v5 offset:7168
    v_exp_f32 v84, v84
    v_exp_f32 v85, v85
    v_exp_f32 v86, v86
    v_exp_f32 v87, v87
    v_exp_f32 v88, v88
    v_exp_f32 v89, v89
    v_exp_f32 v90, v90
    v_exp_f32 v91, v91
    v_add_f32 v84, 1.0, v84
    v_mfma_f32_32x32x16_bf16 v[64:79], v[116:119], v[168:171], v[64:79]
    ds_read_b128 v[112:115], v5 offset:8192
    v_add_f32 v85, 1.0, v85
    v_add_f32 v86, 1.0, v86
    v_add_f32 v87, 1.0, v87
    v_add_f32 v88, 1.0, v88
    v_add_f32 v89, 1.0, v89
    v_add_f32 v90, 1.0, v90
    v_add_f32 v91, 1.0, v91
    v_rcp_f32 v84, v84
    s_waitcnt lgkmcnt(5)
    v_mfma_f32_32x32x16_bf16 v[48:63], v[120:123], v[172:175], v[48:63]
    ds_read_b128 v[116:119], v5 offset:9216
    v_rcp_f32 v85, v85
    v_rcp_f32 v86, v86
    v_rcp_f32 v87, v87
    v_rcp_f32 v88, v88
    v_rcp_f32 v89, v89
    v_rcp_f32 v90, v90
    v_rcp_f32 v91, v91
    v_mul_f32 v16, v16, v84
    v_mfma_f32_32x32x16_bf16 v[64:79], v[124:127], v[172:175], v[64:79]
    ds_read_b128 v[120:123], v5 offset:10240
    v_mul_f32 v17, v17, v85
    v_mul_f32 v18, v18, v86
    v_mul_f32 v19, v19, v87
    v_mul_f32 v20, v20, v88
    v_mul_f32 v21, v21, v89
    v_mul_f32 v22, v22, v90
    v_mul_f32 v23, v23, v91
    v_cvt_pk_bf16_f32 v16, v16, v17
    s_waitcnt lgkmcnt(5)
    v_mfma_f32_32x32x16_bf16 v[48:63], v[96:99], v[176:179], v[48:63]
    ds_read_b128 v[124:127], v5 offset:11264
    v_cvt_pk_bf16_f32 v17, v18, v19
    v_cvt_pk_bf16_f32 v18, v20, v21
    v_cvt_pk_bf16_f32 v19, v22, v23
    buffer_store_dwordx4 v[16:19], v1, s[20:23], s93 offen offset:0 sc1
    v_add_f32 v24, v24, v248
    v_add_f32 v25, v25, v249
    v_add_f32 v26, v26, v250
    v_add_f32 v27, v27, v251
    v_mfma_f32_32x32x16_bf16 v[64:79], v[100:103], v[176:179], v[64:79]
    ds_read_b128 v[96:99], v5 offset:12288
    v_add_f32 v28, v28, v252
    v_add_f32 v29, v29, v253
    v_add_f32 v30, v30, v254
    v_add_f32 v31, v31, v255
    v_mul_f32 v24, v24, v81
    v_mul_f32 v25, v25, v81
    v_mul_f32 v26, v26, v81
    v_mul_f32 v27, v27, v81
    s_waitcnt lgkmcnt(5)
    v_mfma_f32_32x32x16_bf16 v[48:63], v[104:107], v[180:183], v[48:63]
    ds_read_b128 v[100:103], v5 offset:13312
    v_mul_f32 v28, v28, v81
    v_mul_f32 v29, v29, v81
    v_mul_f32 v30, v30, v81
    v_mul_f32 v31, v31, v81
    v_mul_f32 v84, v24, v24
    v_mul_f32 v85, v25, v25
    v_mul_f32 v86, v26, v26
    v_mul_f32 v87, v27, v27
    v_mfma_f32_32x32x16_bf16 v[64:79], v[108:111], v[180:183], v[64:79]
    ds_read_b128 v[104:107], v5 offset:14336
    v_mul_f32 v88, v28, v28
    v_mul_f32 v89, v29, v29
    v_mul_f32 v90, v30, v30
    v_mul_f32 v91, v31, v31
    v_fma_f32 v84, v84, s84, v4
    v_fma_f32 v85, v85, s84, v4
    v_fma_f32 v86, v86, s84, v4
    v_fma_f32 v87, v87, s84, v4
    v_fma_f32 v88, v88, s84, v4
    s_waitcnt lgkmcnt(5)
    v_mfma_f32_32x32x16_bf16 v[48:63], v[112:115], v[184:187], v[48:63]
    ds_read_b128 v[108:111], v5 offset:15360
    v_fma_f32 v89, v89, s84, v4
    v_fma_f32 v90, v90, s84, v4
    v_fma_f32 v91, v91, s84, v4
    v_mul_f32 v84, v24, v84
    v_mul_f32 v85, v25, v85
    v_mul_f32 v86, v26, v86
    v_mul_f32 v87, v27, v87
    v_mul_f32 v88, v28, v88
    v_mfma_f32_32x32x16_bf16 v[64:79], v[116:119], v[184:187], v[64:79]
    ds_read_b128 v[112:115], v5 offset:16384
    v_mul_f32 v89, v29, v89
    v_mul_f32 v90, v30, v90
    v_mul_f32 v91, v31, v91
    v_exp_f32 v84, v84
    v_exp_f32 v85, v85
    v_exp_f32 v86, v86
    v_exp_f32 v87, v87
    v_exp_f32 v88, v88
    s_waitcnt lgkmcnt(5)
    v_mfma_f32_32x32x16_bf16 v[48:63], v[120:123], v[188:191], v[48:63]
    ds_read_b128 v[116:119], v5 offset:17408
    v_exp_f32 v89, v89
    v_exp_f32 v90, v90
    v_exp_f32 v91, v91
    v_add_f32 v84, 1.0, v84
    v_add_f32 v85, 1.0, v85
    v_add_f32 v86, 1.0, v86
    v_add_f32 v87, 1.0, v87
    v_add_f32 v88, 1.0, v88
    v_mfma_f32_32x32x16_bf16 v[64:79], v[124:127], v[188:191], v[64:79]
    ds_read_b128 v[120:123], v5 offset:18432
    v_add_f32 v89, 1.0, v89
    v_add_f32 v90, 1.0, v90
    v_add_f32 v91, 1.0, v91
    v_rcp_f32 v84, v84
    v_rcp_f32 v85, v85
    v_rcp_f32 v86, v86
    v_rcp_f32 v87, v87
    v_rcp_f32 v88, v88
    s_waitcnt lgkmcnt(5)
    v_mfma_f32_32x32x16_bf16 v[48:63], v[96:99], v[192:195], v[48:63]
    ds_read_b128 v[124:127], v5 offset:19456
    v_rcp_f32 v89, v89
    v_rcp_f32 v90, v90
    v_rcp_f32 v91, v91
    v_mul_f32 v24, v24, v84
    v_mul_f32 v25, v25, v85
    v_mul_f32 v26, v26, v86
    v_mul_f32 v27, v27, v87
    v_mul_f32 v28, v28, v88
    v_mfma_f32_32x32x16_bf16 v[64:79], v[100:103], v[192:195], v[64:79]
    v_mul_f32 v29, v29, v89
    v_mul_f32 v30, v30, v90
    v_mul_f32 v31, v31, v91
    v_cvt_pk_bf16_f32 v24, v24, v25
    v_cvt_pk_bf16_f32 v25, v26, v27
    v_cvt_pk_bf16_f32 v26, v28, v29
    v_cvt_pk_bf16_f32 v27, v30, v31
    buffer_store_dwordx4 v[24:27], v1, s[20:23], s93 offen offset:1024 sc1
    s_waitcnt lgkmcnt(4)
    v_mfma_f32_32x32x16_bf16 v[48:63], v[104:107], v[196:199], v[48:63]
    v_mfma_f32_32x32x16_bf16 v[64:79], v[108:111], v[196:199], v[64:79]
    s_waitcnt lgkmcnt(2)
    v_mfma_f32_32x32x16_bf16 v[48:63], v[112:115], v[200:203], v[48:63]
    v_mfma_f32_32x32x16_bf16 v[64:79], v[116:119], v[200:203], v[64:79]
    s_waitcnt lgkmcnt(0)
    v_mfma_f32_32x32x16_bf16 v[48:63], v[120:123], v[204:207], v[48:63]
    v_mfma_f32_32x32x16_bf16 v[64:79], v[124:127], v[204:207], v[64:79]
    s_nop 11
    ds_write_b128 v9, v[64:67] offset:0
    ds_write_b128 v9, v[68:71] offset:1024
    ds_write_b128 v9, v[72:75] offset:2048
    ds_write_b128 v9, v[76:79] offset:3072
    v_fma_f32 v48, -v80, v224, v48
    v_fma_f32 v49, -v80, v225, v49
    v_fma_f32 v50, -v80, v226, v50
    v_fma_f32 v51, -v80, v227, v51
    v_fma_f32 v52, -v80, v228, v52
    v_fma_f32 v53, -v80, v229, v53
    v_fma_f32 v54, -v80, v230, v54
    v_fma_f32 v55, -v80, v231, v55
    v_fma_f32 v56, -v80, v232, v56
    v_fma_f32 v57, -v80, v233, v57
    v_fma_f32 v58, -v80, v234, v58
    v_fma_f32 v59, -v80, v235, v59
    v_fma_f32 v60, -v80, v236, v60
    v_fma_f32 v61, -v80, v237, v61
    v_fma_f32 v62, -v80, v238, v62
    v_fma_f32 v63, -v80, v239, v63
    s_lshl_b32 s56, s90, 11
    s_lshl_b32 s57, s91, 7
    s_add_u32 s56, s56, s57
    s_add_u32 s56, s56, 659456
    v_mov_b32 v2, 162832
    v_mov_b32 v3, 1
    s_waitcnt vmcnt(0)
    s_mov_b64 exec, 1
    ds_add_rtn_u32 v3, v2, v3
    v_mov_b32 v2, 0
    s_waitcnt lgkmcnt(0)
    v_cmp_eq_u32 vcc, 7, v3
    v_mov_b32 v3, s54
    s_cmp_lg_u32 vcc_lo, 0
    s_cselect_b32 s56, s56, 0x70000000
    buffer_store_dword v3, v2, s[20:23], s56 offen sc1
    s_mov_b64 exec, -1
    s_barrier
    ds_read_b128 v[240:243], v10 offset:0
    ds_read_b128 v[244:247], v10 offset:1024
    ds_read_b128 v[248:251], v10 offset:2048
    ds_read_b128 v[252:255], v10 offset:3072
    s_waitcnt lgkmcnt(0)
    v_add_f32 v48, v48, v240
    v_add_f32 v49, v49, v241
    v_add_f32 v50, v50, v242
    v_add_f32 v51, v51, v243
    v_add_f32 v52, v52, v244
    v_add_f32 v53, v53, v245
    v_add_f32 v54, v54, v246
    v_add_f32 v55, v55, v247
    v_mul_f32 v48, v48, v81
    v_mul_f32 v49, v49, v81
    v_mul_f32 v50, v50, v81
    v_mul_f32 v51, v51, v81
    v_mul_f32 v52, v52, v81
    v_mul_f32 v53, v53, v81
    v_mul_f32 v54, v54, v81
    v_mul_f32 v55, v55, v81
    v_mul_f32 v84, v48, v48
    v_mul_f32 v85, v49, v49
    v_mul_f32 v86, v50, v50
    v_mul_f32 v87, v51, v51
    v_mul_f32 v88, v52, v52
    v_mul_f32 v89, v53, v53
    v_mul_f32 v90, v54, v54
    v_mul_f32 v91, v55, v55
    v_fma_f32 v84, v84, s84, v4
    v_fma_f32 v85, v85, s84, v4
    v_fma_f32 v86, v86, s84, v4
    v_fma_f32 v87, v87, s84, v4
    v_fma_f32 v88, v88, s84, v4
    v_fma_f32 v89, v89, s84, v4
    v_fma_f32 v90, v90, s84, v4
    v_fma_f32 v91, v91, s84, v4
    v_mul_f32 v84, v48, v84
    v_mul_f32 v85, v49, v85
    v_mul_f32 v86, v50, v86
    v_mul_f32 v87, v51, v87
    v_mul_f32 v88, v52, v88
    v_mul_f32 v89, v53, v89
    v_mul_f32 v90, v54, v90
    v_mul_f32 v91, v55, v91
    v_exp_f32 v84, v84
    v_exp_f32 v85, v85
    v_exp_f32 v86, v86
    v_exp_f32 v87, v87
    v_exp_f32 v88, v88
    v_exp_f32 v89, v89
    v_exp_f32 v90, v90
    v_exp_f32 v91, v91
    v_add_f32 v84, 1.0, v84
    v_add_f32 v85, 1.0, v85
    v_add_f32 v86, 1.0, v86
    v_add_f32 v87, 1.0, v87
    v_add_f32 v88, 1.0, v88
    v_add_f32 v89, 1.0, v89
    v_add_f32 v90, 1.0, v90
    v_add_f32 v91, 1.0, v91
    v_rcp_f32 v84, v84
    v_rcp_f32 v85, v85
    v_rcp_f32 v86, v86
    v_rcp_f32 v87, v87
    v_rcp_f32 v88, v88
    v_rcp_f32 v89, v89
    v_rcp_f32 v90, v90
    v_rcp_f32 v91, v91
    v_mul_f32 v48, v48, v84
    v_mul_f32 v49, v49, v85
    v_mul_f32 v50, v50, v86
    v_mul_f32 v51, v51, v87
    v_mul_f32 v52, v52, v88
    v_mul_f32 v53, v53, v89
    v_mul_f32 v54, v54, v90
    v_mul_f32 v55, v55, v91
    v_cvt_pk_bf16_f32 v48, v48, v49
    v_cvt_pk_bf16_f32 v49, v50, v51
    v_cvt_pk_bf16_f32 v50, v52, v53
    v_cvt_pk_bf16_f32 v51, v54, v55
    buffer_store_dwordx4 v[48:51], v1, s[20:23], s94 offen offset:0 sc1
    v_add_f32 v56, v56, v248
    v_add_f32 v57, v57, v249
    v_add_f32 v58, v58, v250
    v_add_f32 v59, v59, v251
    v_add_f32 v60, v60, v252
    v_add_f32 v61, v61, v253
    v_add_f32 v62, v62, v254
    v_add_f32 v63, v63, v255
    v_mul_f32 v56, v56, v81
    v_mul_f32 v57, v57, v81
    v_mul_f32 v58, v58, v81
    v_mul_f32 v59, v59, v81
    v_mul_f32 v60, v60, v81
    v_mul_f32 v61, v61, v81
    v_mul_f32 v62, v62, v81
    v_mul_f32 v63, v63, v81
    v_mul_f32 v84, v56, v56
    v_mul_f32 v85, v57, v57
    v_mul_f32 v86, v58, v58
    v_mul_f32 v87, v59, v59
    v_mul_f32 v88, v60, v60
    v_mul_f32 v89, v61, v61
    v_mul_f32 v90, v62, v62
    v_mul_f32 v91, v63, v63
    v_fma_f32 v84, v84, s84, v4
    v_fma_f32 v85, v85, s84, v4
    v_fma_f32 v86, v86, s84, v4
    v_fma_f32 v87, v87, s84, v4
    v_fma_f32 v88, v88, s84, v4
    v_fma_f32 v89, v89, s84, v4
    v_fma_f32 v90, v90, s84, v4
    v_fma_f32 v91, v91, s84, v4
    v_mul_f32 v84, v56, v84
    v_mul_f32 v85, v57, v85
    v_mul_f32 v86, v58, v86
    v_mul_f32 v87, v59, v87
    v_mul_f32 v88, v60, v88
    v_mul_f32 v89, v61, v89
    v_mul_f32 v90, v62, v90
    v_mul_f32 v91, v63, v91
    v_exp_f32 v84, v84
    v_exp_f32 v85, v85
    v_exp_f32 v86, v86
    v_exp_f32 v87, v87
    v_exp_f32 v88, v88
    v_exp_f32 v89, v89
    v_exp_f32 v90, v90
    v_exp_f32 v91, v91
    v_add_f32 v84, 1.0, v84
    v_add_f32 v85, 1.0, v85
    v_add_f32 v86, 1.0, v86
    v_add_f32 v87, 1.0, v87
    v_add_f32 v88, 1.0, v88
    v_add_f32 v89, 1.0, v89
    v_add_f32 v90, 1.0, v90
    v_add_f32 v91, 1.0, v91
    v_rcp_f32 v84, v84
    v_rcp_f32 v85, v85
    v_rcp_f32 v86, v86
    v_rcp_f32 v87, v87
    v_rcp_f32 v88, v88
    v_rcp_f32 v89, v89
    v_rcp_f32 v90, v90
    v_rcp_f32 v91, v91
    v_mul_f32 v56, v56, v84
    v_mul_f32 v57, v57, v85
    v_mul_f32 v58, v58, v86
    v_mul_f32 v59, v59, v87
    v_mul_f32 v60, v60, v88
    v_mul_f32 v61, v61, v89
    v_mul_f32 v62, v62, v90
    v_mul_f32 v63, v63, v91
    v_cvt_pk_bf16_f32 v56, v56, v57
    v_cvt_pk_bf16_f32 v57, v58, v59
    v_cvt_pk_bf16_f32 v58, v60, v61
    v_cvt_pk_bf16_f32 v59, v62, v63
    buffer_store_dwordx4 v[56:59], v1, s[20:23], s94 offen offset:1024 sc1
    s_mul_i32 s81, s67, 262144
    s_mul_i32 s56, s70, 55296
    s_add_u32 s81, s81, s56
    s_add_u32 s81, s81, 100663296
    s_cmp_lg_u32 s3, 0
    s_cbranch_scc1 kb_pd4
    s_lshr_b32 s56, s71, 1
    s_lshl_b32 s56, s56, 11
    s_add_u32 s56, s56, 659456
    s_cmp_lt_u32 s34, 14
    s_cselect_b32 s58, 0x3fff, 0
    s_mov_b32 s59, 0
    v_lshlrev_b32 v2, 3, v1
    s_mov_b32 s57, 0
    s_mov_b64 exec, s[58:59]
    s_cbranch_execz kb_pe4
kb_pl4:
    buffer_load_dword v3, v2, s[16:19], s56 offen sc1
    s_add_u32 s57, s57, 1
    s_waitcnt vmcnt(0)
    v_cmp_ne_u32 vcc, s54, v3
    s_cbranch_vccz kb_pe4
    s_mov_b64 exec, vcc
    s_sleep 1
    s_cmp_lt_u32 s57, 0x40000
    s_cbranch_scc1 kb_pl4
kb_pe4:
    s_mov_b64 exec, -1
kb_pd4:
    s_barrier
    s_add_u32 s60, s81, 0
    buffer_load_dwordx4 v[128:131], v1, s[20:23], s60 offen offset:0 sc1
    buffer_load_dwordx4 v[132:135], v1, s[20:23], s60 offen offset:1024 sc1
    buffer_load_dwordx4 v[136:139], v1, s[20:23], s60 offen offset:2048 sc1
    buffer_load_dwordx4 v[140:143], v1, s[20:23], s60 offen offset:3072 sc1
    s_add_u32 s60, s81, 4096
    buffer_load_dwordx4 v[144:147], v1, s[20:23], s60 offen offset:0 sc1
    buffer_load_dwordx4 v[148:151], v1, s[20:23], s60 offen offset:1024 sc1
    s_add_u32 s60, s81, 4096
    buffer_load_dwordx4 v[152:155], v1, s[20:23], s60 offen offset:2048 sc1
    buffer_load_dwordx4 v[156:159], v1, s[20:23], s60 offen offset:3072 sc1
    s_add_u32 s60, s81, 8192
    buffer_load_dwordx4 v[160:163], v1, s[20:23], s60 offen offset:0 sc1
    buffer_load_dwordx4 v[164:167], v1, s[20:23], s60 offen offset:1024 sc1
    buffer_load_dwordx4 v[168:171], v1, s[20:23], s60 offen offset:2048 sc1
    buffer_load_dwordx4 v[172:175], v1, s[20:23], s60 offen offset:3072 sc1
    s_lshl_b32 s56, s90, 11
    s_lshl_b32 s57, s91, 7
    s_add_u32 s56, s56, s57
    s_add_u32 s56, s56, 761856
    v_mov_b32 v2, 162848
    v_mov_b32 v3, 1
    s_waitcnt vmcnt(12)
    s_mov_b64 exec, 1
    ds_add_rtn_u32 v3, v2, v3
    v_mov_b32 v2, 0
    s_waitcnt lgkmcnt(0)
    v_cmp_eq_u32 vcc, 7, v3
    v_mov_b32 v3, s54
    s_cmp_lg_u32 vcc_lo, 0
    s_cselect_b32 s56, s56, 0x70000000
    buffer_store_dword v3, v2, s[20:23], s56 offen sc1
    s_mov_b64 exec, -1
    s_mul_i32 s59, s70, 18432
    v_add_u32 v6, s59, v1
    v_add_u32 v5, 40960, v6
    ds_read_b128 v[96:99], v5 offset:0
    ds_read_b128 v[100:103], v5 offset:1024
    ds_read_b128 v[104:107], v5 offset:2048
    ds_read_b128 v[108:111], v5 offset:3072
    ds_read_b128 v[112:115], v5 offset:4096
    ds_read_b128 v[116:119], v5 offset:5120
    ds_read_b128 v[120:123], v5 offset:6144
    s_waitcnt vmcnt(12)
    s_waitcnt lgkmcnt(5)
    v_mfma_f32_32x32x16_bf16 v[16:31], v[96:99], v[128:131], 0
    ds_read_b128 v[124:127], v5 offset:7168
    s_add_u32 s60, s81, 12288
    buffer_load_dwordx4 v[176:179], v1, s[20:23], s60 offen offset:0 sc1
    v_mfma_f32_32x32x16_bf16 v[32:47], v[100:103], v[128:131], 0
    ds_read_b128 v[96:99], v5 offset:8192
    buffer_load_dwordx4 v[180:183], v1, s[20:23], s60 offen offset:1024 sc1
    s_waitcnt lgkmcnt(5)
    v_mfma_f32_32x32x16_bf16 v[48:63], v[104:107], v[128:131], 0
    ds_read_b128 v[100:103], v5 offset:9216
    s_waitcnt vmcnt(13)
    v_mfma_f32_32x32x16_bf16 v[16:31], v[108:111], v[132:135], v[16:31]
    ds_read_b128 v[104:107], v5 offset:10240
    buffer_load_dwordx4 v[184:187], v1, s[20:23], s60 offen offset:2048 sc1
    s_waitcnt lgkmcnt(5)
    v_mfma_f32_32x32x16_bf16 v[32:47], v[112:115], v[132:135], v[32:47]
    ds_read_b128 v[108:111], v5 offset:11264
    buffer_load_dwordx4 v[188:191], v1, s[20:23], s60 offen offset:3072 sc1
    v_mfma_f32_32x32x16_bf16 v[48:63], v[116:119], v[132:135], v[48:63]
    ds_read_b128 v[112:115], v5 offset:12288
    s_waitcnt vmcnt(14)
    s_waitcnt lgkmcnt(5)
    v_mfma_f32_32x32x16_bf16 v[16:31], v[120:123], v[136:139], v[16:31]
    ds_read_b128 v[116:119], v5 offset:13312
    s_add_u32 s60, s81, 16384
    buffer_load_dwordx4 v[192:195], v1, s[20:23], s60 offen offset:0 sc1
    v_mfma_f32_32x32x16_bf16 v[32:47], v[124:127], v[136:139], v[32:47]
    ds_read_b128 v[120:123], v5 offset:14336
    buffer_load_dwordx4 v[196:199], v1, s[20:23], s60 offen offset:1024 sc1
    s_waitcnt lgkmcnt(5)
    v_mfma_f32_32x32x16_bf16 v[48:63], v[96:99], v[136:139], v[48:63]
    ds_read_b128 v[124:127], v5 offset:15360
    s_waitcnt vmcnt(15)
    v_mfma_f32_32x32x16_bf16 v[16:31], v[100:103], v[140:143], v[16:31]
    ds_read_b128 v[96:99], v5 offset:16384
    s_add_u32 s60, s81, 16384
    buffer_load_dwordx4 v[200:203], v1, s[20:23], s60 offen offset:2048 sc1
    s_waitcnt lgkmcnt(5)
    v_mfma_f32_32x32x16_bf16 v[32:47], v[104:107], v[140:143], v[32:47]
    ds_read_b128 v[100:103], v5 offset:17408
    v_add_u32 v5, 81920, v6
    buffer_load_dwordx4 v[204:207], v1, s[20:23], s60 offen offset:3072 sc1
    v_mfma_f32_32x32x16_bf16 v[48:63], v[108:111], v[140:143], v[48:63]
    ds_read_b128 v[104:107], v5 offset:0
    s_waitcnt vmcnt(16)
    s_waitcnt lgkmcnt(5)
    v_mfma_f32_32x32x16_bf16 v[16:31], v[112:115], v[144:147], v[16:31]
    ds_read_b128 v[108:111], v5 offset:1024
    s_add_u32 s60, s81, 20480
    buffer_load_dwordx4 v[208:211], v1, s[20:23], s60 offen offset:0 sc1
    v_mfma_f32_32x32x16_bf16 v[32:47], v[116:119], v[144:147], v[32:47]
    ds_read_b128 v[112:115], v5 offset:2048
    buffer_load_dwordx4 v[212:215], v1, s[20:23], s60 offen offset:1024 sc1
    s_waitcnt lgkmcnt(5)
    v_mfma_f32_32x32x16_bf16 v[48:63], v[120:123], v[144:147], v[48:63]
    ds_read_b128 v[116:119], v5 offset:3072
    s_waitcnt vmcnt(17)
    v_mfma_f32_32x32x16_bf16 v[16:31], v[124:127], v[148:151], v[16:31]
    ds_read_b128 v[120:123], v5 offset:4096
    buffer_load_dwordx4 v[216:219], v1, s[20:23], s60 offen offset:2048 sc1
    s_waitcnt lgkmcnt(5)
    v_mfma_f32_32x32x16_bf16 v[32:47], v[96:99], v[148:151], v[32:47]
    ds_read_b128 v[124:127], v5 offset:5120
    buffer_load_dwordx4 v[220:223], v1, s[20:23], s60 offen offset:3072 sc1
    v_mfma_f32_32x32x16_bf16 v[48:63], v[100:103], v[148:151], v[48:63]
    ds_read_b128 v[96:99], v5 offset:6144
    s_barrier
    s_waitcnt vmcnt(18)
    s_waitcnt lgkmcnt(5)
    v_mfma_f32_32x32x16_bf16 v[16:31], v[104:107], v[152:155], v[16:31]
    ds_read_b128 v[100:103], v5 offset:7168
    v_mfma_f32_32x32x16_bf16 v[32:47], v[108:111], v[152:155], v[32:47]
    ds_read_b128 v[104:107], v5 offset:8192
    s_waitcnt lgkmcnt(5)
    v_mfma_f32_32x32x16_bf16 v[48:63], v[112:115], v[152:155], v[48:63]
    ds_read_b128 v[108:111], v5 offset:9216
    s_waitcnt vmcnt(17)
    v_mfma_f32_32x32x16_bf16 v[16:31], v[116:119], v[156:159], v[16:31]
    ds_read_b128 v[112:115], v5 offset:10240
    s_waitcnt lgkmcnt(5)
    v_mfma_f32_32x32x16_bf16 v[32:47], v[120:123], v[156:159], v[32:47]
    ds_read_b128 v[116:119], v5 offset:11264
    v_mfma_f32_32x32x16_bf16 v[48:63], v[124:127], v[156:159], v[48:63]
    ds_read_b128 v[120:123], v5 offset:12288
    s_waitcnt vmcnt(16)
    s_waitcnt lgkmcnt(5)
    v_mfma_f32_32x32x16_bf16 v[16:31], v[96:99], v[160:163], v[16:31]
    ds_read_b128 v[124:127], v5 offset:13312
    v_mfma_f32_32x32x16_bf16 v[32:47], v[100:103], v[160:163], v[32:47]
    ds_read_b128 v[96:99], v5 offset:14336
    s_waitcnt lgkmcnt(5)
    v_mfma_f32_32x32x16_bf16 v[48:63], v[104:107], v[160:163], v[48:63]
    ds_read_b128 v[100:103], v5 offset:15360
    s_waitcnt vmcnt(15)
    v_mfma_f32_32x32x16_bf16 v[16:31], v[108:111], v[164:167], v[16:31]
    ds_read_b128 v[104:107], v5 offset:16384
    s_waitcnt lgkmcnt(5)
    v_mfma_f32_32x32x16_bf16 v[32:47], v[112:115], v[164:167], v[32:47]
    ds_read_b128 v[108:111], v5 offset:17408
    v_add_u32 v5, 0, v6
    v_mfma_f32_32x32x16_bf16 v[48:63], v[116:119], v[164:167], v[48:63]
    ds_read_b128 v[112:115], v5 offset:0
    s_waitcnt vmcnt(14)
    s_waitcnt lgkmcnt(5)
    v_mfma_f32_32x32x16_bf16 v[16:31], v[120:123], v[168:171], v[16:31]
    ds_read_b128 v[116:119], v5 offset:1024
    v_mfma_f32_32x32x16_bf16 v[32:47], v[124:127], v[168:171], v[32:47]
    ds_read_b128 v[120:123], v5 offset:2048
    s_lshr_b32 s92, s71, 1
    s_lshl_b32 s92, s92, 11
    s_add_u32 s92, s92, 761856
    v_lshlrev_b32 v9, 3, v1
    v_min_u32 v9, 1664, v9
    buffer_load_dword v10, v9, s[16:19], s92 offen sc1
    s_waitcnt lgkmcnt(5)
    v_mfma_f32_32x32x16_bf16 v[48:63], v[96:99], v[168:171], v[48:63]
    ds_read_b128 v[124:127], v5 offset:3072
    s_waitcnt vmcnt(14)
    v_mfma_f32_32x32x16_bf16 v[16:31], v[100:103], v[172:175], v[16:31]
    ds_read_b128 v[96:99], v5 offset:4096
    s_waitcnt lgkmcnt(5)
    v_mfma_f32_32x32x16_bf16 v[32:47], v[104:107], v[172:175], v[32:47]
    ds_read_b128 v[100:103], v5 offset:5120
    v_mfma_f32_32x32x16_bf16 v[48:63], v[108:111], v[172:175], v[48:63]
    ds_read_b128 v[104:107], v5 offset:6144
    s_barrier
    s_waitcnt vmcnt(12)
    s_waitcnt lgkmcnt(5)
    v_mfma_f32_32x32x16_bf16 v[16:31], v[112:115], v[176:179], v[16:31]
    ds_read_b128 v[108:111], v5 offset:7168
    s_waitcnt vmcnt(0)
    s_mov_b32 s93, 0
kb_f6l:
    v_cmp_ne_u32 vcc, s54, v10
    s_cbranch_vccz kb_f6d
    s_sleep 2
    buffer_load_dword v10, v9, s[16:19], s92 offen sc1
    s_add_u32 s93, s93, 1
    s_waitcnt vmcnt(0)
    s_cmp_lt_u32 s93, 0x40000
    s_cbranch_scc1 kb_f6l
kb_f6d:
    v_mfma_f32_32x32x16_bf16 v[32:47], v[116:119], v[176:179], v[32:47]
    ds_read_b128 v[112:115], v5 offset:8192
    s_add_u32 s60, s81, 24576
    buffer_load_dwordx4 v[224:227], v1, s[20:23], s60 offen offset:0 sc1
    s_waitcnt lgkmcnt(5)
    v_mfma_f32_32x32x16_bf16 v[48:63], v[120:123], v[176:179], v[48:63]
    ds_read_b128 v[116:119], v5 offset:9216
    buffer_load_dwordx4 v[228:231], v1, s[20:23], s60 offen offset:1024 sc1
    v_mfma_f32_32x32x16_bf16 v[16:31], v[124:127], v[180:183], v[16:31]
    ds_read_b128 v[120:123], v5 offset:10240
    s_waitcnt lgkmcnt(5)
    v_mfma_f32_32x32x16_bf16 v[32:47], v[96:99], v[180:183], v[32:47]
    ds_read_b128 v[124:127], v5 offset:11264
    buffer_load_dwordx4 v[232:235], v1, s[20:23], s60 offen offset:2048 sc1
    v_mfma_f32_32x32x16_bf16 v[48:63], v[100:103], v[180:183], v[48:63]
    ds_read_b128 v[96:99], v5 offset:12288
    buffer_load_dwordx4 v[236:239], v1, s[20:23], s60 offen offset:3072 sc1
    s_waitcnt lgkmcnt(5)
    v_mfma_f32_32x32x16_bf16 v[16:31], v[104:107], v[184:187], v[16:31]
    ds_read_b128 v[100:103], v5 offset:13312
    s_add_u32 s60, s81, 28672
    buffer_load_dwordx4 v[240:243], v1, s[20:23], s60 offen offset:0 sc1
    v_mfma_f32_32x32x16_bf16 v[32:47], v[108:111], v[184:187], v[32:47]
    ds_read_b128 v[104:107], v5 offset:14336
    s_waitcnt lgkmcnt(5)
    v_mfma_f32_32x32x16_bf16 v[48:63], v[112:115], v[184:187], v[48:63]
    ds_read_b128 v[108:111], v5 offset:15360
    buffer_load_dwordx4 v[244:247], v1, s[20:23], s60 offen offset:1024 sc1
    v_mfma_f32_32x32x16_bf16 v[16:31], v[116:119], v[188:191], v[16:31]
    ds_read_b128 v[112:115], v5 offset:16384
    s_add_u32 s60, s81, 28672
    buffer_load_dwordx4 v[248:251], v1, s[20:23], s60 offen offset:2048 sc1
    s_waitcnt lgkmcnt(5)
    v_mfma_f32_32x32x16_bf16 v[32:47], v[120:123], v[188:191], v[32:47]
    ds_read_b128 v[116:119], v5 offset:17408
    v_add_u32 v5, 122880, v6
    v_mfma_f32_32x32x16_bf16 v[48:63], v[124:127], v[188:191], v[48:63]
    ds_read_b128 v[120:123], v5 offset:0
    buffer_load_dwordx4 v[252:255], v1, s[20:23], s60 offen offset:3072 sc1
    s_waitcnt lgkmcnt(5)
    v_mfma_f32_32x32x16_bf16 v[16:31], v[96:99], v[192:195], v[16:31]
    ds_read_b128 v[124:127], v5 offset:1024
    s_add_u32 s60, s81, 32768
    buffer_load_dwordx4 v[128:131], v1, s[20:23], s60 offen offset:0 sc1
    v_mfma_f32_32x32x16_bf16 v[32:47], v[100:103], v[192:195], v[32:47]
    ds_read_b128 v[96:99], v5 offset:2048
    buffer_load_dwordx4 v[132:135], v1, s[20:23], s60 offen offset:1024 sc1
    s_waitcnt lgkmcnt(5)
    v_mfma_f32_32x32x16_bf16 v[48:63], v[104:107], v[192:195], v[48:63]
    ds_read_b128 v[100:103], v5 offset:3072
    v_mfma_f32_32x32x16_bf16 v[16:31], v[108:111], v[196:199], v[16:31]
    ds_read_b128 v[104:107], v5 offset:4096
    buffer_load_dwordx4 v[136:139], v1, s[20:23], s60 offen offset:2048 sc1
    s_waitcnt lgkmcnt(5)
    v_mfma_f32_32x32x16_bf16 v[32:47], v[112:115], v[196:199], v[32:47]
    ds_read_b128 v[108:111], v5 offset:5120
    buffer_load_dwordx4 v[140:143], v1, s[20:23], s60 offen offset:3072 sc1
    v_mfma_f32_32x32x16_bf16 v[48:63], v[116:119], v[196:199], v[48:63]
    ds_read_b128 v[112:115], v5 offset:6144
    s_barrier
    s_waitcnt lgkmcnt(5)
    v_mfma_f32_32x32x16_bf16 v[16:31], v[120:123], v[200:203], v[16:31]
    ds_read_b128 v[116:119], v5 offset:7168
    s_add_u32 s60, s81, 36864
    buffer_load_dwordx4 v[144:147], v1, s[20:23], s60 offen offset:0 sc1
    v_mfma_f32_32x32x16_bf16 v[32:47], v[124:127], v[200:203], v[32:47]
    ds_read_b128 v[120:123], v5 offset:8192
    buffer_load_dwordx4 v[148:151], v1, s[20:23], s60 offen offset:1024 sc1
    s_waitcnt lgkmcnt(5)
    v_mfma_f32_32x32x16_bf16 v[48:63], v[96:99], v[200:203], v[48:63]
    ds_read_b128 v[124:127], v5 offset:9216
    v_mfma_f32_32x32x16_bf16 v[16:31], v[100:103], v[204:207], v[16:31]
    ds_read_b128 v[96:99], v5 offset:10240
    buffer_load_dwordx4 v[152:155], v1, s[20:23], s60 offen offset:2048 sc1
    s_waitcnt lgkmcnt(5)
    v_mfma_f32_32x32x16_bf16 v[32:47], v[104:107], v[204:207], v[32:47]
    ds_read_b128 v[100:103], v5 offset:11264
    buffer_load_dwordx4 v[156:159], v1, s[20:23], s60 offen offset:3072 sc1
    v_mfma_f32_32x32x16_bf16 v[48:63], v[108:111], v[204:207], v[48:63]
    ds_read_b128 v[104:107], v5 offset:12288
    s_waitcnt lgkmcnt(5)
    v_mfma_f32_32x32x16_bf16 v[16:31], v[112:115], v[208:211], v[16:31]
    ds_read_b128 v[108:111], v5 offset:13312
    s_add_u32 s60, s81, 40960
    buffer_load_dwordx4 v[160:163], v1, s[20:23], s60 offen offset:0 sc1
    v_mfma_f32_32x32x16_bf16 v[32:47], v[116:119], v[208:211], v[32:47]
    ds_read_b128 v[112:115], v5 offset:14336
    buffer_load_dwordx4 v[164:167], v1, s[20:23], s60 offen offset:1024 sc1
    s_waitcnt lgkmcnt(5)
    v_mfma_f32_32x32x16_bf16 v[48:63], v[120:123], v[208:211], v[48:63]
    ds_read_b128 v[116:119], v5 offset:15360
    v_mfma_f32_32x32x16_bf16 v[16:31], v[124:127], v[212:215], v[16:31]
    ds_read_b128 v[120:123], v5 offset:16384
    s_add_u32 s60, s81, 40960
    buffer_load_dwordx4 v[168:171], v1, s[20:23], s60 offen offset:2048 sc1
    s_waitcnt lgkmcnt(5)
    v_mfma_f32_32x32x16_bf16 v[32:47], v[96:99], v[212:215], v[32:47]
    ds_read_b128 v[124:127], v5 offset:17408
    v_add_u32 v5, 40960, v6
    buffer_load_dwordx4 v[172:175], v1, s[20:23], s60 offen offset:3072 sc1
    v_mfma_f32_32x32x16_bf16 v[48:63], v[100:103], v[212:215], v[48:63]
    ds_read_b128 v[96:99], v5 offset:0
    s_waitcnt lgkmcnt(5)
    v_mfma_f32_32x32x16_bf16 v[16:31], v[104:107], v[216:219], v[16:31]
    ds_read_b128 v[100:103], v5 offset:1024
    s_add_u32 s60, s81, 45056
    buffer_load_dwordx4 v[176:179], v1, s[20:23], s60 offen offset:0 sc1
    v_mfma_f32_32x32x16_bf16 v[32:47], v[108:111], v[216:219], v[32:47]
    ds_read_b128 v[104:107], v5 offset:2048
    buffer_load_dwordx4 v[180:183], v1, s[20:23], s60 offen offset:1024 sc1
    s_waitcnt lgkmcnt(5)
    v_mfma_f32_32x32x16_bf16 v[48:63], v[112:115], v[216:219], v[48:63]
    ds_read_b128 v[108:111], v5 offset:3072
    v_mfma_f32_32x32x16_bf16 v[16:31], v[116:119], v[220:223], v[16:31]
    ds_read_b128 v[112:115], v5 offset:4096
    buffer_load_dwordx4 v[184:187], v1, s[20:23], s60 offen offset:2048 sc1
    s_waitcnt lgkmcnt(5)
    v_mfma_f32_32x32x16_bf16 v[32:47], v[120:123], v[220:223], v[32:47]
    ds_read_b128 v[116:119], v5 offset:5120
    buffer_load_dwordx4 v[188:191], v1, s[20:23], s60 offen offset:3072 sc1
    v_mfma_f32_32x32x16_bf16 v[48:63], v[124:127], v[220:223], v[48:63]
    ds_read_b128 v[120:123], v5 offset:6144
    s_barrier
    s_waitcnt vmcnt(23)
    s_waitcnt lgkmcnt(5)
    v_mfma_f32_32x32x16_bf16 v[16:31], v[96:99], v[224:227], v[16:31]
    ds_read_b128 v[124:127], v5 offset:7168
    s_add_u32 s60, s81, 49152
    buffer_load_dwordx4 v[192:195], v1, s[20:23], s60 offen offset:0 sc1
    v_mfma_f32_32x32x16_bf16 v[32:47], v[100:103], v[224:227], v[32:47]
    ds_read_b128 v[96:99], v5 offset:8192
    s_waitcnt lgkmcnt(5)
    v_mfma_f32_32x32x16_bf16 v[48:63], v[104:107], v[224:227], v[48:63]
    ds_read_b128 v[100:103], v5 offset:9216
    s_waitcnt vmcnt(23)
    v_mfma_f32_32x32x16_bf16 v[16:31], v[108:111], v[228:231], v[16:31]
    ds_read_b128 v[104:107], v5 offset:10240
    buffer_load_dwordx4 v[196:199], v1, s[20:23], s60 offen offset:1024 sc1
    s_waitcnt lgkmcnt(5)
    v_mfma_f32_32x32x16_bf16 v[32:47], v[112:115], v[228:231], v[32:47]
    ds_read_b128 v[108:111], v5 offset:11264
    v_mfma_f32_32x32x16_bf16 v[48:63], v[116:119], v[228:231], v[48:63]
    ds_read_b128 v[112:115], v5 offset:12288
    s_waitcnt vmcnt(23)
    s_waitcnt lgkmcnt(5)
    v_mfma_f32_32x32x16_bf16 v[16:31], v[120:123], v[232:235], v[16:31]
    ds_read_b128 v[116:119], v5 offset:13312
    buffer_load_dwordx4 v[200:203], v1, s[20:23], s60 offen offset:2048 sc1
    v_mfma_f32_32x32x16_bf16 v[32:47], v[124:127], v[232:235], v[32:47]
    ds_read_b128 v[120:123], v5 offset:14336
    s_waitcnt lgkmcnt(5)
    v_mfma_f32_32x32x16_bf16 v[48:63], v[96:99], v[232:235], v[48:63]
    ds_read_b128 v[124:127], v5 offset:15360
    s_waitcnt vmcnt(23)
    v_mfma_f32_32x32x16_bf16 v[16:31], v[100:103], v[236:239], v[16:31]
    ds_read_b128 v[96:99], v5 offset:16384
    buffer_load_dwordx4 v[204:207], v1, s[20:23], s60 offen offset:3072 sc1
    s_waitcnt lgkmcnt(5)
    v_mfma_f32_32x32x16_bf16 v[32:47], v[104:107], v[236:239], v[32:47]
    ds_read_b128 v[100:103], v5 offset:17408
    v_add_u32 v5, 81920, v6
    v_mfma_f32_32x32x16_bf16 v[48:63], v[108:111], v[236:239], v[48:63]
    ds_read_b128 v[104:107], v5 offset:0
    s_waitcnt vmcnt(23)
    s_waitcnt lgkmcnt(5)
    v_mfma_f32_32x32x16_bf16 v[16:31], v[112:115], v[240:243], v[16:31]
    ds_read_b128 v[108:111], v5 offset:1024
    s_add_u32 s60, s81, 53248
    buffer_load_dwordx4 v[208:211], v1, s[20:23], s60 offen offset:0 sc1
    v_mfma_f32_32x32x16_bf16 v[32:47], v[116:119], v[240:243], v[32:47]
    ds_read_b128 v[112:115], v5 offset:2048
    s_waitcnt lgkmcnt(5)
    v_mfma_f32_32x32x16_bf16 v[48:63], v[120:123], v[240:243], v[48:63]
    ds_read_b128 v[116:119], v5 offset:3072
    s_waitcnt vmcnt(23)
    v_mfma_f32_32x32x16_bf16 v[16:31], v[124:127], v[244:247], v[16:31]
    ds_read_b128 v[120:123], v5 offset:4096
    buffer_load_dwordx4 v[212:215], v1, s[20:23], s60 offen offset:1024 sc1
    s_waitcnt lgkmcnt(5)
    v_mfma_f32_32x32x16_bf16 v[32:47], v[96:99], v[244:247], v[32:47]
    ds_read_b128 v[124:127], v5 offset:5120
    v_mfma_f32_32x32x16_bf16 v[48:63], v[100:103], v[244:247], v[48:63]
    ds_read_b128 v[96:99], v5 offset:6144
    s_barrier
    s_waitcnt vmcnt(23)
    s_waitcnt lgkmcnt(5)
    v_mfma_f32_32x32x16_bf16 v[16:31], v[104:107], v[248:251], v[16:31]
    ds_read_b128 v[100:103], v5 offset:7168
    v_mfma_f32_32x32x16_bf16 v[32:47], v[108:111], v[248:251], v[32:47]
    ds_read_b128 v[104:107], v5 offset:8192
    s_waitcnt lgkmcnt(5)
    v_mfma_f32_32x32x16_bf16 v[48:63], v[112:115], v[248:251], v[48:63]
    ds_read_b128 v[108:111], v5 offset:9216
    s_waitcnt vmcnt(22)
    v_mfma_f32_32x32x16_bf16 v[16:31], v[116:119], v[252:255], v[16:31]
    ds_read_b128 v[112:115], v5 offset:10240
    s_waitcnt lgkmcnt(5)
    v_mfma_f32_32x32x16_bf16 v[32:47], v[120:123], v[252:255], v[32:47]
    ds_read_b128 v[116:119], v5 offset:11264
    v_mfma_f32_32x32x16_bf16 v[48:63], v[124:127], v[252:255], v[48:63]
    ds_read_b128 v[120:123], v5 offset:12288
    s_waitcnt vmcnt(21)
    s_waitcnt lgkmcnt(5)
    v_mfma_f32_32x32x16_bf16 v[16:31], v[96:99], v[128:131], v[16:31]
    ds_read_b128 v[124:127], v5 offset:13312
    v_mfma_f32_32x32x16_bf16 v[32:47], v[100:103], v[128:131], v[32:47]
    ds_read_b128 v[96:99], v5 offset:14336
    s_waitcnt lgkmcnt(5)
    v_mfma_f32_32x32x16_bf16 v[48:63], v[104:107], v[128:131], v[48:63]
    ds_read_b128 v[100:103], v5 offset:15360
    s_waitcnt vmcnt(20)
    v_mfma_f32_32x32x16_bf16 v[16:31], v[108:111], v[132:135], v[16:31]
    ds_read_b128 v[104:107], v5 offset:16384
    s_waitcnt lgkmcnt(5)
    v_mfma_f32_32x32x16_bf16 v[32:47], v[112:115], v[132:135], v[32:47]
    ds_read_b128 v[108:111], v5 offset:17408
    v_add_u32 v5, 0, v6
    v_mfma_f32_32x32x16_bf16 v[48:63], v[116:119], v[132:135], v[48:63]
    ds_read_b128 v[112:115], v5 offset:0
    s_waitcnt vmcnt(19)
    s_waitcnt lgkmcnt(5)
    v_mfma_f32_32x32x16_bf16 v[16:31], v[120:123], v[136:139], v[16:31]
    ds_read_b128 v[116:119], v5 offset:1024
    v_mfma_f32_32x32x16_bf16 v[32:47], v[124:127], v[136:139], v[32:47]
    ds_read_b128 v[120:123], v5 offset:2048
    s_waitcnt lgkmcnt(5)
    v_mfma_f32_32x32x16_bf16 v[48:63], v[96:99], v[136:139], v[48:63]
    ds_read_b128 v[124:127], v5 offset:3072
    s_waitcnt vmcnt(18)
    v_mfma_f32_32x32x16_bf16 v[16:31], v[100:103], v[140:143], v[16:31]
    ds_read_b128 v[96:99], v5 offset:4096
    s_waitcnt lgkmcnt(5)
    v_mfma_f32_32x32x16_bf16 v[32:47], v[104:107], v[140:143], v[32:47]
    ds_read_b128 v[100:103], v5 offset:5120
    v_mfma_f32_32x32x16_bf16 v[48:63], v[108:111], v[140:143], v[48:63]
    ds_read_b128 v[104:107], v5 offset:6144
    s_barrier
    s_waitcnt vmcnt(17)
    s_waitcnt lgkmcnt(5)
    v_mfma_f32_32x32x16_bf16 v[16:31], v[112:115], v[144:147], v[16:31]
    ds_read_b128 v[108:111], v5 offset:7168
    s_add_u32 s83, s82, 84049920
    v_mfma_f32_32x32x16_bf16 v[32:47], v[116:119], v[144:147], v[32:47]
    ds_read_b128 v[112:115], v5 offset:8192
    s_waitcnt lgkmcnt(5)
    v_mfma_f32_32x32x16_bf16 v[48:63], v[120:123], v[144:147], v[48:63]
    ds_read_b128 v[116:119], v5 offset:9216
    buffer_load_dwordx4 v[64:67], v1, s[20:23], s83 offen offset:0 sc1
    s_waitcnt vmcnt(17)
    v_mfma_f32_32x32x16_bf16 v[16:31], v[124:127], v[148:151], v[16:31]
    ds_read_b128 v[120:123], v5 offset:10240
    s_waitcnt lgkmcnt(5)
    v_mfma_f32_32x32x16_bf16 v[32:47], v[96:99], v[148:151], v[32:47]
    ds_read_b128 v[124:127], v5 offset:11264
    buffer_load_dwordx4 v[68:71], v1, s[20:23], s83 offen offset:1024 sc1
    v_mfma_f32_32x32x16_bf16 v[48:63], v[100:103], v[148:151], v[48:63]
    ds_read_b128 v[96:99], v5 offset:12288
    s_waitcnt vmcnt(17)
    s_waitcnt lgkmcnt(5)
    v_mfma_f32_32x32x16_bf16 v[16:31], v[104:107], v[152:155], v[16:31]
    ds_read_b128 v[100:103], v5 offset:13312
    buffer_load_dwordx4 v[72:75], v1, s[20:23], s83 offen offset:2048 sc1
    v_mfma_f32_32x32x16_bf16 v[32:47], v[108:111], v[152:155], v[32:47]
    ds_read_b128 v[104:107], v5 offset:14336
    s_waitcnt lgkmcnt(5)
    v_mfma_f32_32x32x16_bf16 v[48:63], v[112:115], v[152:155], v[48:63]
    ds_read_b128 v[108:111], v5 offset:15360
    s_waitcnt vmcnt(17)
    v_mfma_f32_32x32x16_bf16 v[16:31], v[116:119], v[156:159], v[16:31]
    ds_read_b128 v[112:115], v5 offset:16384
    s_add_u32 s83, s82, 83886080
    s_waitcnt lgkmcnt(5)
    v_mfma_f32_32x32x16_bf16 v[32:47], v[120:123], v[156:159], v[32:47]
    ds_read_b128 v[116:119], v5 offset:17408
    v_add_u32 v5, 122880, v6
    v_mfma_f32_32x32x16_bf16 v[48:63], v[124:127], v[156:159], v[48:63]
    ds_read_b128 v[120:123], v5 offset:0
    buffer_load_dwordx4 v[76:79], v1, s[20:23], s83 offen offset:0 sc1
    s_waitcnt vmcnt(17)
    s_waitcnt lgkmcnt(5)
    v_mfma_f32_32x32x16_bf16 v[16:31], v[96:99], v[160:163], v[16:31]
    ds_read_b128 v[124:127], v5 offset:1024
    v_mfma_f32_32x32x16_bf16 v[32:47], v[100:103], v[160:163], v[32:47]
    ds_read_b128 v[96:99], v5 offset:2048
    buffer_load_dwordx4 v[80:83], v1, s[20:23], s83 offen offset:1024 sc1
    s_waitcnt lgkmcnt(5)
    v_mfma_f32_32x32x16_bf16 v[48:63], v[104:107], v[160:163], v[48:63]
    ds_read_b128 v[100:103], v5 offset:3072
    s_waitcnt vmcnt(17)
    v_mfma_f32_32x32x16_bf16 v[16:31], v[108:111], v[164:167], v[16:31]
    ds_read_b128 v[104:107], v5 offset:4096
    buffer_load_dwordx4 v[84:87], v1, s[20:23], s83 offen offset:2048 sc1
    s_waitcnt lgkmcnt(5)
    v_mfma_f32_32x32x16_bf16 v[32:47], v[112:115], v[164:167], v[32:47]
    ds_read_b128 v[108:111], v5 offset:5120
    v_mfma_f32_32x32x16_bf16 v[48:63], v[116:119], v[164:167], v[48:63]
    ds_read_b128 v[112:115], v5 offset:6144
    s_barrier
    s_waitcnt vmcnt(17)
    s_waitcnt lgkmcnt(5)
    v_mfma_f32_32x32x16_bf16 v[16:31], v[120:123], v[168:171], v[16:31]
    ds_read_b128 v[116:119], v5 offset:7168
    v_bfe_u32 v2, v0, 5, 1
    v_lshlrev_b32 v2, 4, v2
    s_lshl_b32 s83, s68, 7
    s_mul_i32 s57, s70, 192
    s_add_u32 s83, s83, s57
    s_add_u32 s83, s83, 12800
    v_mfma_f32_32x32x16_bf16 v[32:47], v[124:127], v[168:171], v[32:47]
    ds_read_b128 v[120:123], v5 offset:8192
    s_waitcnt lgkmcnt(5)
    v_mfma_f32_32x32x16_bf16 v[48:63], v[96:99], v[168:171], v[48:63]
    ds_read_b128 v[124:127], v5 offset:9216
    buffer_load_dwordx4 v[128:131], v2, s[20:23], s83 offen offset:0 sc1
    s_waitcnt vmcnt(17)
    v_mfma_f32_32x32x16_bf16 v[16:31], v[100:103], v[172:175], v[16:31]
    ds_read_b128 v[96:99], v5 offset:10240
    s_waitcnt lgkmcnt(5)
    v_mfma_f32_32x32x16_bf16 v[32:47], v[104:107], v[172:175], v[32:47]
    ds_read_b128 v[100:103], v5 offset:11264
    v_mfma_f32_32x32x16_bf16 v[48:63], v[108:111], v[172:175], v[48:63]
    ds_read_b128 v[104:107], v5 offset:12288
    buffer_load_dwordx4 v[132:135], v2, s[20:23], s83 offen offset:32 sc1
    s_waitcnt vmcnt(17)
    s_waitcnt lgkmcnt(5)
    v_mfma_f32_32x32x16_bf16 v[16:31], v[112:115], v[176:179], v[16:31]
    ds_read_b128 v[108:111], v5 offset:13312
    v_mfma_f32_32x32x16_bf16 v[32:47], v[116:119], v[176:179], v[32:47]
    ds_read_b128 v[112:115], v5 offset:14336
    buffer_load_dwordx4 v[136:139], v2, s[20:23], s83 offen offset:64 sc1
    s_waitcnt lgkmcnt(5)
    v_mfma_f32_32x32x16_bf16 v[48:63], v[120:123], v[176:179], v[48:63]
    ds_read_b128 v[116:119], v5 offset:15360
    s_waitcnt vmcnt(17)
    v_mfma_f32_32x32x16_bf16 v[16:31], v[124:127], v[180:183], v[16:31]
    ds_read_b128 v[120:123], v5 offset:16384
    s_waitcnt lgkmcnt(5)
    v_mfma_f32_32x32x16_bf16 v[32:47], v[96:99], v[180:183], v[32:47]
    ds_read_b128 v[124:127], v5 offset:17408
    v_add_u32 v5, 40960, v6
    buffer_load_dwordx4 v[140:143], v2, s[20:23], s83 offen offset:96 sc1
    v_mfma_f32_32x32x16_bf16 v[48:63], v[100:103], v[180:183], v[48:63]
    ds_read_b128 v[96:99], v5 offset:0
    s_waitcnt vmcnt(17)
    s_waitcnt lgkmcnt(5)
    v_mfma_f32_32x32x16_bf16 v[16:31], v[104:107], v[184:187], v[16:31]
    ds_read_b128 v[100:103], v5 offset:1024
    buffer_load_dwordx4 v[144:147], v2, s[20:23], s83 offen offset:128 sc1
    v_mfma_f32_32x32x16_bf16 v[32:47], v[108:111], v[184:187], v[32:47]
    ds_read_b128 v[104:107], v5 offset:2048
    s_waitcnt lgkmcnt(5)
    v_mfma_f32_32x32x16_bf16 v[48:63], v[112:115], v[184:187], v[48:63]
    ds_read_b128 v[108:111], v5 offset:3072
    s_waitcnt vmcnt(17)
    v_mfma_f32_32x32x16_bf16 v[16:31], v[116:119], v[188:191], v[16:31]
    ds_read_b128 v[112:115], v5 offset:4096
    buffer_load_dwordx4 v[148:151], v2, s[20:23], s83 offen offset:160 sc1
    s_waitcnt lgkmcnt(5)
    v_mfma_f32_32x32x16_bf16 v[32:47], v[120:123], v[188:191], v[32:47]
    ds_read_b128 v[116:119], v5 offset:5120
    v_mfma_f32_32x32x16_bf16 v[48:63], v[124:127], v[188:191], v[48:63]
    ds_read_b128 v[120:123], v5 offset:6144
    s_barrier
    s_waitcnt vmcnt(17)
    s_waitcnt lgkmcnt(5)
    v_mfma_f32_32x32x16_bf16 v[16:31], v[96:99], v[192:195], v[16:31]
    ds_read_b128 v[124:127], v5 offset:7168
    v_mfma_f32_32x32x16_bf16 v[32:47], v[100:103], v[192:195], v[32:47]
    ds_read_b128 v[96:99], v5 offset:8192
    s_waitcnt lgkmcnt(5)
    v_mfma_f32_32x32x16_bf16 v[48:63], v[104:107], v[192:195], v[48:63]
    ds_read_b128 v[100:103], v5 offset:9216
    s_waitcnt vmcnt(16)
    v_mfma_f32_32x32x16_bf16 v[16:31], v[108:111], v[196:199], v[16:31]
    ds_read_b128 v[104:107], v5 offset:10240
    s_waitcnt lgkmcnt(5)
    v_mfma_f32_32x32x16_bf16 v[32:47], v[112:115], v[196:199], v[32:47]
    ds_read_b128 v[108:111], v5 offset:11264
    v_mfma_f32_32x32x16_bf16 v[48:63], v[116:119], v[196:199], v[48:63]
    ds_read_b128 v[112:115], v5 offset:12288
    s_waitcnt vmcnt(15)
    s_waitcnt lgkmcnt(5)
    v_mfma_f32_32x32x16_bf16 v[16:31], v[120:123], v[200:203], v[16:31]
    ds_read_b128 v[116:119], v5 offset:13312
    v_mfma_f32_32x32x16_bf16 v[32:47], v[124:127], v[200:203], v[32:47]
    ds_read_b128 v[120:123], v5 offset:14336
    s_waitcnt lgkmcnt(5)
    v_mfma_f32_32x32x16_bf16 v[48:63], v[96:99], v[200:203], v[48:63]
    ds_read_b128 v[124:127], v5 offset:15360
    s_waitcnt vmcnt(14)
    v_mfma_f32_32x32x16_bf16 v[16:31], v[100:103], v[204:207], v[16:31]
    ds_read_b128 v[96:99], v5 offset:16384
    s_waitcnt lgkmcnt(5)
    v_mfma_f32_32x32x16_bf16 v[32:47], v[104:107], v[204:207], v[32:47]
    ds_read_b128 v[100:103], v5 offset:17408
    v_mfma_f32_32x32x16_bf16 v[48:63], v[108:111], v[204:207], v[48:63]
    s_waitcnt vmcnt(13)
    s_waitcnt lgkmcnt(4)
    v_mfma_f32_32x32x16_bf16 v[16:31], v[112:115], v[208:211], v[16:31]
    v_mfma_f32_32x32x16_bf16 v[32:47], v[116:119], v[208:211], v[32:47]
    s_waitcnt lgkmcnt(2)
    v_mfma_f32_32x32x16_bf16 v[48:63], v[120:123], v[208:211], v[48:63]
    s_waitcnt vmcnt(12)
    v_mfma_f32_32x32x16_bf16 v[16:31], v[124:127], v[212:215], v[16:31]
    s_waitcnt lgkmcnt(0)
    v_mfma_f32_32x32x16_bf16 v[32:47], v[96:99], v[212:215], v[32:47]
    v_mfma_f32_32x32x16_bf16 v[48:63], v[100:103], v[212:215], v[48:63]
    s_barrier
    s_mul_i32 s56, s3, 6144
    s_add_u32 s56, s56, 40960
    v_add_u32 v3, s56, v1
    s_xor_b32 s56, s3, 2
    s_mul_i32 s56, s56, 6144
    s_add_u32 s56, s56, 40960
    v_add_u32 v5, s56, v1
    v_mov_b32 v4, 0xc0135761
    s_nop 1
    s_cmp_eq_u32 s70, 1
    s_cbranch_scc1 kb_g5e1
    ds_write_b128 v3, v[40:43] offset:0
    ds_write_b128 v3, v[44:47] offset:1024
    ds_write_b128 v3, v[48:51] offset:2048
    ds_write_b128 v3, v[52:55] offset:3072
    ds_write_b128 v3, v[56:59] offset:4096
    ds_write_b128 v3, v[60:63] offset:5120
    s_waitcnt lgkmcnt(0)
    s_barrier
    ds_read_b128 v[96:99], v5 offset:0
    ds_read_b128 v[100:103], v5 offset:1024
    ds_read_b128 v[104:107], v5 offset:2048
    ds_read_b128 v[108:111], v5 offset:3072
    ds_read_b128 v[112:115], v5 offset:4096
    ds_read_b128 v[116:119], v5 offset:5120
    s_waitcnt lgkmcnt(5)
    v_add_f32 v16, v16, v96
    v_add_f32 v17, v17, v97
    v_add_f32 v18, v18, v98
    v_add_f32 v19, v19, v99
    s_waitcnt lgkmcnt(4)
    v_add_f32 v20, v20, v100
    v_add_f32 v21, v21, v101
    v_add_f32 v22, v22, v102
    v_add_f32 v23, v23, v103
    s_waitcnt lgkmcnt(3)
    v_add_f32 v24, v24, v104
    v_add_f32 v25, v25, v105
    v_add_f32 v26, v26, v106
    v_add_f32 v27, v27, v107
    s_waitcnt lgkmcnt(2)
    v_add_f32 v28, v28, v108
    v_add_f32 v29, v29, v109
    v_add_f32 v30, v30, v110
    v_add_f32 v31, v31, v111
    s_waitcnt lgkmcnt(1)
    v_add_f32 v32, v32, v112
    v_add_f32 v33, v33, v113
    v_add_f32 v34, v34, v114
    v_add_f32 v35, v35, v115
    s_waitcnt lgkmcnt(0)
    v_add_f32 v36, v36, v116
    v_add_f32 v37, v37, v117
    v_add_f32 v38, v38, v118
    v_add_f32 v39, v39, v119
    s_waitcnt vmcnt(0)
    v_lshlrev_b32 v160, 16, v64
    v_and_b32 v161, 0xffff0000, v64
    v_lshlrev_b32 v162, 16, v65
    v_and_b32 v163, 0xffff0000, v65
    v_lshlrev_b32 v164, 16, v66
    v_and_b32 v165, 0xffff0000, v66
    v_lshlrev_b32 v166, 16, v67
    v_and_b32 v167, 0xffff0000, v67
    v_lshlrev_b32 v168, 16, v68
    v_and_b32 v169, 0xffff0000, v68
    v_lshlrev_b32 v170, 16, v69
    v_and_b32 v171, 0xffff0000, v69
    v_lshlrev_b32 v172, 16, v70
    v_and_b32 v173, 0xffff0000, v70
    v_lshlrev_b32 v174, 16, v71
    v_and_b32 v175, 0xffff0000, v71
    v_lshlrev_b32 v176, 16, v72
    v_and_b32 v177, 0xffff0000, v72
    v_lshlrev_b32 v178, 16, v73
    v_and_b32 v179, 0xffff0000, v73
    v_lshlrev_b32 v180, 16, v74
    v_and_b32 v181, 0xffff0000, v74
    v_lshlrev_b32 v182, 16, v75
    v_and_b32 v183, 0xffff0000, v75
    v_add_f32 v16, v16, v160
    v_add_f32 v17, v17, v161
    v_add_f32 v18, v18, v162
    v_add_f32 v19, v19, v163
    v_add_f32 v20, v20, v164
    v_add_f32 v21, v21, v165
    v_add_f32 v22, v22, v166
    v_add_f32 v23, v23, v167
    v_add_f32 v24, v24, v168
    v_add_f32 v25, v25, v169
    v_add_f32 v26, v26, v170
    v_add_f32 v27, v27, v171
    v_add_f32 v28, v28, v172
    v_add_f32 v29, v29, v173
    v_add_f32 v30, v30, v174
    v_add_f32 v31, v31, v175
    v_add_f32 v32, v32, v176
    v_add_f32 v33, v33, v177
    v_add_f32 v34, v34, v178
    v_add_f32 v35, v35, v179
    v_add_f32 v36, v36, v180
    v_add_f32 v37, v37, v181
    v_add_f32 v38, v38, v182
    v_add_f32 v39, v39, v183
    v_lshlrev_b32 v160, 16, v76
    v_and_b32 v161, 0xffff0000, v76
    v_lshlrev_b32 v162, 16, v77
    v_and_b32 v163, 0xffff0000, v77
    v_lshlrev_b32 v164, 16, v78
    v_and_b32 v165, 0xffff0000, v78
    v_lshlrev_b32 v166, 16, v79
    v_and_b32 v167, 0xffff0000, v79
    v_lshlrev_b32 v168, 16, v80
    v_and_b32 v169, 0xffff0000, v80
    v_lshlrev_b32 v170, 16, v81
    v_and_b32 v171, 0xffff0000, v81
    v_lshlrev_b32 v172, 16, v82
    v_and_b32 v173, 0xffff0000, v82
    v_lshlrev_b32 v174, 16, v83
    v_and_b32 v175, 0xffff0000, v83
    v_lshlrev_b32 v176, 16, v84
    v_and_b32 v177, 0xffff0000, v84
    v_lshlrev_b32 v178, 16, v85
    v_and_b32 v179, 0xffff0000, v85
    v_lshlrev_b32 v180, 16, v86
    v_and_b32 v181, 0xffff0000, v86
    v_lshlrev_b32 v182, 16, v87
    v_and_b32 v183, 0xffff0000, v87
    v_fma_f32 v16, v16, v128, v160
    v_fma_f32 v17, v17, v129, v161
    v_fma_f32 v18, v18, v130, v162
    v_fma_f32 v19, v19, v131, v163
    v_fma_f32 v20, v20, v132, v164
    v_fma_f32 v21, v21, v133, v165
    v_fma_f32 v22, v22, v134, v166
    v_fma_f32 v23, v23, v135, v167
    v_fma_f32 v24, v24, v136, v168
    v_fma_f32 v25, v25, v137, v169
    v_fma_f32 v26, v26, v138, v170
    v_fma_f32 v27, v27, v139, v171
    v_fma_f32 v28, v28, v140, v172
    v_fma_f32 v29, v29, v141, v173
    v_fma_f32 v30, v30, v142, v174
    v_fma_f32 v31, v31, v143, v175
    v_fma_f32 v32, v32, v144, v176
    v_fma_f32 v33, v33, v145, v177
    v_fma_f32 v34, v34, v146, v178
    v_fma_f32 v35, v35, v147, v179
    v_fma_f32 v36, v36, v148, v180
    v_fma_f32 v37, v37, v149, v181
    v_fma_f32 v38, v38, v150, v182
    v_fma_f32 v39, v39, v151, v183
    v_and_b32 v2, 31, v0
    v_mul_u32_u24 v2, 1280, v2
    v_bfe_u32 v3, v0, 5, 1
    v_lshl_add_u32 v2, v3, 4, v2
    s_mul_i32 s56, s67, 40960
    s_lshl_b32 s57, s68, 6
    s_add_u32 s56, s56, s57
    v_cvt_pk_bf16_f32 v16, v16, v17
    v_cvt_pk_bf16_f32 v17, v18, v19
    v_cvt_pk_bf16_f32 v18, v20, v21
    v_cvt_pk_bf16_f32 v19, v22, v23
    s_nop 1
    v_permlane32_swap_b32 v16, v18
    v_permlane32_swap_b32 v17, v19
    buffer_store_dwordx4 v[16:19], v2, s[28:31], s56 offen offset:0
    v_cvt_pk_bf16_f32 v24, v24, v25
    v_cvt_pk_bf16_f32 v25, v26, v27
    v_cvt_pk_bf16_f32 v26, v28, v29
    v_cvt_pk_bf16_f32 v27, v30, v31
    s_nop 1
    v_permlane32_swap_b32 v24, v26
    v_permlane32_swap_b32 v25, v27
    buffer_store_dwordx4 v[24:27], v2, s[28:31], s56 offen offset:32
    v_cvt_pk_bf16_f32 v32, v32, v33
    v_cvt_pk_bf16_f32 v33, v34, v35
    v_cvt_pk_bf16_f32 v34, v36, v37
    v_cvt_pk_bf16_f32 v35, v38, v39
    s_nop 1
    v_permlane32_swap_b32 v32, v34
    v_permlane32_swap_b32 v33, v35
    buffer_store_dwordx4 v[32:35], v2, s[28:31], s56 offen offset:64
    s_branch kb_g5e2
kb_g5e1:
    ds_write_b128 v3, v[16:19] offset:0
    ds_write_b128 v3, v[20:23] offset:1024
    ds_write_b128 v3, v[24:27] offset:2048
    ds_write_b128 v3, v[28:31] offset:3072
    ds_write_b128 v3, v[32:35] offset:4096
    ds_write_b128 v3, v[36:39] offset:5120
    s_waitcnt lgkmcnt(0)
    s_barrier
    ds_read_b128 v[96:99], v5 offset:0
    ds_read_b128 v[100:103], v5 offset:1024
    ds_read_b128 v[104:107], v5 offset:2048
    ds_read_b128 v[108:111], v5 offset:3072
    ds_read_b128 v[112:115], v5 offset:4096
    ds_read_b128 v[116:119], v5 offset:5120
    s_waitcnt lgkmcnt(5)
    v_add_f32 v40, v40, v96
    v_add_f32 v41, v41, v97
    v_add_f32 v42, v42, v98
    v_add_f32 v43, v43, v99
    s_waitcnt lgkmcnt(4)
    v_add_f32 v44, v44, v100
    v_add_f32 v45, v45, v101
    v_add_f32 v46, v46, v102
    v_add_f32 v47, v47, v103
    s_waitcnt lgkmcnt(3)
    v_add_f32 v48, v48, v104
    v_add_f32 v49, v49, v105
    v_add_f32 v50, v50, v106
    v_add_f32 v51, v51, v107
    s_waitcnt lgkmcnt(2)
    v_add_f32 v52, v52, v108
    v_add_f32 v53, v53, v109
    v_add_f32 v54, v54, v110
    v_add_f32 v55, v55, v111
    s_waitcnt lgkmcnt(1)
    v_add_f32 v56, v56, v112
    v_add_f32 v57, v57, v113
    v_add_f32 v58, v58, v114
    v_add_f32 v59, v59, v115
    s_waitcnt lgkmcnt(0)
    v_add_f32 v60, v60, v116
    v_add_f32 v61, v61, v117
    v_add_f32 v62, v62, v118
    v_add_f32 v63, v63, v119
    s_waitcnt vmcnt(0)
    v_lshlrev_b32 v160, 16, v64
    v_and_b32 v161, 0xffff0000, v64
    v_lshlrev_b32 v162, 16, v65
    v_and_b32 v163, 0xffff0000, v65
    v_lshlrev_b32 v164, 16, v66
    v_and_b32 v165, 0xffff0000, v66
    v_lshlrev_b32 v166, 16, v67
    v_and_b32 v167, 0xffff0000, v67
    v_lshlrev_b32 v168, 16, v68
    v_and_b32 v169, 0xffff0000, v68
    v_lshlrev_b32 v170, 16, v69
    v_and_b32 v171, 0xffff0000, v69
    v_lshlrev_b32 v172, 16, v70
    v_and_b32 v173, 0xffff0000, v70
    v_lshlrev_b32 v174, 16, v71
    v_and_b32 v175, 0xffff0000, v71
    v_lshlrev_b32 v176, 16, v72
    v_and_b32 v177, 0xffff0000, v72
    v_lshlrev_b32 v178, 16, v73
    v_and_b32 v179, 0xffff0000, v73
    v_lshlrev_b32 v180, 16, v74
    v_and_b32 v181, 0xffff0000, v74
    v_lshlrev_b32 v182, 16, v75
    v_and_b32 v183, 0xffff0000, v75
    v_add_f32 v40, v40, v160
    v_add_f32 v41, v41, v161
    v_add_f32 v42, v42, v162
    v_add_f32 v43, v43, v163
    v_add_f32 v44, v44, v164
    v_add_f32 v45, v45, v165
    v_add_f32 v46, v46, v166
    v_add_f32 v47, v47, v167
    v_add_f32 v48, v48, v168
    v_add_f32 v49, v49, v169
    v_add_f32 v50, v50, v170
    v_add_f32 v51, v51, v171
    v_add_f32 v52, v52, v172
    v_add_f32 v53, v53, v173
    v_add_f32 v54, v54, v174
    v_add_f32 v55, v55, v175
    v_add_f32 v56, v56, v176
    v_add_f32 v57, v57, v177
    v_add_f32 v58, v58, v178
    v_add_f32 v59, v59, v179
    v_add_f32 v60, v60, v180
    v_add_f32 v61, v61, v181
    v_add_f32 v62, v62, v182
    v_add_f32 v63, v63, v183
    v_lshlrev_b32 v160, 16, v76
    v_and_b32 v161, 0xffff0000, v76
    v_lshlrev_b32 v162, 16, v77
    v_and_b32 v163, 0xffff0000, v77
    v_lshlrev_b32 v164, 16, v78
    v_and_b32 v165, 0xffff0000, v78
    v_lshlrev_b32 v166, 16, v79
    v_and_b32 v167, 0xffff0000, v79
    v_lshlrev_b32 v168, 16, v80
    v_and_b32 v169, 0xffff0000, v80
    v_lshlrev_b32 v170, 16, v81
    v_and_b32 v171, 0xffff0000, v81
    v_lshlrev_b32 v172, 16, v82
    v_and_b32 v173, 0xffff0000, v82
    v_lshlrev_b32 v174, 16, v83
    v_and_b32 v175, 0xffff0000, v83
    v_lshlrev_b32 v176, 16, v84
    v_and_b32 v177, 0xffff0000, v84
    v_lshlrev_b32 v178, 16, v85
    v_and_b32 v179, 0xffff0000, v85
    v_lshlrev_b32 v180, 16, v86
    v_and_b32 v181, 0xffff0000, v86
    v_lshlrev_b32 v182, 16, v87
    v_and_b32 v183, 0xffff0000, v87
    v_fma_f32 v40, v40, v128, v160
    v_fma_f32 v41, v41, v129, v161
    v_fma_f32 v42, v42, v130, v162
    v_fma_f32 v43, v43, v131, v163
    v_fma_f32 v44, v44, v132, v164
    v_fma_f32 v45, v45, v133, v165
    v_fma_f32 v46, v46, v134, v166
    v_fma_f32 v47, v47, v135, v167
    v_fma_f32 v48, v48, v136, v168
    v_fma_f32 v49, v49, v137, v169
    v_fma_f32 v50, v50, v138, v170
    v_fma_f32 v51, v51, v139, v171
    v_fma_f32 v52, v52, v140, v172
    v_fma_f32 v53, v53, v141, v173
    v_fma_f32 v54, v54, v142, v174
    v_fma_f32 v55, v55, v143, v175
    v_fma_f32 v56, v56, v144, v176
    v_fma_f32 v57, v57, v145, v177
    v_fma_f32 v58, v58, v146, v178
    v_fma_f32 v59, v59, v147, v179
    v_fma_f32 v60, v60, v148, v180
    v_fma_f32 v61, v61, v149, v181
    v_fma_f32 v62, v62, v150, v182
    v_fma_f32 v63, v63, v151, v183
    v_and_b32 v2, 31, v0
    v_mul_u32_u24 v2, 1280, v2
    v_bfe_u32 v3, v0, 5, 1
    v_lshl_add_u32 v2, v3, 4, v2
    s_mul_i32 s56, s67, 40960
    s_lshl_b32 s57, s68, 6
    s_add_u32 s56, s56, s57
    v_cvt_pk_bf16_f32 v40, v40, v41
    v_cvt_pk_bf16_f32 v41, v42, v43
    v_cvt_pk_bf16_f32 v42, v44, v45
    v_cvt_pk_bf16_f32 v43, v46, v47
    s_nop 1
    v_permlane32_swap_b32 v40, v42
    v_permlane32_swap_b32 v41, v43
    buffer_store_dwordx4 v[40:43], v2, s[28:31], s56 offen offset:96
    v_cvt_pk_bf16_f32 v48, v48, v49
    v_cvt_pk_bf16_f32 v49, v50, v51
    v_cvt_pk_bf16_f32 v50, v52, v53
    v_cvt_pk_bf16_f32 v51, v54, v55
    s_nop 1
    v_permlane32_swap_b32 v48, v50
    v_permlane32_swap_b32 v49, v51
    buffer_store_dwordx4 v[48:51], v2, s[28:31], s56 offen offset:128
    v_cvt_pk_bf16_f32 v56, v56, v57
    v_cvt_pk_bf16_f32 v57, v58, v59
    v_cvt_pk_bf16_f32 v58, v60, v61
    v_cvt_pk_bf16_f32 v59, v62, v63
    s_nop 1
    v_permlane32_swap_b32 v56, v58
    v_permlane32_swap_b32 v57, v59
    buffer_store_dwordx4 v[56:59], v2, s[28:31], s56 offen offset:160
kb_g5e2:
    s_endpgm
S_path:
    s_waitcnt lgkmcnt(10)
    v_mfma_f32_16x16x32_bf16 v[16:19], v[80:83], v[112:115], 0
    ds_read_b64_tr_b16 v[108:109], v2 offset:25376
    ds_read_b64_tr_b16 v[110:111], v2 offset:25888
    v_mfma_f32_16x16x32_bf16 v[24:27], v[80:83], v[116:119], 0
    s_add_u32 m0, s15, 69632
    s_add_u32 s41, s38, 2097152
    buffer_load_dwordx4 v14, s[20:23], s41 offen nt lds
    v_mfma_f32_16x16x32_bf16 v[20:23], v[84:87], v[112:115], 0
    ds_read_b64_tr_b16 v[80:81], v2 offset:64
    ds_read_b64_tr_b16 v[82:83], v2 offset:576
    v_mfma_f32_16x16x32_bf16 v[28:31], v[84:87], v[116:119], 0
    s_waitcnt lgkmcnt(10)
    v_mfma_f32_16x16x32_bf16 v[16:19], v[88:91], v[120:123], v[16:19]
    ds_read_b64_tr_b16 v[84:85], v2 offset:96
    ds_read_b64_tr_b16 v[86:87], v2 offset:608
    v_mfma_f32_16x16x32_bf16 v[24:27], v[88:91], v[124:127], v[24:27]
    s_add_u32 s92, s90, 32505856
    buffer_store_dwordx4 v[192:195], v4, s[16:19], s92 offen offset:0 sc1
    v_mfma_f32_16x16x32_bf16 v[20:23], v[92:95], v[120:123], v[20:23]
    ds_read_b64_tr_b16 v[88:89], v2 offset:8512
    ds_read_b64_tr_b16 v[90:91], v2 offset:9024
    v_mfma_f32_16x16x32_bf16 v[28:31], v[92:95], v[124:127], v[28:31]
    v_cvt_pk_bf16_f32 v248, v64, v65
    v_cvt_pk_bf16_f32 v249, v66, v67
    v_cvt_pk_bf16_f32 v250, v72, v73
    v_cvt_pk_bf16_f32 v251, v74, v75
    v_cvt_pk_bf16_f32 v252, v68, v69
    s_add_u32 m0, s15, 70688
    s_add_u32 s41, s38, 2105344
    buffer_load_dwordx4 v14, s[20:23], s41 offen nt lds
    s_waitcnt lgkmcnt(10)
    v_mfma_f32_16x16x32_bf16 v[16:19], v[96:99], v[128:131], v[16:19]
    ds_read_b64_tr_b16 v[92:93], v2 offset:8544
    ds_read_b64_tr_b16 v[94:95], v2 offset:9056
    v_mfma_f32_16x16x32_bf16 v[24:27], v[96:99], v[132:135], v[24:27]
    v_cvt_pk_bf16_f32 v253, v70, v71
    v_cvt_pk_bf16_f32 v254, v76, v77
    v_cvt_pk_bf16_f32 v255, v78, v79
    s_nop 0
    v_mfma_f32_16x16x32_bf16 v[20:23], v[100:103], v[128:131], v[20:23]
    ds_read_b64_tr_b16 v[96:97], v2 offset:16960
    ds_read_b64_tr_b16 v[98:99], v2 offset:17472
    v_mfma_f32_16x16x32_bf16 v[28:31], v[100:103], v[132:135], v[28:31]
    v_permlane16_swap_b32 v248, v250
    v_permlane16_swap_b32 v249, v251
    v_permlane16_swap_b32 v252, v254
    v_permlane16_swap_b32 v253, v255
    s_waitcnt lgkmcnt(10)
    v_mfma_f32_16x16x32_bf16 v[16:19], v[104:107], v[136:139], v[16:19]
    ds_read_b64_tr_b16 v[100:101], v2 offset:16992
    ds_read_b64_tr_b16 v[102:103], v2 offset:17504
    v_mfma_f32_16x16x32_bf16 v[24:27], v[104:107], v[140:143], v[24:27]
    v_permlane32_swap_b32 v248, v250
    v_permlane32_swap_b32 v249, v251
    v_permlane32_swap_b32 v252, v254
    v_permlane32_swap_b32 v253, v255
    s_add_u32 m0, s15, 71744
    s_add_u32 s41, s38, 2113536
    buffer_load_dwordx4 v14, s[20:23], s41 offen nt lds
    v_mfma_f32_16x16x32_bf16 v[20:23], v[108:111], v[136:139], v[20:23]
    ds_read_b64_tr_b16 v[104:105], v2 offset:25408
    ds_read_b64_tr_b16 v[106:107], v2 offset:25920
    v_mfma_f32_16x16x32_bf16 v[28:31], v[108:111], v[140:143], v[28:31]
    s_waitcnt lgkmcnt(10)
    v_mfma_f32_16x16x32_bf16 v[32:35], v[80:83], v[112:115], 0
    ds_read_b64_tr_b16 v[108:109], v2 offset:25440
    ds_read_b64_tr_b16 v[110:111], v2 offset:25952
    v_mfma_f32_16x16x32_bf16 v[40:43], v[80:83], v[116:119], 0
    v_mfma_f32_16x16x32_bf16 v[36:39], v[84:87], v[112:115], 0
    ds_read_b64_tr_b16 v[80:81], v2 offset:128
    ds_read_b64_tr_b16 v[82:83], v2 offset:640
    v_mfma_f32_16x16x32_bf16 v[44:47], v[84:87], v[116:119], 0
    s_add_u32 m0, s15, 72800
    s_add_u32 s41, s38, 2121728
    buffer_load_dwordx4 v14, s[20:23], s41 offen nt lds
    s_waitcnt lgkmcnt(10)
    v_mfma_f32_16x16x32_bf16 v[32:35], v[88:91], v[120:123], v[32:35]
    ds_read_b64_tr_b16 v[84:85], v2 offset:160
    ds_read_b64_tr_b16 v[86:87], v2 offset:672
    v_mfma_f32_16x16x32_bf16 v[40:43], v[88:91], v[124:127], v[40:43]
    v_mfma_f32_16x16x32_bf16 v[36:39], v[92:95], v[120:123], v[36:39]
    ds_read_b64_tr_b16 v[88:89], v2 offset:8576
    ds_read_b64_tr_b16 v[90:91], v2 offset:9088
    v_mfma_f32_16x16x32_bf16 v[44:47], v[92:95], v[124:127], v[44:47]
    s_waitcnt lgkmcnt(10)
    v_mfma_f32_16x16x32_bf16 v[32:35], v[96:99], v[128:131], v[32:35]
    ds_read_b64_tr_b16 v[92:93], v2 offset:8608
    ds_read_b64_tr_b16 v[94:95], v2 offset:9120
    v_mfma_f32_16x16x32_bf16 v[40:43], v[96:99], v[132:135], v[40:43]
    s_add_u32 s92, s90, 32509952
    buffer_store_dwordx4 v[196:199], v4, s[16:19], s92 offen offset:0 sc1
    s_add_u32 s42, s40, 16384
    buffer_load_dwordx4 v[176:179], v4, s[16:19], s42 offen offset:0 sc1
    v_mfma_f32_16x16x32_bf16 v[36:39], v[100:103], v[128:131], v[36:39]
    ds_read_b64_tr_b16 v[96:97], v2 offset:17024
    ds_read_b64_tr_b16 v[98:99], v2 offset:17536
    v_mfma_f32_16x16x32_bf16 v[44:47], v[100:103], v[132:135], v[44:47]
    s_waitcnt lgkmcnt(10)
    v_mfma_f32_16x16x32_bf16 v[32:35], v[104:107], v[136:139], v[32:35]
    ds_read_b64_tr_b16 v[100:101], v2 offset:17056
    ds_read_b64_tr_b16 v[102:103], v2 offset:17568
    v_mfma_f32_16x16x32_bf16 v[40:43], v[104:107], v[140:143], v[40:43]
    v_mfma_f32_16x16x32_bf16 v[36:39], v[108:111], v[136:139], v[36:39]
    ds_read_b64_tr_b16 v[104:105], v2 offset:25472
    ds_read_b64_tr_b16 v[106:107], v2 offset:25984
    v_mfma_f32_16x16x32_bf16 v[44:47], v[108:111], v[140:143], v[44:47]
    buffer_load_dwordx4 v[180:183], v4, s[16:19], s42 offen offset:1024 sc1
    s_waitcnt lgkmcnt(10)
    v_mfma_f32_16x16x32_bf16 v[48:51], v[80:83], v[112:115], 0
    ds_read_b64_tr_b16 v[108:109], v2 offset:25504
    ds_read_b64_tr_b16 v[110:111], v2 offset:26016
    v_mfma_f32_16x16x32_bf16 v[56:59], v[80:83], v[116:119], 0
    v_mfma_f32_16x16x32_bf16 v[52:55], v[84:87], v[112:115], 0
    ds_read_b64_tr_b16 v[80:81], v2 offset:192
    ds_read_b64_tr_b16 v[82:83], v2 offset:704
    v_mfma_f32_16x16x32_bf16 v[60:63], v[84:87], v[116:119], 0
    s_waitcnt lgkmcnt(10)
    v_mfma_f32_16x16x32_bf16 v[48:51], v[88:91], v[120:123], v[48:51]
    ds_read_b64_tr_b16 v[84:85], v2 offset:224
    ds_read_b64_tr_b16 v[86:87], v2 offset:736
    v_mfma_f32_16x16x32_bf16 v[56:59], v[88:91], v[124:127], v[56:59]
    buffer_load_dwordx4 v[184:187], v4, s[16:19], s42 offen offset:2048 sc1
    v_mfma_f32_16x16x32_bf16 v[52:55], v[92:95], v[120:123], v[52:55]
    ds_read_b64_tr_b16 v[88:89], v2 offset:8640
    ds_read_b64_tr_b16 v[90:91], v2 offset:9152
    v_mfma_f32_16x16x32_bf16 v[60:63], v[92:95], v[124:127], v[60:63]
    s_waitcnt lgkmcnt(10)
    v_mfma_f32_16x16x32_bf16 v[48:51], v[96:99], v[128:131], v[48:51]
    ds_read_b64_tr_b16 v[92:93], v2 offset:8672
    ds_read_b64_tr_b16 v[94:95], v2 offset:9184
    v_mfma_f32_16x16x32_bf16 v[56:59], v[96:99], v[132:135], v[56:59]
    v_mfma_f32_16x16x32_bf16 v[52:55], v[100:103], v[128:131], v[52:55]
    ds_read_b64_tr_b16 v[96:97], v2 offset:17088
    ds_read_b64_tr_b16 v[98:99], v2 offset:17600
    v_mfma_f32_16x16x32_bf16 v[60:63], v[100:103], v[132:135], v[60:63]
    buffer_load_dwordx4 v[188:191], v4, s[16:19], s42 offen offset:3072 sc1
    s_waitcnt lgkmcnt(10)
    v_mfma_f32_16x16x32_bf16 v[48:51], v[104:107], v[136:139], v[48:51]
    ds_read_b64_tr_b16 v[100:101], v2 offset:17120
    ds_read_b64_tr_b16 v[102:103], v2 offset:17632
    v_mfma_f32_16x16x32_bf16 v[56:59], v[104:107], v[140:143], v[56:59]
    s_add_u32 s92, s90, 32505856
    buffer_store_dwordx4 v[200:203], v4, s[16:19], s92 offen offset:1024 sc1
    v_mfma_f32_16x16x32_bf16 v[52:55], v[108:111], v[136:139], v[52:55]
    ds_read_b64_tr_b16 v[104:105], v2 offset:25536
    ds_read_b64_tr_b16 v[106:107], v2 offset:26048
    v_mfma_f32_16x16x32_bf16 v[60:63], v[108:111], v[140:143], v[60:63]
    s_waitcnt lgkmcnt(10)
    v_mfma_f32_16x16x32_bf16 v[64:67], v[80:83], v[112:115], 0
    ds_read_b64_tr_b16 v[108:109], v2 offset:25568
    ds_read_b64_tr_b16 v[110:111], v2 offset:26080
    v_mfma_f32_16x16x32_bf16 v[72:75], v[80:83], v[116:119], 0
    v_add_u32 v2, s9, v1
    s_waitcnt vmcnt(14)
    s_barrier
    v_mfma_f32_16x16x32_bf16 v[68:71], v[84:87], v[112:115], 0
    ds_read_b64_tr_b16 v[80:81], v2 offset:0
    ds_read_b64_tr_b16 v[82:83], v2 offset:512
    v_mfma_f32_16x16x32_bf16 v[76:79], v[84:87], v[116:119], 0
    s_waitcnt lgkmcnt(10)
    v_mfma_f32_16x16x32_bf16 v[64:67], v[88:91], v[120:123], v[64:67]
    ds_read_b64_tr_b16 v[84:85], v2 offset:32
    ds_read_b64_tr_b16 v[86:87], v2 offset:544
    v_mfma_f32_16x16x32_bf16 v[72:75], v[88:91], v[124:127], v[72:75]
    v_mfma_f32_16x16x32_bf16 v[68:71], v[92:95], v[120:123], v[68:71]
    ds_read_b64_tr_b16 v[88:89], v2 offset:64
    ds_read_b64_tr_b16 v[90:91], v2 offset:576
    v_mfma_f32_16x16x32_bf16 v[76:79], v[92:95], v[124:127], v[76:79]
    s_waitcnt lgkmcnt(10)
    v_mfma_f32_16x16x32_bf16 v[64:67], v[96:99], v[128:131], v[64:67]
    ds_read_b64_tr_b16 v[92:93], v2 offset:96
    ds_read_b64_tr_b16 v[94:95], v2 offset:608
    v_mfma_f32_16x16x32_bf16 v[72:75], v[96:99], v[132:135], v[72:75]
    v_mfma_f32_16x16x32_bf16 v[68:71], v[100:103], v[128:131], v[68:71]
    ds_read_b64_tr_b16 v[96:97], v2 offset:128
    ds_read_b64_tr_b16 v[98:99], v2 offset:640
    v_mfma_f32_16x16x32_bf16 v[76:79], v[100:103], v[132:135], v[76:79]
    s_waitcnt lgkmcnt(10)
    v_mfma_f32_16x16x32_bf16 v[64:67], v[104:107], v[136:139], v[64:67]
    ds_read_b64_tr_b16 v[100:101], v2 offset:160
    ds_read_b64_tr_b16 v[102:103], v2 offset:672
    v_mfma_f32_16x16x32_bf16 v[72:75], v[104:107], v[140:143], v[72:75]
    v_mfma_f32_16x16x32_bf16 v[68:71], v[108:111], v[136:139], v[68:71]
    ds_read_b64_tr_b16 v[104:105], v2 offset:192
    ds_read_b64_tr_b16 v[106:107], v2 offset:704
    v_mfma_f32_16x16x32_bf16 v[76:79], v[108:111], v[140:143], v[76:79]
    s_waitcnt lgkmcnt(10)
    v_mfma_f32_16x16x32_bf16 v[16:19], v[80:83], v[144:147], v[16:19]
    ds_read_b64_tr_b16 v[108:109], v2 offset:224
    ds_read_b64_tr_b16 v[110:111], v2 offset:736
    v_mfma_f32_16x16x32_bf16 v[24:27], v[80:83], v[148:151], v[24:27]
    s_add_u32 s92, s90, 32509952
    buffer_store_dwordx4 v[204:207], v4, s[16:19], s92 offen offset:1024 sc1
    v_and_b32 v10, 31, v0
    v_mfma_f32_16x16x32_bf16 v[20:23], v[84:87], v[144:147], v[20:23]
    ds_read_b64_tr_b16 v[80:81], v2 offset:8448
    ds_read_b64_tr_b16 v[82:83], v2 offset:8960
    v_mfma_f32_16x16x32_bf16 v[28:31], v[84:87], v[148:151], v[28:31]
    v_bfe_u32 v11, v0, 5, 1
    s_add_u32 s42, s40, 20480
    buffer_load_dwordx4 v[192:195], v4, s[16:19], s42 offen offset:0 sc1
    s_waitcnt lgkmcnt(10)
    v_mfma_f32_16x16x32_bf16 v[32:35], v[88:91], v[144:147], v[32:35]
    ds_read_b64_tr_b16 v[84:85], v2 offset:8480
    ds_read_b64_tr_b16 v[86:87], v2 offset:8992
    v_mfma_f32_16x16x32_bf16 v[40:43], v[88:91], v[148:151], v[40:43]
    v_lshlrev_b32 v11, 2, v11
    v_mfma_f32_16x16x32_bf16 v[36:39], v[92:95], v[144:147], v[36:39]
    ds_read_b64_tr_b16 v[88:89], v2 offset:8512
    ds_read_b64_tr_b16 v[90:91], v2 offset:9024
    v_mfma_f32_16x16x32_bf16 v[44:47], v[92:95], v[148:151], v[44:47]
    v_sub_u32 v10, v10, v11
    buffer_load_dwordx4 v[196:199], v4, s[16:19], s42 offen offset:1024 sc1
    s_waitcnt lgkmcnt(10)
    v_mfma_f32_16x16x32_bf16 v[48:51], v[96:99], v[144:147], v[48:51]
    ds_read_b64_tr_b16 v[92:93], v2 offset:8544
    ds_read_b64_tr_b16 v[94:95], v2 offset:9056
    v_mfma_f32_16x16x32_bf16 v[56:59], v[96:99], v[148:151], v[56:59]
    v_cmp_gt_i32 s[48:49], 0, v10
    v_mfma_f32_16x16x32_bf16 v[52:55], v[100:103], v[144:147], v[52:55]
    ds_read_b64_tr_b16 v[96:97], v2 offset:8576
    ds_read_b64_tr_b16 v[98:99], v2 offset:9088
    v_mfma_f32_16x16x32_bf16 v[60:63], v[100:103], v[148:151], v[60:63]
    v_cmp_gt_i32 s[50:51], 1, v10
    s_waitcnt lgkmcnt(10)
    v_mfma_f32_16x16x32_bf16 v[64:67], v[104:107], v[144:147], v[64:67]
    ds_read_b64_tr_b16 v[100:101], v2 offset:8608
    ds_read_b64_tr_b16 v[102:103], v2 offset:9120
    v_mfma_f32_16x16x32_bf16 v[72:75], v[104:107], v[148:151], v[72:75]
    v_cmp_gt_i32 s[52:53], 2, v10
    buffer_load_dwordx4 v[200:203], v4, s[16:19], s42 offen offset:2048 sc1
    v_mfma_f32_16x16x32_bf16 v[68:71], v[108:111], v[144:147], v[68:71]
    ds_read_b64_tr_b16 v[104:105], v2 offset:8640
    ds_read_b64_tr_b16 v[106:107], v2 offset:9152
    v_mfma_f32_16x16x32_bf16 v[76:79], v[108:111], v[148:151], v[76:79]
    v_cmp_gt_i32 s[54:55], 3, v10
    s_waitcnt lgkmcnt(10)
    v_mfma_f32_16x16x32_bf16 v[16:19], v[80:83], v[152:155], v[16:19]
    ds_read_b64_tr_b16 v[108:109], v2 offset:8672
    ds_read_b64_tr_b16 v[110:111], v2 offset:9184
    v_mfma_f32_16x16x32_bf16 v[24:27], v[80:83], v[156:159], v[24:27]
    v_cmp_gt_i32 s[56:57], 8, v10
    buffer_load_dwordx4 v[204:207], v4, s[16:19], s42 offen offset:3072 sc1
    v_mfma_f32_16x16x32_bf16 v[20:23], v[84:87], v[152:155], v[20:23]
    ds_read_b64_tr_b16 v[80:81], v2 offset:16896
    ds_read_b64_tr_b16 v[82:83], v2 offset:17408
    v_mfma_f32_16x16x32_bf16 v[28:31], v[84:87], v[156:159], v[28:31]
    v_cmp_gt_i32 s[58:59], 9, v10
    s_waitcnt lgkmcnt(10)
    v_mfma_f32_16x16x32_bf16 v[32:35], v[88:91], v[152:155], v[32:35]
    ds_read_b64_tr_b16 v[84:85], v2 offset:16928
    ds_read_b64_tr_b16 v[86:87], v2 offset:17440
    v_mfma_f32_16x16x32_bf16 v[40:43], v[88:91], v[156:159], v[40:43]
    v_cmp_gt_i32 s[60:61], 10, v10
    v_mfma_f32_16x16x32_bf16 v[36:39], v[92:95], v[152:155], v[36:39]
    ds_read_b64_tr_b16 v[88:89], v2 offset:16960
    ds_read_b64_tr_b16 v[90:91], v2 offset:17472
    v_mfma_f32_16x16x32_bf16 v[44:47], v[92:95], v[156:159], v[44:47]
    v_cmp_gt_i32 s[62:63], 11, v10
    s_add_u32 m0, s15, 104448
    s_add_u32 s41, s38, 3145728
    buffer_load_dwordx4 v14, s[20:23], s41 offen nt lds
    s_waitcnt lgkmcnt(10)
    v_mfma_f32_16x16x32_bf16 v[48:51], v[96:99], v[152:155], v[48:51]
    ds_read_b64_tr_b16 v[92:93], v2 offset:16992
    ds_read_b64_tr_b16 v[94:95], v2 offset:17504
    v_mfma_f32_16x16x32_bf16 v[56:59], v[96:99], v[156:159], v[56:59]
    s_add_u32 s92, s90, 32505856
    buffer_store_dwordx4 v[240:243], v4, s[16:19], s92 offen offset:2048 sc1
    v_cmp_gt_i32 s[64:65], 16, v10
    v_mfma_f32_16x16x32_bf16 v[52:55], v[100:103], v[152:155], v[52:55]
    ds_read_b64_tr_b16 v[96:97], v2 offset:17024
    ds_read_b64_tr_b16 v[98:99], v2 offset:17536
    v_mfma_f32_16x16x32_bf16 v[60:63], v[100:103], v[156:159], v[60:63]
    v_cmp_gt_i32 s[66:67], 17, v10
    s_add_u32 m0, s15, 105504
    s_add_u32 s41, s38, 3153920
    buffer_load_dwordx4 v14, s[20:23], s41 offen nt lds
    s_waitcnt lgkmcnt(10)
    v_mfma_f32_16x16x32_bf16 v[64:67], v[104:107], v[152:155], v[64:67]
    ds_read_b64_tr_b16 v[100:101], v2 offset:17056
    ds_read_b64_tr_b16 v[102:103], v2 offset:17568
    v_mfma_f32_16x16x32_bf16 v[72:75], v[104:107], v[156:159], v[72:75]
    v_cmp_gt_i32 s[68:69], 18, v10
    v_mfma_f32_16x16x32_bf16 v[68:71], v[108:111], v[152:155], v[68:71]
    ds_read_b64_tr_b16 v[104:105], v2 offset:17088
    ds_read_b64_tr_b16 v[106:107], v2 offset:17600
    v_mfma_f32_16x16x32_bf16 v[76:79], v[108:111], v[156:159], v[76:79]
    v_cmp_gt_i32 s[70:71], 19, v10
    s_waitcnt vmcnt(21)
    s_waitcnt lgkmcnt(10)
    v_mfma_f32_16x16x32_bf16 v[16:19], v[80:83], v[160:163], v[16:19]
    ds_read_b64_tr_b16 v[108:109], v2 offset:17120
    ds_read_b64_tr_b16 v[110:111], v2 offset:17632
    v_mfma_f32_16x16x32_bf16 v[24:27], v[80:83], v[164:167], v[24:27]
    v_cmp_gt_i32 s[72:73], 24, v10
    s_add_u32 m0, s15, 106560
    s_add_u32 s41, s38, 3162112
    buffer_load_dwordx4 v14, s[20:23], s41 offen nt lds
    v_mfma_f32_16x16x32_bf16 v[20:23], v[84:87], v[160:163], v[20:23]
    ds_read_b64_tr_b16 v[80:81], v2 offset:25344
    ds_read_b64_tr_b16 v[82:83], v2 offset:25856
    v_mfma_f32_16x16x32_bf16 v[28:31], v[84:87], v[164:167], v[28:31]
    v_cmp_gt_i32 s[74:75], 25, v10
    s_waitcnt lgkmcnt(10)
    v_mfma_f32_16x16x32_bf16 v[32:35], v[88:91], v[160:163], v[32:35]
    ds_read_b64_tr_b16 v[84:85], v2 offset:25376
    ds_read_b64_tr_b16 v[86:87], v2 offset:25888
    v_mfma_f32_16x16x32_bf16 v[40:43], v[88:91], v[164:167], v[40:43]
    v_cmp_gt_i32 s[76:77], 26, v10
    s_add_u32 m0, s15, 107616
    s_add_u32 s41, s38, 3170304
    buffer_load_dwordx4 v14, s[20:23], s41 offen nt lds
    v_mfma_f32_16x16x32_bf16 v[36:39], v[92:95], v[160:163], v[36:39]
    ds_read_b64_tr_b16 v[88:89], v2 offset:25408
    ds_read_b64_tr_b16 v[90:91], v2 offset:25920
    v_mfma_f32_16x16x32_bf16 v[44:47], v[92:95], v[164:167], v[44:47]
    v_cmp_gt_i32 s[78:79], 27, v10
    s_waitcnt lgkmcnt(10)
    v_mfma_f32_16x16x32_bf16 v[48:51], v[96:99], v[160:163], v[48:51]
    ds_read_b64_tr_b16 v[92:93], v2 offset:25440
    ds_read_b64_tr_b16 v[94:95], v2 offset:25952
    v_mfma_f32_16x16x32_bf16 v[56:59], v[96:99], v[164:167], v[56:59]
    v_mov_b32 v9, 0xff61b1e6
    v_mfma_f32_16x16x32_bf16 v[52:55], v[100:103], v[160:163], v[52:55]
    ds_read_b64_tr_b16 v[96:97], v2 offset:25472
    ds_read_b64_tr_b16 v[98:99], v2 offset:25984
    v_mfma_f32_16x16x32_bf16 v[60:63], v[100:103], v[164:167], v[60:63]
    s_add_u32 s42, s40, 24576
    buffer_load_dwordx4 v[208:211], v4, s[16:19], s42 offen offset:0 sc1
    s_waitcnt lgkmcnt(10)
    v_mfma_f32_16x16x32_bf16 v[64:67], v[104:107], v[160:163], v[64:67]
    ds_read_b64_tr_b16 v[100:101], v2 offset:25504
    ds_read_b64_tr_b16 v[102:103], v2 offset:26016
    v_mfma_f32_16x16x32_bf16 v[72:75], v[104:107], v[164:167], v[72:75]
    v_mfma_f32_16x16x32_bf16 v[68:71], v[108:111], v[160:163], v[68:71]
    ds_read_b64_tr_b16 v[104:105], v2 offset:25536
    ds_read_b64_tr_b16 v[106:107], v2 offset:26048
    v_mfma_f32_16x16x32_bf16 v[76:79], v[108:111], v[164:167], v[76:79]
    buffer_load_dwordx4 v[212:215], v4, s[16:19], s42 offen offset:1024 sc1
    s_waitcnt vmcnt(23)
    s_waitcnt lgkmcnt(10)
    v_mfma_f32_16x16x32_bf16 v[16:19], v[80:83], v[168:171], v[16:19]
    ds_read_b64_tr_b16 v[108:109], v2 offset:25568
    ds_read_b64_tr_b16 v[110:111], v2 offset:26080
    v_mfma_f32_16x16x32_bf16 v[24:27], v[80:83], v[172:175], v[24:27]
    v_add_u32 v2, s10, v1
    s_waitcnt vmcnt(18)
    s_barrier
    v_mfma_f32_16x16x32_bf16 v[20:23], v[84:87], v[168:171], v[20:23]
    ds_read_b64_tr_b16 v[80:81], v2 offset:0
    ds_read_b64_tr_b16 v[82:83], v2 offset:512
    v_mfma_f32_16x16x32_bf16 v[28:31], v[84:87], v[172:175], v[28:31]
    s_waitcnt lgkmcnt(10)
    v_mfma_f32_16x16x32_bf16 v[32:35], v[88:91], v[168:171], v[32:35]
    ds_read_b64_tr_b16 v[84:85], v2 offset:32
    ds_read_b64_tr_b16 v[86:87], v2 offset:544
    v_mfma_f32_16x16x32_bf16 v[40:43], v[88:91], v[172:175], v[40:43]
    s_add_u32 s92, s90, 32509952
    buffer_store_dwordx4 v[244:247], v4, s[16:19], s92 offen offset:2048 sc1
    buffer_load_dwordx4 v[216:219], v4, s[16:19], s42 offen offset:2048 sc1
    v_mfma_f32_16x16x32_bf16 v[36:39], v[92:95], v[168:171], v[36:39]
    ds_read_b64_tr_b16 v[88:89], v2 offset:64
    ds_read_b64_tr_b16 v[90:91], v2 offset:576
    v_mfma_f32_16x16x32_bf16 v[44:47], v[92:95], v[172:175], v[44:47]
    s_waitcnt lgkmcnt(10)
    v_mfma_f32_16x16x32_bf16 v[48:51], v[96:99], v[168:171], v[48:51]
    ds_read_b64_tr_b16 v[92:93], v2 offset:96
    ds_read_b64_tr_b16 v[94:95], v2 offset:608
    v_mfma_f32_16x16x32_bf16 v[56:59], v[96:99], v[172:175], v[56:59]
    buffer_load_dwordx4 v[220:223], v4, s[16:19], s42 offen offset:3072 sc1
    v_mfma_f32_16x16x32_bf16 v[52:55], v[100:103], v[168:171], v[52:55]
    ds_read_b64_tr_b16 v[96:97], v2 offset:128
    ds_read_b64_tr_b16 v[98:99], v2 offset:640
    v_mfma_f32_16x16x32_bf16 v[60:63], v[100:103], v[172:175], v[60:63]
    s_waitcnt lgkmcnt(10)
    v_mfma_f32_16x16x32_bf16 v[64:67], v[104:107], v[168:171], v[64:67]
    ds_read_b64_tr_b16 v[100:101], v2 offset:160
    ds_read_b64_tr_b16 v[102:103], v2 offset:672
    v_mfma_f32_16x16x32_bf16 v[72:75], v[104:107], v[172:175], v[72:75]
    v_mfma_f32_16x16x32_bf16 v[68:71], v[108:111], v[168:171], v[68:71]
    ds_read_b64_tr_b16 v[104:105], v2 offset:192
    ds_read_b64_tr_b16 v[106:107], v2 offset:704
    v_mfma_f32_16x16x32_bf16 v[76:79], v[108:111], v[172:175], v[76:79]
    s_waitcnt vmcnt(18)
    s_waitcnt lgkmcnt(10)
    v_mfma_f32_16x16x32_bf16 v[16:19], v[80:83], v[176:179], v[16:19]
    ds_read_b64_tr_b16 v[108:109], v2 offset:224
    ds_read_b64_tr_b16 v[110:111], v2 offset:736
    v_mfma_f32_16x16x32_bf16 v[24:27], v[80:83], v[180:183], v[24:27]
    s_add_u32 s42, s40, 28672
    buffer_load_dwordx4 v[224:227], v4, s[16:19], s42 offen offset:0 sc1
    v_mfma_f32_16x16x32_bf16 v[20:23], v[84:87], v[176:179], v[20:23]
    ds_read_b64_tr_b16 v[80:81], v2 offset:8448
    ds_read_b64_tr_b16 v[82:83], v2 offset:8960
    v_mfma_f32_16x16x32_bf16 v[28:31], v[84:87], v[180:183], v[28:31]
    s_waitcnt lgkmcnt(10)
    v_mfma_f32_16x16x32_bf16 v[32:35], v[88:91], v[176:179], v[32:35]
    ds_read_b64_tr_b16 v[84:85], v2 offset:8480
    ds_read_b64_tr_b16 v[86:87], v2 offset:8992
    v_mfma_f32_16x16x32_bf16 v[40:43], v[88:91], v[180:183], v[40:43]
    s_add_u32 s92, s90, 32505856
    buffer_store_dwordx4 v[248:251], v4, s[16:19], s92 offen offset:3072 sc1
    buffer_load_dwordx4 v[228:231], v4, s[16:19], s42 offen offset:1024 sc1
    v_mfma_f32_16x16x32_bf16 v[36:39], v[92:95], v[176:179], v[36:39]
    ds_read_b64_tr_b16 v[88:89], v2 offset:8512
    ds_read_b64_tr_b16 v[90:91], v2 offset:9024
    v_mfma_f32_16x16x32_bf16 v[44:47], v[92:95], v[180:183], v[44:47]
    s_waitcnt lgkmcnt(10)
    v_mfma_f32_16x16x32_bf16 v[48:51], v[96:99], v[176:179], v[48:51]
    ds_read_b64_tr_b16 v[92:93], v2 offset:8544
    ds_read_b64_tr_b16 v[94:95], v2 offset:9056
    v_mfma_f32_16x16x32_bf16 v[56:59], v[96:99], v[180:183], v[56:59]
    v_mfma_f32_16x16x32_bf16 v[52:55], v[100:103], v[176:179], v[52:55]
    ds_read_b64_tr_b16 v[96:97], v2 offset:8576
    ds_read_b64_tr_b16 v[98:99], v2 offset:9088
    v_mfma_f32_16x16x32_bf16 v[60:63], v[100:103], v[180:183], v[60:63]
    buffer_load_dwordx4 v[232:235], v4, s[16:19], s42 offen offset:2048 sc1
    s_waitcnt lgkmcnt(10)
    v_mfma_f32_16x16x32_bf16 v[64:67], v[104:107], v[176:179], v[64:67]
    ds_read_b64_tr_b16 v[100:101], v2 offset:8608
    ds_read_b64_tr_b16 v[102:103], v2 offset:9120
    v_mfma_f32_16x16x32_bf16 v[72:75], v[104:107], v[180:183], v[72:75]
    v_mfma_f32_16x16x32_bf16 v[68:71], v[108:111], v[176:179], v[68:71]
    ds_read_b64_tr_b16 v[104:105], v2 offset:8640
    ds_read_b64_tr_b16 v[106:107], v2 offset:9152
    v_mfma_f32_16x16x32_bf16 v[76:79], v[108:111], v[180:183], v[76:79]
    buffer_load_dwordx4 v[236:239], v4, s[16:19], s42 offen offset:3072 sc1
    s_waitcnt vmcnt(21)
    s_waitcnt lgkmcnt(10)
    v_mfma_f32_16x16x32_bf16 v[16:19], v[80:83], v[184:187], v[16:19]
    ds_read_b64_tr_b16 v[108:109], v2 offset:8672
    ds_read_b64_tr_b16 v[110:111], v2 offset:9184
    v_mfma_f32_16x16x32_bf16 v[24:27], v[80:83], v[188:191], v[24:27]
    v_mfma_f32_16x16x32_bf16 v[20:23], v[84:87], v[184:187], v[20:23]
    ds_read_b64_tr_b16 v[80:81], v2 offset:16896
    ds_read_b64_tr_b16 v[82:83], v2 offset:17408
    v_mfma_f32_16x16x32_bf16 v[28:31], v[84:87], v[188:191], v[28:31]
    s_waitcnt lgkmcnt(10)
    v_mfma_f32_16x16x32_bf16 v[32:35], v[88:91], v[184:187], v[32:35]
    ds_read_b64_tr_b16 v[84:85], v2 offset:16928
    ds_read_b64_tr_b16 v[86:87], v2 offset:17440
    v_mfma_f32_16x16x32_bf16 v[40:43], v[88:91], v[188:191], v[40:43]
    s_add_u32 m0, s14, 0
    s_add_u32 s41, s38, 4194304
    buffer_load_dwordx4 v14, s[20:23], s41 offen nt lds
    v_mfma_f32_16x16x32_bf16 v[36:39], v[92:95], v[184:187], v[36:39]
    ds_read_b64_tr_b16 v[88:89], v2 offset:16960
    ds_read_b64_tr_b16 v[90:91], v2 offset:17472
    v_mfma_f32_16x16x32_bf16 v[44:47], v[92:95], v[188:191], v[44:47]
    s_waitcnt lgkmcnt(10)
    v_mfma_f32_16x16x32_bf16 v[48:51], v[96:99], v[184:187], v[48:51]
    ds_read_b64_tr_b16 v[92:93], v2 offset:16992
    ds_read_b64_tr_b16 v[94:95], v2 offset:17504
    v_mfma_f32_16x16x32_bf16 v[56:59], v[96:99], v[188:191], v[56:59]
    s_add_u32 s92, s90, 32509952
    buffer_store_dwordx4 v[252:255], v4, s[16:19], s92 offen offset:3072 sc1
    s_add_u32 m0, s14, 1056
    s_add_u32 s41, s38, 4202496
    buffer_load_dwordx4 v14, s[20:23], s41 offen nt lds
    v_mfma_f32_16x16x32_bf16 v[52:55], v[100:103], v[184:187], v[52:55]
    ds_read_b64_tr_b16 v[96:97], v2 offset:17024
    ds_read_b64_tr_b16 v[98:99], v2 offset:17536
    v_mfma_f32_16x16x32_bf16 v[60:63], v[100:103], v[188:191], v[60:63]
    s_waitcnt lgkmcnt(10)
    v_mfma_f32_16x16x32_bf16 v[64:67], v[104:107], v[184:187], v[64:67]
    ds_read_b64_tr_b16 v[100:101], v2 offset:17056
    ds_read_b64_tr_b16 v[102:103], v2 offset:17568
    v_mfma_f32_16x16x32_bf16 v[72:75], v[104:107], v[188:191], v[72:75]
    v_mfma_f32_16x16x32_bf16 v[68:71], v[108:111], v[184:187], v[68:71]
    ds_read_b64_tr_b16 v[104:105], v2 offset:17088
    ds_read_b64_tr_b16 v[106:107], v2 offset:17600
    v_mfma_f32_16x16x32_bf16 v[76:79], v[108:111], v[188:191], v[76:79]
    s_add_u32 m0, s14, 2112
    s_add_u32 s41, s38, 4210688
    buffer_load_dwordx4 v14, s[20:23], s41 offen nt lds
    s_waitcnt vmcnt(21)
    s_waitcnt lgkmcnt(10)
    v_mfma_f32_16x16x32_bf16 v[16:19], v[80:83], v[192:195], v[16:19]
    ds_read_b64_tr_b16 v[108:109], v2 offset:17120
    ds_read_b64_tr_b16 v[110:111], v2 offset:17632
    v_mfma_f32_16x16x32_bf16 v[24:27], v[80:83], v[196:199], v[24:27]
    v_mfma_f32_16x16x32_bf16 v[20:23], v[84:87], v[192:195], v[20:23]
    ds_read_b64_tr_b16 v[80:81], v2 offset:25344
    ds_read_b64_tr_b16 v[82:83], v2 offset:25856
    v_mfma_f32_16x16x32_bf16 v[28:31], v[84:87], v[196:199], v[28:31]
    s_waitcnt lgkmcnt(10)
    v_mfma_f32_16x16x32_bf16 v[32:35], v[88:91], v[192:195], v[32:35]
    ds_read_b64_tr_b16 v[84:85], v2 offset:25376
    ds_read_b64_tr_b16 v[86:87], v2 offset:25888
    v_mfma_f32_16x16x32_bf16 v[40:43], v[88:91], v[196:199], v[40:43]
    s_add_u32 m0, s14, 3168
    s_add_u32 s41, s38, 4218880
    buffer_load_dwordx4 v14, s[20:23], s41 offen nt lds
    v_mfma_f32_16x16x32_bf16 v[36:39], v[92:95], v[192:195], v[36:39]
    ds_read_b64_tr_b16 v[88:89], v2 offset:25408
    ds_read_b64_tr_b16 v[90:91], v2 offset:25920
    v_mfma_f32_16x16x32_bf16 v[44:47], v[92:95], v[196:199], v[44:47]
    s_waitcnt lgkmcnt(10)
    v_mfma_f32_16x16x32_bf16 v[48:51], v[96:99], v[192:195], v[48:51]
    ds_read_b64_tr_b16 v[92:93], v2 offset:25440
    ds_read_b64_tr_b16 v[94:95], v2 offset:25952
    v_mfma_f32_16x16x32_bf16 v[56:59], v[96:99], v[196:199], v[56:59]
    s_add_u32 s42, s40, 32768
    buffer_load_dwordx4 v[112:115], v4, s[16:19], s42 offen offset:0 sc1
    v_mfma_f32_16x16x32_bf16 v[52:55], v[100:103], v[192:195], v[52:55]
    ds_read_b64_tr_b16 v[96:97], v2 offset:25472
    ds_read_b64_tr_b16 v[98:99], v2 offset:25984
    v_mfma_f32_16x16x32_bf16 v[60:63], v[100:103], v[196:199], v[60:63]
    s_waitcnt lgkmcnt(10)
    v_mfma_f32_16x16x32_bf16 v[64:67], v[104:107], v[192:195], v[64:67]
    ds_read_b64_tr_b16 v[100:101], v2 offset:25504
    ds_read_b64_tr_b16 v[102:103], v2 offset:26016
    v_mfma_f32_16x16x32_bf16 v[72:75], v[104:107], v[196:199], v[72:75]
    v_mfma_f32_16x16x32_bf16 v[68:71], v[108:111], v[192:195], v[68:71]
    ds_read_b64_tr_b16 v[104:105], v2 offset:25536
    ds_read_b64_tr_b16 v[106:107], v2 offset:26048
    v_mfma_f32_16x16x32_bf16 v[76:79], v[108:111], v[196:199], v[76:79]
    buffer_load_dwordx4 v[116:119], v4, s[16:19], s42 offen offset:1024 sc1
    s_waitcnt vmcnt(22)
    s_waitcnt lgkmcnt(10)
    v_mfma_f32_16x16x32_bf16 v[16:19], v[80:83], v[200:203], v[16:19]
    ds_read_b64_tr_b16 v[108:109], v2 offset:25568
    ds_read_b64_tr_b16 v[110:111], v2 offset:26080
    v_mfma_f32_16x16x32_bf16 v[24:27], v[80:83], v[204:207], v[24:27]
    v_add_u32 v2, s11, v1
    s_waitcnt vmcnt(17)
    s_barrier
    v_mfma_f32_16x16x32_bf16 v[20:23], v[84:87], v[200:203], v[20:23]
    ds_read_b64_tr_b16 v[80:81], v2 offset:0
    ds_read_b64_tr_b16 v[82:83], v2 offset:512
    v_mfma_f32_16x16x32_bf16 v[28:31], v[84:87], v[204:207], v[28:31]
    buffer_load_dwordx4 v[120:123], v4, s[16:19], s42 offen offset:2048 sc1
    s_waitcnt lgkmcnt(10)
    v_mfma_f32_16x16x32_bf16 v[32:35], v[88:91], v[200:203], v[32:35]
    ds_read_b64_tr_b16 v[84:85], v2 offset:32
    ds_read_b64_tr_b16 v[86:87], v2 offset:544
    v_mfma_f32_16x16x32_bf16 v[40:43], v[88:91], v[204:207], v[40:43]
    v_mfma_f32_16x16x32_bf16 v[36:39], v[92:95], v[200:203], v[36:39]
    ds_read_b64_tr_b16 v[88:89], v2 offset:64
    ds_read_b64_tr_b16 v[90:91], v2 offset:576
    v_mfma_f32_16x16x32_bf16 v[44:47], v[92:95], v[204:207], v[44:47]
    s_waitcnt lgkmcnt(10)
    v_mfma_f32_16x16x32_bf16 v[48:51], v[96:99], v[200:203], v[48:51]
    ds_read_b64_tr_b16 v[92:93], v2 offset:96
    ds_read_b64_tr_b16 v[94:95], v2 offset:608
    v_mfma_f32_16x16x32_bf16 v[56:59], v[96:99], v[204:207], v[56:59]
    buffer_load_dwordx4 v[124:127], v4, s[16:19], s42 offen offset:3072 sc1
    v_mfma_f32_16x16x32_bf16 v[52:55], v[100:103], v[200:203], v[52:55]
    ds_read_b64_tr_b16 v[96:97], v2 offset:128
    ds_read_b64_tr_b16 v[98:99], v2 offset:640
    v_mfma_f32_16x16x32_bf16 v[60:63], v[100:103], v[204:207], v[60:63]
    s_waitcnt lgkmcnt(10)
    v_mfma_f32_16x16x32_bf16 v[64:67], v[104:107], v[200:203], v[64:67]
    ds_read_b64_tr_b16 v[100:101], v2 offset:160
    ds_read_b64_tr_b16 v[102:103], v2 offset:672
    v_mfma_f32_16x16x32_bf16 v[72:75], v[104:107], v[204:207], v[72:75]
    v_mfma_f32_16x16x32_bf16 v[68:71], v[108:111], v[200:203], v[68:71]
    ds_read_b64_tr_b16 v[104:105], v2 offset:192
    ds_read_b64_tr_b16 v[106:107], v2 offset:704
    v_mfma_f32_16x16x32_bf16 v[76:79], v[108:111], v[204:207], v[76:79]
    s_waitcnt vmcnt(17)
    s_waitcnt lgkmcnt(10)
    v_mfma_f32_16x16x32_bf16 v[16:19], v[80:83], v[208:211], v[16:19]
    ds_read_b64_tr_b16 v[108:109], v2 offset:224
    ds_read_b64_tr_b16 v[110:111], v2 offset:736
    v_mfma_f32_16x16x32_bf16 v[24:27], v[80:83], v[212:215], v[24:27]
    s_add_u32 s42, s40, 36864
    buffer_load_dwordx4 v[128:131], v4, s[16:19], s42 offen offset:0 sc1
    v_mfma_f32_16x16x32_bf16 v[20:23], v[84:87], v[208:211], v[20:23]
    ds_read_b64_tr_b16 v[80:81], v2 offset:8448
    ds_read_b64_tr_b16 v[82:83], v2 offset:8960
    v_mfma_f32_16x16x32_bf16 v[28:31], v[84:87], v[212:215], v[28:31]
    buffer_load_dwordx4 v[132:135], v4, s[16:19], s42 offen offset:1024 sc1
    s_waitcnt lgkmcnt(10)
    v_mfma_f32_16x16x32_bf16 v[32:35], v[88:91], v[208:211], v[32:35]
    ds_read_b64_tr_b16 v[84:85], v2 offset:8480
    ds_read_b64_tr_b16 v[86:87], v2 offset:8992
    v_mfma_f32_16x16x32_bf16 v[40:43], v[88:91], v[212:215], v[40:43]
    v_mfma_f32_16x16x32_bf16 v[36:39], v[92:95], v[208:211], v[36:39]
    ds_read_b64_tr_b16 v[88:89], v2 offset:8512
    ds_read_b64_tr_b16 v[90:91], v2 offset:9024
    v_mfma_f32_16x16x32_bf16 v[44:47], v[92:95], v[212:215], v[44:47]
    buffer_load_dwordx4 v[136:139], v4, s[16:19], s42 offen offset:2048 sc1
    s_waitcnt lgkmcnt(10)
    v_mfma_f32_16x16x32_bf16 v[48:51], v[96:99], v[208:211], v[48:51]
    ds_read_b64_tr_b16 v[92:93], v2 offset:8544
    ds_read_b64_tr_b16 v[94:95], v2 offset:9056
    v_mfma_f32_16x16x32_bf16 v[56:59], v[96:99], v[212:215], v[56:59]
    v_mfma_f32_16x16x32_bf16 v[52:55], v[100:103], v[208:211], v[52:55]
    ds_read_b64_tr_b16 v[96:97], v2 offset:8576
    ds_read_b64_tr_b16 v[98:99], v2 offset:9088
    v_mfma_f32_16x16x32_bf16 v[60:63], v[100:103], v[212:215], v[60:63]
    buffer_load_dwordx4 v[140:143], v4, s[16:19], s42 offen offset:3072 sc1
    s_waitcnt lgkmcnt(10)
    v_mfma_f32_16x16x32_bf16 v[64:67], v[104:107], v[208:211], v[64:67]
    ds_read_b64_tr_b16 v[100:101], v2 offset:8608
    ds_read_b64_tr_b16 v[102:103], v2 offset:9120
    v_mfma_f32_16x16x32_bf16 v[72:75], v[104:107], v[212:215], v[72:75]
    v_mfma_f32_16x16x32_bf16 v[68:71], v[108:111], v[208:211], v[68:71]
    ds_read_b64_tr_b16 v[104:105], v2 offset:8640
    ds_read_b64_tr_b16 v[106:107], v2 offset:9152
    v_mfma_f32_16x16x32_bf16 v[76:79], v[108:111], v[212:215], v[76:79]
    s_waitcnt vmcnt(11)
    s_barrier
    s_lshl_b32 s92, s85, 5
    s_lshr_b32 s94, s86, 3
    s_lshl_b32 s94, s94, 2
    s_add_u32 s92, s92, s94
    s_add_u32 s92, s92, 694272
    s_cmp_eq_u32 s3, 4
    s_cselect_b32 s92, s92, s82
    v_mov_b32 v7, 0
    v_mov_b32 v8, s91
    s_mov_b64 exec, 1
    buffer_store_dword v8, v7, s[16:19], s92 offen sc1
    s_mov_b64 exec, -1
    s_waitcnt lgkmcnt(10)
    v_mfma_f32_16x16x32_bf16 v[16:19], v[80:83], v[216:219], v[16:19]
    ds_read_b64_tr_b16 v[108:109], v2 offset:8672
    ds_read_b64_tr_b16 v[110:111], v2 offset:9184
    v_mfma_f32_16x16x32_bf16 v[24:27], v[80:83], v[220:223], v[24:27]
    v_mfma_f32_16x16x32_bf16 v[20:23], v[84:87], v[216:219], v[20:23]
    ds_read_b64_tr_b16 v[80:81], v2 offset:16896
    ds_read_b64_tr_b16 v[82:83], v2 offset:17408
    v_mfma_f32_16x16x32_bf16 v[28:31], v[84:87], v[220:223], v[28:31]
    s_waitcnt lgkmcnt(10)
    v_mfma_f32_16x16x32_bf16 v[32:35], v[88:91], v[216:219], v[32:35]
    ds_read_b64_tr_b16 v[84:85], v2 offset:16928
    ds_read_b64_tr_b16 v[86:87], v2 offset:17440
    v_mfma_f32_16x16x32_bf16 v[40:43], v[88:91], v[220:223], v[40:43]
    v_mfma_f32_16x16x32_bf16 v[36:39], v[92:95], v[216:219], v[36:39]
    ds_read_b64_tr_b16 v[88:89], v2 offset:16960
    ds_read_b64_tr_b16 v[90:91], v2 offset:17472
    v_mfma_f32_16x16x32_bf16 v[44:47], v[92:95], v[220:223], v[44:47]
    s_waitcnt lgkmcnt(10)
    v_mfma_f32_16x16x32_bf16 v[48:51], v[96:99], v[216:219], v[48:51]
    ds_read_b64_tr_b16 v[92:93], v2 offset:16992
    ds_read_b64_tr_b16 v[94:95], v2 offset:17504
    v_mfma_f32_16x16x32_bf16 v[56:59], v[96:99], v[220:223], v[56:59]
    v_mfma_f32_16x16x32_bf16 v[52:55], v[100:103], v[216:219], v[52:55]
    ds_read_b64_tr_b16 v[96:97], v2 offset:17024
    ds_read_b64_tr_b16 v[98:99], v2 offset:17536
    v_mfma_f32_16x16x32_bf16 v[60:63], v[100:103], v[220:223], v[60:63]
    s_waitcnt lgkmcnt(10)
    v_mfma_f32_16x16x32_bf16 v[64:67], v[104:107], v[216:219], v[64:67]
    ds_read_b64_tr_b16 v[100:101], v2 offset:17056
    ds_read_b64_tr_b16 v[102:103], v2 offset:17568
    v_mfma_f32_16x16x32_bf16 v[72:75], v[104:107], v[220:223], v[72:75]
    v_mfma_f32_16x16x32_bf16 v[68:71], v[108:111], v[216:219], v[68:71]
    ds_read_b64_tr_b16 v[104:105], v2 offset:17088
    ds_read_b64_tr_b16 v[106:107], v2 offset:17600
    v_mfma_f32_16x16x32_bf16 v[76:79], v[108:111], v[220:223], v[76:79]
    s_waitcnt lgkmcnt(10)
    v_mfma_f32_16x16x32_bf16 v[16:19], v[80:83], v[224:227], v[16:19]
    ds_read_b64_tr_b16 v[108:109], v2 offset:17120
    ds_read_b64_tr_b16 v[110:111], v2 offset:17632
    v_mfma_f32_16x16x32_bf16 v[24:27], v[80:83], v[228:231], v[24:27]
    v_mfma_f32_16x16x32_bf16 v[20:23], v[84:87], v[224:227], v[20:23]
    ds_read_b64_tr_b16 v[80:81], v2 offset:25344
    ds_read_b64_tr_b16 v[82:83], v2 offset:25856
    v_mfma_f32_16x16x32_bf16 v[28:31], v[84:87], v[228:231], v[28:31]
    s_waitcnt lgkmcnt(10)
    v_mfma_f32_16x16x32_bf16 v[32:35], v[88:91], v[224:227], v[32:35]
    ds_read_b64_tr_b16 v[84:85], v2 offset:25376
    ds_read_b64_tr_b16 v[86:87], v2 offset:25888
    v_mfma_f32_16x16x32_bf16 v[40:43], v[88:91], v[228:231], v[40:43]
    v_mfma_f32_16x16x32_bf16 v[36:39], v[92:95], v[224:227], v[36:39]
    ds_read_b64_tr_b16 v[88:89], v2 offset:25408
    ds_read_b64_tr_b16 v[90:91], v2 offset:25920
    v_mfma_f32_16x16x32_bf16 v[44:47], v[92:95], v[228:231], v[44:47]
    s_waitcnt lgkmcnt(10)
    v_mfma_f32_16x16x32_bf16 v[48:51], v[96:99], v[224:227], v[48:51]
    ds_read_b64_tr_b16 v[92:93], v2 offset:25440
    ds_read_b64_tr_b16 v[94:95], v2 offset:25952
    v_mfma_f32_16x16x32_bf16 v[56:59], v[96:99], v[228:231], v[56:59]
    v_mfma_f32_16x16x32_bf16 v[52:55], v[100:103], v[224:227], v[52:55]
    ds_read_b64_tr_b16 v[96:97], v2 offset:25472
    ds_read_b64_tr_b16 v[98:99], v2 offset:25984
    v_mfma_f32_16x16x32_bf16 v[60:63], v[100:103], v[228:231], v[60:63]
    s_waitcnt lgkmcnt(10)
    v_mfma_f32_16x16x32_bf16 v[64:67], v[104:107], v[224:227], v[64:67]
    ds_read_b64_tr_b16 v[100:101], v2 offset:25504
    ds_read_b64_tr_b16 v[102:103], v2 offset:26016
    v_mfma_f32_16x16x32_bf16 v[72:75], v[104:107], v[228:231], v[72:75]
    v_mfma_f32_16x16x32_bf16 v[68:71], v[108:111], v[224:227], v[68:71]
    ds_read_b64_tr_b16 v[104:105], v2 offset:25536
    ds_read_b64_tr_b16 v[106:107], v2 offset:26048
    v_mfma_f32_16x16x32_bf16 v[76:79], v[108:111], v[228:231], v[76:79]
    s_waitcnt lgkmcnt(10)
    v_mfma_f32_16x16x32_bf16 v[16:19], v[80:83], v[232:235], v[16:19]
    ds_read_b64_tr_b16 v[108:109], v2 offset:25568
    ds_read_b64_tr_b16 v[110:111], v2 offset:26080
    v_mfma_f32_16x16x32_bf16 v[24:27], v[80:83], v[236:239], v[24:27]
    v_add_u32 v2, s8, v1
    s_waitcnt vmcnt(9)
    s_barrier
    v_mfma_f32_16x16x32_bf16 v[20:23], v[84:87], v[232:235], v[20:23]
    ds_read_b64_tr_b16 v[80:81], v2 offset:0
    ds_read_b64_tr_b16 v[82:83], v2 offset:512
    v_mfma_f32_16x16x32_bf16 v[28:31], v[84:87], v[236:239], v[28:31]
    s_waitcnt lgkmcnt(10)
    v_mfma_f32_16x16x32_bf16 v[32:35], v[88:91], v[232:235], v[32:35]
    ds_read_b64_tr_b16 v[84:85], v2 offset:32
    ds_read_b64_tr_b16 v[86:87], v2 offset:544
    v_mfma_f32_16x16x32_bf16 v[40:43], v[88:91], v[236:239], v[40:43]
    v_mfma_f32_16x16x32_bf16 v[36:39], v[92:95], v[232:235], v[36:39]
    ds_read_b64_tr_b16 v[88:89], v2 offset:8448
    ds_read_b64_tr_b16 v[90:91], v2 offset:8960
    v_mfma_f32_16x16x32_bf16 v[44:47], v[92:95], v[236:239], v[44:47]
    s_waitcnt lgkmcnt(10)
    v_mfma_f32_16x16x32_bf16 v[48:51], v[96:99], v[232:235], v[48:51]
    ds_read_b64_tr_b16 v[92:93], v2 offset:8480
    ds_read_b64_tr_b16 v[94:95], v2 offset:8992
    v_mfma_f32_16x16x32_bf16 v[56:59], v[96:99], v[236:239], v[56:59]
    v_mfma_f32_16x16x32_bf16 v[52:55], v[100:103], v[232:235], v[52:55]
    ds_read_b64_tr_b16 v[96:97], v2 offset:16896
    ds_read_b64_tr_b16 v[98:99], v2 offset:17408
    v_mfma_f32_16x16x32_bf16 v[60:63], v[100:103], v[236:239], v[60:63]
    s_waitcnt lgkmcnt(10)
    v_mfma_f32_16x16x32_bf16 v[64:67], v[104:107], v[232:235], v[64:67]
    ds_read_b64_tr_b16 v[100:101], v2 offset:16928
    ds_read_b64_tr_b16 v[102:103], v2 offset:17440
    v_mfma_f32_16x16x32_bf16 v[72:75], v[104:107], v[236:239], v[72:75]
    v_mfma_f32_16x16x32_bf16 v[68:71], v[108:111], v[232:235], v[68:71]
    ds_read_b64_tr_b16 v[104:105], v2 offset:25344
    ds_read_b64_tr_b16 v[106:107], v2 offset:25856
    v_mfma_f32_16x16x32_bf16 v[76:79], v[108:111], v[236:239], v[76:79]
    s_waitcnt vmcnt(1)
    s_waitcnt lgkmcnt(10)
    v_mfma_f32_16x16x32_bf16 v[16:19], v[80:83], v[112:115], v[16:19]
    ds_read_b64_tr_b16 v[108:109], v2 offset:25376
    ds_read_b64_tr_b16 v[110:111], v2 offset:25888
    v_mfma_f32_16x16x32_bf16 v[24:27], v[80:83], v[116:119], v[24:27]
    v_mov_b32 v208, 0
    v_mov_b32 v209, 0
    v_mfma_f32_16x16x32_bf16 v[20:23], v[84:87], v[112:115], v[20:23]
    ds_read_b64_tr_b16 v[80:81], v2 offset:64
    ds_read_b64_tr_b16 v[82:83], v2 offset:576
    v_mfma_f32_16x16x32_bf16 v[28:31], v[84:87], v[116:119], v[28:31]
    v_mov_b32 v210, 0
    v_mov_b32 v211, 0
    s_waitcnt lgkmcnt(10)
    v_mfma_f32_16x16x32_bf16 v[16:19], v[88:91], v[120:123], v[16:19]
    ds_read_b64_tr_b16 v[84:85], v2 offset:96
    ds_read_b64_tr_b16 v[86:87], v2 offset:608
    v_mfma_f32_16x16x32_bf16 v[24:27], v[88:91], v[124:127], v[24:27]
    v_mov_b32 v212, 0
    v_mov_b32 v213, 0
    v_mfma_f32_16x16x32_bf16 v[20:23], v[92:95], v[120:123], v[20:23]
    ds_read_b64_tr_b16 v[88:89], v2 offset:8512
    ds_read_b64_tr_b16 v[90:91], v2 offset:9024
    v_mfma_f32_16x16x32_bf16 v[28:31], v[92:95], v[124:127], v[28:31]
    v_mov_b32 v214, 0
    v_mov_b32 v215, 0
    s_waitcnt lgkmcnt(10)
    v_mfma_f32_16x16x32_bf16 v[16:19], v[96:99], v[128:131], v[16:19]
    ds_read_b64_tr_b16 v[92:93], v2 offset:8544
    ds_read_b64_tr_b16 v[94:95], v2 offset:9056
    v_mfma_f32_16x16x32_bf16 v[24:27], v[96:99], v[132:135], v[24:27]
    v_mov_b32 v216, 0
    v_mov_b32 v217, 0
    v_mfma_f32_16x16x32_bf16 v[20:23], v[100:103], v[128:131], v[20:23]
    ds_read_b64_tr_b16 v[96:97], v2 offset:16960
    ds_read_b64_tr_b16 v[98:99], v2 offset:17472
    v_mfma_f32_16x16x32_bf16 v[28:31], v[100:103], v[132:135], v[28:31]
    v_mov_b32 v218, 0
    v_mov_b32 v219, 0
    s_waitcnt lgkmcnt(10)
    v_mfma_f32_16x16x32_bf16 v[16:19], v[104:107], v[136:139], v[16:19]
    ds_read_b64_tr_b16 v[100:101], v2 offset:16992
    ds_read_b64_tr_b16 v[102:103], v2 offset:17504
    v_mfma_f32_16x16x32_bf16 v[24:27], v[104:107], v[140:143], v[24:27]
    v_mov_b32 v220, 0
    v_mov_b32 v221, 0
    v_mfma_f32_16x16x32_bf16 v[20:23], v[108:111], v[136:139], v[20:23]
    ds_read_b64_tr_b16 v[104:105], v2 offset:25408
    ds_read_b64_tr_b16 v[106:107], v2 offset:25920
    v_mfma_f32_16x16x32_bf16 v[28:31], v[108:111], v[140:143], v[28:31]
    v_mov_b32 v222, 0
    v_mov_b32 v223, 0
    s_waitcnt lgkmcnt(10)
    v_mfma_f32_16x16x32_bf16 v[32:35], v[80:83], v[112:115], v[32:35]
    ds_read_b64_tr_b16 v[108:109], v2 offset:25440
    ds_read_b64_tr_b16 v[110:111], v2 offset:25952
    v_mfma_f32_16x16x32_bf16 v[40:43], v[80:83], v[116:119], v[40:43]
    v_mfma_f32_16x16x32_bf16 v[36:39], v[84:87], v[112:115], v[36:39]
    ds_read_b64_tr_b16 v[80:81], v2 offset:128
    ds_read_b64_tr_b16 v[82:83], v2 offset:640
    v_mfma_f32_16x16x32_bf16 v[44:47], v[84:87], v[116:119], v[44:47]
    s_waitcnt lgkmcnt(10)
    v_mfma_f32_16x16x32_bf16 v[32:35], v[88:91], v[120:123], v[32:35]
    ds_read_b64_tr_b16 v[84:85], v2 offset:160
    ds_read_b64_tr_b16 v[86:87], v2 offset:672
    v_mfma_f32_16x16x32_bf16 v[40:43], v[88:91], v[124:127], v[40:43]
    s_lshl_b32 s93, s32, 5
    s_add_u32 s93, s93, 694272
    v_lshrrev_b32 v13, 2, v4
    v_min_u32 v13, 28, v13
    buffer_load_dword v12, v13, s[16:19], s93 offen sc1
    v_mfma_f32_16x16x32_bf16 v[36:39], v[92:95], v[120:123], v[36:39]
    ds_read_b64_tr_b16 v[88:89], v2 offset:8576
    ds_read_b64_tr_b16 v[90:91], v2 offset:9088
    v_mfma_f32_16x16x32_bf16 v[44:47], v[92:95], v[124:127], v[44:47]
    v_mul_f32 v16, 0x3e0293ee, v16
    v_mul_f32 v17, 0x3e0293ee, v17
    v_mul_f32 v18, 0x3e0293ee, v18
    v_mul_f32 v19, 0x3e0293ee, v19
    v_mul_f32 v20, 0x3e0293ee, v20
    v_mul_f32 v21, 0x3e0293ee, v21
    v_mul_f32 v22, 0x3e0293ee, v22
    v_mul_f32 v23, 0x3e0293ee, v23
    v_mul_f32 v24, 0x3e0293ee, v24
    v_mul_f32 v25, 0x3e0293ee, v25
    s_waitcnt lgkmcnt(10)
    v_mfma_f32_16x16x32_bf16 v[32:35], v[96:99], v[128:131], v[32:35]
    ds_read_b64_tr_b16 v[92:93], v2 offset:8608
    ds_read_b64_tr_b16 v[94:95], v2 offset:9120
    v_mfma_f32_16x16x32_bf16 v[40:43], v[96:99], v[132:135], v[40:43]
    v_mul_f32 v26, 0x3e0293ee, v26
    v_mul_f32 v27, 0x3e0293ee, v27
    v_mul_f32 v28, 0x3e0293ee, v28
    v_mul_f32 v29, 0x3e0293ee, v29
    v_mul_f32 v30, 0x3e0293ee, v30
    v_mul_f32 v31, 0x3e0293ee, v31
    v_cvt_pk_bf16_f32 v144, v16, v17
    v_cvt_pk_bf16_f32 v145, v18, v19
    v_cvt_pk_bf16_f32 v146, v24, v25
    v_cvt_pk_bf16_f32 v147, v26, v27
    v_mfma_f32_16x16x32_bf16 v[36:39], v[100:103], v[128:131], v[36:39]
    ds_read_b64_tr_b16 v[96:97], v2 offset:17024
    ds_read_b64_tr_b16 v[98:99], v2 offset:17536
    v_mfma_f32_16x16x32_bf16 v[44:47], v[100:103], v[132:135], v[44:47]
    v_cvt_pk_bf16_f32 v148, v20, v21
    v_cvt_pk_bf16_f32 v149, v22, v23
    v_cvt_pk_bf16_f32 v150, v28, v29
    v_cvt_pk_bf16_f32 v151, v30, v31
    v_mov_b32 v16, 0
    v_mov_b32 v17, 0
    v_mov_b32 v18, 0
    v_mov_b32 v19, 0
    v_mov_b32 v20, 0
    s_waitcnt lgkmcnt(10)
    v_mfma_f32_16x16x32_bf16 v[32:35], v[104:107], v[136:139], v[32:35]
    ds_read_b64_tr_b16 v[100:101], v2 offset:17056
    ds_read_b64_tr_b16 v[102:103], v2 offset:17568
    v_mfma_f32_16x16x32_bf16 v[40:43], v[104:107], v[140:143], v[40:43]
    v_mov_b32 v21, 0
    v_mov_b32 v22, 0
    v_mov_b32 v23, 0
    v_mov_b32 v24, 0
    v_mov_b32 v25, 0
    v_mov_b32 v26, 0
    v_mov_b32 v27, 0
    v_mov_b32 v28, 0
    v_mov_b32 v29, 0
    v_mov_b32 v30, 0
    v_mfma_f32_16x16x32_bf16 v[36:39], v[108:111], v[136:139], v[36:39]
    ds_read_b64_tr_b16 v[104:105], v2 offset:25472
    ds_read_b64_tr_b16 v[106:107], v2 offset:25984
    v_mfma_f32_16x16x32_bf16 v[44:47], v[108:111], v[140:143], v[44:47]
    v_mov_b32 v31, 0
    v_permlane16_swap_b32 v144, v146
    v_permlane16_swap_b32 v145, v147
    v_permlane16_swap_b32 v148, v150
    v_permlane16_swap_b32 v149, v151
    v_permlane32_swap_b32 v144, v146
    v_permlane32_swap_b32 v145, v147
    v_permlane32_swap_b32 v148, v150
    v_permlane32_swap_b32 v149, v151
    s_waitcnt lgkmcnt(10)
    v_mfma_f32_16x16x32_bf16 v[48:51], v[80:83], v[112:115], v[48:51]
    ds_read_b64_tr_b16 v[108:109], v2 offset:25504
    ds_read_b64_tr_b16 v[110:111], v2 offset:26016
    v_mfma_f32_16x16x32_bf16 v[56:59], v[80:83], v[116:119], v[56:59]
    v_mfma_f32_16x16x32_bf16 v[52:55], v[84:87], v[112:115], v[52:55]
    ds_read_b64_tr_b16 v[80:81], v2 offset:192
    ds_read_b64_tr_b16 v[82:83], v2 offset:704
    v_mfma_f32_16x16x32_bf16 v[60:63], v[84:87], v[116:119], v[60:63]
    s_waitcnt lgkmcnt(10)
    v_mfma_f32_16x16x32_bf16 v[48:51], v[88:91], v[120:123], v[48:51]
    ds_read_b64_tr_b16 v[84:85], v2 offset:224
    ds_read_b64_tr_b16 v[86:87], v2 offset:736
    v_mfma_f32_16x16x32_bf16 v[56:59], v[88:91], v[124:127], v[56:59]
    v_mfma_f32_16x16x32_bf16 v[52:55], v[92:95], v[120:123], v[52:55]
    ds_read_b64_tr_b16 v[88:89], v2 offset:8640
    ds_read_b64_tr_b16 v[90:91], v2 offset:9152
    v_mfma_f32_16x16x32_bf16 v[60:63], v[92:95], v[124:127], v[60:63]
    v_mul_f32 v32, 0x3e0293ee, v32
    v_mul_f32 v33, 0x3e0293ee, v33
    v_mul_f32 v34, 0x3e0293ee, v34
    v_mul_f32 v35, 0x3e0293ee, v35
    v_mul_f32 v36, 0x3e0293ee, v36
    v_mul_f32 v37, 0x3e0293ee, v37
    v_mul_f32 v38, 0x3e0293ee, v38
    v_mul_f32 v39, 0x3e0293ee, v39
    v_mul_f32 v40, 0x3e0293ee, v40
    v_mul_f32 v41, 0x3e0293ee, v41
    s_waitcnt lgkmcnt(10)
    v_mfma_f32_16x16x32_bf16 v[48:51], v[96:99], v[128:131], v[48:51]
    ds_read_b64_tr_b16 v[92:93], v2 offset:8672
    ds_read_b64_tr_b16 v[94:95], v2 offset:9184
    v_mfma_f32_16x16x32_bf16 v[56:59], v[96:99], v[132:135], v[56:59]
    s_waitcnt vmcnt(0)
    v_cmp_ne_u32 vcc, s91, v12
    s_cbranch_vccnz F_slow2
F_ok2:
    v_mul_f32 v42, 0x3e0293ee, v42
    v_mul_f32 v43, 0x3e0293ee, v43
    v_mul_f32 v44, 0x3e0293ee, v44
    v_mul_f32 v45, 0x3e0293ee, v45
    v_mul_f32 v46, 0x3e0293ee, v46
    v_mul_f32 v47, 0x3e0293ee, v47
    v_cvt_pk_bf16_f32 v152, v32, v33
    v_cvt_pk_bf16_f32 v153, v34, v35
    v_cvt_pk_bf16_f32 v154, v40, v41
    v_cvt_pk_bf16_f32 v155, v42, v43
    v_mfma_f32_16x16x32_bf16 v[52:55], v[100:103], v[128:131], v[52:55]
    ds_read_b64_tr_b16 v[96:97], v2 offset:17088
    ds_read_b64_tr_b16 v[98:99], v2 offset:17600
    v_mfma_f32_16x16x32_bf16 v[60:63], v[100:103], v[132:135], v[60:63]
    s_add_u32 m0, s84, s10
    s_add_u32 m0, m0, 16384
    s_add_u32 s41, s47, 4294950912
    buffer_load_dwordx4 v4, s[24:27], s41 offen offset:0 sc1 lds
    v_cvt_pk_bf16_f32 v156, v36, v37
    v_cvt_pk_bf16_f32 v157, v38, v39
    v_cvt_pk_bf16_f32 v158, v44, v45
    v_cvt_pk_bf16_f32 v159, v46, v47
    v_mov_b32 v32, 0
    v_mov_b32 v33, 0
    v_mov_b32 v34, 0
    v_mov_b32 v35, 0
    v_mov_b32 v36, 0
    s_waitcnt lgkmcnt(10)
    v_mfma_f32_16x16x32_bf16 v[48:51], v[104:107], v[136:139], v[48:51]
    ds_read_b64_tr_b16 v[100:101], v2 offset:17120
    ds_read_b64_tr_b16 v[102:103], v2 offset:17632
    v_mfma_f32_16x16x32_bf16 v[56:59], v[104:107], v[140:143], v[56:59]
    v_mov_b32 v37, 0
    v_mov_b32 v38, 0
    v_mov_b32 v39, 0
    v_mov_b32 v40, 0
    v_mov_b32 v41, 0
    v_mov_b32 v42, 0
    v_mov_b32 v43, 0
    v_mov_b32 v44, 0
    v_mov_b32 v45, 0
    v_mov_b32 v46, 0
    v_mfma_f32_16x16x32_bf16 v[52:55], v[108:111], v[136:139], v[52:55]
    ds_read_b64_tr_b16 v[104:105], v2 offset:25536
    ds_read_b64_tr_b16 v[106:107], v2 offset:26048
    v_mfma_f32_16x16x32_bf16 v[60:63], v[108:111], v[140:143], v[60:63]
    buffer_load_dwordx4 v4, s[24:27], s41 offen offset:1024 sc1 lds
    v_mov_b32 v47, 0
    v_permlane16_swap_b32 v152, v154
    v_permlane16_swap_b32 v153, v155
    v_permlane16_swap_b32 v156, v158
    v_permlane16_swap_b32 v157, v159
    v_permlane32_swap_b32 v152, v154
    v_permlane32_swap_b32 v153, v155
    v_permlane32_swap_b32 v156, v158
    v_permlane32_swap_b32 v157, v159
    s_waitcnt lgkmcnt(10)
    v_mfma_f32_16x16x32_bf16 v[64:67], v[80:83], v[112:115], v[64:67]
    ds_read_b64_tr_b16 v[108:109], v2 offset:25568
    ds_read_b64_tr_b16 v[110:111], v2 offset:26080
    v_mfma_f32_16x16x32_bf16 v[72:75], v[80:83], v[116:119], v[72:75]
    v_add_u32 v2, s9, v4
    s_barrier
    v_mfma_f32_16x16x32_bf16 v[68:71], v[84:87], v[112:115], v[68:71]
    ds_read_b128 v[80:83], v2 offset:0
    v_mfma_f32_16x16x32_bf16 v[76:79], v[84:87], v[116:119], v[76:79]
    buffer_load_dwordx4 v4, s[24:27], s41 offen offset:2048 sc1 lds
    s_waitcnt lgkmcnt(9)
    v_mfma_f32_16x16x32_bf16 v[64:67], v[88:91], v[120:123], v[64:67]
    ds_read_b128 v[84:87], v2 offset:1024
    v_mfma_f32_16x16x32_bf16 v[72:75], v[88:91], v[124:127], v[72:75]
    v_mfma_f32_16x16x32_bf16 v[68:71], v[92:95], v[120:123], v[68:71]
    ds_read_b128 v[88:91], v2 offset:2048
    v_mfma_f32_16x16x32_bf16 v[76:79], v[92:95], v[124:127], v[76:79]
    buffer_load_dwordx4 v4, s[24:27], s41 offen offset:3072 sc1 lds
    v_mul_f32 v48, 0x3e0293ee, v48
    v_mul_f32 v49, 0x3e0293ee, v49
    v_mul_f32 v50, 0x3e0293ee, v50
    v_mul_f32 v51, 0x3e0293ee, v51
    v_mul_f32 v52, 0x3e0293ee, v52
    v_mul_f32 v53, 0x3e0293ee, v53
    v_mul_f32 v54, 0x3e0293ee, v54
    v_mul_f32 v55, 0x3e0293ee, v55
    v_mul_f32 v56, 0x3e0293ee, v56
    v_mul_f32 v57, 0x3e0293ee, v57
    s_waitcnt lgkmcnt(7)
    v_mfma_f32_16x16x32_bf16 v[64:67], v[96:99], v[128:131], v[64:67]
    ds_read_b128 v[92:95], v2 offset:3072
    v_mfma_f32_16x16x32_bf16 v[72:75], v[96:99], v[132:135], v[72:75]
    v_mul_f32 v58, 0x3e0293ee, v58
    v_mul_f32 v59, 0x3e0293ee, v59
    v_mul_f32 v60, 0x3e0293ee, v60
    v_mul_f32 v61, 0x3e0293ee, v61
    v_mul_f32 v62, 0x3e0293ee, v62
    v_mul_f32 v63, 0x3e0293ee, v63
    v_cvt_pk_bf16_f32 v160, v48, v49
    v_cvt_pk_bf16_f32 v161, v50, v51
    v_cvt_pk_bf16_f32 v162, v56, v57
    v_cvt_pk_bf16_f32 v163, v58, v59
    v_mfma_f32_16x16x32_bf16 v[68:71], v[100:103], v[128:131], v[68:71]
    ds_read_b128 v[96:99], v2 offset:4096
    v_mfma_f32_16x16x32_bf16 v[76:79], v[100:103], v[132:135], v[76:79]
    v_cvt_pk_bf16_f32 v164, v52, v53
    v_cvt_pk_bf16_f32 v165, v54, v55
    v_cvt_pk_bf16_f32 v166, v60, v61
    v_cvt_pk_bf16_f32 v167, v62, v63
    v_mov_b32 v48, 0
    v_mov_b32 v49, 0
    v_mov_b32 v50, 0
    v_mov_b32 v51, 0
    v_mov_b32 v52, 0
    s_waitcnt lgkmcnt(5)
    v_mfma_f32_16x16x32_bf16 v[64:67], v[104:107], v[136:139], v[64:67]
    ds_read_b128 v[100:103], v2 offset:5120
    v_mfma_f32_16x16x32_bf16 v[72:75], v[104:107], v[140:143], v[72:75]
    v_mov_b32 v53, 0
    v_mov_b32 v54, 0
    v_mov_b32 v55, 0
    v_mov_b32 v56, 0
    v_mov_b32 v57, 0
    v_mov_b32 v58, 0
    v_mov_b32 v59, 0
    v_mov_b32 v60, 0
    v_mov_b32 v61, 0
    v_mov_b32 v62, 0
    v_mfma_f32_16x16x32_bf16 v[68:71], v[108:111], v[136:139], v[68:71]
    ds_read_b128 v[104:107], v2 offset:6144
    v_mfma_f32_16x16x32_bf16 v[76:79], v[108:111], v[140:143], v[76:79]
    v_mov_b32 v63, 0
    v_permlane16_swap_b32 v160, v162
    v_permlane16_swap_b32 v161, v163
    v_permlane16_swap_b32 v164, v166
    v_permlane16_swap_b32 v165, v167
    v_permlane32_swap_b32 v160, v162
    v_permlane32_swap_b32 v161, v163
    v_permlane32_swap_b32 v164, v166
    v_permlane32_swap_b32 v165, v167
    s_cmp_lg_u32 s35, 1
    s_cbranch_scc1 S_nm0
    v_cndmask_b32 v208, v208, v9, s[48:49]
    v_cndmask_b32 v209, v209, v9, s[50:51]
    v_cndmask_b32 v210, v210, v9, s[52:53]
    v_cndmask_b32 v211, v211, v9, s[54:55]
    v_cndmask_b32 v212, v212, v9, s[56:57]
    v_cndmask_b32 v213, v213, v9, s[58:59]
    v_cndmask_b32 v214, v214, v9, s[60:61]
    v_cndmask_b32 v215, v215, v9, s[62:63]
    v_cndmask_b32 v216, v216, v9, s[64:65]
    v_cndmask_b32 v217, v217, v9, s[66:67]
    v_cndmask_b32 v218, v218, v9, s[68:69]
    v_cndmask_b32 v219, v219, v9, s[70:71]
    v_cndmask_b32 v220, v220, v9, s[72:73]
    v_cndmask_b32 v221, v221, v9, s[74:75]
    v_cndmask_b32 v222, v222, v9, s[76:77]
    v_cndmask_b32 v223, v223, v9, s[78:79]
S_nm0:
    s_nop 7
    v_mul_f32 v64, 0x3e0293ee, v64
    v_mul_f32 v65, 0x3e0293ee, v65
    v_mul_f32 v66, 0x3e0293ee, v66
    v_mul_f32 v67, 0x3e0293ee, v67
    v_mul_f32 v68, 0x3e0293ee, v68
    v_mul_f32 v69, 0x3e0293ee, v69
    v_mul_f32 v70, 0x3e0293ee, v70
    v_mul_f32 v71, 0x3e0293ee, v71
    v_mul_f32 v72, 0x3e0293ee, v72
    v_mul_f32 v73, 0x3e0293ee, v73
    v_mul_f32 v74, 0x3e0293ee, v74
    v_mul_f32 v75, 0x3e0293ee, v75
    v_mul_f32 v76, 0x3e0293ee, v76
    v_mul_f32 v77, 0x3e0293ee, v77
    v_mul_f32 v78, 0x3e0293ee, v78
    v_mul_f32 v79, 0x3e0293ee, v79
    v_cvt_pk_bf16_f32 v168, v64, v65
    v_cvt_pk_bf16_f32 v169, v66, v67
    v_cvt_pk_bf16_f32 v170, v72, v73
    v_cvt_pk_bf16_f32 v171, v74, v75
    v_cvt_pk_bf16_f32 v172, v68, v69
    v_cvt_pk_bf16_f32 v173, v70, v71
    v_cvt_pk_bf16_f32 v174, v76, v77
    v_cvt_pk_bf16_f32 v175, v78, v79
    v_mov_b32 v64, 0
    v_mov_b32 v65, 0
    v_mov_b32 v66, 0
    v_mov_b32 v67, 0
    v_mov_b32 v68, 0
    v_mov_b32 v69, 0
    v_mov_b32 v70, 0
    v_mov_b32 v71, 0
    v_mov_b32 v72, 0
    v_mov_b32 v73, 0
    v_mov_b32 v74, 0
    v_mov_b32 v75, 0
    v_mov_b32 v76, 0
    v_mov_b32 v77, 0
    v_mov_b32 v78, 0
    v_mov_b32 v79, 0
    v_permlane16_swap_b32 v168, v170
    v_permlane16_swap_b32 v169, v171
    v_permlane16_swap_b32 v172, v174
    v_permlane16_swap_b32 v173, v175
    v_permlane32_swap_b32 v168, v170
    v_permlane32_swap_b32 v169, v171
    v_permlane32_swap_b32 v172, v174
    v_permlane32_swap_b32 v173, v175
    s_waitcnt lgkmcnt(5)
    v_mfma_f32_32x32x16_bf16 v[176:191], v[80:83], v[144:147], v[208:223]
    ds_read_b128 v[108:111], v2 offset:7168
    s_add_u32 m0, s43, s84
    s_cmp_lt_u32 s46, s80
    s_cselect_b32 s41, s46, s82
    s_add_u32 s46, s46, 16384
    buffer_load_dwordx4 v4, s[24:27], s41 offen offset:0 sc1 lds
    v_mfma_f32_32x32x16_bf16 v[176:191], v[84:87], v[148:151], v[176:191]
    ds_read_b128 v[80:83], v2 offset:8192
    buffer_load_dwordx4 v4, s[24:27], s41 offen offset:1024 sc1 lds
    s_waitcnt lgkmcnt(5)
    v_mfma_f32_32x32x16_bf16 v[176:191], v[88:91], v[152:155], v[176:191]
    ds_read_b128 v[84:87], v2 offset:9216
    buffer_load_dwordx4 v4, s[24:27], s41 offen offset:2048 sc1 lds
    v_mfma_f32_32x32x16_bf16 v[176:191], v[92:95], v[156:159], v[176:191]
    ds_read_b128 v[88:91], v2 offset:10240
    buffer_load_dwordx4 v4, s[24:27], s41 offen offset:3072 sc1 lds
    s_waitcnt lgkmcnt(5)
    v_mfma_f32_32x32x16_bf16 v[176:191], v[96:99], v[160:163], v[176:191]
    ds_read_b128 v[92:95], v2 offset:11264
    s_add_u32 m0, m0, 16384
    s_cmp_lt_u32 s47, s81
    s_cselect_b32 s41, s47, s82
    s_add_u32 s47, s47, 16384
    buffer_load_dwordx4 v4, s[24:27], s41 offen offset:0 sc1 lds
    v_mfma_f32_32x32x16_bf16 v[176:191], v[100:103], v[164:167], v[176:191]
    ds_read_b128 v[96:99], v2 offset:12288
    buffer_load_dwordx4 v4, s[24:27], s41 offen offset:1024 sc1 lds
    s_waitcnt lgkmcnt(5)
    v_mfma_f32_32x32x16_bf16 v[176:191], v[104:107], v[168:171], v[176:191]
    ds_read_b128 v[100:103], v2 offset:13312
    buffer_load_dwordx4 v4, s[24:27], s41 offen offset:2048 sc1 lds
    v_mfma_f32_32x32x16_bf16 v[176:191], v[108:111], v[172:175], v[176:191]
    ds_read_b128 v[104:107], v2 offset:14336
    buffer_load_dwordx4 v4, s[24:27], s41 offen offset:3072 sc1 lds
    s_nop 7
    s_nop 3
    v_max3_f32 v10, v176, v177, v178
    v_max3_f32 v10, v10, v179, v180
    v_max3_f32 v10, v10, v181, v182
    v_max3_f32 v10, v10, v183, v184
    v_max3_f32 v10, v10, v185, v186
    v_max3_f32 v10, v10, v187, v188
    v_max3_f32 v10, v10, v189, v190
    v_max_f32 v10, v10, v191
    v_mov_b32 v7, v10
    s_nop 1
    v_permlane32_swap_b32 v10, v7
    v_max_f32 v10, v10, v7
    v_sub_f32 v208, 0, v10
    v_sub_f32 v209, 0, v10
    v_sub_f32 v210, 0, v10
    v_sub_f32 v211, 0, v10
    v_sub_f32 v212, 0, v10
    v_sub_f32 v213, 0, v10
    v_sub_f32 v214, 0, v10
    v_sub_f32 v215, 0, v10
    v_sub_f32 v216, 0, v10
    v_sub_f32 v217, 0, v10
    v_sub_f32 v218, 0, v10
    v_sub_f32 v219, 0, v10
    v_sub_f32 v220, 0, v10
    v_sub_f32 v221, 0, v10
    v_sub_f32 v222, 0, v10
    v_sub_f32 v223, 0, v10
    s_cmp_lg_u32 s35, 2
    s_cbranch_scc1 S_nm1
    v_cndmask_b32 v208, v208, v9, s[48:49]
    v_cndmask_b32 v209, v209, v9, s[50:51]
    v_cndmask_b32 v210, v210, v9, s[52:53]
    v_cndmask_b32 v211, v211, v9, s[54:55]
    v_cndmask_b32 v212, v212, v9, s[56:57]
    v_cndmask_b32 v213, v213, v9, s[58:59]
    v_cndmask_b32 v214, v214, v9, s[60:61]
    v_cndmask_b32 v215, v215, v9, s[62:63]
    v_cndmask_b32 v216, v216, v9, s[64:65]
    v_cndmask_b32 v217, v217, v9, s[66:67]
    v_cndmask_b32 v218, v218, v9, s[68:69]
    v_cndmask_b32 v219, v219, v9, s[70:71]
    v_cndmask_b32 v220, v220, v9, s[72:73]
    v_cndmask_b32 v221, v221, v9, s[74:75]
    v_cndmask_b32 v222, v222, v9, s[76:77]
    v_cndmask_b32 v223, v223, v9, s[78:79]
S_nm1:
    v_sub_f32 v176, v176, v10
    v_sub_f32 v177, v177, v10
    v_sub_f32 v178, v178, v10
    v_sub_f32 v179, v179, v10
    v_sub_f32 v180, v180, v10
    v_sub_f32 v181, v181, v10
    v_sub_f32 v182, v182, v10
    v_sub_f32 v183, v183, v10
    v_sub_f32 v184, v184, v10
    v_sub_f32 v185, v185, v10
    v_sub_f32 v186, v186, v10
    v_sub_f32 v187, v187, v10
    v_sub_f32 v188, v188, v10
    v_sub_f32 v189, v189, v10
    v_sub_f32 v190, v190, v10
    v_sub_f32 v191, v191, v10
    s_waitcnt vmcnt(8)
    s_barrier
    s_waitcnt lgkmcnt(5)
    v_mfma_f32_32x32x16_bf16 v[192:207], v[80:83], v[144:147], v[208:223]
    ds_read_b128 v[108:111], v2 offset:15360
    v_add_u32 v2, s45, v4
    v_exp_f32 v112, v176
    v_exp_f32 v113, v177
    v_exp_f32 v114, v178
    v_add_f32 v6, v112, v113
    v_cvt_pk_bf16_f32 v224, v112, v113
    v_mfma_f32_32x32x16_bf16 v[192:207], v[84:87], v[148:151], v[192:207]
    ds_read_b128 v[80:83], v2 offset:16384
    v_exp_f32 v115, v179
    v_add_f32 v6, v6, v114
    v_exp_f32 v116, v180
    v_add_f32 v6, v6, v115
    v_cvt_pk_bf16_f32 v225, v114, v115
    s_waitcnt lgkmcnt(5)
    v_mfma_f32_32x32x16_bf16 v[192:207], v[88:91], v[152:155], v[192:207]
    ds_read_b128 v[84:87], v2 offset:17408
    v_exp_f32 v117, v181
    v_add_f32 v6, v6, v116
    v_exp_f32 v118, v182
    v_add_f32 v6, v6, v117
    v_cvt_pk_bf16_f32 v226, v116, v117
    v_mfma_f32_32x32x16_bf16 v[192:207], v[92:95], v[156:159], v[192:207]
    ds_read_b128 v[88:91], v2 offset:18432
    v_exp_f32 v119, v183
    v_add_f32 v6, v6, v118
    v_exp_f32 v120, v184
    v_add_f32 v6, v6, v119
    v_cvt_pk_bf16_f32 v227, v118, v119
    s_waitcnt lgkmcnt(5)
    v_mfma_f32_32x32x16_bf16 v[192:207], v[96:99], v[160:163], v[192:207]
    ds_read_b128 v[92:95], v2 offset:19456
    v_exp_f32 v121, v185
    v_add_f32 v6, v6, v120
    v_exp_f32 v122, v186
    v_add_f32 v6, v6, v121
    v_cvt_pk_bf16_f32 v228, v120, v121
    v_mfma_f32_32x32x16_bf16 v[192:207], v[100:103], v[164:167], v[192:207]
    ds_read_b128 v[96:99], v2 offset:20480
    v_exp_f32 v123, v187
    v_add_f32 v6, v6, v122
    v_exp_f32 v124, v188
    v_add_f32 v6, v6, v123
    v_cvt_pk_bf16_f32 v229, v122, v123
    s_waitcnt lgkmcnt(5)
    v_mfma_f32_32x32x16_bf16 v[192:207], v[104:107], v[168:171], v[192:207]
    ds_read_b128 v[100:103], v2 offset:21504
    v_exp_f32 v125, v189
    v_add_f32 v6, v6, v124
    v_exp_f32 v126, v190
    v_add_f32 v6, v6, v125
    v_cvt_pk_bf16_f32 v230, v124, v125
    v_mfma_f32_32x32x16_bf16 v[192:207], v[108:111], v[172:175], v[192:207]
    ds_read_b128 v[104:107], v2 offset:22528
    v_exp_f32 v127, v191
    v_add_f32 v6, v6, v126
    v_add_f32 v6, v6, v127
    v_cvt_pk_bf16_f32 v231, v126, v127
    v_mov_b32 v5, 0
    s_sub_u32 s35, s35, 1
    s_mov_b32 s45, s43
    s_add_u32 s43, s43, 34816
    s_cmp_eq_u32 s43, 139264
    s_cselect_b32 s43, 0, s43
    s_add_u32 s36, s36, 1
    s_branch S_rareA
.p2align 6
S_goA:
    s_waitcnt lgkmcnt(5)
    v_mfma_f32_32x32x16_bf16 v[16:31], v[80:83], v[224:227], v[16:31]
    ds_read_b128 v[108:111], v2 offset:23552
    v_add_f32 v5, v5, v6
    s_sub_u32 s35, s35, 1
    s_cmp_le_u32 s35, 2
    s_cselect_b32 s44, -1.0, s83
    v_mfma_f32_32x32x16_bf16 v[32:47], v[84:87], v[224:227], v[32:47]
    ds_read_b128 v[80:83], v2 offset:0
    v_exp_f32 v112, v192
    v_exp_f32 v113, v193
    s_add_u32 m0, s43, s84
    s_cmp_lt_u32 s46, s80
    s_cselect_b32 s41, s46, s82
    s_add_u32 s46, s46, 16384
    buffer_load_dwordx4 v4, s[24:27], s41 offen offset:0 sc1 lds
    s_waitcnt lgkmcnt(5)
    v_mfma_f32_32x32x16_bf16 v[48:63], v[88:91], v[224:227], v[48:63]
    ds_read_b128 v[84:87], v2 offset:1024
    v_exp_f32 v114, v194
    v_exp_f32 v115, v195
    v_add_f32 v6, v112, v113
    v_mfma_f32_32x32x16_bf16 v[64:79], v[92:95], v[224:227], v[64:79]
    ds_read_b128 v[88:91], v2 offset:2048
    v_exp_f32 v116, v196
    v_add_f32 v6, v6, v114
    v_add_f32 v6, v6, v115
    buffer_load_dwordx4 v4, s[24:27], s41 offen offset:1024 sc1 lds
    s_waitcnt lgkmcnt(5)
    v_mfma_f32_32x32x16_bf16 v[16:31], v[96:99], v[228:231], v[16:31]
    ds_read_b128 v[92:95], v2 offset:3072
    v_exp_f32 v117, v197
    v_exp_f32 v118, v198
    v_add_f32 v6, v6, v116
    v_mfma_f32_32x32x16_bf16 v[32:47], v[100:103], v[228:231], v[32:47]
    ds_read_b128 v[96:99], v2 offset:4096
    v_exp_f32 v119, v199
    v_add_f32 v6, v6, v117
    v_add_f32 v6, v6, v118
    buffer_load_dwordx4 v4, s[24:27], s41 offen offset:2048 sc1 lds
    s_waitcnt lgkmcnt(5)
    v_mfma_f32_32x32x16_bf16 v[48:63], v[104:107], v[228:231], v[48:63]
    ds_read_b128 v[100:103], v2 offset:5120
    v_exp_f32 v120, v200
    v_add_f32 v6, v6, v119
    v_cvt_pk_bf16_f32 v232, v112, v113
    v_cvt_pk_bf16_f32 v233, v114, v115
    v_mfma_f32_32x32x16_bf16 v[64:79], v[108:111], v[228:231], v[64:79]
    ds_read_b128 v[104:107], v2 offset:6144
    v_exp_f32 v121, v201
    v_add_f32 v6, v6, v120
    v_cvt_pk_bf16_f32 v234, v116, v117
    buffer_load_dwordx4 v4, s[24:27], s41 offen offset:3072 sc1 lds
    s_waitcnt lgkmcnt(5)
    v_mfma_f32_32x32x16_bf16 v[176:191], v[80:83], v[144:147], v[208:223]
    ds_read_b128 v[108:111], v2 offset:7168
    v_exp_f32 v122, v202
    v_add_f32 v6, v6, v121
    v_cvt_pk_bf16_f32 v235, v118, v119
    v_mfma_f32_32x32x16_bf16 v[176:191], v[84:87], v[148:151], v[176:191]
    ds_read_b128 v[80:83], v2 offset:24576
    v_exp_f32 v123, v203
    v_add_f32 v6, v6, v122
    v_cvt_pk_bf16_f32 v236, v120, v121
    s_add_u32 m0, m0, 16384
    s_cmp_lt_u32 s47, s81
    s_cselect_b32 s41, s47, s82
    s_add_u32 s47, s47, 16384
    buffer_load_dwordx4 v4, s[24:27], s41 offen offset:0 sc1 lds
    s_waitcnt lgkmcnt(5)
    v_mfma_f32_32x32x16_bf16 v[176:191], v[88:91], v[152:155], v[176:191]
    ds_read_b128 v[84:87], v2 offset:25600
    v_exp_f32 v124, v204
    v_exp_f32 v125, v205
    v_add_f32 v6, v6, v123
    v_mfma_f32_32x32x16_bf16 v[176:191], v[92:95], v[156:159], v[176:191]
    ds_read_b128 v[88:91], v2 offset:26624
    v_exp_f32 v126, v206
    v_add_f32 v6, v6, v124
    v_add_f32 v6, v6, v125
    buffer_load_dwordx4 v4, s[24:27], s41 offen offset:1024 sc1 lds
    s_waitcnt lgkmcnt(5)
    v_mfma_f32_32x32x16_bf16 v[176:191], v[96:99], v[160:163], v[176:191]
    ds_read_b128 v[92:95], v2 offset:27648
    v_exp_f32 v127, v207
    v_add_f32 v6, v6, v126
    v_cvt_pk_bf16_f32 v237, v122, v123
    v_mfma_f32_32x32x16_bf16 v[176:191], v[100:103], v[164:167], v[176:191]
    ds_read_b128 v[96:99], v2 offset:28672
    v_add_f32 v6, v6, v127
    v_cvt_pk_bf16_f32 v238, v124, v125
    buffer_load_dwordx4 v4, s[24:27], s41 offen offset:2048 sc1 lds
    s_waitcnt lgkmcnt(5)
    v_mfma_f32_32x32x16_bf16 v[176:191], v[104:107], v[168:171], v[176:191]
    ds_read_b128 v[100:103], v2 offset:29696
    v_cmp_nge_f32 vcc, s44, v6
    buffer_load_dwordx4 v4, s[24:27], s41 offen offset:3072 sc1 lds
    v_mfma_f32_32x32x16_bf16 v[176:191], v[108:111], v[172:175], v[176:191]
    ds_read_b128 v[104:107], v2 offset:30720
    v_cvt_pk_bf16_f32 v239, v126, v127
    s_cbranch_vccnz S_hdlA
S_goB:
    s_waitcnt lgkmcnt(5)
    v_mfma_f32_32x32x16_bf16 v[16:31], v[80:83], v[232:235], v[16:31]
    ds_read_b128 v[108:111], v2 offset:31744
    v_add_f32 v5, v5, v6
    s_sub_u32 s35, s35, 1
    s_cmp_le_u32 s35, 2
    s_cselect_b32 s44, -1.0, s83
    v_mfma_f32_32x32x16_bf16 v[32:47], v[84:87], v[232:235], v[32:47]
    ds_read_b128 v[80:83], v2 offset:8192
    v_exp_f32 v112, v176
    v_exp_f32 v113, v177
    s_waitcnt lgkmcnt(5)
    v_mfma_f32_32x32x16_bf16 v[48:63], v[88:91], v[232:235], v[48:63]
    ds_read_b128 v[84:87], v2 offset:9216
    v_exp_f32 v114, v178
    v_exp_f32 v115, v179
    v_add_f32 v6, v112, v113
    v_mfma_f32_32x32x16_bf16 v[64:79], v[92:95], v[232:235], v[64:79]
    ds_read_b128 v[88:91], v2 offset:10240
    v_exp_f32 v116, v180
    v_add_f32 v6, v6, v114
    v_add_f32 v6, v6, v115
    s_waitcnt lgkmcnt(5)
    v_mfma_f32_32x32x16_bf16 v[16:31], v[96:99], v[236:239], v[16:31]
    ds_read_b128 v[92:95], v2 offset:11264
    v_exp_f32 v117, v181
    v_exp_f32 v118, v182
    v_add_f32 v6, v6, v116
    v_mfma_f32_32x32x16_bf16 v[32:47], v[100:103], v[236:239], v[32:47]
    ds_read_b128 v[96:99], v2 offset:12288
    v_exp_f32 v119, v183
    v_add_f32 v6, v6, v117
    v_add_f32 v6, v6, v118
    s_waitcnt lgkmcnt(5)
    v_mfma_f32_32x32x16_bf16 v[48:63], v[104:107], v[236:239], v[48:63]
    ds_read_b128 v[100:103], v2 offset:13312
    v_exp_f32 v120, v184
    v_add_f32 v6, v6, v119
    v_cvt_pk_bf16_f32 v224, v112, v113
    v_cvt_pk_bf16_f32 v225, v114, v115
    v_mfma_f32_32x32x16_bf16 v[64:79], v[108:111], v[236:239], v[64:79]
    ds_read_b128 v[104:107], v2 offset:14336
    v_exp_f32 v121, v185
    v_add_f32 v6, v6, v120
    v_cvt_pk_bf16_f32 v226, v116, v117
    s_waitcnt lgkmcnt(5)
    v_mfma_f32_32x32x16_bf16 v[192:207], v[80:83], v[144:147], v[208:223]
    ds_read_b128 v[108:111], v2 offset:15360
    v_add_u32 v2, s45, v4
    v_exp_f32 v122, v186
    v_add_f32 v6, v6, v121
    v_cvt_pk_bf16_f32 v227, v118, v119
    s_waitcnt vmcnt(8)
    s_barrier
    v_mfma_f32_32x32x16_bf16 v[192:207], v[84:87], v[148:151], v[192:207]
    ds_read_b128 v[80:83], v2 offset:16384
    v_exp_f32 v123, v187
    v_add_f32 v6, v6, v122
    v_cvt_pk_bf16_f32 v228, v120, v121
    s_waitcnt lgkmcnt(5)
    v_mfma_f32_32x32x16_bf16 v[192:207], v[88:91], v[152:155], v[192:207]
    ds_read_b128 v[84:87], v2 offset:17408
    v_exp_f32 v124, v188
    v_exp_f32 v125, v189
    v_add_f32 v6, v6, v123
    v_mfma_f32_32x32x16_bf16 v[192:207], v[92:95], v[156:159], v[192:207]
    ds_read_b128 v[88:91], v2 offset:18432
    v_exp_f32 v126, v190
    v_add_f32 v6, v6, v124
    v_add_f32 v6, v6, v125
    s_waitcnt lgkmcnt(5)
    v_mfma_f32_32x32x16_bf16 v[192:207], v[96:99], v[160:163], v[192:207]
    ds_read_b128 v[92:95], v2 offset:19456
    v_exp_f32 v127, v191
    v_add_f32 v6, v6, v126
    v_cvt_pk_bf16_f32 v229, v122, v123
    s_mov_b32 s45, s43
    v_mfma_f32_32x32x16_bf16 v[192:207], v[100:103], v[164:167], v[192:207]
    ds_read_b128 v[96:99], v2 offset:20480
    v_add_f32 v6, v6, v127
    v_cvt_pk_bf16_f32 v230, v124, v125
    s_add_u32 s43, s43, 34816
    s_add_u32 s36, s36, 1
    s_waitcnt lgkmcnt(5)
    v_mfma_f32_32x32x16_bf16 v[192:207], v[104:107], v[168:171], v[192:207]
    ds_read_b128 v[100:103], v2 offset:21504
    v_cmp_nge_f32 vcc, s44, v6
    s_cmp_eq_u32 s43, 139264
    s_cselect_b32 s43, 0, s43
    v_mfma_f32_32x32x16_bf16 v[192:207], v[108:111], v[172:175], v[192:207]
    ds_read_b128 v[104:107], v2 offset:22528
    v_cvt_pk_bf16_f32 v231, v126, v127
    s_cbranch_vccz S_goA
S_hdlB:
    v_cmp_lt_f32 vcc, s83, v6
    s_cbranch_vccnz S_slowB
S_rareA:
    s_cmp_eq_u32 s35, 0
    s_cbranch_scc1 S_finA
    s_cmp_lg_u32 s35, 2
    s_cbranch_scc1 S_goA
    v_cndmask_b32 v208, v208, v9, s[48:49]
    v_cndmask_b32 v209, v209, v9, s[50:51]
    v_cndmask_b32 v210, v210, v9, s[52:53]
    v_cndmask_b32 v211, v211, v9, s[54:55]
    v_cndmask_b32 v212, v212, v9, s[56:57]
    v_cndmask_b32 v213, v213, v9, s[58:59]
    v_cndmask_b32 v214, v214, v9, s[60:61]
    v_cndmask_b32 v215, v215, v9, s[62:63]
    v_cndmask_b32 v216, v216, v9, s[64:65]
    v_cndmask_b32 v217, v217, v9, s[66:67]
    v_cndmask_b32 v218, v218, v9, s[68:69]
    v_cndmask_b32 v219, v219, v9, s[70:71]
    v_cndmask_b32 v220, v220, v9, s[72:73]
    v_cndmask_b32 v221, v221, v9, s[74:75]
    v_cndmask_b32 v222, v222, v9, s[76:77]
    v_cndmask_b32 v223, v223, v9, s[78:79]
    s_branch S_goA
S_hdlA:
    v_cmp_lt_f32 vcc, s83, v6
    s_cbranch_vccnz S_slowA
S_rareB:
    s_cmp_eq_u32 s35, 0
    s_cbranch_scc1 S_finB
    s_cmp_lg_u32 s35, 2
    s_cbranch_scc1 S_goB
    v_cndmask_b32 v208, v208, v9, s[48:49]
    v_cndmask_b32 v209, v209, v9, s[50:51]
    v_cndmask_b32 v210, v210, v9, s[52:53]
    v_cndmask_b32 v211, v211, v9, s[54:55]
    v_cndmask_b32 v212, v212, v9, s[56:57]
    v_cndmask_b32 v213, v213, v9, s[58:59]
    v_cndmask_b32 v214, v214, v9, s[60:61]
    v_cndmask_b32 v215, v215, v9, s[62:63]
    v_cndmask_b32 v216, v216, v9, s[64:65]
    v_cndmask_b32 v217, v217, v9, s[66:67]
    v_cndmask_b32 v218, v218, v9, s[68:69]
    v_cndmask_b32 v219, v219, v9, s[70:71]
    v_cndmask_b32 v220, v220, v9, s[72:73]
    v_cndmask_b32 v221, v221, v9, s[74:75]
    v_cndmask_b32 v222, v222, v9, s[76:77]
    v_cndmask_b32 v223, v223, v9, s[78:79]
    s_branch S_goB
S_slowA:
    v_max3_f32 v10, v192, v193, v194
    v_max3_f32 v10, v10, v195, v196
    v_max3_f32 v10, v10, v197, v198
    v_max3_f32 v10, v10, v199, v200
    v_max3_f32 v10, v10, v201, v202
    v_max3_f32 v10, v10, v203, v204
    v_max3_f32 v10, v10, v205, v206
    v_max3_f32 v10, v10, v207, 0
    v_mov_b32 v7, v10
    s_nop 1
    v_permlane32_swap_b32 v10, v7
    v_max_f32 v10, v10, v7
    v_sub_f32 v11, 0, v10
    v_exp_f32 v11, v11
    v_sub_f32 v192, v192, v10
    v_sub_f32 v193, v193, v10
    v_sub_f32 v194, v194, v10
    v_sub_f32 v195, v195, v10
    v_sub_f32 v196, v196, v10
    v_sub_f32 v197, v197, v10
    v_sub_f32 v198, v198, v10
    v_sub_f32 v199, v199, v10
    v_sub_f32 v200, v200, v10
    v_sub_f32 v201, v201, v10
    v_sub_f32 v202, v202, v10
    v_sub_f32 v203, v203, v10
    v_sub_f32 v204, v204, v10
    v_sub_f32 v205, v205, v10
    v_sub_f32 v206, v206, v10
    v_sub_f32 v207, v207, v10
    v_mul_f32 v16, v16, v11
    v_mul_f32 v17, v17, v11
    v_mul_f32 v18, v18, v11
    v_mul_f32 v19, v19, v11
    v_mul_f32 v20, v20, v11
    v_mul_f32 v21, v21, v11
    v_mul_f32 v22, v22, v11
    v_mul_f32 v23, v23, v11
    v_mul_f32 v24, v24, v11
    v_mul_f32 v25, v25, v11
    v_mul_f32 v26, v26, v11
    v_mul_f32 v27, v27, v11
    v_mul_f32 v28, v28, v11
    v_mul_f32 v29, v29, v11
    v_mul_f32 v30, v30, v11
    v_mul_f32 v31, v31, v11
    v_mul_f32 v32, v32, v11
    v_mul_f32 v33, v33, v11
    v_mul_f32 v34, v34, v11
    v_mul_f32 v35, v35, v11
    v_mul_f32 v36, v36, v11
    v_mul_f32 v37, v37, v11
    v_mul_f32 v38, v38, v11
    v_mul_f32 v39, v39, v11
    v_mul_f32 v40, v40, v11
    v_mul_f32 v41, v41, v11
    v_mul_f32 v42, v42, v11
    v_mul_f32 v43, v43, v11
    v_mul_f32 v44, v44, v11
    v_mul_f32 v45, v45, v11
    v_mul_f32 v46, v46, v11
    v_mul_f32 v47, v47, v11
    v_mul_f32 v48, v48, v11
    v_mul_f32 v49, v49, v11
    v_mul_f32 v50, v50, v11
    v_mul_f32 v51, v51, v11
    v_mul_f32 v52, v52, v11
    v_mul_f32 v53, v53, v11
    v_mul_f32 v54, v54, v11
    v_mul_f32 v55, v55, v11
    v_mul_f32 v56, v56, v11
    v_mul_f32 v57, v57, v11
    v_mul_f32 v58, v58, v11
    v_mul_f32 v59, v59, v11
    v_mul_f32 v60, v60, v11
    v_mul_f32 v61, v61, v11
    v_mul_f32 v62, v62, v11
    v_mul_f32 v63, v63, v11
    v_mul_f32 v64, v64, v11
    v_mul_f32 v65, v65, v11
    v_mul_f32 v66, v66, v11
    v_mul_f32 v67, v67, v11
    v_mul_f32 v68, v68, v11
    v_mul_f32 v69, v69, v11
    v_mul_f32 v70, v70, v11
    v_mul_f32 v71, v71, v11
    v_mul_f32 v72, v72, v11
    v_mul_f32 v73, v73, v11
    v_mul_f32 v74, v74, v11
    v_mul_f32 v75, v75, v11
    v_mul_f32 v76, v76, v11
    v_mul_f32 v77, v77, v11
    v_mul_f32 v78, v78, v11
    v_mul_f32 v79, v79, v11
    v_mul_f32 v5, v5, v11
    v_sub_f32 v208, v208, v10
    v_sub_f32 v209, v209, v10
    v_sub_f32 v210, v210, v10
    v_sub_f32 v211, v211, v10
    v_sub_f32 v212, v212, v10
    v_sub_f32 v213, v213, v10
    v_sub_f32 v214, v214, v10
    v_sub_f32 v215, v215, v10
    v_sub_f32 v216, v216, v10
    v_sub_f32 v217, v217, v10
    v_sub_f32 v218, v218, v10
    v_sub_f32 v219, v219, v10
    v_sub_f32 v220, v220, v10
    v_sub_f32 v221, v221, v10
    v_sub_f32 v222, v222, v10
    v_sub_f32 v223, v223, v10
    v_sub_f32 v176, v176, v10
    v_sub_f32 v177, v177, v10
    v_sub_f32 v178, v178, v10
    v_sub_f32 v179, v179, v10
    v_sub_f32 v180, v180, v10
    v_sub_f32 v181, v181, v10
    v_sub_f32 v182, v182, v10
    v_sub_f32 v183, v183, v10
    v_sub_f32 v184, v184, v10
    v_sub_f32 v185, v185, v10
    v_sub_f32 v186, v186, v10
    v_sub_f32 v187, v187, v10
    v_sub_f32 v188, v188, v10
    v_sub_f32 v189, v189, v10
    v_sub_f32 v190, v190, v10
    v_sub_f32 v191, v191, v10
    v_exp_f32 v112, v192
    v_exp_f32 v113, v193
    v_exp_f32 v114, v194
    v_exp_f32 v115, v195
    v_exp_f32 v116, v196
    v_exp_f32 v117, v197
    v_exp_f32 v118, v198
    v_exp_f32 v119, v199
    v_exp_f32 v120, v200
    v_exp_f32 v121, v201
    v_exp_f32 v122, v202
    v_exp_f32 v123, v203
    v_exp_f32 v124, v204
    v_exp_f32 v125, v205
    v_exp_f32 v126, v206
    v_exp_f32 v127, v207
    v_add_f32 v6, v112, v113
    v_add_f32 v6, v6, v114
    v_add_f32 v6, v6, v115
    v_add_f32 v6, v6, v116
    v_add_f32 v6, v6, v117
    v_add_f32 v6, v6, v118
    v_add_f32 v6, v6, v119
    v_add_f32 v6, v6, v120
    v_add_f32 v6, v6, v121
    v_add_f32 v6, v6, v122
    v_add_f32 v6, v6, v123
    v_add_f32 v6, v6, v124
    v_add_f32 v6, v6, v125
    v_add_f32 v6, v6, v126
    v_add_f32 v6, v6, v127
    v_cvt_pk_bf16_f32 v232, v112, v113
    v_cvt_pk_bf16_f32 v233, v114, v115
    v_cvt_pk_bf16_f32 v234, v116, v117
    v_cvt_pk_bf16_f32 v235, v118, v119
    v_cvt_pk_bf16_f32 v236, v120, v121
    v_cvt_pk_bf16_f32 v237, v122, v123
    v_cvt_pk_bf16_f32 v238, v124, v125
    v_cvt_pk_bf16_f32 v239, v126, v127
    s_branch S_rareB
S_slowB:
    v_max3_f32 v10, v176, v177, v178
    v_max3_f32 v10, v10, v179, v180
    v_max3_f32 v10, v10, v181, v182
    v_max3_f32 v10, v10, v183, v184
    v_max3_f32 v10, v10, v185, v186
    v_max3_f32 v10, v10, v187, v188
    v_max3_f32 v10, v10, v189, v190
    v_max3_f32 v10, v10, v191, 0
    v_mov_b32 v7, v10
    s_nop 1
    v_permlane32_swap_b32 v10, v7
    v_max_f32 v10, v10, v7
    v_sub_f32 v11, 0, v10
    v_exp_f32 v11, v11
    v_sub_f32 v176, v176, v10
    v_sub_f32 v177, v177, v10
    v_sub_f32 v178, v178, v10
    v_sub_f32 v179, v179, v10
    v_sub_f32 v180, v180, v10
    v_sub_f32 v181, v181, v10
    v_sub_f32 v182, v182, v10
    v_sub_f32 v183, v183, v10
    v_sub_f32 v184, v184, v10
    v_sub_f32 v185, v185, v10
    v_sub_f32 v186, v186, v10
    v_sub_f32 v187, v187, v10
    v_sub_f32 v188, v188, v10
    v_sub_f32 v189, v189, v10
    v_sub_f32 v190, v190, v10
    v_sub_f32 v191, v191, v10
    v_mul_f32 v16, v16, v11
    v_mul_f32 v17, v17, v11
    v_mul_f32 v18, v18, v11
    v_mul_f32 v19, v19, v11
    v_mul_f32 v20, v20, v11
    v_mul_f32 v21, v21, v11
    v_mul_f32 v22, v22, v11
    v_mul_f32 v23, v23, v11
    v_mul_f32 v24, v24, v11
    v_mul_f32 v25, v25, v11
    v_mul_f32 v26, v26, v11
    v_mul_f32 v27, v27, v11
    v_mul_f32 v28, v28, v11
    v_mul_f32 v29, v29, v11
    v_mul_f32 v30, v30, v11
    v_mul_f32 v31, v31, v11
    v_mul_f32 v32, v32, v11
    v_mul_f32 v33, v33, v11
    v_mul_f32 v34, v34, v11
    v_mul_f32 v35, v35, v11
    v_mul_f32 v36, v36, v11
    v_mul_f32 v37, v37, v11
    v_mul_f32 v38, v38, v11
    v_mul_f32 v39, v39, v11
    v_mul_f32 v40, v40, v11
    v_mul_f32 v41, v41, v11
    v_mul_f32 v42, v42, v11
    v_mul_f32 v43, v43, v11
    v_mul_f32 v44, v44, v11
    v_mul_f32 v45, v45, v11
    v_mul_f32 v46, v46, v11
    v_mul_f32 v47, v47, v11
    v_mul_f32 v48, v48, v11
    v_mul_f32 v49, v49, v11
    v_mul_f32 v50, v50, v11
    v_mul_f32 v51, v51, v11
    v_mul_f32 v52, v52, v11
    v_mul_f32 v53, v53, v11
    v_mul_f32 v54, v54, v11
    v_mul_f32 v55, v55, v11
    v_mul_f32 v56, v56, v11
    v_mul_f32 v57, v57, v11
    v_mul_f32 v58, v58, v11
    v_mul_f32 v59, v59, v11
    v_mul_f32 v60, v60, v11
    v_mul_f32 v61, v61, v11
    v_mul_f32 v62, v62, v11
    v_mul_f32 v63, v63, v11
    v_mul_f32 v64, v64, v11
    v_mul_f32 v65, v65, v11
    v_mul_f32 v66, v66, v11
    v_mul_f32 v67, v67, v11
    v_mul_f32 v68, v68, v11
    v_mul_f32 v69, v69, v11
    v_mul_f32 v70, v70, v11
    v_mul_f32 v71, v71, v11
    v_mul_f32 v72, v72, v11
    v_mul_f32 v73, v73, v11
    v_mul_f32 v74, v74, v11
    v_mul_f32 v75, v75, v11
    v_mul_f32 v76, v76, v11
    v_mul_f32 v77, v77, v11
    v_mul_f32 v78, v78, v11
    v_mul_f32 v79, v79, v11
    v_mul_f32 v5, v5, v11
    v_sub_f32 v208, v208, v10
    v_sub_f32 v209, v209, v10
    v_sub_f32 v210, v210, v10
    v_sub_f32 v211, v211, v10
    v_sub_f32 v212, v212, v10
    v_sub_f32 v213, v213, v10
    v_sub_f32 v214, v214, v10
    v_sub_f32 v215, v215, v10
    v_sub_f32 v216, v216, v10
    v_sub_f32 v217, v217, v10
    v_sub_f32 v218, v218, v10
    v_sub_f32 v219, v219, v10
    v_sub_f32 v220, v220, v10
    v_sub_f32 v221, v221, v10
    v_sub_f32 v222, v222, v10
    v_sub_f32 v223, v223, v10
    v_sub_f32 v192, v192, v10
    v_sub_f32 v193, v193, v10
    v_sub_f32 v194, v194, v10
    v_sub_f32 v195, v195, v10
    v_sub_f32 v196, v196, v10
    v_sub_f32 v197, v197, v10
    v_sub_f32 v198, v198, v10
    v_sub_f32 v199, v199, v10
    v_sub_f32 v200, v200, v10
    v_sub_f32 v201, v201, v10
    v_sub_f32 v202, v202, v10
    v_sub_f32 v203, v203, v10
    v_sub_f32 v204, v204, v10
    v_sub_f32 v205, v205, v10
    v_sub_f32 v206, v206, v10
    v_sub_f32 v207, v207, v10
    v_exp_f32 v112, v176
    v_exp_f32 v113, v177
    v_exp_f32 v114, v178
    v_exp_f32 v115, v179
    v_exp_f32 v116, v180
    v_exp_f32 v117, v181
    v_exp_f32 v118, v182
    v_exp_f32 v119, v183
    v_exp_f32 v120, v184
    v_exp_f32 v121, v185
    v_exp_f32 v122, v186
    v_exp_f32 v123, v187
    v_exp_f32 v124, v188
    v_exp_f32 v125, v189
    v_exp_f32 v126, v190
    v_exp_f32 v127, v191
    v_add_f32 v6, v112, v113
    v_add_f32 v6, v6, v114
    v_add_f32 v6, v6, v115
    v_add_f32 v6, v6, v116
    v_add_f32 v6, v6, v117
    v_add_f32 v6, v6, v118
    v_add_f32 v6, v6, v119
    v_add_f32 v6, v6, v120
    v_add_f32 v6, v6, v121
    v_add_f32 v6, v6, v122
    v_add_f32 v6, v6, v123
    v_add_f32 v6, v6, v124
    v_add_f32 v6, v6, v125
    v_add_f32 v6, v6, v126
    v_add_f32 v6, v6, v127
    v_cvt_pk_bf16_f32 v224, v112, v113
    v_cvt_pk_bf16_f32 v225, v114, v115
    v_cvt_pk_bf16_f32 v226, v116, v117
    v_cvt_pk_bf16_f32 v227, v118, v119
    v_cvt_pk_bf16_f32 v228, v120, v121
    v_cvt_pk_bf16_f32 v229, v122, v123
    v_cvt_pk_bf16_f32 v230, v124, v125
    v_cvt_pk_bf16_f32 v231, v126, v127
    s_branch S_rareA
S_finA:
    s_waitcnt lgkmcnt(5)
    v_mfma_f32_32x32x16_bf16 v[16:31], v[80:83], v[224:227], v[16:31]
    ds_read_b128 v[108:111], v2 offset:23552
    s_add_u32 m0, s43, s84
    s_cmp_lt_u32 s46, s80
    s_cselect_b32 s41, s46, s82
    s_add_u32 s46, s46, 16384
    buffer_load_dwordx4 v4, s[24:27], s41 offen offset:0 sc1 lds
    v_add_f32 v5, v5, v6
    v_mfma_f32_32x32x16_bf16 v[32:47], v[84:87], v[224:227], v[32:47]
    buffer_load_dwordx4 v4, s[24:27], s41 offen offset:1024 sc1 lds
    s_waitcnt lgkmcnt(4)
    v_mfma_f32_32x32x16_bf16 v[48:63], v[88:91], v[224:227], v[48:63]
    buffer_load_dwordx4 v4, s[24:27], s41 offen offset:2048 sc1 lds
    v_mfma_f32_32x32x16_bf16 v[64:79], v[92:95], v[224:227], v[64:79]
    buffer_load_dwordx4 v4, s[24:27], s41 offen offset:3072 sc1 lds
    s_waitcnt lgkmcnt(2)
    v_mfma_f32_32x32x16_bf16 v[16:31], v[96:99], v[228:231], v[16:31]
    s_add_u32 m0, m0, 16384
    s_cmp_lt_u32 s47, s81
    s_cselect_b32 s41, s47, s82
    s_add_u32 s47, s47, 16384
    buffer_load_dwordx4 v4, s[24:27], s41 offen offset:0 sc1 lds
    v_mfma_f32_32x32x16_bf16 v[32:47], v[100:103], v[228:231], v[32:47]
    buffer_load_dwordx4 v4, s[24:27], s41 offen offset:1024 sc1 lds
    s_waitcnt lgkmcnt(0)
    v_mfma_f32_32x32x16_bf16 v[48:63], v[104:107], v[228:231], v[48:63]
    buffer_load_dwordx4 v4, s[24:27], s41 offen offset:2048 sc1 lds
    v_mfma_f32_32x32x16_bf16 v[64:79], v[108:111], v[228:231], v[64:79]
    buffer_load_dwordx4 v4, s[24:27], s41 offen offset:3072 sc1 lds
    s_mov_b32 s45, s43
    s_add_u32 s43, s43, 34816
    s_cmp_eq_u32 s43, 139264
    s_cselect_b32 s43, 0, s43
    s_add_u32 s36, s36, 1
    s_waitcnt vmcnt(8)
    s_barrier
    s_branch S_epi
S_finB:
    s_waitcnt lgkmcnt(5)
    v_mfma_f32_32x32x16_bf16 v[16:31], v[80:83], v[232:235], v[16:31]
    ds_read_b128 v[108:111], v2 offset:31744
    v_add_f32 v5, v5, v6
    v_mfma_f32_32x32x16_bf16 v[32:47], v[84:87], v[232:235], v[32:47]
    s_waitcnt lgkmcnt(4)
    v_mfma_f32_32x32x16_bf16 v[48:63], v[88:91], v[232:235], v[48:63]
    v_mfma_f32_32x32x16_bf16 v[64:79], v[92:95], v[232:235], v[64:79]
    s_waitcnt lgkmcnt(2)
    v_mfma_f32_32x32x16_bf16 v[16:31], v[96:99], v[236:239], v[16:31]
    v_mfma_f32_32x32x16_bf16 v[32:47], v[100:103], v[236:239], v[32:47]
    s_waitcnt lgkmcnt(0)
    v_mfma_f32_32x32x16_bf16 v[48:63], v[104:107], v[236:239], v[48:63]
    v_mfma_f32_32x32x16_bf16 v[64:79], v[108:111], v[236:239], v[64:79]
    s_mov_b32 s45, s43
    s_add_u32 s43, s43, 34816
    s_cmp_eq_u32 s43, 139264
    s_cselect_b32 s43, 0, s43
    s_add_u32 s36, s36, 1
    s_waitcnt vmcnt(8)
    s_barrier
S_epi:
    s_add_u32 m0, s43, s84
    s_cmp_lt_u32 s46, s80
    s_cselect_b32 s41, s46, s82
    s_add_u32 s46, s46, 16384
    buffer_load_dwordx4 v4, s[24:27], s41 offen offset:0 sc1 lds
    buffer_load_dwordx4 v4, s[24:27], s41 offen offset:1024 sc1 lds
    buffer_load_dwordx4 v4, s[24:27], s41 offen offset:2048 sc1 lds
    buffer_load_dwordx4 v4, s[24:27], s41 offen offset:3072 sc1 lds
    s_add_u32 m0, m0, 16384
    s_cmp_lt_u32 s47, s81
    s_cselect_b32 s41, s47, s82
    s_add_u32 s47, s47, 16384
    buffer_load_dwordx4 v4, s[24:27], s41 offen offset:0 sc1 lds
    buffer_load_dwordx4 v4, s[24:27], s41 offen offset:1024 sc1 lds
    buffer_load_dwordx4 v4, s[24:27], s41 offen offset:2048 sc1 lds
    buffer_load_dwordx4 v4, s[24:27], s41 offen offset:3072 sc1 lds
    v_mov_b32 v7, v5
    s_nop 1
    v_permlane32_swap_b32 v5, v7
    v_add_f32 v5, v5, v7
    v_rcp_f32 v11, v5
    s_lshl_b32 s41, s34, 18
    s_lshl_b32 s42, s32, 13
    s_add_u32 s41, s41, s42
    s_add_u32 s41, s41, 50331648
    s_add_u32 s42, s41, 4096
    v_mul_f32 v16, v16, v11
    v_mul_f32 v17, v17, v11
    v_mul_f32 v18, v18, v11
    v_mul_f32 v19, v19, v11
    v_mul_f32 v20, v20, v11
    v_mul_f32 v21, v21, v11
    v_mul_f32 v22, v22, v11
    v_mul_f32 v23, v23, v11
    v_cvt_pk_bf16_f32 v16, v16, v17
    v_cvt_pk_bf16_f32 v17, v18, v19
    v_cvt_pk_bf16_f32 v18, v20, v21
    v_cvt_pk_bf16_f32 v19, v22, v23
    buffer_store_dwordx4 v[16:19], v4, s[16:19], s41 offen offset:0 sc1
    v_mul_f32 v24, v24, v11
    v_mul_f32 v25, v25, v11
    v_mul_f32 v26, v26, v11
    v_mul_f32 v27, v27, v11
    v_mul_f32 v28, v28, v11
    v_mul_f32 v29, v29, v11
    v_mul_f32 v30, v30, v11
    v_mul_f32 v31, v31, v11
    v_cvt_pk_bf16_f32 v24, v24, v25
    v_cvt_pk_bf16_f32 v25, v26, v27
    v_cvt_pk_bf16_f32 v26, v28, v29
    v_cvt_pk_bf16_f32 v27, v30, v31
    buffer_store_dwordx4 v[24:27], v4, s[16:19], s41 offen offset:1024 sc1
    v_mul_f32 v32, v32, v11
    v_mul_f32 v33, v33, v11
    v_mul_f32 v34, v34, v11
    v_mul_f32 v35, v35, v11
    v_mul_f32 v36, v36, v11
    v_mul_f32 v37, v37, v11
    v_mul_f32 v38, v38, v11
    v_mul_f32 v39, v39, v11
    v_cvt_pk_bf16_f32 v32, v32, v33
    v_cvt_pk_bf16_f32 v33, v34, v35
    v_cvt_pk_bf16_f32 v34, v36, v37
    v_cvt_pk_bf16_f32 v35, v38, v39
    buffer_store_dwordx4 v[32:35], v4, s[16:19], s41 offen offset:2048 sc1
    v_mul_f32 v40, v40, v11
    v_mul_f32 v41, v41, v11
    v_mul_f32 v42, v42, v11
    v_mul_f32 v43, v43, v11
    v_mul_f32 v44, v44, v11
    v_mul_f32 v45, v45, v11
    v_mul_f32 v46, v46, v11
    v_mul_f32 v47, v47, v11
    v_cvt_pk_bf16_f32 v40, v40, v41
    v_cvt_pk_bf16_f32 v41, v42, v43
    v_cvt_pk_bf16_f32 v42, v44, v45
    v_cvt_pk_bf16_f32 v43, v46, v47
    buffer_store_dwordx4 v[40:43], v4, s[16:19], s41 offen offset:3072 sc1
    v_mul_f32 v48, v48, v11
    v_mul_f32 v49, v49, v11
    v_mul_f32 v50, v50, v11
    v_mul_f32 v51, v51, v11
    v_mul_f32 v52, v52, v11
    v_mul_f32 v53, v53, v11
    v_mul_f32 v54, v54, v11
    v_mul_f32 v55, v55, v11
    v_cvt_pk_bf16_f32 v48, v48, v49
    v_cvt_pk_bf16_f32 v49, v50, v51
    v_cvt_pk_bf16_f32 v50, v52, v53
    v_cvt_pk_bf16_f32 v51, v54, v55
    buffer_store_dwordx4 v[48:51], v4, s[16:19], s42 offen offset:0 sc1
    v_mul_f32 v56, v56, v11
    v_mul_f32 v57, v57, v11
    v_mul_f32 v58, v58, v11
    v_mul_f32 v59, v59, v11
    v_mul_f32 v60, v60, v11
    v_mul_f32 v61, v61, v11
    v_mul_f32 v62, v62, v11
    v_mul_f32 v63, v63, v11
    v_cvt_pk_bf16_f32 v56, v56, v57
    v_cvt_pk_bf16_f32 v57, v58, v59
    v_cvt_pk_bf16_f32 v58, v60, v61
    v_cvt_pk_bf16_f32 v59, v62, v63
    buffer_store_dwordx4 v[56:59], v4, s[16:19], s42 offen offset:1024 sc1
    v_mul_f32 v64, v64, v11
    v_mul_f32 v65, v65, v11
    v_mul_f32 v66, v66, v11
    v_mul_f32 v67, v67, v11
    v_mul_f32 v68, v68, v11
    v_mul_f32 v69, v69, v11
    v_mul_f32 v70, v70, v11
    v_mul_f32 v71, v71, v11
    v_cvt_pk_bf16_f32 v64, v64, v65
    v_cvt_pk_bf16_f32 v65, v66, v67
    v_cvt_pk_bf16_f32 v66, v68, v69
    v_cvt_pk_bf16_f32 v67, v70, v71
    buffer_store_dwordx4 v[64:67], v4, s[16:19], s42 offen offset:2048 sc1
    v_mul_f32 v72, v72, v11
    v_mul_f32 v73, v73, v11
    v_mul_f32 v74, v74, v11
    v_mul_f32 v75, v75, v11
    v_mul_f32 v76, v76, v11
    v_mul_f32 v77, v77, v11
    v_mul_f32 v78, v78, v11
    v_mul_f32 v79, v79, v11
    v_cvt_pk_bf16_f32 v72, v72, v73
    v_cvt_pk_bf16_f32 v73, v74, v75
    v_cvt_pk_bf16_f32 v74, v76, v77
    v_cvt_pk_bf16_f32 v75, v78, v79
    buffer_store_dwordx4 v[72:75], v4, s[16:19], s42 offen offset:3072 sc1
    s_add_u32 s41, s36, 1
    s_cmp_lt_u32 s41, s37
    s_cbranch_scc1 S_more
    s_waitcnt vmcnt(0)
    s_barrier
    s_lshr_b32 s92, s34, 2
    s_lshl_b32 s92, s92, 12
    s_lshl_b32 s93, s32, 7
    s_add_u32 s92, s92, s93
    s_add_u32 s92, s92, 696320
    v_mov_b32 v7, 162840
    v_mov_b32 v8, 1
    s_mov_b64 exec, 1
    ds_add_rtn_u32 v8, v7, v8
    v_mov_b32 v7, 0
    s_waitcnt lgkmcnt(0)
    v_cmp_eq_u32 vcc, 3, v8
    v_mov_b32 v8, s91
    s_cbranch_vccz S_sg0
    buffer_store_dword v8, v7, s[16:19], s92 offen sc1
S_sg0:
    s_mov_b64 exec, -1
    s_branch S_exit
S_more:
    s_waitcnt vmcnt(16)
    s_mov_b32 s45, s43
    s_add_u32 s43, s43, 34816
    s_cmp_eq_u32 s43, 139264
    s_cselect_b32 s43, 0, s43
    s_add_u32 s36, s36, 1
    s_barrier
    s_add_u32 m0, s43, s84
    s_cmp_lt_u32 s46, s80
    s_cselect_b32 s41, s46, s82
    s_add_u32 s46, s46, 16384
    buffer_load_dwordx4 v4, s[24:27], s41 offen offset:0 sc1 lds
    buffer_load_dwordx4 v4, s[24:27], s41 offen offset:1024 sc1 lds
    buffer_load_dwordx4 v4, s[24:27], s41 offen offset:2048 sc1 lds
    buffer_load_dwordx4 v4, s[24:27], s41 offen offset:3072 sc1 lds
    s_add_u32 m0, m0, 16384
    s_cmp_lt_u32 s47, s81
    s_cselect_b32 s41, s47, s82
    s_add_u32 s47, s47, 16384
    buffer_load_dwordx4 v4, s[24:27], s41 offen offset:0 sc1 lds
    buffer_load_dwordx4 v4, s[24:27], s41 offen offset:1024 sc1 lds
    buffer_load_dwordx4 v4, s[24:27], s41 offen offset:2048 sc1 lds
    buffer_load_dwordx4 v4, s[24:27], s41 offen offset:3072 sc1 lds
    s_waitcnt vmcnt(8)
    s_lshr_b32 s92, s34, 2
    s_lshl_b32 s92, s92, 12
    s_lshl_b32 s93, s32, 7
    s_add_u32 s92, s92, s93
    s_add_u32 s92, s92, 696320
    v_mov_b32 v7, 162840
    v_mov_b32 v8, 1
    s_mov_b64 exec, 1
    ds_add_rtn_u32 v8, v7, v8
    v_mov_b32 v7, 0
    s_waitcnt lgkmcnt(0)
    v_cmp_eq_u32 vcc, 3, v8
    v_mov_b32 v8, s91
    s_cbranch_vccz S_sg1
    buffer_store_dword v8, v7, s[16:19], s92 offen sc1
S_sg1:
    s_mov_b64 exec, -1
    s_cmp_ge_u32 s2, 160
    s_cbranch_scc1 S_loader
    s_load_dwordx2 s[48:49], s[0:1], 40
    s_load_dwordx8 s[52:59], s[0:1], 56
    s_lshl_b32 s64, s2, 2
    s_add_u32 s64, s64, s3
    s_sub_u32 s64, s64, 4
    v_bfe_u32 v7, v0, 4, 2
    v_mul_u32_u24 v112, 5120, v7
    v_and_b32 v7, 15, v0
    v_lshl_add_u32 v112, v7, 4, v112
    v_bfe_u32 v7, v0, 4, 2
    v_mul_u32_u24 v113, 13824, v7
    v_and_b32 v7, 15, v0
    v_lshl_add_u32 v113, v7, 4, v113
    s_sub_u32 s69, s3, 4
    s_mul_i32 s69, s69, 4352
    s_add_u32 s69, s69, 139264
    v_bfe_u32 v114, v0, 2, 2
    v_mul_u32_u24 v114, 1088, v114
    v_bfe_u32 v7, v0, 5, 1
    v_lshl_add_u32 v114, v7, 8, v114
    v_bfe_u32 v7, v0, 4, 1
    v_lshl_add_u32 v114, v7, 5, v114
    v_and_b32 v7, 3, v0
    v_lshl_add_u32 v114, v7, 3, v114
    v_add_u32 v114, s69, v114
    s_waitcnt lgkmcnt(0)
    s_sub_u32 s77, s2, 128
    s_cmp_ge_u32 s2, 128
    s_cbranch_scc1 S_gv
    s_and_b32 s65, s64, 127
    s_mov_b32 s79, 1024
    s_cmp_ge_u32 s2, 32
    s_cselect_b32 s64, 1024, 0
    s_cselect_b32 s79, 1920, s79
    s_cmp_ge_u32 s2, 64
    s_cselect_b32 s64, 1920, s64
    s_cselect_b32 s79, 2560, s79
    s_cmp_ge_u32 s2, 96
    s_cselect_b32 s64, 2560, s64
    s_cselect_b32 s79, 2816, s79
    s_add_u32 s65, s65, s64
    s_mov_b32 s67, s82
    s_mov_b32 s68, s82
S_cv:
    ds_read_b64_tr_b16 v[116:117], v114 offset:0
    ds_read_b64_tr_b16 v[118:119], v114 offset:512
    ds_read_b64_tr_b16 v[120:121], v114 offset:64
    ds_read_b64_tr_b16 v[122:123], v114 offset:576
    ds_read_b64_tr_b16 v[124:125], v114 offset:128
    ds_read_b64_tr_b16 v[126:127], v114 offset:640
    ds_read_b64_tr_b16 v[128:129], v114 offset:192
    ds_read_b64_tr_b16 v[130:131], v114 offset:704
    s_waitcnt lgkmcnt(0)
    buffer_store_dwordx4 v[116:119], v4, s[16:19], s67 offen offset:0 sc1
    buffer_store_dwordx4 v[120:123], v4, s[16:19], s67 offen offset:1024 sc1
    buffer_store_dwordx4 v[124:127], v4, s[16:19], s68 offen offset:2048 sc1
    buffer_store_dwordx4 v[128:131], v4, s[16:19], s68 offen offset:3072 sc1
    s_cmp_ge_u32 s65, s79
    s_cbranch_scc1 S_cvd
    s_mov_b32 s60, s48
    s_mov_b32 s61, s49
    s_mov_b32 s62, 5242880
    s_mov_b32 s67, 117440512
    s_mov_b32 s74, 0
    s_cmp_ge_u32 s65, 1280
    s_cselect_b32 s60, s52, s60
    s_cselect_b32 s61, s53, s61
    s_cselect_b32 s62, 819200, s62
    s_cselect_b32 s67, 122683392, s67
    s_cselect_b32 s74, 1280, s74
    s_cmp_ge_u32 s65, 1480
    s_cselect_b32 s60, s54, s60
    s_cselect_b32 s61, s55, s61
    s_cselect_b32 s62, 819200, s62
    s_cselect_b32 s67, 123731968, s67
    s_cselect_b32 s74, 1480, s74
    s_cmp_ge_u32 s65, 1680
    s_cselect_b32 s60, s58, s60
    s_cselect_b32 s61, s59, s61
    s_cselect_b32 s62, 2211840, s62
    s_cselect_b32 s67, 127926272, s67
    s_cselect_b32 s74, 1680, s74
    s_cmp_ge_u32 s65, 2220
    s_cselect_b32 s60, s56, s60
    s_cselect_b32 s61, s57, s61
    s_cselect_b32 s62, 2211840, s62
    s_cselect_b32 s67, 124780544, s67
    s_cselect_b32 s74, 2220, s74
    s_mov_b32 s63, 0x00020000
    s_cbranch_scc1 S_u3
    s_sub_u32 s75, s65, s74
    s_mul_i32 s41, s75, 13108
    s_lshr_b32 s41, s41, 16
    s_mul_i32 s42, s41, 5
    s_sub_u32 s42, s75, s42
    s_mul_i32 s66, s41, 20480
    s_cmp_lg_u32 s74, 1680
    s_cbranch_scc1 S_u1
    s_lshr_b32 s70, s41, 3
    s_lshl_b32 s70, s70, 1
    s_bfe_u32 s71, s41, 0x10001
    s_add_u32 s70, s70, s71
    s_bfe_u32 s71, s41, 0x10002
    s_cmp_ge_u32 s41, 100
    s_cselect_b32 s72, 1, 0
    s_xor_b32 s71, s71, s72
    s_lshl_b32 s72, s72, 1
    s_xor_b32 s70, s70, s72
    s_sub_u32 s72, 14, s71
    s_cmp_ge_u32 s70, s72
    s_cselect_b32 s73, s72, 0
    s_cselect_b32 s72, 54, 0
    s_sub_u32 s70, s70, s73
    s_lshl_b32 s70, s70, 1
    s_add_u32 s70, s70, s72
    s_mul_i32 s71, s71, 28
    s_add_u32 s70, s70, s71
    s_and_b32 s41, s41, 1
    s_add_u32 s41, s41, s70
S_u1:
    s_mul_i32 s41, s41, 20480
    s_mov_b32 s75, 1280
    v_mov_b32 v115, v112
    s_mov_b32 s76, 99
    s_branch S_u4
S_u3:
    s_sub_u32 s75, s65, s74
    s_mul_i32 s41, s75, 4682
    s_lshr_b32 s41, s41, 16
    s_mul_i32 s42, s41, 14
    s_sub_u32 s42, s75, s42
    s_mul_i32 s66, s41, 55296
    s_mul_i32 s41, s41, 55296
    s_mov_b32 s75, 3456
    v_mov_b32 v115, v113
    s_mov_b32 s76, 13
S_u4:
    s_add_u32 s67, s67, s41
    s_lshl_b32 s41, s42, 12
    s_add_u32 s67, s67, s41
    s_lshl_b32 s41, s42, 8
    s_add_u32 s66, s66, s41
    s_cmp_lt_u32 s65, 2780
    s_cselect_b32 s67, s67, s82
    s_cmp_eq_u32 s42, s76
    s_cselect_b32 s68, s82, s67
    s_add_u32 m0, s69, 0
    s_nop 0
    buffer_load_dwordx4 v115, s[60:63], s66 offen lds
    s_add_u32 m0, s69, 1088
    s_add_u32 s66, s66, s75
    buffer_load_dwordx4 v115, s[60:63], s66 offen lds
    s_add_u32 m0, s69, 2176
    s_add_u32 s66, s66, s75
    buffer_load_dwordx4 v115, s[60:63], s66 offen lds
    s_add_u32 m0, s69, 3264
    s_add_u32 s66, s66, s75
    buffer_load_dwordx4 v115, s[60:63], s66 offen lds
    s_add_u32 s65, s65, 128
    s_mov_b32 s45, s43
    s_add_u32 s43, s43, 34816
    s_cmp_eq_u32 s43, 139264
    s_cselect_b32 s43, 0, s43
    s_add_u32 s36, s36, 1
    s_barrier
    s_add_u32 m0, s43, s84
    s_cmp_lt_u32 s46, s80
    s_cselect_b32 s41, s46, s82
    s_add_u32 s46, s46, 16384
    buffer_load_dwordx4 v4, s[24:27], s41 offen offset:0 sc1 lds
    buffer_load_dwordx4 v4, s[24:27], s41 offen offset:1024 sc1 lds
    buffer_load_dwordx4 v4, s[24:27], s41 offen offset:2048 sc1 lds
    buffer_load_dwordx4 v4, s[24:27], s41 offen offset:3072 sc1 lds
    s_add_u32 m0, m0, 16384
    s_cmp_lt_u32 s47, s81
    s_cselect_b32 s41, s47, s82
    s_add_u32 s47, s47, 16384
    buffer_load_dwordx4 v4, s[24:27], s41 offen offset:0 sc1 lds
    buffer_load_dwordx4 v4, s[24:27], s41 offen offset:1024 sc1 lds
    buffer_load_dwordx4 v4, s[24:27], s41 offen offset:2048 sc1 lds
    buffer_load_dwordx4 v4, s[24:27], s41 offen offset:3072 sc1 lds
    s_waitcnt vmcnt(16)
    s_mov_b32 s45, s43
    s_add_u32 s43, s43, 34816
    s_cmp_eq_u32 s43, 139264
    s_cselect_b32 s43, 0, s43
    s_add_u32 s36, s36, 1
    s_barrier
    s_add_u32 m0, s43, s84
    s_cmp_lt_u32 s46, s80
    s_cselect_b32 s41, s46, s82
    s_add_u32 s46, s46, 16384
    buffer_load_dwordx4 v4, s[24:27], s41 offen offset:0 sc1 lds
    buffer_load_dwordx4 v4, s[24:27], s41 offen offset:1024 sc1 lds
    buffer_load_dwordx4 v4, s[24:27], s41 offen offset:2048 sc1 lds
    buffer_load_dwordx4 v4, s[24:27], s41 offen offset:3072 sc1 lds
    s_add_u32 m0, m0, 16384
    s_cmp_lt_u32 s47, s81
    s_cselect_b32 s41, s47, s82
    s_add_u32 s47, s47, 16384
    buffer_load_dwordx4 v4, s[24:27], s41 offen offset:0 sc1 lds
    buffer_load_dwordx4 v4, s[24:27], s41 offen offset:1024 sc1 lds
    buffer_load_dwordx4 v4, s[24:27], s41 offen offset:2048 sc1 lds
    buffer_load_dwordx4 v4, s[24:27], s41 offen offset:3072 sc1 lds
    s_waitcnt vmcnt(8)
    s_branch S_cv
S_cvd:
    s_mov_b32 s45, s43
    s_add_u32 s43, s43, 34816
    s_cmp_eq_u32 s43, 139264
    s_cselect_b32 s43, 0, s43
    s_add_u32 s36, s36, 1
    s_barrier
    s_add_u32 m0, s43, s84
    s_cmp_lt_u32 s46, s80
    s_cselect_b32 s41, s46, s82
    s_add_u32 s46, s46, 16384
    buffer_load_dwordx4 v4, s[24:27], s41 offen offset:0 sc1 lds
    buffer_load_dwordx4 v4, s[24:27], s41 offen offset:1024 sc1 lds
    buffer_load_dwordx4 v4, s[24:27], s41 offen offset:2048 sc1 lds
    buffer_load_dwordx4 v4, s[24:27], s41 offen offset:3072 sc1 lds
    s_add_u32 m0, m0, 16384
    s_cmp_lt_u32 s47, s81
    s_cselect_b32 s41, s47, s82
    s_add_u32 s47, s47, 16384
    buffer_load_dwordx4 v4, s[24:27], s41 offen offset:0 sc1 lds
    buffer_load_dwordx4 v4, s[24:27], s41 offen offset:1024 sc1 lds
    buffer_load_dwordx4 v4, s[24:27], s41 offen offset:2048 sc1 lds
    buffer_load_dwordx4 v4, s[24:27], s41 offen offset:3072 sc1 lds
    s_waitcnt vmcnt(12)
    s_branch S_wf
S_gv:
    s_mov_b32 s60, s56
    s_mov_b32 s61, s57
    s_cmp_lt_u32 s77, 27
    s_cselect_b32 s62, 2211840, 0
    s_mov_b32 s63, 0x00020000
    v_bfe_u32 v115, v0, 3, 5
    v_mul_u32_u24 v115, 69120, v115
    v_and_b32 v8, 7, v0
    v_lshl_add_u32 v115, v8, 4, v115
    s_lshl_b32 s76, s77, 7
    s_mov_b32 s70, 0x3f80
    s_mov_b32 s71, 0x3f800000
    v_mov_b32 v120, 0
    v_mov_b32 v121, 0
    v_mov_b32 v122, 0
    v_mov_b32 v123, 0
    v_mov_b32 v124, 0
    v_mov_b32 v125, 0
    v_mov_b32 v126, 0
    v_mov_b32 v127, 0
    buffer_load_dwordx4 v[16:19], v115, s[60:63], s76 offen
    s_add_u32 s76, s76, 3456
    buffer_load_dwordx4 v[20:23], v115, s[60:63], s76 offen
    s_add_u32 s76, s76, 3456
    buffer_load_dwordx4 v[24:27], v115, s[60:63], s76 offen
    s_add_u32 s76, s76, 3456
    buffer_load_dwordx4 v[28:31], v115, s[60:63], s76 offen
    s_add_u32 s76, s76, 3456
    buffer_load_dwordx4 v[32:35], v115, s[60:63], s76 offen
    s_add_u32 s76, s76, 3456
    s_mov_b32 s45, s43
    s_add_u32 s43, s43, 34816
    s_cmp_eq_u32 s43, 139264
    s_cselect_b32 s43, 0, s43
    s_add_u32 s36, s36, 1
    s_barrier
    s_add_u32 m0, s43, s84
    s_cmp_lt_u32 s46, s80
    s_cselect_b32 s41, s46, s82
    s_add_u32 s46, s46, 16384
    buffer_load_dwordx4 v4, s[24:27], s41 offen offset:0 sc1 lds
    buffer_load_dwordx4 v4, s[24:27], s41 offen offset:1024 sc1 lds
    buffer_load_dwordx4 v4, s[24:27], s41 offen offset:2048 sc1 lds
    buffer_load_dwordx4 v4, s[24:27], s41 offen offset:3072 sc1 lds
    s_add_u32 m0, m0, 16384
    s_cmp_lt_u32 s47, s81
    s_cselect_b32 s41, s47, s82
    s_add_u32 s47, s47, 16384
    buffer_load_dwordx4 v4, s[24:27], s41 offen offset:0 sc1 lds
    buffer_load_dwordx4 v4, s[24:27], s41 offen offset:1024 sc1 lds
    buffer_load_dwordx4 v4, s[24:27], s41 offen offset:2048 sc1 lds
    buffer_load_dwordx4 v4, s[24:27], s41 offen offset:3072 sc1 lds
    s_waitcnt vmcnt(13)
    buffer_load_dwordx4 v[36:39], v115, s[60:63], s76 offen
    s_add_u32 s76, s76, 3456
    buffer_load_dwordx4 v[40:43], v115, s[60:63], s76 offen
    s_add_u32 s76, s76, 3456
    buffer_load_dwordx4 v[44:47], v115, s[60:63], s76 offen
    s_add_u32 s76, s76, 3456
    buffer_load_dwordx4 v[48:51], v115, s[60:63], s76 offen
    s_add_u32 s76, s76, 3456
    buffer_load_dwordx4 v[52:55], v115, s[60:63], s76 offen
    s_add_u32 s76, s76, 3456
    s_mov_b32 s45, s43
    s_add_u32 s43, s43, 34816
    s_cmp_eq_u32 s43, 139264
    s_cselect_b32 s43, 0, s43
    s_add_u32 s36, s36, 1
    s_barrier
    s_add_u32 m0, s43, s84
    s_cmp_lt_u32 s46, s80
    s_cselect_b32 s41, s46, s82
    s_add_u32 s46, s46, 16384
    buffer_load_dwordx4 v4, s[24:27], s41 offen offset:0 sc1 lds
    buffer_load_dwordx4 v4, s[24:27], s41 offen offset:1024 sc1 lds
    buffer_load_dwordx4 v4, s[24:27], s41 offen offset:2048 sc1 lds
    buffer_load_dwordx4 v4, s[24:27], s41 offen offset:3072 sc1 lds
    s_add_u32 m0, m0, 16384
    s_cmp_lt_u32 s47, s81
    s_cselect_b32 s41, s47, s82
    s_add_u32 s47, s47, 16384
    buffer_load_dwordx4 v4, s[24:27], s41 offen offset:0 sc1 lds
    buffer_load_dwordx4 v4, s[24:27], s41 offen offset:1024 sc1 lds
    buffer_load_dwordx4 v4, s[24:27], s41 offen offset:2048 sc1 lds
    buffer_load_dwordx4 v4, s[24:27], s41 offen offset:3072 sc1 lds
    s_waitcnt vmcnt(13)
    v_lshlrev_b32 v128, 16, v16
    v_and_b32 v16, 0xffff0000, v16
    v_add_f32 v120, v120, v128
    v_add_f32 v121, v121, v16
    v_lshlrev_b32 v128, 16, v17
    v_and_b32 v17, 0xffff0000, v17
    v_add_f32 v122, v122, v128
    v_add_f32 v123, v123, v17
    v_lshlrev_b32 v128, 16, v18
    v_and_b32 v18, 0xffff0000, v18
    v_add_f32 v124, v124, v128
    v_add_f32 v125, v125, v18
    v_lshlrev_b32 v128, 16, v19
    v_and_b32 v19, 0xffff0000, v19
    v_add_f32 v126, v126, v128
    v_add_f32 v127, v127, v19
    v_lshlrev_b32 v128, 16, v20
    v_and_b32 v20, 0xffff0000, v20
    v_add_f32 v120, v120, v128
    v_add_f32 v121, v121, v20
    v_lshlrev_b32 v128, 16, v21
    v_and_b32 v21, 0xffff0000, v21
    v_add_f32 v122, v122, v128
    v_add_f32 v123, v123, v21
    v_lshlrev_b32 v128, 16, v22
    v_and_b32 v22, 0xffff0000, v22
    v_add_f32 v124, v124, v128
    v_add_f32 v125, v125, v22
    v_lshlrev_b32 v128, 16, v23
    v_and_b32 v23, 0xffff0000, v23
    v_add_f32 v126, v126, v128
    v_add_f32 v127, v127, v23
    v_lshlrev_b32 v128, 16, v24
    v_and_b32 v24, 0xffff0000, v24
    v_add_f32 v120, v120, v128
    v_add_f32 v121, v121, v24
    v_lshlrev_b32 v128, 16, v25
    v_and_b32 v25, 0xffff0000, v25
    v_add_f32 v122, v122, v128
    v_add_f32 v123, v123, v25
    v_lshlrev_b32 v128, 16, v26
    v_and_b32 v26, 0xffff0000, v26
    v_add_f32 v124, v124, v128
    v_add_f32 v125, v125, v26
    v_lshlrev_b32 v128, 16, v27
    v_and_b32 v27, 0xffff0000, v27
    v_add_f32 v126, v126, v128
    v_add_f32 v127, v127, v27
    v_lshlrev_b32 v128, 16, v28
    v_and_b32 v28, 0xffff0000, v28
    v_add_f32 v120, v120, v128
    v_add_f32 v121, v121, v28
    v_lshlrev_b32 v128, 16, v29
    v_and_b32 v29, 0xffff0000, v29
    v_add_f32 v122, v122, v128
    v_add_f32 v123, v123, v29
    v_lshlrev_b32 v128, 16, v30
    v_and_b32 v30, 0xffff0000, v30
    v_add_f32 v124, v124, v128
    v_add_f32 v125, v125, v30
    v_lshlrev_b32 v128, 16, v31
    v_and_b32 v31, 0xffff0000, v31
    v_add_f32 v126, v126, v128
    v_add_f32 v127, v127, v31
    v_lshlrev_b32 v128, 16, v32
    v_and_b32 v32, 0xffff0000, v32
    v_add_f32 v120, v120, v128
    v_add_f32 v121, v121, v32
    v_lshlrev_b32 v128, 16, v33
    v_and_b32 v33, 0xffff0000, v33
    v_add_f32 v122, v122, v128
    v_add_f32 v123, v123, v33
    v_lshlrev_b32 v128, 16, v34
    v_and_b32 v34, 0xffff0000, v34
    v_add_f32 v124, v124, v128
    v_add_f32 v125, v125, v34
    v_lshlrev_b32 v128, 16, v35
    v_and_b32 v35, 0xffff0000, v35
    v_add_f32 v126, v126, v128
    v_add_f32 v127, v127, v35
    buffer_load_dwordx4 v[56:59], v115, s[60:63], s76 offen
    s_add_u32 s76, s76, 3456
    buffer_load_dwordx4 v[60:63], v115, s[60:63], s76 offen
    s_add_u32 s76, s76, 3456
    buffer_load_dwordx4 v[64:67], v115, s[60:63], s76 offen
    s_add_u32 s76, s76, 3456
    buffer_load_dwordx4 v[68:71], v115, s[60:63], s76 offen
    s_add_u32 s76, s76, 3456
    buffer_load_dwordx4 v[72:75], v115, s[60:63], s76 offen
    s_add_u32 s76, s76, 3456
    s_mov_b32 s45, s43
    s_add_u32 s43, s43, 34816
    s_cmp_eq_u32 s43, 139264
    s_cselect_b32 s43, 0, s43
    s_add_u32 s36, s36, 1
    s_barrier
    s_add_u32 m0, s43, s84
    s_cmp_lt_u32 s46, s80
    s_cselect_b32 s41, s46, s82
    s_add_u32 s46, s46, 16384
    buffer_load_dwordx4 v4, s[24:27], s41 offen offset:0 sc1 lds
    buffer_load_dwordx4 v4, s[24:27], s41 offen offset:1024 sc1 lds
    buffer_load_dwordx4 v4, s[24:27], s41 offen offset:2048 sc1 lds
    buffer_load_dwordx4 v4, s[24:27], s41 offen offset:3072 sc1 lds
    s_add_u32 m0, m0, 16384
    s_cmp_lt_u32 s47, s81
    s_cselect_b32 s41, s47, s82
    s_add_u32 s47, s47, 16384
    buffer_load_dwordx4 v4, s[24:27], s41 offen offset:0 sc1 lds
    buffer_load_dwordx4 v4, s[24:27], s41 offen offset:1024 sc1 lds
    buffer_load_dwordx4 v4, s[24:27], s41 offen offset:2048 sc1 lds
    buffer_load_dwordx4 v4, s[24:27], s41 offen offset:3072 sc1 lds
    s_waitcnt vmcnt(13)
    v_lshlrev_b32 v128, 16, v36
    v_and_b32 v36, 0xffff0000, v36
    v_add_f32 v120, v120, v128
    v_add_f32 v121, v121, v36
    v_lshlrev_b32 v128, 16, v37
    v_and_b32 v37, 0xffff0000, v37
    v_add_f32 v122, v122, v128
    v_add_f32 v123, v123, v37
    v_lshlrev_b32 v128, 16, v38
    v_and_b32 v38, 0xffff0000, v38
    v_add_f32 v124, v124, v128
    v_add_f32 v125, v125, v38
    v_lshlrev_b32 v128, 16, v39
    v_and_b32 v39, 0xffff0000, v39
    v_add_f32 v126, v126, v128
    v_add_f32 v127, v127, v39
    v_lshlrev_b32 v128, 16, v40
    v_and_b32 v40, 0xffff0000, v40
    v_add_f32 v120, v120, v128
    v_add_f32 v121, v121, v40
    v_lshlrev_b32 v128, 16, v41
    v_and_b32 v41, 0xffff0000, v41
    v_add_f32 v122, v122, v128
    v_add_f32 v123, v123, v41
    v_lshlrev_b32 v128, 16, v42
    v_and_b32 v42, 0xffff0000, v42
    v_add_f32 v124, v124, v128
    v_add_f32 v125, v125, v42
    v_lshlrev_b32 v128, 16, v43
    v_and_b32 v43, 0xffff0000, v43
    v_add_f32 v126, v126, v128
    v_add_f32 v127, v127, v43
    v_lshlrev_b32 v128, 16, v44
    v_and_b32 v44, 0xffff0000, v44
    v_add_f32 v120, v120, v128
    v_add_f32 v121, v121, v44
    v_lshlrev_b32 v128, 16, v45
    v_and_b32 v45, 0xffff0000, v45
    v_add_f32 v122, v122, v128
    v_add_f32 v123, v123, v45
    v_lshlrev_b32 v128, 16, v46
    v_and_b32 v46, 0xffff0000, v46
    v_add_f32 v124, v124, v128
    v_add_f32 v125, v125, v46
    v_lshlrev_b32 v128, 16, v47
    v_and_b32 v47, 0xffff0000, v47
    v_add_f32 v126, v126, v128
    v_add_f32 v127, v127, v47
    v_lshlrev_b32 v128, 16, v48
    v_and_b32 v48, 0xffff0000, v48
    v_add_f32 v120, v120, v128
    v_add_f32 v121, v121, v48
    v_lshlrev_b32 v128, 16, v49
    v_and_b32 v49, 0xffff0000, v49
    v_add_f32 v122, v122, v128
    v_add_f32 v123, v123, v49
    v_lshlrev_b32 v128, 16, v50
    v_and_b32 v50, 0xffff0000, v50
    v_add_f32 v124, v124, v128
    v_add_f32 v125, v125, v50
    v_lshlrev_b32 v128, 16, v51
    v_and_b32 v51, 0xffff0000, v51
    v_add_f32 v126, v126, v128
    v_add_f32 v127, v127, v51
    v_lshlrev_b32 v128, 16, v52
    v_and_b32 v52, 0xffff0000, v52
    v_add_f32 v120, v120, v128
    v_add_f32 v121, v121, v52
    v_lshlrev_b32 v128, 16, v53
    v_and_b32 v53, 0xffff0000, v53
    v_add_f32 v122, v122, v128
    v_add_f32 v123, v123, v53
    v_lshlrev_b32 v128, 16, v54
    v_and_b32 v54, 0xffff0000, v54
    v_add_f32 v124, v124, v128
    v_add_f32 v125, v125, v54
    v_lshlrev_b32 v128, 16, v55
    v_and_b32 v55, 0xffff0000, v55
    v_add_f32 v126, v126, v128
    v_add_f32 v127, v127, v55
    buffer_load_dwordx4 v[76:79], v115, s[60:63], s76 offen
    s_add_u32 s76, s76, 3456
    buffer_load_dwordx4 v[80:83], v115, s[60:63], s76 offen
    s_add_u32 s76, s76, 3456
    buffer_load_dwordx4 v[84:87], v115, s[60:63], s76 offen
    s_add_u32 s76, s76, 3456
    buffer_load_dwordx4 v[88:91], v115, s[60:63], s76 offen
    s_add_u32 s76, s76, 3456
    buffer_load_dwordx4 v[92:95], v115, s[60:63], s76 offen
    s_add_u32 s76, s76, 3456
    s_mov_b32 s45, s43
    s_add_u32 s43, s43, 34816
    s_cmp_eq_u32 s43, 139264
    s_cselect_b32 s43, 0, s43
    s_add_u32 s36, s36, 1
    s_barrier
    s_add_u32 m0, s43, s84
    s_cmp_lt_u32 s46, s80
    s_cselect_b32 s41, s46, s82
    s_add_u32 s46, s46, 16384
    buffer_load_dwordx4 v4, s[24:27], s41 offen offset:0 sc1 lds
    buffer_load_dwordx4 v4, s[24:27], s41 offen offset:1024 sc1 lds
    buffer_load_dwordx4 v4, s[24:27], s41 offen offset:2048 sc1 lds
    buffer_load_dwordx4 v4, s[24:27], s41 offen offset:3072 sc1 lds
    s_add_u32 m0, m0, 16384
    s_cmp_lt_u32 s47, s81
    s_cselect_b32 s41, s47, s82
    s_add_u32 s47, s47, 16384
    buffer_load_dwordx4 v4, s[24:27], s41 offen offset:0 sc1 lds
    buffer_load_dwordx4 v4, s[24:27], s41 offen offset:1024 sc1 lds
    buffer_load_dwordx4 v4, s[24:27], s41 offen offset:2048 sc1 lds
    buffer_load_dwordx4 v4, s[24:27], s41 offen offset:3072 sc1 lds
    s_waitcnt vmcnt(13)
    v_lshlrev_b32 v128, 16, v56
    v_and_b32 v56, 0xffff0000, v56
    v_add_f32 v120, v120, v128
    v_add_f32 v121, v121, v56
    v_lshlrev_b32 v128, 16, v57
    v_and_b32 v57, 0xffff0000, v57
    v_add_f32 v122, v122, v128
    v_add_f32 v123, v123, v57
    v_lshlrev_b32 v128, 16, v58
    v_and_b32 v58, 0xffff0000, v58
    v_add_f32 v124, v124, v128
    v_add_f32 v125, v125, v58
    v_lshlrev_b32 v128, 16, v59
    v_and_b32 v59, 0xffff0000, v59
    v_add_f32 v126, v126, v128
    v_add_f32 v127, v127, v59
    v_lshlrev_b32 v128, 16, v60
    v_and_b32 v60, 0xffff0000, v60
    v_add_f32 v120, v120, v128
    v_add_f32 v121, v121, v60
    v_lshlrev_b32 v128, 16, v61
    v_and_b32 v61, 0xffff0000, v61
    v_add_f32 v122, v122, v128
    v_add_f32 v123, v123, v61
    v_lshlrev_b32 v128, 16, v62
    v_and_b32 v62, 0xffff0000, v62
    v_add_f32 v124, v124, v128
    v_add_f32 v125, v125, v62
    v_lshlrev_b32 v128, 16, v63
    v_and_b32 v63, 0xffff0000, v63
    v_add_f32 v126, v126, v128
    v_add_f32 v127, v127, v63
    v_lshlrev_b32 v128, 16, v64
    v_and_b32 v64, 0xffff0000, v64
    v_add_f32 v120, v120, v128
    v_add_f32 v121, v121, v64
    v_lshlrev_b32 v128, 16, v65
    v_and_b32 v65, 0xffff0000, v65
    v_add_f32 v122, v122, v128
    v_add_f32 v123, v123, v65
    v_lshlrev_b32 v128, 16, v66
    v_and_b32 v66, 0xffff0000, v66
    v_add_f32 v124, v124, v128
    v_add_f32 v125, v125, v66
    v_lshlrev_b32 v128, 16, v67
    v_and_b32 v67, 0xffff0000, v67
    v_add_f32 v126, v126, v128
    v_add_f32 v127, v127, v67
    v_lshlrev_b32 v128, 16, v68
    v_and_b32 v68, 0xffff0000, v68
    v_add_f32 v120, v120, v128
    v_add_f32 v121, v121, v68
    v_lshlrev_b32 v128, 16, v69
    v_and_b32 v69, 0xffff0000, v69
    v_add_f32 v122, v122, v128
    v_add_f32 v123, v123, v69
    v_lshlrev_b32 v128, 16, v70
    v_and_b32 v70, 0xffff0000, v70
    v_add_f32 v124, v124, v128
    v_add_f32 v125, v125, v70
    v_lshlrev_b32 v128, 16, v71
    v_and_b32 v71, 0xffff0000, v71
    v_add_f32 v126, v126, v128
    v_add_f32 v127, v127, v71
    v_lshlrev_b32 v128, 16, v72
    v_and_b32 v72, 0xffff0000, v72
    v_add_f32 v120, v120, v128
    v_add_f32 v121, v121, v72
    v_lshlrev_b32 v128, 16, v73
    v_and_b32 v73, 0xffff0000, v73
    v_add_f32 v122, v122, v128
    v_add_f32 v123, v123, v73
    v_lshlrev_b32 v128, 16, v74
    v_and_b32 v74, 0xffff0000, v74
    v_add_f32 v124, v124, v128
    v_add_f32 v125, v125, v74
    v_lshlrev_b32 v128, 16, v75
    v_and_b32 v75, 0xffff0000, v75
    v_add_f32 v126, v126, v128
    v_add_f32 v127, v127, v75
    s_mov_b32 s45, s43
    s_add_u32 s43, s43, 34816
    s_cmp_eq_u32 s43, 139264
    s_cselect_b32 s43, 0, s43
    s_add_u32 s36, s36, 1
    s_barrier
    s_add_u32 m0, s43, s84
    s_cmp_lt_u32 s46, s80
    s_cselect_b32 s41, s46, s82
    s_add_u32 s46, s46, 16384
    buffer_load_dwordx4 v4, s[24:27], s41 offen offset:0 sc1 lds
    buffer_load_dwordx4 v4, s[24:27], s41 offen offset:1024 sc1 lds
    buffer_load_dwordx4 v4, s[24:27], s41 offen offset:2048 sc1 lds
    buffer_load_dwordx4 v4, s[24:27], s41 offen offset:3072 sc1 lds
    s_add_u32 m0, m0, 16384
    s_cmp_lt_u32 s47, s81
    s_cselect_b32 s41, s47, s82
    s_add_u32 s47, s47, 16384
    buffer_load_dwordx4 v4, s[24:27], s41 offen offset:0 sc1 lds
    buffer_load_dwordx4 v4, s[24:27], s41 offen offset:1024 sc1 lds
    buffer_load_dwordx4 v4, s[24:27], s41 offen offset:2048 sc1 lds
    buffer_load_dwordx4 v4, s[24:27], s41 offen offset:3072 sc1 lds
    s_waitcnt vmcnt(8)
    v_lshlrev_b32 v128, 16, v76
    v_and_b32 v76, 0xffff0000, v76
    v_add_f32 v120, v120, v128
    v_add_f32 v121, v121, v76
    v_lshlrev_b32 v128, 16, v77
    v_and_b32 v77, 0xffff0000, v77
    v_add_f32 v122, v122, v128
    v_add_f32 v123, v123, v77
    v_lshlrev_b32 v128, 16, v78
    v_and_b32 v78, 0xffff0000, v78
    v_add_f32 v124, v124, v128
    v_add_f32 v125, v125, v78
    v_lshlrev_b32 v128, 16, v79
    v_and_b32 v79, 0xffff0000, v79
    v_add_f32 v126, v126, v128
    v_add_f32 v127, v127, v79
    v_lshlrev_b32 v128, 16, v80
    v_and_b32 v80, 0xffff0000, v80
    v_add_f32 v120, v120, v128
    v_add_f32 v121, v121, v80
    v_lshlrev_b32 v128, 16, v81
    v_and_b32 v81, 0xffff0000, v81
    v_add_f32 v122, v122, v128
    v_add_f32 v123, v123, v81
    v_lshlrev_b32 v128, 16, v82
    v_and_b32 v82, 0xffff0000, v82
    v_add_f32 v124, v124, v128
    v_add_f32 v125, v125, v82
    v_lshlrev_b32 v128, 16, v83
    v_and_b32 v83, 0xffff0000, v83
    v_add_f32 v126, v126, v128
    v_add_f32 v127, v127, v83
    v_lshlrev_b32 v128, 16, v84
    v_and_b32 v84, 0xffff0000, v84
    v_add_f32 v120, v120, v128
    v_add_f32 v121, v121, v84
    v_lshlrev_b32 v128, 16, v85
    v_and_b32 v85, 0xffff0000, v85
    v_add_f32 v122, v122, v128
    v_add_f32 v123, v123, v85
    v_lshlrev_b32 v128, 16, v86
    v_and_b32 v86, 0xffff0000, v86
    v_add_f32 v124, v124, v128
    v_add_f32 v125, v125, v86
    v_lshlrev_b32 v128, 16, v87
    v_and_b32 v87, 0xffff0000, v87
    v_add_f32 v126, v126, v128
    v_add_f32 v127, v127, v87
    v_lshlrev_b32 v128, 16, v88
    v_and_b32 v88, 0xffff0000, v88
    v_add_f32 v120, v120, v128
    v_add_f32 v121, v121, v88
    v_lshlrev_b32 v128, 16, v89
    v_and_b32 v89, 0xffff0000, v89
    v_add_f32 v122, v122, v128
    v_add_f32 v123, v123, v89
    v_lshlrev_b32 v128, 16, v90
    v_and_b32 v90, 0xffff0000, v90
    v_add_f32 v124, v124, v128
    v_add_f32 v125, v125, v90
    v_lshlrev_b32 v128, 16, v91
    v_and_b32 v91, 0xffff0000, v91
    v_add_f32 v126, v126, v128
    v_add_f32 v127, v127, v91
    v_lshlrev_b32 v128, 16, v92
    v_and_b32 v92, 0xffff0000, v92
    v_add_f32 v120, v120, v128
    v_add_f32 v121, v121, v92
    v_lshlrev_b32 v128, 16, v93
    v_and_b32 v93, 0xffff0000, v93
    v_add_f32 v122, v122, v128
    v_add_f32 v123, v123, v93
    v_lshlrev_b32 v128, 16, v94
    v_and_b32 v94, 0xffff0000, v94
    v_add_f32 v124, v124, v128
    v_add_f32 v125, v125, v94
    v_lshlrev_b32 v128, 16, v95
    v_and_b32 v95, 0xffff0000, v95
    v_add_f32 v126, v126, v128
    v_add_f32 v127, v127, v95
    s_mov_b32 s45, s43
    s_add_u32 s43, s43, 34816
    s_cmp_eq_u32 s43, 139264
    s_cselect_b32 s43, 0, s43
    s_add_u32 s36, s36, 1
    s_barrier
    s_add_u32 m0, s43, s84
    s_cmp_lt_u32 s46, s80
    s_cselect_b32 s41, s46, s82
    s_add_u32 s46, s46, 16384
    buffer_load_dwordx4 v4, s[24:27], s41 offen offset:0 sc1 lds
    buffer_load_dwordx4 v4, s[24:27], s41 offen offset:1024 sc1 lds
    buffer_load_dwordx4 v4, s[24:27], s41 offen offset:2048 sc1 lds
    buffer_load_dwordx4 v4, s[24:27], s41 offen offset:3072 sc1 lds
    s_add_u32 m0, m0, 16384
    s_cmp_lt_u32 s47, s81
    s_cselect_b32 s41, s47, s82
    s_add_u32 s47, s47, 16384
    buffer_load_dwordx4 v4, s[24:27], s41 offen offset:0 sc1 lds
    buffer_load_dwordx4 v4, s[24:27], s41 offen offset:1024 sc1 lds
    buffer_load_dwordx4 v4, s[24:27], s41 offen offset:2048 sc1 lds
    buffer_load_dwordx4 v4, s[24:27], s41 offen offset:3072 sc1 lds
    s_waitcnt vmcnt(8)
    s_nop 2
    s_nop 1
    v_add_f32_dpp v120, v120, v120 row_ror:8 row_mask:0xf bank_mask:0xf
    v_add_f32_dpp v121, v121, v121 row_ror:8 row_mask:0xf bank_mask:0xf
    v_add_f32_dpp v122, v122, v122 row_ror:8 row_mask:0xf bank_mask:0xf
    v_add_f32_dpp v123, v123, v123 row_ror:8 row_mask:0xf bank_mask:0xf
    v_add_f32_dpp v124, v124, v124 row_ror:8 row_mask:0xf bank_mask:0xf
    v_add_f32_dpp v125, v125, v125 row_ror:8 row_mask:0xf bank_mask:0xf
    v_add_f32_dpp v126, v126, v126 row_ror:8 row_mask:0xf bank_mask:0xf
    v_add_f32_dpp v127, v127, v127 row_ror:8 row_mask:0xf bank_mask:0xf
    v_mov_b32 v128, v120
    v_mov_b32 v129, v121
    v_mov_b32 v130, v122
    v_mov_b32 v131, v123
    s_nop 0
    v_permlane16_swap_b32 v120, v128
    v_permlane16_swap_b32 v121, v129
    v_permlane16_swap_b32 v122, v130
    v_permlane16_swap_b32 v123, v131
    v_add_f32 v120, v120, v128
    v_add_f32 v121, v121, v129
    v_add_f32 v122, v122, v130
    v_add_f32 v123, v123, v131
    v_mov_b32 v128, v124
    v_mov_b32 v129, v125
    v_mov_b32 v130, v126
    v_mov_b32 v131, v127
    s_nop 0
    v_permlane16_swap_b32 v124, v128
    v_permlane16_swap_b32 v125, v129
    v_permlane16_swap_b32 v126, v130
    v_permlane16_swap_b32 v127, v131
    v_add_f32 v124, v124, v128
    v_add_f32 v125, v125, v129
    v_add_f32 v126, v126, v130
    v_add_f32 v127, v127, v131
    v_mov_b32 v128, v120
    v_mov_b32 v129, v121
    v_mov_b32 v130, v122
    v_mov_b32 v131, v123
    s_nop 0
    v_permlane32_swap_b32 v120, v128
    v_permlane32_swap_b32 v121, v129
    v_permlane32_swap_b32 v122, v130
    v_permlane32_swap_b32 v123, v131
    v_add_f32 v120, v120, v128
    v_add_f32 v121, v121, v129
    v_add_f32 v122, v122, v130
    v_add_f32 v123, v123, v131
    v_mov_b32 v128, v124
    v_mov_b32 v129, v125
    v_mov_b32 v130, v126
    v_mov_b32 v131, v127
    s_nop 0
    v_permlane32_swap_b32 v124, v128
    v_permlane32_swap_b32 v125, v129
    v_permlane32_swap_b32 v126, v130
    v_permlane32_swap_b32 v127, v131
    v_add_f32 v124, v124, v128
    v_add_f32 v125, v125, v129
    v_add_f32 v126, v126, v130
    v_add_f32 v127, v127, v131
    v_and_b32 v7, 7, v0
    v_lshlrev_b32 v7, 5, v7
    s_lshl_b32 s76, s3, 8
    s_add_u32 s76, s76, 138240
    v_add_u32 v7, s76, v7
    ds_write_b128 v7, v[120:123]
    ds_write_b128 v7, v[124:127] offset:16
    s_waitcnt lgkmcnt(0)
    s_mov_b32 s45, s43
    s_add_u32 s43, s43, 34816
    s_cmp_eq_u32 s43, 139264
    s_cselect_b32 s43, 0, s43
    s_add_u32 s36, s36, 1
    s_barrier
    s_add_u32 m0, s43, s84
    s_cmp_lt_u32 s46, s80
    s_cselect_b32 s41, s46, s82
    s_add_u32 s46, s46, 16384
    buffer_load_dwordx4 v4, s[24:27], s41 offen offset:0 sc1 lds
    buffer_load_dwordx4 v4, s[24:27], s41 offen offset:1024 sc1 lds
    buffer_load_dwordx4 v4, s[24:27], s41 offen offset:2048 sc1 lds
    buffer_load_dwordx4 v4, s[24:27], s41 offen offset:3072 sc1 lds
    s_add_u32 m0, m0, 16384
    s_cmp_lt_u32 s47, s81
    s_cselect_b32 s41, s47, s82
    s_add_u32 s47, s47, 16384
    buffer_load_dwordx4 v4, s[24:27], s41 offen offset:0 sc1 lds
    buffer_load_dwordx4 v4, s[24:27], s41 offen offset:1024 sc1 lds
    buffer_load_dwordx4 v4, s[24:27], s41 offen offset:2048 sc1 lds
    buffer_load_dwordx4 v4, s[24:27], s41 offen offset:3072 sc1 lds
    s_waitcnt vmcnt(8)
    v_lshrrev_b32 v7, 2, v4
    v_add_u32 v8, 139264, v7
    ds_read_b32 v120, v8 offset:0
    ds_read_b32 v121, v8 offset:256
    ds_read_b32 v122, v8 offset:512
    ds_read_b32 v123, v8 offset:768
    s_waitcnt lgkmcnt(0)
    v_add_f32 v120, v120, v121
    v_add_f32 v120, v120, v122
    v_add_f32 v120, v120, v123
    s_lshl_b32 s76, s77, 8
    s_add_u32 s76, s76, 20480
    s_cmp_lt_u32 s77, 27
    s_cselect_b32 s76, s76, s82
    s_cmp_eq_u32 s3, 4
    s_cselect_b32 s76, s76, s82
    buffer_store_dword v120, v7, s[16:19], s76 offen sc1
    s_mov_b32 s45, s43
    s_add_u32 s43, s43, 34816
    s_cmp_eq_u32 s43, 139264
    s_cselect_b32 s43, 0, s43
    s_add_u32 s36, s36, 1
    s_barrier
    s_add_u32 m0, s43, s84
    s_cmp_lt_u32 s46, s80
    s_cselect_b32 s41, s46, s82
    s_add_u32 s46, s46, 16384
    buffer_load_dwordx4 v4, s[24:27], s41 offen offset:0 sc1 lds
    buffer_load_dwordx4 v4, s[24:27], s41 offen offset:1024 sc1 lds
    buffer_load_dwordx4 v4, s[24:27], s41 offen offset:2048 sc1 lds
    buffer_load_dwordx4 v4, s[24:27], s41 offen offset:3072 sc1 lds
    s_add_u32 m0, m0, 16384
    s_cmp_lt_u32 s47, s81
    s_cselect_b32 s41, s47, s82
    s_add_u32 s47, s47, 16384
    buffer_load_dwordx4 v4, s[24:27], s41 offen offset:0 sc1 lds
    buffer_load_dwordx4 v4, s[24:27], s41 offen offset:1024 sc1 lds
    buffer_load_dwordx4 v4, s[24:27], s41 offen offset:2048 sc1 lds
    buffer_load_dwordx4 v4, s[24:27], s41 offen offset:3072 sc1 lds
    s_waitcnt vmcnt(9)
S_wf:
    s_mov_b32 s45, s43
    s_add_u32 s43, s43, 34816
    s_cmp_eq_u32 s43, 139264
    s_cselect_b32 s43, 0, s43
    s_add_u32 s36, s36, 1
    s_barrier
    s_add_u32 m0, s43, s84
    s_cmp_lt_u32 s46, s80
    s_cselect_b32 s41, s46, s82
    s_add_u32 s46, s46, 16384
    buffer_load_dwordx4 v4, s[24:27], s41 offen offset:0 sc1 lds
    buffer_load_dwordx4 v4, s[24:27], s41 offen offset:1024 sc1 lds
    buffer_load_dwordx4 v4, s[24:27], s41 offen offset:2048 sc1 lds
    buffer_load_dwordx4 v4, s[24:27], s41 offen offset:3072 sc1 lds
    s_add_u32 m0, m0, 16384
    s_cmp_lt_u32 s47, s81
    s_cselect_b32 s41, s47, s82
    s_add_u32 s47, s47, 16384
    buffer_load_dwordx4 v4, s[24:27], s41 offen offset:0 sc1 lds
    buffer_load_dwordx4 v4, s[24:27], s41 offen offset:1024 sc1 lds
    buffer_load_dwordx4 v4, s[24:27], s41 offen offset:2048 sc1 lds
    buffer_load_dwordx4 v4, s[24:27], s41 offen offset:3072 sc1 lds
    s_waitcnt vmcnt(8)
    s_lshl_b32 s92, s2, 2
    s_add_u32 s92, s92, 695296
    v_mov_b32 v7, 162844
    v_mov_b32 v8, 1
    s_mov_b64 exec, 1
    ds_add_rtn_u32 v8, v7, v8
    v_mov_b32 v7, 0
    s_waitcnt lgkmcnt(0)
    v_cmp_eq_u32 vcc, 3, v8
    v_mov_b32 v8, s91
    s_cbranch_vccz S_sg2
    buffer_store_dword v8, v7, s[16:19], s92 offen sc1
S_sg2:
    s_mov_b64 exec, -1
S_loader:
    s_add_u32 s41, s36, 1
    s_cmp_ge_u32 s41, s37
    s_cbranch_scc1 S_last
    s_waitcnt vmcnt(8)
    s_mov_b32 s45, s43
    s_add_u32 s43, s43, 34816
    s_cmp_eq_u32 s43, 139264
    s_cselect_b32 s43, 0, s43
    s_add_u32 s36, s36, 1
    s_barrier
    s_add_u32 m0, s43, s84
    s_cmp_lt_u32 s46, s80
    s_cselect_b32 s41, s46, s82
    s_add_u32 s46, s46, 16384
    buffer_load_dwordx4 v4, s[24:27], s41 offen offset:0 sc1 lds
    buffer_load_dwordx4 v4, s[24:27], s41 offen offset:1024 sc1 lds
    buffer_load_dwordx4 v4, s[24:27], s41 offen offset:2048 sc1 lds
    buffer_load_dwordx4 v4, s[24:27], s41 offen offset:3072 sc1 lds
    s_add_u32 m0, m0, 16384
    s_cmp_lt_u32 s47, s81
    s_cselect_b32 s41, s47, s82
    s_add_u32 s47, s47, 16384
    buffer_load_dwordx4 v4, s[24:27], s41 offen offset:0 sc1 lds
    buffer_load_dwordx4 v4, s[24:27], s41 offen offset:1024 sc1 lds
    buffer_load_dwordx4 v4, s[24:27], s41 offen offset:2048 sc1 lds
    buffer_load_dwordx4 v4, s[24:27], s41 offen offset:3072 sc1 lds
    s_branch S_loader
S_last:
    s_waitcnt vmcnt(0)
    s_barrier
S_exit:
    s_load_dwordx2 s[28:29], s[0:1], 104
    s_load_dwordx2 s[36:37], s[0:1], 0
    s_mov_b32 s38, 2621440
    s_mov_b32 s39, 0x00020000
    v_lshrrev_b32 v5, 6, v0
    v_and_b32 v3, 63, v0
    v_readfirstlane_b32 s3, v5
    v_lshlrev_b32 v1, 4, v3
    s_and_b32 s52, s2, 7
    s_lshr_b32 s53, s2, 3
    s_and_b32 s55, s3, 3
    s_mov_b32 s54, s91
    s_lshr_b32 s62, s52, 1
    s_and_b32 s34, s53, 15
    s_cmp_lt_u32 s53, 16
    s_cselect_b32 s57, 8, 0
    s_add_u32 s33, s52, s57
    s_lshl_b32 s35, s33, 4
    s_add_u32 s35, s35, s34
    s_lshr_b32 s56, s34, 2
    s_lshl_b32 s56, s56, 1
    s_add_u32 s56, s56, s57
    s_and_b32 s65, s52, 1
    s_add_u32 s65, s65, s56
    s_and_b32 s66, s53, 3
    s_lshl_b32 s63, s65, 2
    s_add_u32 s63, s63, s55
    s_mul_i32 s64, s66, 5
    s_lshl_b32 s56, s62, 6
    s_add_u32 s56, s56, s55
    s_mul_i32 s56, s56, 20
    s_add_u32 s56, s56, s64
    s_lshl_b32 s73, s56, 10
    s_add_u32 s73, s73, 117440512
    s_mul_i32 s77, s55, 5120
    s_lshl_b32 s81, s63, 18
    s_lshl_b32 s56, s62, 16
    s_add_u32 s81, s81, s56
    s_add_u32 s81, s81, 50331648
    s_waitcnt lgkmcnt(0)
    v_min_u32 v2, 496, v1
    s_mov_b32 s56, 695296
    s_mov_b32 s57, 0
kb_wl:
    buffer_load_dwordx4 v[8:11], v2, s[16:19], s56 offen sc1
    s_add_u32 s57, s57, 1
    s_waitcnt vmcnt(0)
    v_xor_b32 v8, s54, v8
    v_xor_b32 v9, s54, v9
    v_xor_b32 v10, s54, v10
    v_xor_b32 v11, s54, v11
    v_or3_b32 v8, v8, v9, v10
    v_or_b32 v8, v8, v11
    v_cmp_ne_u32 vcc, 0, v8
    s_cbranch_vccz kb_wd
    s_sleep 4
    s_cmp_lt_u32 s57, 0x40000
    s_cbranch_scc1 kb_wl
kb_wd:
    s_add_u32 m0, s77, 0
    s_add_u32 s61, s73, 0
    buffer_load_dwordx4 v1, s[16:19], s61 offen offset:0 sc1 lds
    buffer_load_dwordx4 v1, s[16:19], s61 offen offset:1024 sc1 lds
    buffer_load_dwordx4 v1, s[16:19], s61 offen offset:2048 sc1 lds
    buffer_load_dwordx4 v1, s[16:19], s61 offen offset:3072 sc1 lds
    s_add_u32 m0, s77, 4096
    s_add_u32 s61, s73, 4096
    buffer_load_dwordx4 v1, s[16:19], s61 offen offset:0 sc1 lds
    s_add_u32 m0, s77, 20480
    s_add_u32 s61, s73, 81920
    buffer_load_dwordx4 v1, s[16:19], s61 offen offset:0 sc1 lds
    buffer_load_dwordx4 v1, s[16:19], s61 offen offset:1024 sc1 lds
    buffer_load_dwordx4 v1, s[16:19], s61 offen offset:2048 sc1 lds
    buffer_load_dwordx4 v1, s[16:19], s61 offen offset:3072 sc1 lds
    s_add_u32 m0, s77, 24576
    s_add_u32 s61, s73, 86016
    buffer_load_dwordx4 v1, s[16:19], s61 offen offset:0 sc1 lds
    s_add_u32 m0, s77, 40960
    s_add_u32 s61, s73, 163840
    buffer_load_dwordx4 v1, s[16:19], s61 offen offset:0 sc1 lds
    buffer_load_dwordx4 v1, s[16:19], s61 offen offset:1024 sc1 lds
    buffer_load_dwordx4 v1, s[16:19], s61 offen offset:2048 sc1 lds
    buffer_load_dwordx4 v1, s[16:19], s61 offen offset:3072 sc1 lds
    s_add_u32 m0, s77, 45056
    s_add_u32 s61, s73, 167936
    buffer_load_dwordx4 v1, s[16:19], s61 offen offset:0 sc1 lds
    s_getpc_b64 s[92:93]
kb_pc:
    s_sub_u32 s92, s92, kb_pc-adaLN_cond__compressed_kv_cla__mixer_s_mlp__prompt_kernel
    s_subb_u32 s93, s93, 0
    s_mov_b32 s94, CODE_END_F-adaLN_cond__compressed_kv_cla__mixer_s_mlp__prompt_kernel
    s_mov_b32 s95, 0x00020000
    s_lshl_b32 s56, s53, 2
    s_add_u32 s56, s56, s55
    s_mul_i32 s56, s56, 896
    v_lshlrev_b32 v2, 3, v1
    s_mov_b64 exec, 127
    buffer_load_dword v252, v2, s[92:95], s56 offen
    s_mov_b64 exec, -1
    s_and_b32 s56, s34, 1
    s_lshr_b32 s69, s34, 1
    s_lshl_b32 s71, s33, 1
    s_add_u32 s71, s71, s56
    s_lshl_b32 s67, s71, 1
    s_and_b32 s56, s3, 1
    s_add_u32 s67, s67, s56
    s_mul_i32 s68, s69, 3
    s_min_u32 s68, s68, 17
    s_lshr_b32 s70, s55, 1
    s_mov_b32 s90, s33
    s_lshl_b32 s72, s90, 2
    s_add_u32 s72, s72, s55
    s_mov_b32 s91, s34
    s_lshl_b32 s85, s91, 2
    s_min_u32 s85, s85, 50
    s_mov_b32 s20, s4
    s_mov_b32 s21, s5
    s_mov_b32 s22, 0x0
    s_mov_b32 s23, 0x00020000
    s_mov_b32 s31, 0x00020000
    s_cmp_lt_u32 s34, 14
    s_cselect_b32 s22, 268435456, 0
    s_cselect_b32 s30, 2621440, 0
    s_mov_b32 s84, 0xbdd2d3e8
    s_mul_i32 s56, s55, 2
    s_mul_i32 s78, s56, 3072
    s_mul_i32 s57, s70, 16
    s_add_u32 s56, s56, s57
    s_mul_i32 s56, s56, 20
    s_add_u32 s56, s56, s68
    s_lshl_b32 s74, s56, 10
    s_add_u32 s74, s74, 122683392
    s_mul_i32 s56, s55, 2
    s_mul_i32 s78, s56, 3072
    s_mul_i32 s57, s70, 16
    s_add_u32 s56, s56, s57
    s_mul_i32 s56, s56, 20
    s_add_u32 s56, s56, s68
    s_lshl_b32 s32, s56, 10
    s_add_u32 s32, s32, 123731968
    s_mul_i32 s56, s55, 5
    s_mul_i32 s79, s56, 2048
    s_mul_i32 s57, s70, 10
    s_add_u32 s56, s56, s57
    s_mul_i32 s56, s56, 54
    s_add_u32 s56, s56, s85
    s_lshl_b32 s75, s56, 10
    s_add_u32 s75, s75, 124780544
    s_mul_i32 s56, s55, 3
    s_mul_i32 s80, s56, 3072
    s_mul_i32 s57, s70, 48
    s_add_u32 s56, s56, s57
    s_mul_i32 s56, s56, 20
    s_add_u32 s56, s56, s68
    s_lshl_b32 s76, s56, 10
    s_add_u32 s76, s76, 127926272
    s_waitcnt vmcnt(6)
    s_barrier
    s_add_u32 m0, s77, 61440
    s_add_u32 s61, s73, 245760
    buffer_load_dwordx4 v1, s[16:19], s61 offen offset:0 sc1 lds
    buffer_load_dwordx4 v1, s[16:19], s61 offen offset:1024 sc1 lds
    buffer_load_dwordx4 v1, s[16:19], s61 offen offset:2048 sc1 lds
    buffer_load_dwordx4 v1, s[16:19], s61 offen offset:3072 sc1 lds
    s_add_u32 m0, s77, 65536
    s_add_u32 s61, s73, 249856
    buffer_load_dwordx4 v1, s[16:19], s61 offen offset:0 sc1 lds
    s_add_u32 m0, s77, 81920
    s_add_u32 s61, s73, 327680
    buffer_load_dwordx4 v1, s[16:19], s61 offen offset:0 sc1 lds
    buffer_load_dwordx4 v1, s[16:19], s61 offen offset:1024 sc1 lds
    buffer_load_dwordx4 v1, s[16:19], s61 offen offset:2048 sc1 lds
    buffer_load_dwordx4 v1, s[16:19], s61 offen offset:3072 sc1 lds
    s_add_u32 m0, s77, 86016
    s_add_u32 s61, s73, 331776
    buffer_load_dwordx4 v1, s[16:19], s61 offen offset:0 sc1 lds
    s_add_u32 m0, s77, 102400
    s_add_u32 s61, s73, 409600
    buffer_load_dwordx4 v1, s[16:19], s61 offen offset:0 sc1 lds
    buffer_load_dwordx4 v1, s[16:19], s61 offen offset:1024 sc1 lds
    buffer_load_dwordx4 v1, s[16:19], s61 offen offset:2048 sc1 lds
    buffer_load_dwordx4 v1, s[16:19], s61 offen offset:3072 sc1 lds
    s_add_u32 m0, s77, 106496
    s_add_u32 s61, s73, 413696
    buffer_load_dwordx4 v1, s[16:19], s61 offen offset:0 sc1 lds
    s_add_u32 m0, s77, 122880
    s_add_u32 s61, s73, 491520
    buffer_load_dwordx4 v1, s[16:19], s61 offen offset:0 sc1 lds
    buffer_load_dwordx4 v1, s[16:19], s61 offen offset:1024 sc1 lds
    buffer_load_dwordx4 v1, s[16:19], s61 offen offset:2048 sc1 lds
    buffer_load_dwordx4 v1, s[16:19], s61 offen offset:3072 sc1 lds
    s_add_u32 m0, s77, 126976
    s_add_u32 s61, s73, 495616
    buffer_load_dwordx4 v1, s[16:19], s61 offen offset:0 sc1 lds
    s_waitcnt vmcnt(21)
    s_barrier
    s_add_u32 m0, s77, 0
    s_add_u32 s61, s73, 573440
    buffer_load_dwordx4 v1, s[16:19], s61 offen offset:0 sc1 lds
    buffer_load_dwordx4 v1, s[16:19], s61 offen offset:1024 sc1 lds
    buffer_load_dwordx4 v1, s[16:19], s61 offen offset:2048 sc1 lds
    buffer_load_dwordx4 v1, s[16:19], s61 offen offset:3072 sc1 lds
    s_add_u32 m0, s77, 4096
    s_add_u32 s61, s73, 577536
    buffer_load_dwordx4 v1, s[16:19], s61 offen offset:0 sc1 lds
    s_waitcnt vmcnt(20)
    s_barrier
    s_add_u32 m0, s77, 20480
    s_add_u32 s61, s73, 655360
    buffer_load_dwordx4 v1, s[16:19], s61 offen offset:0 sc1 lds
    buffer_load_dwordx4 v1, s[16:19], s61 offen offset:1024 sc1 lds
    buffer_load_dwordx4 v1, s[16:19], s61 offen offset:2048 sc1 lds
    buffer_load_dwordx4 v1, s[16:19], s61 offen offset:3072 sc1 lds
    s_add_u32 m0, s77, 24576
    s_add_u32 s61, s73, 659456
    buffer_load_dwordx4 v1, s[16:19], s61 offen offset:0 sc1 lds
    s_waitcnt vmcnt(20)
    s_barrier
    s_add_u32 m0, s77, 40960
    s_add_u32 s61, s73, 737280
    buffer_load_dwordx4 v1, s[16:19], s61 offen offset:0 sc1 lds
    buffer_load_dwordx4 v1, s[16:19], s61 offen offset:1024 sc1 lds
    buffer_load_dwordx4 v1, s[16:19], s61 offen offset:2048 sc1 lds
    buffer_load_dwordx4 v1, s[16:19], s61 offen offset:3072 sc1 lds
    s_add_u32 m0, s77, 45056
    s_add_u32 s61, s73, 741376
    buffer_load_dwordx4 v1, s[16:19], s61 offen offset:0 sc1 lds
    s_waitcnt vmcnt(20)
    s_barrier
    s_add_u32 m0, s77, 61440
    s_add_u32 s61, s73, 819200
    buffer_load_dwordx4 v1, s[16:19], s61 offen offset:0 sc1 lds
    buffer_load_dwordx4 v1, s[16:19], s61 offen offset:1024 sc1 lds
    buffer_load_dwordx4 v1, s[16:19], s61 offen offset:2048 sc1 lds
    buffer_load_dwordx4 v1, s[16:19], s61 offen offset:3072 sc1 lds
    s_add_u32 m0, s77, 65536
    s_add_u32 s61, s73, 823296
    buffer_load_dwordx4 v1, s[16:19], s61 offen offset:0 sc1 lds
    s_waitcnt vmcnt(20)
    s_barrier
    s_add_u32 m0, s77, 81920
    s_add_u32 s61, s73, 901120
    buffer_load_dwordx4 v1, s[16:19], s61 offen offset:0 sc1 lds
    buffer_load_dwordx4 v1, s[16:19], s61 offen offset:1024 sc1 lds
    buffer_load_dwordx4 v1, s[16:19], s61 offen offset:2048 sc1 lds
    buffer_load_dwordx4 v1, s[16:19], s61 offen offset:3072 sc1 lds
    s_add_u32 m0, s77, 86016
    s_add_u32 s61, s73, 905216
    buffer_load_dwordx4 v1, s[16:19], s61 offen offset:0 sc1 lds
    s_waitcnt vmcnt(20)
    s_barrier
    s_add_u32 m0, s77, 102400
    s_add_u32 s61, s73, 983040
    buffer_load_dwordx4 v1, s[16:19], s61 offen offset:0 sc1 lds
    buffer_load_dwordx4 v1, s[16:19], s61 offen offset:1024 sc1 lds
    buffer_load_dwordx4 v1, s[16:19], s61 offen offset:2048 sc1 lds
    buffer_load_dwordx4 v1, s[16:19], s61 offen offset:3072 sc1 lds
    s_add_u32 m0, s77, 106496
    s_add_u32 s61, s73, 987136
    buffer_load_dwordx4 v1, s[16:19], s61 offen offset:0 sc1 lds
    s_waitcnt vmcnt(20)
    s_barrier
    s_add_u32 m0, s77, 122880
    s_add_u32 s61, s73, 1064960
    buffer_load_dwordx4 v1, s[16:19], s61 offen offset:0 sc1 lds
    buffer_load_dwordx4 v1, s[16:19], s61 offen offset:1024 sc1 lds
    buffer_load_dwordx4 v1, s[16:19], s61 offen offset:2048 sc1 lds
    buffer_load_dwordx4 v1, s[16:19], s61 offen offset:3072 sc1 lds
    s_add_u32 m0, s77, 126976
    s_add_u32 s61, s73, 1069056
    buffer_load_dwordx4 v1, s[16:19], s61 offen offset:0 sc1 lds
    s_waitcnt vmcnt(20)
    s_barrier
    s_add_u32 m0, s77, 0
    s_add_u32 s61, s73, 1146880
    buffer_load_dwordx4 v1, s[16:19], s61 offen offset:0 sc1 lds
    buffer_load_dwordx4 v1, s[16:19], s61 offen offset:1024 sc1 lds
    buffer_load_dwordx4 v1, s[16:19], s61 offen offset:2048 sc1 lds
    buffer_load_dwordx4 v1, s[16:19], s61 offen offset:3072 sc1 lds
    s_add_u32 m0, s77, 4096
    s_add_u32 s61, s73, 1150976
    buffer_load_dwordx4 v1, s[16:19], s61 offen offset:0 sc1 lds
    s_waitcnt vmcnt(20)
    s_barrier
    s_add_u32 m0, s77, 20480
    s_add_u32 s61, s73, 1228800
    buffer_load_dwordx4 v1, s[16:19], s61 offen offset:0 sc1 lds
    buffer_load_dwordx4 v1, s[16:19], s61 offen offset:1024 sc1 lds
    buffer_load_dwordx4 v1, s[16:19], s61 offen offset:2048 sc1 lds
    buffer_load_dwordx4 v1, s[16:19], s61 offen offset:3072 sc1 lds
    s_add_u32 m0, s77, 24576
    s_add_u32 s61, s73, 1232896
    buffer_load_dwordx4 v1, s[16:19], s61 offen offset:0 sc1 lds
    s_waitcnt vmcnt(20)
    s_barrier
    v_lshrrev_b32 v7, 1, v1
    v_min_u32 v7, 120, v7
    s_mov_b32 s56, 695808
    s_mov_b32 s57, 0
    buffer_load_dwordx2 v[10:11], v7, s[16:19], s56 offen sc1
    s_waitcnt vmcnt(16)
    s_barrier
    s_add_u32 m0, s78, 40960
    s_add_u32 s61, s74, 0
    buffer_load_dwordx4 v1, s[20:23], s61 offen offset:0 sc1 lds
    buffer_load_dwordx4 v1, s[20:23], s61 offen offset:1024 sc1 lds
    buffer_load_dwordx4 v1, s[20:23], s61 offen offset:2048 sc1 lds
    s_add_u32 m0, s78, 44032
    s_add_u32 s61, s74, 20480
    buffer_load_dwordx4 v1, s[20:23], s61 offen offset:0 sc1 lds
    buffer_load_dwordx4 v1, s[20:23], s61 offen offset:1024 sc1 lds
    buffer_load_dwordx4 v1, s[20:23], s61 offen offset:2048 sc1 lds
    s_waitcnt vmcnt(17)
    s_barrier
    s_add_u32 m0, s78, 65536
    s_add_u32 s61, s74, 81920
    buffer_load_dwordx4 v1, s[20:23], s61 offen offset:0 sc1 lds
    buffer_load_dwordx4 v1, s[20:23], s61 offen offset:1024 sc1 lds
    buffer_load_dwordx4 v1, s[20:23], s61 offen offset:2048 sc1 lds
    s_add_u32 m0, s78, 68608
    s_add_u32 s61, s74, 102400
    buffer_load_dwordx4 v1, s[20:23], s61 offen offset:0 sc1 lds
    buffer_load_dwordx4 v1, s[20:23], s61 offen offset:1024 sc1 lds
    buffer_load_dwordx4 v1, s[20:23], s61 offen offset:2048 sc1 lds
    s_waitcnt vmcnt(18)
    s_barrier
    s_add_u32 m0, s78, 90112
    s_add_u32 s61, s74, 163840
    buffer_load_dwordx4 v1, s[20:23], s61 offen offset:0 sc1 lds
    buffer_load_dwordx4 v1, s[20:23], s61 offen offset:1024 sc1 lds
    buffer_load_dwordx4 v1, s[20:23], s61 offen offset:2048 sc1 lds
    s_add_u32 m0, s78, 93184
    s_add_u32 s61, s74, 184320
    buffer_load_dwordx4 v1, s[20:23], s61 offen offset:0 sc1 lds
    buffer_load_dwordx4 v1, s[20:23], s61 offen offset:1024 sc1 lds
    buffer_load_dwordx4 v1, s[20:23], s61 offen offset:2048 sc1 lds
    s_waitcnt vmcnt(19)
    s_barrier
    s_add_u32 m0, s78, 114688
    s_add_u32 s61, s74, 245760
    buffer_load_dwordx4 v1, s[20:23], s61 offen offset:0 sc1 lds
    buffer_load_dwordx4 v1, s[20:23], s61 offen offset:1024 sc1 lds
    buffer_load_dwordx4 v1, s[20:23], s61 offen offset:2048 sc1 lds
    s_add_u32 m0, s78, 117760
    s_add_u32 s61, s74, 266240
    buffer_load_dwordx4 v1, s[20:23], s61 offen offset:0 sc1 lds
    buffer_load_dwordx4 v1, s[20:23], s61 offen offset:1024 sc1 lds
    buffer_load_dwordx4 v1, s[20:23], s61 offen offset:2048 sc1 lds
    s_waitcnt vmcnt(24)
kb_yl:
    v_xor_b32 v10, s54, v10
    v_xor_b32 v11, s54, v11
    v_or_b32 v10, v10, v11
    v_cmp_ne_u32 vcc, 0, v10
    s_cbranch_vccz kb_yd
    s_sleep 4
    buffer_load_dwordx2 v[10:11], v7, s[16:19], s56 offen sc1
    s_add_u32 s57, s57, 1
    s_waitcnt vmcnt(0)
    s_cmp_lt_u32 s57, 0x40000
    s_cbranch_scc1 kb_yl
kb_yd:
    s_barrier
    s_barrier
    s_add_u32 m0, s78, 0
    s_add_u32 s61, s74, 327680
    buffer_load_dwordx4 v1, s[20:23], s61 offen offset:0 sc1 lds
    buffer_load_dwordx4 v1, s[20:23], s61 offen offset:1024 sc1 lds
    buffer_load_dwordx4 v1, s[20:23], s61 offen offset:2048 sc1 lds
    s_add_u32 m0, s78, 3072
    s_add_u32 s61, s74, 348160
    buffer_load_dwordx4 v1, s[20:23], s61 offen offset:0 sc1 lds
    buffer_load_dwordx4 v1, s[20:23], s61 offen offset:1024 sc1 lds
    buffer_load_dwordx4 v1, s[20:23], s61 offen offset:2048 sc1 lds
    v_lshrrev_b32 v2, 3, v0
    v_add_u32 v2, 32, v2
    v_lshlrev_b32 v128, 9, v2
    v_and_b32 v129, 7, v0
    v_lshl_add_u32 v128, v129, 4, v128
    v_lshrrev_b32 v129, 1, v2
    v_lshlrev_b32 v129, 6, v129
    v_and_b32 v2, 1, v2
    v_lshl_add_u32 v129, v2, 4, v129
    s_lshr_b32 s83, s35, 2
    s_mul_i32 s82, s83, 262144
    s_and_b32 s57, s53, 3
    s_lshl_b32 s57, s57, 7
    s_add_u32 s82, s82, s57
    s_mov_b32 s58, 0
    s_cmp_lt_u32 s3, 6
    s_cselect_b32 s82, s82, 0x70000000
    s_cselect_b32 s58, 0, 0x70000000
    v_and_b32 v2, 7, v0
    v_mul_u32_u24 v2, 1280, v2
    v_lshrrev_b32 v3, 1, v129
    v_add_u32 v2, v2, v3
    s_mul_i32 s57, s35, 10240
    s_add_u32 s57, s57, s58
    buffer_load_dwordx2 v[132:133], v2, s[36:39], s57 offen offset:0
    buffer_load_dwordx2 v[134:135], v2, s[36:39], s57 offen offset:16
    s_add_u32 s57, s58, 5120
    buffer_load_dwordx4 v[140:143], v129, s[16:19], s57 offen offset:0 sc1
    buffer_load_dwordx4 v[144:147], v129, s[16:19], s57 offen offset:32 sc1
    s_add_u32 s57, s58, 10240
    buffer_load_dwordx4 v[156:159], v129, s[16:19], s57 offen offset:0 sc1
    buffer_load_dwordx4 v[160:163], v129, s[16:19], s57 offen offset:32 sc1
    s_add_u32 s57, s58, 7680
    buffer_load_dwordx4 v[172:175], v129, s[16:19], s57 offen offset:0 sc1
    buffer_load_dwordx4 v[176:179], v129, s[16:19], s57 offen offset:32 sc1
    v_and_b32 v130, 7, v0
    v_lshlrev_b32 v130, 6, v130
    v_add_u32 v130, 161792, v130
    s_lshl_b32 s57, s3, 3
    v_add_u32 v131, s57, v130
    v_mov_b32 v2, 162860
    s_cmp_lg_u32 s3, 7
    s_cbranch_scc1 kb_rw
    s_lshr_b32 s56, s83, 2
    s_lshl_b32 s56, s56, 11
    s_add_u32 s56, s56, 524288
    v_lshlrev_b32 v7, 3, v1
    s_mov_b32 s57, 0
    s_mov_b64 exec, 0xffff
kb_rp:
    buffer_load_dword v8, v7, s[16:19], s56 offen sc1
    s_add_u32 s57, s57, 1
    s_waitcnt vmcnt(0)
    v_cmp_eq_u32 vcc, s54, v8
    s_lshr_b32 s58, vcc_lo, 2
    s_and_b32 s58, s58, vcc_lo
    s_lshr_b32 s59, s58, 1
    s_and_b32 s58, s58, s59
    s_and_b32 s58, s58, 0x1111
    s_cmp_ge_u32 s57, 0x40000
    s_cselect_b32 s58, 0x1111, s58
    v_mov_b32 v8, s58
    ds_write_b32 v2, v8
    s_cmp_eq_u32 s58, 0x1111
    s_cbranch_scc1 kb_rq
    s_sleep 1
    s_branch kb_rp
kb_rq:
    s_mov_b64 exec, -1
kb_rw:
    s_mov_b32 s59, 0
kb_rlL:
    ds_read_b32 v8, v2
    s_waitcnt lgkmcnt(0)
    v_readfirstlane_b32 s58, v8
    s_andn2_b32 s56, s58, s59
    s_cbranch_scc1 kb_rnL
    s_sleep 1
    s_branch kb_rlL
kb_rnL:
    s_mov_b32 s59, s58
    s_bitcmp0_b32 s56, 0
    s_cbranch_scc1 kb_rsL0
    s_add_u32 s57, s82, 67108864
    buffer_load_dwordx4 v[16:19], v128, s[16:19], s57 offen sc1
kb_rsL0:
    s_bitcmp0_b32 s56, 4
    s_cbranch_scc1 kb_rsL1
    s_add_u32 s57, s82, 67149824
    buffer_load_dwordx4 v[24:27], v128, s[16:19], s57 offen sc1
kb_rsL1:
    s_bitcmp0_b32 s56, 8
    s_cbranch_scc1 kb_rsL2
    s_add_u32 s57, s82, 67190784
    buffer_load_dwordx4 v[32:35], v128, s[16:19], s57 offen sc1
kb_rsL2:
    s_bitcmp0_b32 s56, 12
    s_cbranch_scc1 kb_rsL3
    s_add_u32 s57, s82, 67231744
    buffer_load_dwordx4 v[40:43], v128, s[16:19], s57 offen sc1
kb_rsL3:
    s_cmp_lg_u32 s59, 0x1111
    s_cbranch_scc1 kb_rlL
    s_waitcnt vmcnt(4)
    v_lshlrev_b32 v192, 16, v132
    v_and_b32 v193, 0xffff0000, v132
    v_lshlrev_b32 v194, 16, v133
    v_and_b32 v195, 0xffff0000, v133
    v_lshlrev_b32 v196, 16, v134
    v_and_b32 v197, 0xffff0000, v134
    v_lshlrev_b32 v198, 16, v135
    v_and_b32 v199, 0xffff0000, v135
    s_waitcnt vmcnt(0)
    v_lshlrev_b32 v48, 16, v16
    v_and_b32 v49, 0xffff0000, v16
    v_lshlrev_b32 v50, 16, v17
    v_and_b32 v51, 0xffff0000, v17
    v_lshlrev_b32 v52, 16, v18
    v_and_b32 v53, 0xffff0000, v18
    v_lshlrev_b32 v54, 16, v19
    v_and_b32 v55, 0xffff0000, v19
    v_lshlrev_b32 v64, 16, v24
    v_and_b32 v65, 0xffff0000, v24
    v_lshlrev_b32 v66, 16, v25
    v_and_b32 v67, 0xffff0000, v25
    v_lshlrev_b32 v68, 16, v26
    v_and_b32 v69, 0xffff0000, v26
    v_lshlrev_b32 v70, 16, v27
    v_and_b32 v71, 0xffff0000, v27
    v_add_f32 v48, v48, v64
    v_add_f32 v49, v49, v65
    v_add_f32 v50, v50, v66
    v_add_f32 v51, v51, v67
    v_add_f32 v52, v52, v68
    v_add_f32 v53, v53, v69
    v_add_f32 v54, v54, v70
    v_add_f32 v55, v55, v71
    v_lshlrev_b32 v64, 16, v32
    v_and_b32 v65, 0xffff0000, v32
    v_lshlrev_b32 v66, 16, v33
    v_and_b32 v67, 0xffff0000, v33
    v_lshlrev_b32 v68, 16, v34
    v_and_b32 v69, 0xffff0000, v34
    v_lshlrev_b32 v70, 16, v35
    v_and_b32 v71, 0xffff0000, v35
    v_add_f32 v48, v48, v64
    v_add_f32 v49, v49, v65
    v_add_f32 v50, v50, v66
    v_add_f32 v51, v51, v67
    v_add_f32 v52, v52, v68
    v_add_f32 v53, v53, v69
    v_add_f32 v54, v54, v70
    v_add_f32 v55, v55, v71
    v_lshlrev_b32 v64, 16, v40
    v_and_b32 v65, 0xffff0000, v40
    v_lshlrev_b32 v66, 16, v41
    v_and_b32 v67, 0xffff0000, v41
    v_lshlrev_b32 v68, 16, v42
    v_and_b32 v69, 0xffff0000, v42
    v_lshlrev_b32 v70, 16, v43
    v_and_b32 v71, 0xffff0000, v43
    v_add_f32 v48, v48, v64
    v_add_f32 v49, v49, v65
    v_add_f32 v50, v50, v66
    v_add_f32 v51, v51, v67
    v_add_f32 v52, v52, v68
    v_add_f32 v53, v53, v69
    v_add_f32 v54, v54, v70
    v_add_f32 v55, v55, v71
    v_fma_f32 v48, v48, v140, v192
    v_fma_f32 v49, v49, v141, v193
    v_fma_f32 v50, v50, v142, v194
    v_fma_f32 v51, v51, v143, v195
    v_fma_f32 v52, v52, v144, v196
    v_fma_f32 v53, v53, v145, v197
    v_fma_f32 v54, v54, v146, v198
    v_fma_f32 v55, v55, v147, v199
    v_cvt_pk_bf16_f32 v16, v48, v49
    v_cvt_pk_bf16_f32 v17, v50, v51
    v_cvt_pk_bf16_f32 v18, v52, v53
    v_cvt_pk_bf16_f32 v19, v54, v55
    s_add_u32 s57, s82, 83886080
    buffer_store_dwordx4 v[16:19], v128, s[16:19], s57 offen sc1
    v_lshlrev_b32 v48, 16, v16
    v_and_b32 v49, 0xffff0000, v16
    v_lshlrev_b32 v50, 16, v17
    v_and_b32 v51, 0xffff0000, v17
    v_lshlrev_b32 v52, 16, v18
    v_and_b32 v53, 0xffff0000, v18
    v_lshlrev_b32 v54, 16, v19
    v_and_b32 v55, 0xffff0000, v19
    v_add_f32 v80, v48, v49
    v_mul_f32 v81, v48, v48
    v_add_f32 v80, v80, v50
    v_add_f32 v80, v80, v51
    v_add_f32 v80, v80, v52
    v_add_f32 v80, v80, v53
    v_add_f32 v80, v80, v54
    v_add_f32 v80, v80, v55
    v_fmac_f32 v81, v49, v49
    v_fmac_f32 v81, v50, v50
    v_fmac_f32 v81, v51, v51
    v_fmac_f32 v81, v52, v52
    v_fmac_f32 v81, v53, v53
    v_fmac_f32 v81, v54, v54
    v_fmac_f32 v81, v55, v55
    s_nop 1
    v_add_f32_dpp v80, v80, v80 row_ror:8 row_mask:0xf bank_mask:0xf
    v_add_f32_dpp v81, v81, v81 row_ror:8 row_mask:0xf bank_mask:0xf
    v_mov_b32 v82, v80
    v_mov_b32 v83, v81
    s_nop 0
    v_permlane16_swap_b32 v80, v82
    v_permlane16_swap_b32 v81, v83
    v_add_f32 v80, v80, v82
    v_add_f32 v81, v81, v83
    v_mov_b32 v82, v80
    v_mov_b32 v83, v81
    s_nop 0
    v_permlane32_swap_b32 v80, v82
    v_permlane32_swap_b32 v81, v83
    v_add_f32 v80, v80, v82
    v_add_f32 v81, v81, v83
    ds_write_b64 v131, v[80:81] offset:0
    s_waitcnt lgkmcnt(0)
    s_barrier
    ds_read_b128 v[64:67], v130 offset:0
    ds_read_b128 v[68:71], v130 offset:16
    ds_read_b128 v[72:75], v130 offset:32
    s_waitcnt lgkmcnt(0)
    v_add_f32 v80, v64, v66
    v_add_f32 v81, v65, v67
    v_add_f32 v80, v80, v68
    v_add_f32 v81, v81, v69
    v_add_f32 v80, v80, v70
    v_add_f32 v81, v81, v71
    v_add_f32 v80, v80, v72
    v_add_f32 v81, v81, v73
    v_add_f32 v80, v80, v74
    v_add_f32 v81, v81, v75
    v_mul_f32 v80, 0x3acccccd, v80
    v_mov_b32 v82, 0x3727c5ac
    v_fmac_f32 v82, 0x3acccccd, v81
    v_fma_f32 v82, -v80, v80, v82
    v_max_f32 v82, 0x3727c5ac, v82
    v_rsq_f32 v81, v82
    s_nop 0
    v_mul_f32 v80, v80, v81
    v_fma_f32 v48, v48, v81, -v80
    v_fma_f32 v49, v49, v81, -v80
    v_fma_f32 v50, v50, v81, -v80
    v_fma_f32 v51, v51, v81, -v80
    v_fma_f32 v52, v52, v81, -v80
    v_fma_f32 v53, v53, v81, -v80
    v_fma_f32 v54, v54, v81, -v80
    v_fma_f32 v55, v55, v81, -v80
    v_fma_f32 v48, v48, v156, v172
    v_fma_f32 v49, v49, v157, v173
    v_fma_f32 v50, v50, v158, v174
    v_fma_f32 v51, v51, v159, v175
    v_fma_f32 v52, v52, v160, v176
    v_fma_f32 v53, v53, v161, v177
    v_fma_f32 v54, v54, v162, v178
    v_fma_f32 v55, v55, v163, v179
    v_cvt_pk_bf16_f32 v24, v48, v49
    v_cvt_pk_bf16_f32 v25, v50, v51
    v_cvt_pk_bf16_f32 v26, v52, v53
    v_cvt_pk_bf16_f32 v27, v54, v55
    s_add_u32 s57, s82, 83927040
    buffer_store_dwordx4 v[24:27], v128, s[16:19], s57 offen sc1
    v_lshlrev_b32 v48, 16, v24
    v_and_b32 v49, 0xffff0000, v24
    v_lshlrev_b32 v50, 16, v25
    v_and_b32 v51, 0xffff0000, v25
    v_lshlrev_b32 v52, 16, v26
    v_and_b32 v53, 0xffff0000, v26
    v_lshlrev_b32 v54, 16, v27
    v_and_b32 v55, 0xffff0000, v27
    v_add_f32 v80, v48, v49
    v_mul_f32 v81, v48, v48
    v_add_f32 v80, v80, v50
    v_add_f32 v80, v80, v51
    v_add_f32 v80, v80, v52
    v_add_f32 v80, v80, v53
    v_add_f32 v80, v80, v54
    v_add_f32 v80, v80, v55
    v_fmac_f32 v81, v49, v49
    v_fmac_f32 v81, v50, v50
    v_fmac_f32 v81, v51, v51
    v_fmac_f32 v81, v52, v52
    v_fmac_f32 v81, v53, v53
    v_fmac_f32 v81, v54, v54
    v_fmac_f32 v81, v55, v55
    s_nop 1
    v_add_f32_dpp v80, v80, v80 row_ror:8 row_mask:0xf bank_mask:0xf
    v_add_f32_dpp v81, v81, v81 row_ror:8 row_mask:0xf bank_mask:0xf
    v_mov_b32 v82, v80
    v_mov_b32 v83, v81
    s_nop 0
    v_permlane16_swap_b32 v80, v82
    v_permlane16_swap_b32 v81, v83
    v_add_f32 v80, v80, v82
    v_add_f32 v81, v81, v83
    v_mov_b32 v82, v80
    v_mov_b32 v83, v81
    s_nop 0
    v_permlane32_swap_b32 v80, v82
    v_permlane32_swap_b32 v81, v83
    v_add_f32 v80, v80, v82
    v_add_f32 v81, v81, v83
    ds_write_b64 v131, v[80:81] offset:512
    s_waitcnt lgkmcnt(0)
    s_barrier
    ds_read_b128 v[64:67], v130 offset:512
    ds_read_b128 v[68:71], v130 offset:528
    ds_read_b128 v[72:75], v130 offset:544
    s_waitcnt lgkmcnt(0)
    v_add_f32 v80, v64, v66
    v_add_f32 v81, v65, v67
    v_add_f32 v80, v80, v68
    v_add_f32 v81, v81, v69
    v_add_f32 v80, v80, v70
    v_add_f32 v81, v81, v71
    v_add_f32 v80, v80, v72
    v_add_f32 v81, v81, v73
    v_add_f32 v80, v80, v74
    v_add_f32 v81, v81, v75
    v_mul_f32 v80, 0x3acccccd, v80
    v_mov_b32 v82, 0x3727c5ac
    v_fmac_f32 v82, 0x3acccccd, v81
    v_fma_f32 v82, -v80, v80, v82
    v_max_f32 v82, 0x3727c5ac, v82
    v_rsq_f32 v81, v82
    s_nop 0
    v_mul_f32 v80, v80, v81
    v_fma_f32 v48, v48, v81, -v80
    v_fma_f32 v49, v49, v81, -v80
    v_fma_f32 v50, v50, v81, -v80
    v_fma_f32 v51, v51, v81, -v80
    v_fma_f32 v52, v52, v81, -v80
    v_fma_f32 v53, v53, v81, -v80
    v_fma_f32 v54, v54, v81, -v80
    v_fma_f32 v55, v55, v81, -v80
    v_cvt_pk_bf16_f32 v32, v48, v49
    v_cvt_pk_bf16_f32 v33, v50, v51
    v_cvt_pk_bf16_f32 v34, v52, v53
    v_cvt_pk_bf16_f32 v35, v54, v55
    s_add_u32 s57, s82, 83968000
    buffer_store_dwordx4 v[32:35], v128, s[16:19], s57 offen sc1
    s_lshl_b32 s56, s35, 7
    s_add_u32 s56, s56, 557056
    v_mov_b32 v2, 162820
    v_mov_b32 v3, 1
    s_waitcnt vmcnt(0)
    s_mov_b64 exec, 1
    ds_add_rtn_u32 v3, v2, v3
    v_mov_b32 v2, 0
    s_waitcnt lgkmcnt(0)
    v_cmp_eq_u32 vcc, 7, v3
    v_mov_b32 v3, s54
    s_cmp_lg_u32 vcc_lo, 0
    s_cselect_b32 s56, s56, 0x70000000
    buffer_store_dword v3, v2, s[16:19], s56 offen sc1
    s_mov_b64 exec, -1
    s_barrier
    s_barrier
    s_add_u32 m0, s78, 24576
    s_add_u32 s61, s32, 0
    buffer_load_dwordx4 v1, s[20:23], s61 offen offset:0 sc1 lds
    buffer_load_dwordx4 v1, s[20:23], s61 offen offset:1024 sc1 lds
    buffer_load_dwordx4 v1, s[20:23], s61 offen offset:2048 sc1 lds
    s_add_u32 m0, s78, 27648
    s_add_u32 s61, s32, 20480
    buffer_load_dwordx4 v1, s[20:23], s61 offen offset:0 sc1 lds
    buffer_load_dwordx4 v1, s[20:23], s61 offen offset:1024 sc1 lds
    buffer_load_dwordx4 v1, s[20:23], s61 offen offset:2048 sc1 lds
    s_add_u32 m0, s78, 49152
    s_add_u32 s61, s32, 81920
    buffer_load_dwordx4 v1, s[20:23], s61 offen offset:0 sc1 lds
    buffer_load_dwordx4 v1, s[20:23], s61 offen offset:1024 sc1 lds
    s_barrier
    buffer_load_dwordx4 v1, s[20:23], s61 offen offset:2048 sc1 lds
    s_add_u32 m0, s78, 52224
    s_add_u32 s61, s32, 102400
    buffer_load_dwordx4 v1, s[20:23], s61 offen offset:0 sc1 lds
    buffer_load_dwordx4 v1, s[20:23], s61 offen offset:1024 sc1 lds
    buffer_load_dwordx4 v1, s[20:23], s61 offen offset:2048 sc1 lds
    s_barrier
    s_add_u32 m0, s78, 73728
    s_add_u32 s61, s32, 163840
    buffer_load_dwordx4 v1, s[20:23], s61 offen offset:0 sc1 lds
    buffer_load_dwordx4 v1, s[20:23], s61 offen offset:1024 sc1 lds
    buffer_load_dwordx4 v1, s[20:23], s61 offen offset:2048 sc1 lds
    s_add_u32 m0, s78, 76800
    s_add_u32 s61, s32, 184320
    buffer_load_dwordx4 v1, s[20:23], s61 offen offset:0 sc1 lds
    buffer_load_dwordx4 v1, s[20:23], s61 offen offset:1024 sc1 lds
    buffer_load_dwordx4 v1, s[20:23], s61 offen offset:2048 sc1 lds
    s_add_u32 m0, s78, 98304
    s_add_u32 s61, s32, 245760
    buffer_load_dwordx4 v1, s[20:23], s61 offen offset:0 sc1 lds
    buffer_load_dwordx4 v1, s[20:23], s61 offen offset:1024 sc1 lds
    buffer_load_dwordx4 v1, s[20:23], s61 offen offset:2048 sc1 lds
    s_add_u32 m0, s78, 101376
    s_add_u32 s61, s32, 266240
    buffer_load_dwordx4 v1, s[20:23], s61 offen offset:0 sc1 lds
    buffer_load_dwordx4 v1, s[20:23], s61 offen offset:1024 sc1 lds
    buffer_load_dwordx4 v1, s[20:23], s61 offen offset:2048 sc1 lds
    s_add_u32 m0, s78, 122880
    s_add_u32 s61, s32, 327680
    buffer_load_dwordx4 v1, s[20:23], s61 offen offset:0 sc1 lds
    buffer_load_dwordx4 v1, s[20:23], s61 offen offset:1024 sc1 lds
    buffer_load_dwordx4 v1, s[20:23], s61 offen offset:2048 sc1 lds
    s_add_u32 m0, s78, 125952
    s_add_u32 s61, s32, 348160
    buffer_load_dwordx4 v1, s[20:23], s61 offen offset:0 sc1 lds
    buffer_load_dwordx4 v1, s[20:23], s61 offen offset:1024 sc1 lds
    buffer_load_dwordx4 v1, s[20:23], s61 offen offset:2048 sc1 lds
    s_waitcnt vmcnt(0)
    s_barrier
    s_barrier
    s_add_u32 m0, s79, 0
    s_add_u32 s61, s75, 0
    buffer_load_dwordx4 v1, s[20:23], s61 offen offset:0 sc1 lds
    buffer_load_dwordx4 v1, s[20:23], s61 offen offset:1024 sc1 lds
    s_add_u32 m0, s79, 2048
    s_add_u32 s61, s75, 55296
    buffer_load_dwordx4 v1, s[20:23], s61 offen offset:0 sc1 lds
    buffer_load_dwordx4 v1, s[20:23], s61 offen offset:1024 sc1 lds
    s_add_u32 m0, s79, 4096
    s_add_u32 s61, s75, 110592
    buffer_load_dwordx4 v1, s[20:23], s61 offen offset:0 sc1 lds
    buffer_load_dwordx4 v1, s[20:23], s61 offen offset:1024 sc1 lds
    s_add_u32 m0, s79, 6144
    s_add_u32 s61, s75, 165888
    buffer_load_dwordx4 v1, s[20:23], s61 offen offset:0 sc1 lds
    buffer_load_dwordx4 v1, s[20:23], s61 offen offset:1024 sc1 lds
    s_barrier
    s_add_u32 m0, s79, 8192
    s_add_u32 s61, s75, 221184
    buffer_load_dwordx4 v1, s[20:23], s61 offen offset:0 sc1 lds
    buffer_load_dwordx4 v1, s[20:23], s61 offen offset:1024 sc1 lds
    s_add_u32 m0, s79, 40960
    s_add_u32 s61, s75, 552960
    buffer_load_dwordx4 v1, s[20:23], s61 offen offset:0 sc1 lds
    buffer_load_dwordx4 v1, s[20:23], s61 offen offset:1024 sc1 lds
    s_barrier
    s_add_u32 m0, s79, 43008
    s_add_u32 s61, s75, 608256
    buffer_load_dwordx4 v1, s[20:23], s61 offen offset:0 sc1 lds
    buffer_load_dwordx4 v1, s[20:23], s61 offen offset:1024 sc1 lds
    s_add_u32 m0, s79, 45056
    s_add_u32 s61, s75, 663552
    buffer_load_dwordx4 v1, s[20:23], s61 offen offset:0 sc1 lds
    buffer_load_dwordx4 v1, s[20:23], s61 offen offset:1024 sc1 lds
    s_add_u32 m0, s79, 47104
    s_add_u32 s61, s75, 718848
    buffer_load_dwordx4 v1, s[20:23], s61 offen offset:0 sc1 lds
    buffer_load_dwordx4 v1, s[20:23], s61 offen offset:1024 sc1 lds
    s_add_u32 m0, s79, 49152
    s_add_u32 s61, s75, 774144
    buffer_load_dwordx4 v1, s[20:23], s61 offen offset:0 sc1 lds
    buffer_load_dwordx4 v1, s[20:23], s61 offen offset:1024 sc1 lds
    s_add_u32 m0, s79, 81920
    s_add_u32 s61, s75, 2048
    buffer_load_dwordx4 v1, s[20:23], s61 offen offset:0 sc1 lds
    buffer_load_dwordx4 v1, s[20:23], s61 offen offset:1024 sc1 lds
    s_add_u32 m0, s79, 83968
    s_add_u32 s61, s75, 57344
    buffer_load_dwordx4 v1, s[20:23], s61 offen offset:0 sc1 lds
    buffer_load_dwordx4 v1, s[20:23], s61 offen offset:1024 sc1 lds
    s_add_u32 m0, s79, 86016
    s_add_u32 s61, s75, 112640
    buffer_load_dwordx4 v1, s[20:23], s61 offen offset:0 sc1 lds
    buffer_load_dwordx4 v1, s[20:23], s61 offen offset:1024 sc1 lds
    s_add_u32 m0, s79, 88064
    s_add_u32 s61, s75, 167936
    buffer_load_dwordx4 v1, s[20:23], s61 offen offset:0 sc1 lds
    buffer_load_dwordx4 v1, s[20:23], s61 offen offset:1024 sc1 lds
    s_add_u32 m0, s79, 90112
    s_add_u32 s61, s75, 223232
    buffer_load_dwordx4 v1, s[20:23], s61 offen offset:0 sc1 lds
    buffer_load_dwordx4 v1, s[20:23], s61 offen offset:1024 sc1 lds
    s_mul_i32 s81, s72, 262144
    s_add_u32 s81, s81, 84070400
    v_bfe_u32 v6, v0, 5, 1
    v_lshlrev_b32 v6, 4, v6
    s_lshl_b32 s57, s85, 7
    s_add_u32 s57, s57, 20608
    buffer_load_dwordx4 v[208:211], v6, s[20:23], s57 offen offset:0 sc1
    buffer_load_dwordx4 v[212:215], v6, s[20:23], s57 offen offset:32 sc1
    buffer_load_dwordx4 v[216:219], v6, s[20:23], s57 offen offset:64 sc1
    buffer_load_dwordx4 v[220:223], v6, s[20:23], s57 offen offset:96 sc1
    buffer_load_dwordx4 v[224:227], v6, s[20:23], s57 offen offset:256 sc1
    buffer_load_dwordx4 v[228:231], v6, s[20:23], s57 offen offset:288 sc1
    buffer_load_dwordx4 v[232:235], v6, s[20:23], s57 offen offset:320 sc1
    buffer_load_dwordx4 v[236:239], v6, s[20:23], s57 offen offset:352 sc1
    s_lshl_b32 s56, s91, 1
    s_add_u32 s56, s56, 1
    s_mul_i32 s58, s72, 262144
    s_add_u32 s58, s58, 100663296
    s_cmp_ge_u32 s56, 14
    s_cselect_b32 s57, 26624, 0
    s_lshl_b32 s93, s56, 11
    s_add_u32 s93, s93, s57
    s_add_u32 s93, s93, s58
    s_min_u32 s56, s56, 25
    s_cmp_ge_u32 s56, 13
    s_cselect_b32 s57, 28672, 0
    s_lshl_b32 s94, s56, 11
    s_add_u32 s94, s94, s57
    s_add_u32 s94, s94, s58
    s_add_u32 s94, s94, 28672
    s_cmp_eq_u32 s91, 12
    s_cselect_b32 s94, 0x70000000, s94
    v_add_u32 v6, 20480, v1
    v_add_u32 v5, 0, v6
    s_lshl_b32 s56, s55, 12
    v_add_u32 v9, s56, v1
    v_add_u32 v10, 122880, v9
    v_add_u32 v9, 139264, v9
    v_mov_b32 v4, 0xc0135761
    s_waitcnt vmcnt(18)
    s_barrier
    s_add_u32 s60, s81, 0
    buffer_load_dwordx4 v[128:131], v1, s[20:23], s60 offen offset:0 sc1
    buffer_load_dwordx4 v[132:135], v1, s[20:23], s60 offen offset:1024 sc1
    buffer_load_dwordx4 v[136:139], v1, s[20:23], s60 offen offset:2048 sc1
    buffer_load_dwordx4 v[140:143], v1, s[20:23], s60 offen offset:3072 sc1
    s_add_u32 s60, s81, 4096
    buffer_load_dwordx4 v[144:147], v1, s[20:23], s60 offen offset:0 sc1
    buffer_load_dwordx4 v[148:151], v1, s[20:23], s60 offen offset:1024 sc1
    buffer_load_dwordx4 v[152:155], v1, s[20:23], s60 offen offset:2048 sc1
    buffer_load_dwordx4 v[156:159], v1, s[20:23], s60 offen offset:3072 sc1
    ds_read_b128 v[96:99], v5 offset:0
    ds_read_b128 v[100:103], v5 offset:1024
    ds_read_b128 v[104:107], v5 offset:2048
    ds_read_b128 v[108:111], v5 offset:3072
    ds_read_b128 v[112:115], v5 offset:4096
    ds_read_b128 v[116:119], v5 offset:5120
    ds_read_b128 v[120:123], v5 offset:6144
    s_waitcnt vmcnt(7)
    s_waitcnt lgkmcnt(5)
    v_mfma_f32_32x32x16_bf16 v[16:31], v[96:99], v[128:131], 0
    ds_read_b128 v[124:127], v5 offset:7168
    s_add_u32 s60, s81, 8192
    buffer_load_dwordx4 v[160:163], v1, s[20:23], s60 offen offset:0 sc1
    v_mfma_f32_32x32x16_bf16 v[32:47], v[100:103], v[128:131], 0
    ds_read_b128 v[96:99], v5 offset:8192
    buffer_load_dwordx4 v[164:167], v1, s[20:23], s60 offen offset:1024 sc1
    s_waitcnt vmcnt(8)
    s_waitcnt lgkmcnt(5)
    v_mfma_f32_32x32x16_bf16 v[16:31], v[104:107], v[132:135], v[16:31]
    ds_read_b128 v[100:103], v5 offset:9216
    buffer_load_dwordx4 v[168:171], v1, s[20:23], s60 offen offset:2048 sc1
    v_mfma_f32_32x32x16_bf16 v[32:47], v[108:111], v[132:135], v[32:47]
    ds_read_b128 v[104:107], v5 offset:10240
    buffer_load_dwordx4 v[172:175], v1, s[20:23], s60 offen offset:3072 sc1
    s_waitcnt vmcnt(9)
    s_waitcnt lgkmcnt(5)
    v_mfma_f32_32x32x16_bf16 v[16:31], v[112:115], v[136:139], v[16:31]
    ds_read_b128 v[108:111], v5 offset:11264
    s_add_u32 s60, s81, 12288
    buffer_load_dwordx4 v[176:179], v1, s[20:23], s60 offen offset:0 sc1
    v_mfma_f32_32x32x16_bf16 v[32:47], v[116:119], v[136:139], v[32:47]
    ds_read_b128 v[112:115], v5 offset:12288
    buffer_load_dwordx4 v[180:183], v1, s[20:23], s60 offen offset:1024 sc1
    s_waitcnt vmcnt(10)
    s_waitcnt lgkmcnt(5)
    v_mfma_f32_32x32x16_bf16 v[16:31], v[120:123], v[140:143], v[16:31]
    ds_read_b128 v[116:119], v5 offset:13312
    buffer_load_dwordx4 v[184:187], v1, s[20:23], s60 offen offset:2048 sc1
    v_mfma_f32_32x32x16_bf16 v[32:47], v[124:127], v[140:143], v[32:47]
    ds_read_b128 v[120:123], v5 offset:14336
    buffer_load_dwordx4 v[188:191], v1, s[20:23], s60 offen offset:3072 sc1
    s_waitcnt vmcnt(11)
    s_waitcnt lgkmcnt(5)
    v_mfma_f32_32x32x16_bf16 v[16:31], v[96:99], v[144:147], v[16:31]
    ds_read_b128 v[124:127], v5 offset:15360
    s_add_u32 s60, s81, 16384
    buffer_load_dwordx4 v[192:195], v1, s[20:23], s60 offen offset:0 sc1
    v_mfma_f32_32x32x16_bf16 v[32:47], v[100:103], v[144:147], v[32:47]
    ds_read_b128 v[96:99], v5 offset:16384
    buffer_load_dwordx4 v[196:199], v1, s[20:23], s60 offen offset:1024 sc1
    s_waitcnt vmcnt(12)
    s_waitcnt lgkmcnt(5)
    v_mfma_f32_32x32x16_bf16 v[16:31], v[104:107], v[148:151], v[16:31]
    ds_read_b128 v[100:103], v5 offset:17408
    buffer_load_dwordx4 v[200:203], v1, s[20:23], s60 offen offset:2048 sc1
    v_mfma_f32_32x32x16_bf16 v[32:47], v[108:111], v[148:151], v[32:47]
    ds_read_b128 v[104:107], v5 offset:18432
    buffer_load_dwordx4 v[204:207], v1, s[20:23], s60 offen offset:3072 sc1
    s_waitcnt vmcnt(13)
    s_waitcnt lgkmcnt(5)
    v_mfma_f32_32x32x16_bf16 v[16:31], v[112:115], v[152:155], v[16:31]
    ds_read_b128 v[108:111], v5 offset:19456
    v_add_u32 v5, 40960, v6
    v_and_b32 v2, 31, v0
    v_lshlrev_b32 v2, 3, v2
    v_bfe_u32 v3, v0, 5, 1
    v_lshl_add_u32 v2, v3, 14, v2
    s_lshl_b32 s56, s72, 8
    s_add_u32 s56, s56, 65536
    v_mfma_f32_32x32x16_bf16 v[32:47], v[116:119], v[152:155], v[32:47]
    ds_read_b128 v[112:115], v5 offset:0
    buffer_load_dwordx2 v[80:81], v2, s[20:23], s56 offen sc1
    s_add_u32 s56, s56, 32768
    s_waitcnt vmcnt(13)
    s_waitcnt lgkmcnt(5)
    v_mfma_f32_32x32x16_bf16 v[16:31], v[120:123], v[156:159], v[16:31]
    ds_read_b128 v[116:119], v5 offset:1024
    buffer_load_dwordx2 v[82:83], v2, s[20:23], s56 offen sc1
    s_add_u32 s56, s56, 32768
    v_mfma_f32_32x32x16_bf16 v[32:47], v[124:127], v[156:159], v[32:47]
    ds_read_b128 v[120:123], v5 offset:2048
    buffer_load_dwordx2 v[84:85], v2, s[20:23], s56 offen sc1
    s_add_u32 s56, s56, 32768
    s_waitcnt vmcnt(14)
    s_waitcnt lgkmcnt(5)
    v_mfma_f32_32x32x16_bf16 v[16:31], v[96:99], v[160:163], v[16:31]
    ds_read_b128 v[124:127], v5 offset:3072
    buffer_load_dwordx2 v[86:87], v2, s[20:23], s56 offen sc1
    s_add_u32 s56, s56, 32768
    v_mfma_f32_32x32x16_bf16 v[32:47], v[100:103], v[160:163], v[32:47]
    ds_read_b128 v[96:99], v5 offset:4096
    buffer_load_dwordx2 v[88:89], v2, s[20:23], s56 offen sc1
    s_add_u32 s56, s56, 32768
    s_waitcnt vmcnt(15)
    s_waitcnt lgkmcnt(5)
    v_mfma_f32_32x32x16_bf16 v[16:31], v[104:107], v[164:167], v[16:31]
    ds_read_b128 v[100:103], v5 offset:5120
    buffer_load_dwordx2 v[90:91], v2, s[20:23], s56 offen sc1
    s_add_u32 s56, s56, 32768
    v_mfma_f32_32x32x16_bf16 v[32:47], v[108:111], v[164:167], v[32:47]
    ds_read_b128 v[104:107], v5 offset:6144
    buffer_load_dwordx2 v[92:93], v2, s[20:23], s56 offen sc1
    s_add_u32 s56, s56, 32768
    s_barrier
    s_waitcnt vmcnt(16)
    s_waitcnt lgkmcnt(5)
    v_mfma_f32_32x32x16_bf16 v[16:31], v[112:115], v[168:171], v[16:31]
    ds_read_b128 v[108:111], v5 offset:7168
    s_add_u32 m0, s79, 0
    s_add_u32 s61, s75, 555008
    buffer_load_dwordx4 v1, s[20:23], s61 offen offset:0 sc1 lds
    v_mfma_f32_32x32x16_bf16 v[32:47], v[116:119], v[168:171], v[32:47]
    ds_read_b128 v[112:115], v5 offset:8192
    buffer_load_dwordx4 v1, s[20:23], s61 offen offset:1024 sc1 lds
    s_waitcnt vmcnt(17)
    s_waitcnt lgkmcnt(5)
    v_mfma_f32_32x32x16_bf16 v[16:31], v[120:123], v[172:175], v[16:31]
    ds_read_b128 v[116:119], v5 offset:9216
    s_add_u32 m0, s79, 2048
    s_add_u32 s61, s75, 610304
    buffer_load_dwordx4 v1, s[20:23], s61 offen offset:0 sc1 lds
    v_mfma_f32_32x32x16_bf16 v[32:47], v[124:127], v[172:175], v[32:47]
    ds_read_b128 v[120:123], v5 offset:10240
    buffer_load_dwordx4 v1, s[20:23], s61 offen offset:1024 sc1 lds
    s_waitcnt vmcnt(18)
    s_waitcnt lgkmcnt(5)
    v_mfma_f32_32x32x16_bf16 v[16:31], v[96:99], v[176:179], v[16:31]
    ds_read_b128 v[124:127], v5 offset:11264
    v_mfma_f32_32x32x16_bf16 v[32:47], v[100:103], v[176:179], v[32:47]
    ds_read_b128 v[96:99], v5 offset:12288
    s_add_u32 m0, s79, 4096
    s_add_u32 s61, s75, 665600
    buffer_load_dwordx4 v1, s[20:23], s61 offen offset:0 sc1 lds
    s_waitcnt vmcnt(18)
    s_waitcnt lgkmcnt(5)
    v_mfma_f32_32x32x16_bf16 v[16:31], v[104:107], v[180:183], v[16:31]
    ds_read_b128 v[100:103], v5 offset:13312
    buffer_load_dwordx4 v1, s[20:23], s61 offen offset:1024 sc1 lds
    v_mfma_f32_32x32x16_bf16 v[32:47], v[108:111], v[180:183], v[32:47]
    ds_read_b128 v[104:107], v5 offset:14336
    s_add_u32 m0, s79, 6144
    s_add_u32 s61, s75, 720896
    buffer_load_dwordx4 v1, s[20:23], s61 offen offset:0 sc1 lds
    s_waitcnt vmcnt(19)
    s_waitcnt lgkmcnt(5)
    v_mfma_f32_32x32x16_bf16 v[16:31], v[112:115], v[184:187], v[16:31]
    ds_read_b128 v[108:111], v5 offset:15360
    v_mfma_f32_32x32x16_bf16 v[32:47], v[116:119], v[184:187], v[32:47]
    ds_read_b128 v[112:115], v5 offset:16384
    buffer_load_dwordx4 v1, s[20:23], s61 offen offset:1024 sc1 lds
    s_waitcnt vmcnt(19)
    s_waitcnt lgkmcnt(5)
    v_mfma_f32_32x32x16_bf16 v[16:31], v[120:123], v[188:191], v[16:31]
    ds_read_b128 v[116:119], v5 offset:17408
    s_add_u32 m0, s79, 8192
    s_add_u32 s61, s75, 776192
    buffer_load_dwordx4 v1, s[20:23], s61 offen offset:0 sc1 lds
    v_mfma_f32_32x32x16_bf16 v[32:47], v[124:127], v[188:191], v[32:47]
    ds_read_b128 v[120:123], v5 offset:18432
    buffer_load_dwordx4 v1, s[20:23], s61 offen offset:1024 sc1 lds
    s_waitcnt vmcnt(20)
    s_waitcnt lgkmcnt(5)
    v_mfma_f32_32x32x16_bf16 v[16:31], v[96:99], v[192:195], v[16:31]
    ds_read_b128 v[124:127], v5 offset:19456
    v_add_u32 v5, 81920, v6
    s_waitcnt vmcnt(10)
    v_add_f32 v80, v80, v82
    v_add_f32 v81, v81, v83
    v_add_f32 v80, v80, v84
    v_mfma_f32_32x32x16_bf16 v[32:47], v[100:103], v[192:195], v[32:47]
    ds_read_b128 v[96:99], v5 offset:0
    v_add_f32 v81, v81, v85
    v_add_f32 v80, v80, v86
    v_add_f32 v81, v81, v87
    s_waitcnt lgkmcnt(5)
    v_mfma_f32_32x32x16_bf16 v[16:31], v[104:107], v[196:199], v[16:31]
    ds_read_b128 v[100:103], v5 offset:1024
    v_add_f32 v80, v80, v88
    v_add_f32 v81, v81, v89
    v_add_f32 v80, v80, v90
    v_add_f32 v81, v81, v91
    v_mfma_f32_32x32x16_bf16 v[32:47], v[108:111], v[196:199], v[32:47]
    ds_read_b128 v[104:107], v5 offset:2048
    v_add_f32 v80, v80, v92
    v_add_f32 v81, v81, v93
    v_mov_b32 v2, v80
    s_waitcnt lgkmcnt(5)
    v_mfma_f32_32x32x16_bf16 v[16:31], v[112:115], v[200:203], v[16:31]
    ds_read_b128 v[108:111], v5 offset:3072
    s_nop 1
    v_permlane32_swap_b32 v80, v2
    v_add_f32 v80, v80, v2
    v_mov_b32 v2, v81
    v_mfma_f32_32x32x16_bf16 v[32:47], v[116:119], v[200:203], v[32:47]
    ds_read_b128 v[112:115], v5 offset:4096
    s_nop 1
    v_permlane32_swap_b32 v81, v2
    v_add_f32 v81, v81, v2
    s_waitcnt lgkmcnt(5)
    v_mfma_f32_32x32x16_bf16 v[16:31], v[120:123], v[204:207], v[16:31]
    ds_read_b128 v[116:119], v5 offset:5120
    v_mul_f32 v80, 0x3acccccd, v80
    v_mov_b32 v2, 0x3727c5ac
    v_fmac_f32 v2, 0x3acccccd, v81
    v_fma_f32 v2, -v80, v80, v2
    v_mfma_f32_32x32x16_bf16 v[32:47], v[124:127], v[204:207], v[32:47]
    ds_read_b128 v[120:123], v5 offset:6144
    v_max_f32 v2, 0x3727c5ac, v2
    v_rsq_f32 v81, v2
    s_nop 0
    s_waitcnt lgkmcnt(5)
    v_mfma_f32_32x32x16_bf16 v[48:63], v[96:99], v[128:131], 0
    ds_read_b128 v[124:127], v5 offset:7168
    v_mfma_f32_32x32x16_bf16 v[64:79], v[100:103], v[128:131], 0
    ds_read_b128 v[96:99], v5 offset:8192
    s_waitcnt lgkmcnt(5)
    v_mfma_f32_32x32x16_bf16 v[48:63], v[104:107], v[132:135], v[48:63]
    ds_read_b128 v[100:103], v5 offset:9216
    v_mfma_f32_32x32x16_bf16 v[64:79], v[108:111], v[132:135], v[64:79]
    ds_read_b128 v[104:107], v5 offset:10240
    s_waitcnt lgkmcnt(5)
    v_mfma_f32_32x32x16_bf16 v[48:63], v[112:115], v[136:139], v[48:63]
    ds_read_b128 v[108:111], v5 offset:11264
    ds_write_b128 v9, v[16:19] offset:0
    v_fma_f32 v32, -v80, v208, v32
    v_fma_f32 v33, -v80, v209, v33
    v_fma_f32 v34, -v80, v210, v34
    v_mfma_f32_32x32x16_bf16 v[64:79], v[116:119], v[136:139], v[64:79]
    ds_read_b128 v[112:115], v5 offset:12288
    ds_write_b128 v9, v[20:23] offset:1024
    v_fma_f32 v35, -v80, v211, v35
    v_fma_f32 v36, -v80, v212, v36
    s_waitcnt lgkmcnt(5)
    v_mfma_f32_32x32x16_bf16 v[48:63], v[120:123], v[140:143], v[48:63]
    ds_read_b128 v[116:119], v5 offset:13312
    ds_write_b128 v9, v[24:27] offset:2048
    v_fma_f32 v37, -v80, v213, v37
    v_fma_f32 v38, -v80, v214, v38
    v_mfma_f32_32x32x16_bf16 v[64:79], v[124:127], v[140:143], v[64:79]
    ds_read_b128 v[120:123], v5 offset:14336
    ds_write_b128 v9, v[28:31] offset:3072
    v_fma_f32 v39, -v80, v215, v39
    v_fma_f32 v40, -v80, v216, v40
    v_fma_f32 v41, -v80, v217, v41
    s_waitcnt lgkmcnt(5)
    v_mfma_f32_32x32x16_bf16 v[48:63], v[96:99], v[144:147], v[48:63]
    ds_read_b128 v[124:127], v5 offset:15360
    v_fma_f32 v42, -v80, v218, v42
    v_fma_f32 v43, -v80, v219, v43
    v_mfma_f32_32x32x16_bf16 v[64:79], v[100:103], v[144:147], v[64:79]
    ds_read_b128 v[96:99], v5 offset:16384
    v_fma_f32 v44, -v80, v220, v44
    v_fma_f32 v45, -v80, v221, v45
    s_waitcnt lgkmcnt(5)
    v_mfma_f32_32x32x16_bf16 v[48:63], v[104:107], v[148:151], v[48:63]
    ds_read_b128 v[100:103], v5 offset:17408
    v_fma_f32 v46, -v80, v222, v46
    v_fma_f32 v47, -v80, v223, v47
    v_mfma_f32_32x32x16_bf16 v[64:79], v[108:111], v[148:151], v[64:79]
    ds_read_b128 v[104:107], v5 offset:18432
    s_waitcnt lgkmcnt(0)
    s_waitcnt vmcnt(0)
    s_barrier
    ds_read_b128 v[240:243], v10 offset:0
    ds_read_b128 v[244:247], v10 offset:1024
    ds_read_b128 v[248:251], v10 offset:2048
    ds_read_b128 v[252:255], v10 offset:3072
    s_waitcnt lgkmcnt(5)
    v_mfma_f32_32x32x16_bf16 v[48:63], v[112:115], v[152:155], v[48:63]
    ds_read_b128 v[108:111], v5 offset:19456
    v_add_u32 v5, 0, v6
    s_add_u32 m0, s80, 40960
    s_add_u32 s61, s76, 0
    buffer_load_dwordx4 v1, s[20:23], s61 offen offset:0 sc1 lds
    buffer_load_dwordx4 v1, s[20:23], s61 offen offset:1024 sc1 lds
    v_mfma_f32_32x32x16_bf16 v[64:79], v[116:119], v[152:155], v[64:79]
    ds_read_b128 v[112:115], v5 offset:0
    buffer_load_dwordx4 v1, s[20:23], s61 offen offset:2048 sc1 lds
    s_waitcnt lgkmcnt(5)
    v_mfma_f32_32x32x16_bf16 v[48:63], v[120:123], v[156:159], v[48:63]
    ds_read_b128 v[116:119], v5 offset:1024
    s_add_u32 m0, s80, 44032
    s_add_u32 s61, s76, 20480
    buffer_load_dwordx4 v1, s[20:23], s61 offen offset:0 sc1 lds
    s_waitcnt lgkmcnt(3)
    v_mfma_f32_32x32x16_bf16 v[64:79], v[124:127], v[156:159], v[64:79]
    ds_read_b128 v[120:123], v5 offset:2048
    buffer_load_dwordx4 v1, s[20:23], s61 offen offset:1024 sc1 lds
    v_add_f32 v32, v32, v240
    v_add_f32 v33, v33, v241
    v_add_f32 v34, v34, v242
    v_add_f32 v35, v35, v243
    v_add_f32 v36, v36, v244
    v_add_f32 v37, v37, v245
    v_add_f32 v38, v38, v246
    v_add_f32 v39, v39, v247
    s_waitcnt lgkmcnt(5)
    v_mfma_f32_32x32x16_bf16 v[48:63], v[96:99], v[160:163], v[48:63]
    ds_read_b128 v[124:127], v5 offset:3072
    buffer_load_dwordx4 v1, s[20:23], s61 offen offset:2048 sc1 lds
    v_mul_f32 v32, v32, v81
    v_mul_f32 v33, v33, v81
    v_mul_f32 v34, v34, v81
    v_mul_f32 v35, v35, v81
    v_mul_f32 v36, v36, v81
    v_mul_f32 v37, v37, v81
    v_mul_f32 v38, v38, v81
    v_mul_f32 v39, v39, v81
    v_mfma_f32_32x32x16_bf16 v[64:79], v[100:103], v[160:163], v[64:79]
    ds_read_b128 v[96:99], v5 offset:4096
    s_add_u32 m0, s80, 47104
    s_add_u32 s61, s76, 40960
    buffer_load_dwordx4 v1, s[20:23], s61 offen offset:0 sc1 lds
    v_mul_f32 v84, v32, v32
    v_mul_f32 v85, v33, v33
    v_mul_f32 v86, v34, v34
    v_mul_f32 v87, v35, v35
    v_mul_f32 v88, v36, v36
    v_mul_f32 v89, v37, v37
    v_mul_f32 v90, v38, v38
    v_mul_f32 v91, v39, v39
    s_waitcnt lgkmcnt(5)
    v_mfma_f32_32x32x16_bf16 v[48:63], v[104:107], v[164:167], v[48:63]
    ds_read_b128 v[100:103], v5 offset:5120
    buffer_load_dwordx4 v1, s[20:23], s61 offen offset:1024 sc1 lds
    v_fma_f32 v84, v84, s84, v4
    v_fma_f32 v85, v85, s84, v4
    v_fma_f32 v86, v86, s84, v4
    v_fma_f32 v87, v87, s84, v4
    v_fma_f32 v88, v88, s84, v4
    v_fma_f32 v89, v89, s84, v4
    v_fma_f32 v90, v90, s84, v4
    v_fma_f32 v91, v91, s84, v4
    v_mfma_f32_32x32x16_bf16 v[64:79], v[108:111], v[164:167], v[64:79]
    ds_read_b128 v[104:107], v5 offset:6144
    buffer_load_dwordx4 v1, s[20:23], s61 offen offset:2048 sc1 lds
    v_mul_f32 v84, v32, v84
    v_mul_f32 v85, v33, v85
    v_mul_f32 v86, v34, v86
    v_mul_f32 v87, v35, v87
    v_mul_f32 v88, v36, v88
    v_mul_f32 v89, v37, v89
    v_mul_f32 v90, v38, v90
    v_mul_f32 v91, v39, v91
    s_barrier
    s_waitcnt lgkmcnt(5)
    v_mfma_f32_32x32x16_bf16 v[48:63], v[112:115], v[168:171], v[48:63]
    ds_read_b128 v[108:111], v5 offset:7168
    v_exp_f32 v84, v84
    v_exp_f32 v85, v85
    v_exp_f32 v86, v86
    v_exp_f32 v87, v87
    v_exp_f32 v88, v88
    v_exp_f32 v89, v89
    v_exp_f32 v90, v90
    v_exp_f32 v91, v91
    v_add_f32 v84, 1.0, v84
    v_mfma_f32_32x32x16_bf16 v[64:79], v[116:119], v[168:171], v[64:79]
    ds_read_b128 v[112:115], v5 offset:8192
    v_add_f32 v85, 1.0, v85
    v_add_f32 v86, 1.0, v86
    v_add_f32 v87, 1.0, v87
    v_add_f32 v88, 1.0, v88
    v_add_f32 v89, 1.0, v89
    v_add_f32 v90, 1.0, v90
    v_add_f32 v91, 1.0, v91
    v_rcp_f32 v84, v84
    s_waitcnt lgkmcnt(5)
    v_mfma_f32_32x32x16_bf16 v[48:63], v[120:123], v[172:175], v[48:63]
    ds_read_b128 v[116:119], v5 offset:9216
    v_rcp_f32 v85, v85
    v_rcp_f32 v86, v86
    v_rcp_f32 v87, v87
    v_rcp_f32 v88, v88
    v_rcp_f32 v89, v89
    v_rcp_f32 v90, v90
    v_rcp_f32 v91, v91
    v_mul_f32 v32, v32, v84
    v_mfma_f32_32x32x16_bf16 v[64:79], v[124:127], v[172:175], v[64:79]
    ds_read_b128 v[120:123], v5 offset:10240
    v_mul_f32 v33, v33, v85
    v_mul_f32 v34, v34, v86
    v_mul_f32 v35, v35, v87
    v_mul_f32 v36, v36, v88
    v_mul_f32 v37, v37, v89
    v_mul_f32 v38, v38, v90
    v_mul_f32 v39, v39, v91
    v_cvt_pk_bf16_f32 v32, v32, v33
    s_waitcnt lgkmcnt(5)
    v_mfma_f32_32x32x16_bf16 v[48:63], v[96:99], v[176:179], v[48:63]
    ds_read_b128 v[124:127], v5 offset:11264
    v_cvt_pk_bf16_f32 v33, v34, v35
    v_cvt_pk_bf16_f32 v34, v36, v37
    v_cvt_pk_bf16_f32 v35, v38, v39
    buffer_store_dwordx4 v[32:35], v1, s[20:23], s93 offen offset:0 sc1
    v_add_f32 v40, v40, v248
    v_add_f32 v41, v41, v249
    v_add_f32 v42, v42, v250
    v_add_f32 v43, v43, v251
    v_mfma_f32_32x32x16_bf16 v[64:79], v[100:103], v[176:179], v[64:79]
    ds_read_b128 v[96:99], v5 offset:12288
    v_add_f32 v44, v44, v252
    v_add_f32 v45, v45, v253
    v_add_f32 v46, v46, v254
    v_add_f32 v47, v47, v255
    v_mul_f32 v40, v40, v81
    v_mul_f32 v41, v41, v81
    v_mul_f32 v42, v42, v81
    v_mul_f32 v43, v43, v81
    s_waitcnt lgkmcnt(5)
    v_mfma_f32_32x32x16_bf16 v[48:63], v[104:107], v[180:183], v[48:63]
    ds_read_b128 v[100:103], v5 offset:13312
    v_mul_f32 v44, v44, v81
    v_mul_f32 v45, v45, v81
    v_mul_f32 v46, v46, v81
    v_mul_f32 v47, v47, v81
    v_mul_f32 v84, v40, v40
    v_mul_f32 v85, v41, v41
    v_mul_f32 v86, v42, v42
    v_mul_f32 v87, v43, v43
    v_mfma_f32_32x32x16_bf16 v[64:79], v[108:111], v[180:183], v[64:79]
    ds_read_b128 v[104:107], v5 offset:14336
    v_mul_f32 v88, v44, v44
    v_mul_f32 v89, v45, v45
    v_mul_f32 v90, v46, v46
    v_mul_f32 v91, v47, v47
    v_fma_f32 v84, v84, s84, v4
    v_fma_f32 v85, v85, s84, v4
    v_fma_f32 v86, v86, s84, v4
    v_fma_f32 v87, v87, s84, v4
    v_fma_f32 v88, v88, s84, v4
    s_waitcnt lgkmcnt(5)
    v_mfma_f32_32x32x16_bf16 v[48:63], v[112:115], v[184:187], v[48:63]
    ds_read_b128 v[108:111], v5 offset:15360
    v_fma_f32 v89, v89, s84, v4
    v_fma_f32 v90, v90, s84, v4
    v_fma_f32 v91, v91, s84, v4
    v_mul_f32 v84, v40, v84
    v_mul_f32 v85, v41, v85
    v_mul_f32 v86, v42, v86
    v_mul_f32 v87, v43, v87
    v_mul_f32 v88, v44, v88
    v_mfma_f32_32x32x16_bf16 v[64:79], v[116:119], v[184:187], v[64:79]
    ds_read_b128 v[112:115], v5 offset:16384
    v_mul_f32 v89, v45, v89
    v_mul_f32 v90, v46, v90
    v_mul_f32 v91, v47, v91
    v_exp_f32 v84, v84
    v_exp_f32 v85, v85
    v_exp_f32 v86, v86
    v_exp_f32 v87, v87
    v_exp_f32 v88, v88
    s_waitcnt lgkmcnt(5)
    v_mfma_f32_32x32x16_bf16 v[48:63], v[120:123], v[188:191], v[48:63]
    ds_read_b128 v[116:119], v5 offset:17408
    v_exp_f32 v89, v89
    v_exp_f32 v90, v90
    v_exp_f32 v91, v91
    v_add_f32 v84, 1.0, v84
    v_add_f32 v85, 1.0, v85
    v_add_f32 v86, 1.0, v86
    v_add_f32 v87, 1.0, v87
    v_add_f32 v88, 1.0, v88
    v_mfma_f32_32x32x16_bf16 v[64:79], v[124:127], v[188:191], v[64:79]
    ds_read_b128 v[120:123], v5 offset:18432
    v_add_f32 v89, 1.0, v89
    v_add_f32 v90, 1.0, v90
    v_add_f32 v91, 1.0, v91
    v_rcp_f32 v84, v84
    v_rcp_f32 v85, v85
    v_rcp_f32 v86, v86
    v_rcp_f32 v87, v87
    v_rcp_f32 v88, v88
    s_waitcnt lgkmcnt(5)
    v_mfma_f32_32x32x16_bf16 v[48:63], v[96:99], v[192:195], v[48:63]
    ds_read_b128 v[124:127], v5 offset:19456
    v_rcp_f32 v89, v89
    v_rcp_f32 v90, v90
    v_rcp_f32 v91, v91
    v_mul_f32 v40, v40, v84
    v_mul_f32 v41, v41, v85
    v_mul_f32 v42, v42, v86
    v_mul_f32 v43, v43, v87
    v_mul_f32 v44, v44, v88
    v_mfma_f32_32x32x16_bf16 v[64:79], v[100:103], v[192:195], v[64:79]
    v_mul_f32 v45, v45, v89
    v_mul_f32 v46, v46, v90
    v_mul_f32 v47, v47, v91
    v_cvt_pk_bf16_f32 v40, v40, v41
    v_cvt_pk_bf16_f32 v41, v42, v43
    v_cvt_pk_bf16_f32 v42, v44, v45
    v_cvt_pk_bf16_f32 v43, v46, v47
    buffer_store_dwordx4 v[40:43], v1, s[20:23], s93 offen offset:1024 sc1
    s_waitcnt lgkmcnt(4)
    v_mfma_f32_32x32x16_bf16 v[48:63], v[104:107], v[196:199], v[48:63]
    s_add_u32 m0, s80, 81920
    s_add_u32 s61, s76, 122880
    buffer_load_dwordx4 v1, s[20:23], s61 offen offset:0 sc1 lds
    buffer_load_dwordx4 v1, s[20:23], s61 offen offset:1024 sc1 lds
    v_mfma_f32_32x32x16_bf16 v[64:79], v[108:111], v[196:199], v[64:79]
    buffer_load_dwordx4 v1, s[20:23], s61 offen offset:2048 sc1 lds
    s_waitcnt lgkmcnt(2)
    v_mfma_f32_32x32x16_bf16 v[48:63], v[112:115], v[200:203], v[48:63]
    s_add_u32 m0, s80, 84992
    s_add_u32 s61, s76, 143360
    buffer_load_dwordx4 v1, s[20:23], s61 offen offset:0 sc1 lds
    buffer_load_dwordx4 v1, s[20:23], s61 offen offset:1024 sc1 lds
    v_mfma_f32_32x32x16_bf16 v[64:79], v[116:119], v[200:203], v[64:79]
    buffer_load_dwordx4 v1, s[20:23], s61 offen offset:2048 sc1 lds
    s_waitcnt lgkmcnt(0)
    v_mfma_f32_32x32x16_bf16 v[48:63], v[120:123], v[204:207], v[48:63]
    s_add_u32 m0, s80, 88064
    s_add_u32 s61, s76, 163840
    buffer_load_dwordx4 v1, s[20:23], s61 offen offset:0 sc1 lds
    buffer_load_dwordx4 v1, s[20:23], s61 offen offset:1024 sc1 lds
    v_mfma_f32_32x32x16_bf16 v[64:79], v[124:127], v[204:207], v[64:79]
    buffer_load_dwordx4 v1, s[20:23], s61 offen offset:2048 sc1 lds
    s_nop 11
    ds_write_b128 v9, v[48:51] offset:0
    ds_write_b128 v9, v[52:55] offset:1024
    ds_write_b128 v9, v[56:59] offset:2048
    ds_write_b128 v9, v[60:63] offset:3072
    v_fma_f32 v64, -v80, v224, v64
    v_fma_f32 v65, -v80, v225, v65
    v_fma_f32 v66, -v80, v226, v66
    v_fma_f32 v67, -v80, v227, v67
    v_fma_f32 v68, -v80, v228, v68
    v_fma_f32 v69, -v80, v229, v69
    v_fma_f32 v70, -v80, v230, v70
    v_fma_f32 v71, -v80, v231, v71
    v_fma_f32 v72, -v80, v232, v72
    v_fma_f32 v73, -v80, v233, v73
    v_fma_f32 v74, -v80, v234, v74
    v_fma_f32 v75, -v80, v235, v75
    v_fma_f32 v76, -v80, v236, v76
    v_fma_f32 v77, -v80, v237, v77
    v_fma_f32 v78, -v80, v238, v78
    v_fma_f32 v79, -v80, v239, v79
    s_lshl_b32 s56, s90, 11
    s_lshl_b32 s57, s91, 7
    s_add_u32 s56, s56, s57
    s_add_u32 s56, s56, 659456
    v_mov_b32 v2, 162832
    v_mov_b32 v3, 1
    s_waitcnt vmcnt(9)
    s_mov_b64 exec, 1
    ds_add_rtn_u32 v3, v2, v3
    v_mov_b32 v2, 0
    s_waitcnt lgkmcnt(0)
    v_cmp_eq_u32 vcc, 7, v3
    v_mov_b32 v3, s54
    s_cmp_lg_u32 vcc_lo, 0
    s_cselect_b32 s56, s56, 0x70000000
    buffer_store_dword v3, v2, s[20:23], s56 offen sc1
    s_mov_b64 exec, -1
    s_barrier
    ds_read_b128 v[240:243], v10 offset:0
    ds_read_b128 v[244:247], v10 offset:1024
    ds_read_b128 v[248:251], v10 offset:2048
    ds_read_b128 v[252:255], v10 offset:3072
    s_add_u32 m0, s80, 0
    s_add_u32 s61, s76, 245760
    buffer_load_dwordx4 v1, s[20:23], s61 offen offset:0 sc1 lds
    buffer_load_dwordx4 v1, s[20:23], s61 offen offset:1024 sc1 lds
    buffer_load_dwordx4 v1, s[20:23], s61 offen offset:2048 sc1 lds
    s_add_u32 m0, s80, 3072
    s_add_u32 s61, s76, 266240
    buffer_load_dwordx4 v1, s[20:23], s61 offen offset:0 sc1 lds
    buffer_load_dwordx4 v1, s[20:23], s61 offen offset:1024 sc1 lds
    buffer_load_dwordx4 v1, s[20:23], s61 offen offset:2048 sc1 lds
    s_add_u32 m0, s80, 6144
    s_add_u32 s61, s76, 286720
    buffer_load_dwordx4 v1, s[20:23], s61 offen offset:0 sc1 lds
    buffer_load_dwordx4 v1, s[20:23], s61 offen offset:1024 sc1 lds
    buffer_load_dwordx4 v1, s[20:23], s61 offen offset:2048 sc1 lds
    s_waitcnt lgkmcnt(0)
    v_add_f32 v64, v64, v240
    v_add_f32 v65, v65, v241
    v_add_f32 v66, v66, v242
    v_add_f32 v67, v67, v243
    v_add_f32 v68, v68, v244
    v_add_f32 v69, v69, v245
    v_add_f32 v70, v70, v246
    v_add_f32 v71, v71, v247
    v_mul_f32 v64, v64, v81
    v_mul_f32 v65, v65, v81
    v_mul_f32 v66, v66, v81
    v_mul_f32 v67, v67, v81
    v_mul_f32 v68, v68, v81
    v_mul_f32 v69, v69, v81
    v_mul_f32 v70, v70, v81
    v_mul_f32 v71, v71, v81
    v_mul_f32 v84, v64, v64
    v_mul_f32 v85, v65, v65
    v_mul_f32 v86, v66, v66
    v_mul_f32 v87, v67, v67
    v_mul_f32 v88, v68, v68
    v_mul_f32 v89, v69, v69
    v_mul_f32 v90, v70, v70
    v_mul_f32 v91, v71, v71
    v_fma_f32 v84, v84, s84, v4
    v_fma_f32 v85, v85, s84, v4
    v_fma_f32 v86, v86, s84, v4
    v_fma_f32 v87, v87, s84, v4
    v_fma_f32 v88, v88, s84, v4
    v_fma_f32 v89, v89, s84, v4
    v_fma_f32 v90, v90, s84, v4
    v_fma_f32 v91, v91, s84, v4
    v_mul_f32 v84, v64, v84
    v_mul_f32 v85, v65, v85
    v_mul_f32 v86, v66, v86
    v_mul_f32 v87, v67, v87
    v_mul_f32 v88, v68, v88
    v_mul_f32 v89, v69, v89
    v_mul_f32 v90, v70, v90
    v_mul_f32 v91, v71, v91
    v_exp_f32 v84, v84
    v_exp_f32 v85, v85
    v_exp_f32 v86, v86
    v_exp_f32 v87, v87
    v_exp_f32 v88, v88
    v_exp_f32 v89, v89
    v_exp_f32 v90, v90
    v_exp_f32 v91, v91
    v_add_f32 v84, 1.0, v84
    v_add_f32 v85, 1.0, v85
    v_add_f32 v86, 1.0, v86
    v_add_f32 v87, 1.0, v87
    v_add_f32 v88, 1.0, v88
    v_add_f32 v89, 1.0, v89
    v_add_f32 v90, 1.0, v90
    v_add_f32 v91, 1.0, v91
    v_rcp_f32 v84, v84
    v_rcp_f32 v85, v85
    v_rcp_f32 v86, v86
    v_rcp_f32 v87, v87
    v_rcp_f32 v88, v88
    v_rcp_f32 v89, v89
    v_rcp_f32 v90, v90
    v_rcp_f32 v91, v91
    v_mul_f32 v64, v64, v84
    v_mul_f32 v65, v65, v85
    v_mul_f32 v66, v66, v86
    v_mul_f32 v67, v67, v87
    v_mul_f32 v68, v68, v88
    v_mul_f32 v69, v69, v89
    v_mul_f32 v70, v70, v90
    v_mul_f32 v71, v71, v91
    v_cvt_pk_bf16_f32 v64, v64, v65
    v_cvt_pk_bf16_f32 v65, v66, v67
    v_cvt_pk_bf16_f32 v66, v68, v69
    v_cvt_pk_bf16_f32 v67, v70, v71
    buffer_store_dwordx4 v[64:67], v1, s[20:23], s94 offen offset:0 sc1
    v_add_f32 v72, v72, v248
    v_add_f32 v73, v73, v249
    v_add_f32 v74, v74, v250
    v_add_f32 v75, v75, v251
    v_add_f32 v76, v76, v252
    v_add_f32 v77, v77, v253
    v_add_f32 v78, v78, v254
    v_add_f32 v79, v79, v255
    v_mul_f32 v72, v72, v81
    v_mul_f32 v73, v73, v81
    v_mul_f32 v74, v74, v81
    v_mul_f32 v75, v75, v81
    v_mul_f32 v76, v76, v81
    v_mul_f32 v77, v77, v81
    v_mul_f32 v78, v78, v81
    v_mul_f32 v79, v79, v81
    v_mul_f32 v84, v72, v72
    v_mul_f32 v85, v73, v73
    v_mul_f32 v86, v74, v74
    v_mul_f32 v87, v75, v75
    v_mul_f32 v88, v76, v76
    v_mul_f32 v89, v77, v77
    v_mul_f32 v90, v78, v78
    v_mul_f32 v91, v79, v79
    v_fma_f32 v84, v84, s84, v4
    v_fma_f32 v85, v85, s84, v4
    v_fma_f32 v86, v86, s84, v4
    v_fma_f32 v87, v87, s84, v4
    v_fma_f32 v88, v88, s84, v4
    v_fma_f32 v89, v89, s84, v4
    v_fma_f32 v90, v90, s84, v4
    v_fma_f32 v91, v91, s84, v4
    v_mul_f32 v84, v72, v84
    v_mul_f32 v85, v73, v85
    v_mul_f32 v86, v74, v86
    v_mul_f32 v87, v75, v87
    v_mul_f32 v88, v76, v88
    v_mul_f32 v89, v77, v89
    v_mul_f32 v90, v78, v90
    v_mul_f32 v91, v79, v91
    v_exp_f32 v84, v84
    v_exp_f32 v85, v85
    v_exp_f32 v86, v86
    v_exp_f32 v87, v87
    v_exp_f32 v88, v88
    v_exp_f32 v89, v89
    v_exp_f32 v90, v90
    v_exp_f32 v91, v91
    v_add_f32 v84, 1.0, v84
    v_add_f32 v85, 1.0, v85
    v_add_f32 v86, 1.0, v86
    v_add_f32 v87, 1.0, v87
    v_add_f32 v88, 1.0, v88
    v_add_f32 v89, 1.0, v89
    v_add_f32 v90, 1.0, v90
    v_add_f32 v91, 1.0, v91
    v_rcp_f32 v84, v84
    v_rcp_f32 v85, v85
    v_rcp_f32 v86, v86
    v_rcp_f32 v87, v87
    v_rcp_f32 v88, v88
    v_rcp_f32 v89, v89
    v_rcp_f32 v90, v90
    v_rcp_f32 v91, v91
    v_mul_f32 v72, v72, v84
    v_mul_f32 v73, v73, v85
    v_mul_f32 v74, v74, v86
    v_mul_f32 v75, v75, v87
    v_mul_f32 v76, v76, v88
    v_mul_f32 v77, v77, v89
    v_mul_f32 v78, v78, v90
    v_mul_f32 v79, v79, v91
    v_cvt_pk_bf16_f32 v72, v72, v73
    v_cvt_pk_bf16_f32 v73, v74, v75
    v_cvt_pk_bf16_f32 v74, v76, v77
    v_cvt_pk_bf16_f32 v75, v78, v79
    buffer_store_dwordx4 v[72:75], v1, s[20:23], s94 offen offset:1024 sc1
    s_waitcnt vmcnt(12)
    s_barrier
    s_lshl_b32 s56, s90, 11
    s_lshl_b32 s57, s91, 7
    s_add_u32 s56, s56, s57
    s_add_u32 s56, s56, 761856
    v_mov_b32 v2, 162848
    v_mov_b32 v3, 1
    s_waitcnt vmcnt(0)
    s_mov_b64 exec, 1
    ds_add_rtn_u32 v3, v2, v3
    v_mov_b32 v2, 0
    s_waitcnt lgkmcnt(0)
    v_cmp_eq_u32 vcc, 7, v3
    v_mov_b32 v3, s54
    s_cmp_lg_u32 vcc_lo, 0
    s_cselect_b32 s56, s56, 0x70000000
    buffer_store_dword v3, v2, s[20:23], s56 offen sc1
    s_mov_b64 exec, -1
    s_add_u32 m0, s80, 122880
    s_add_u32 s61, s76, 368640
    buffer_load_dwordx4 v1, s[20:23], s61 offen offset:0 sc1 lds
    buffer_load_dwordx4 v1, s[20:23], s61 offen offset:1024 sc1 lds
    buffer_load_dwordx4 v1, s[20:23], s61 offen offset:2048 sc1 lds
    s_add_u32 m0, s80, 125952
    s_add_u32 s61, s76, 389120
    buffer_load_dwordx4 v1, s[20:23], s61 offen offset:0 sc1 lds
    buffer_load_dwordx4 v1, s[20:23], s61 offen offset:1024 sc1 lds
    buffer_load_dwordx4 v1, s[20:23], s61 offen offset:2048 sc1 lds
    s_add_u32 m0, s80, 129024
    s_add_u32 s61, s76, 409600
    buffer_load_dwordx4 v1, s[20:23], s61 offen offset:0 sc1 lds
    buffer_load_dwordx4 v1, s[20:23], s61 offen offset:1024 sc1 lds
    buffer_load_dwordx4 v1, s[20:23], s61 offen offset:2048 sc1 lds
    s_barrier
    s_add_u32 m0, s80, 40960
    s_add_u32 s61, s76, 491520
    buffer_load_dwordx4 v1, s[20:23], s61 offen offset:0 sc1 lds
    buffer_load_dwordx4 v1, s[20:23], s61 offen offset:1024 sc1 lds
    buffer_load_dwordx4 v1, s[20:23], s61 offen offset:2048 sc1 lds
    s_add_u32 m0, s80, 44032
    s_add_u32 s61, s76, 512000
    buffer_load_dwordx4 v1, s[20:23], s61 offen offset:0 sc1 lds
    buffer_load_dwordx4 v1, s[20:23], s61 offen offset:1024 sc1 lds
    buffer_load_dwordx4 v1, s[20:23], s61 offen offset:2048 sc1 lds
    s_add_u32 m0, s80, 47104
    s_add_u32 s61, s76, 532480
    buffer_load_dwordx4 v1, s[20:23], s61 offen offset:0 sc1 lds
    buffer_load_dwordx4 v1, s[20:23], s61 offen offset:1024 sc1 lds
    buffer_load_dwordx4 v1, s[20:23], s61 offen offset:2048 sc1 lds
    s_waitcnt vmcnt(9)
    s_barrier
    s_add_u32 m0, s80, 81920
    s_add_u32 s61, s76, 614400
    buffer_load_dwordx4 v1, s[20:23], s61 offen offset:0 sc1 lds
    buffer_load_dwordx4 v1, s[20:23], s61 offen offset:1024 sc1 lds
    buffer_load_dwordx4 v1, s[20:23], s61 offen offset:2048 sc1 lds
    s_add_u32 m0, s80, 84992
    s_add_u32 s61, s76, 634880
    buffer_load_dwordx4 v1, s[20:23], s61 offen offset:0 sc1 lds
    buffer_load_dwordx4 v1, s[20:23], s61 offen offset:1024 sc1 lds
    buffer_load_dwordx4 v1, s[20:23], s61 offen offset:2048 sc1 lds
    s_add_u32 m0, s80, 88064
    s_add_u32 s61, s76, 655360
    buffer_load_dwordx4 v1, s[20:23], s61 offen offset:0 sc1 lds
    buffer_load_dwordx4 v1, s[20:23], s61 offen offset:1024 sc1 lds
    buffer_load_dwordx4 v1, s[20:23], s61 offen offset:2048 sc1 lds
    s_waitcnt vmcnt(9)
    s_barrier
    s_add_u32 m0, s80, 0
    s_add_u32 s61, s76, 737280
    buffer_load_dwordx4 v1, s[20:23], s61 offen offset:0 sc1 lds
    buffer_load_dwordx4 v1, s[20:23], s61 offen offset:1024 sc1 lds
    buffer_load_dwordx4 v1, s[20:23], s61 offen offset:2048 sc1 lds
    s_add_u32 m0, s80, 3072
    s_add_u32 s61, s76, 757760
    buffer_load_dwordx4 v1, s[20:23], s61 offen offset:0 sc1 lds
    buffer_load_dwordx4 v1, s[20:23], s61 offen offset:1024 sc1 lds
    buffer_load_dwordx4 v1, s[20:23], s61 offen offset:2048 sc1 lds
    s_add_u32 m0, s80, 6144
    s_add_u32 s61, s76, 778240
    buffer_load_dwordx4 v1, s[20:23], s61 offen offset:0 sc1 lds
    buffer_load_dwordx4 v1, s[20:23], s61 offen offset:1024 sc1 lds
    buffer_load_dwordx4 v1, s[20:23], s61 offen offset:2048 sc1 lds
    s_waitcnt vmcnt(9)
    s_barrier
    s_add_u32 m0, s80, 122880
    s_add_u32 s61, s76, 860160
    buffer_load_dwordx4 v1, s[20:23], s61 offen offset:0 sc1 lds
    buffer_load_dwordx4 v1, s[20:23], s61 offen offset:1024 sc1 lds
    buffer_load_dwordx4 v1, s[20:23], s61 offen offset:2048 sc1 lds
    s_add_u32 m0, s80, 125952
    s_add_u32 s61, s76, 880640
    buffer_load_dwordx4 v1, s[20:23], s61 offen offset:0 sc1 lds
    buffer_load_dwordx4 v1, s[20:23], s61 offen offset:1024 sc1 lds
    buffer_load_dwordx4 v1, s[20:23], s61 offen offset:2048 sc1 lds
    s_add_u32 m0, s80, 129024
    s_add_u32 s61, s76, 901120
    buffer_load_dwordx4 v1, s[20:23], s61 offen offset:0 sc1 lds
    buffer_load_dwordx4 v1, s[20:23], s61 offen offset:1024 sc1 lds
    buffer_load_dwordx4 v1, s[20:23], s61 offen offset:2048 sc1 lds
    s_waitcnt vmcnt(9)
    s_barrier
    s_add_u32 m0, s80, 40960
    s_add_u32 s61, s76, 983040
    buffer_load_dwordx4 v1, s[20:23], s61 offen offset:0 sc1 lds
    buffer_load_dwordx4 v1, s[20:23], s61 offen offset:1024 sc1 lds
    buffer_load_dwordx4 v1, s[20:23], s61 offen offset:2048 sc1 lds
    s_add_u32 m0, s80, 44032
    s_add_u32 s61, s76, 1003520
    buffer_load_dwordx4 v1, s[20:23], s61 offen offset:0 sc1 lds
    buffer_load_dwordx4 v1, s[20:23], s61 offen offset:1024 sc1 lds
    buffer_load_dwordx4 v1, s[20:23], s61 offen offset:2048 sc1 lds
    s_add_u32 m0, s80, 47104
    s_add_u32 s61, s76, 1024000
    buffer_load_dwordx4 v1, s[20:23], s61 offen offset:0 sc1 lds
    buffer_load_dwordx4 v1, s[20:23], s61 offen offset:1024 sc1 lds
    buffer_load_dwordx4 v1, s[20:23], s61 offen offset:2048 sc1 lds
    s_waitcnt vmcnt(9)
    s_barrier
    s_waitcnt vmcnt(0)
    s_barrier
    s_barrier
    s_barrier
    s_barrier
    s_endpgm
TG_slow:
    s_mov_b32 s94, 0
    v_mov_b32 v12, 0
TG_sl:
    buffer_load_dword v12, v12, s[68:71], 0 offen sc1
    s_add_u32 s94, s94, 1
    s_waitcnt vmcnt(0)
    v_readfirstlane_b32 s91, v12
    s_cmp_lg_u32 s91, 0
    s_cbranch_scc1 TG_ok
    s_cmp_lt_u32 s94, 0x40000
    s_cbranch_scc1 TG_sl
    s_branch TG_ok
FM_slow:
    s_mov_b32 s94, 0
FM_sl:
    buffer_load_dwordx4 v[252:255], v13, s[16:19], s93 offen sc1
    s_add_u32 s94, s94, 1
    s_waitcnt vmcnt(0)
    v_xor_b32 v252, s91, v252
    v_xor_b32 v253, s91, v253
    v_xor_b32 v254, s91, v254
    v_xor_b32 v255, s91, v255
    v_or3_b32 v252, v252, v253, v254
    v_or_b32 v252, v252, v255
    v_cmp_ne_u32 vcc, 0, v252
    s_cbranch_vccz FM_ok
    s_cmp_lt_u32 s94, 0x40000
    s_cbranch_scc1 FM_sl
    s_branch FM_ok
F_slow0:
    s_mov_b32 s94, 0
F_sl0:
    buffer_load_dword v12, v13, s[16:19], s93 offen sc1
    s_add_u32 s94, s94, 1
    s_waitcnt vmcnt(0)
    v_cmp_ne_u32 vcc, s91, v12
    s_cbranch_vccz F_ok0
    s_cmp_lt_u32 s94, 0x40000
    s_cbranch_scc1 F_sl0
    s_branch F_ok0
F_slow1:
    s_mov_b32 s94, 0
F_sl1:
    buffer_load_dword v12, v13, s[16:19], s93 offen sc1
    s_add_u32 s94, s94, 1
    s_waitcnt vmcnt(0)
    v_cmp_ne_u32 vcc, s91, v12
    s_cbranch_vccz F_ok1
    s_cmp_lt_u32 s94, 0x40000
    s_cbranch_scc1 F_sl1
    s_branch F_ok1
F_slow2:
    s_mov_b32 s94, 0
F_sl2:
    buffer_load_dword v12, v13, s[16:19], s93 offen sc1
    s_add_u32 s94, s94, 1
    s_waitcnt vmcnt(0)
    v_cmp_ne_u32 vcc, s91, v12
    s_cbranch_vccz F_ok2
    s_cmp_lt_u32 s94, 0x40000
    s_cbranch_scc1 F_sl2
    s_branch F_ok2
KF_end:
    s_endpgm
CODE_END_F:
.section .rodata,"a"
.p2align 6
.amdhsa_kernel adaLN_cond__compressed_kv_cla__mixer_s_mlp__prompt_kernel
  .amdhsa_next_free_vgpr 256
  .amdhsa_next_free_sgpr 102
  .amdhsa_accum_offset 256
  .amdhsa_group_segment_fixed_size 0
  .amdhsa_kernarg_size 128
  .amdhsa_user_sgpr_count 2
  .amdhsa_user_sgpr_kernarg_segment_ptr 1
  .amdhsa_system_sgpr_workgroup_id_x 1
  .amdhsa_float_denorm_mode_32 3
.end_amdhsa_kernel
```
